```python
import torch

def _softmax(x, axis=-1):
    return torch.softmax(x, dim=axis)
def _gelu(x):
    return torch.nn.functional.gelu(x, approximate="tanh")
def _silu(x):
    return torch.nn.functional.silu(x)
def _sigmoid(x):
    return torch.sigmoid(x)
def _layernorm(x, axis=-1, eps=1e-5):
    m = x.mean(dim=axis, keepdim=True)
    v = x.var(dim=axis, keepdim=True, unbiased=False)
    return (x - m) / torch.sqrt(v + eps)
def _scatter_add(tgt, idx, src, axis=0):
    return tgt.clone().index_add_(axis, idx, src)
def _segment_sum(src, seg, n):
    out = torch.zeros((n,) + src.shape[1:], dtype=src.dtype)
    return out.index_add_(0, seg, src)
def _pad(x, pw):
    flat = tuple(v for pair in reversed(pw) for v in pair)
    return torch.nn.functional.pad(x, flat)

kernel_name = 'recurrent_scan__gqa_block_cached__glu_gated_bilinear__prompt'

def setup_inputs():

    _w = (lambda a: (lambda t: t.to(torch.bfloat16) if t.is_floating_point() else t)(torch.as_tensor(a)))
    def _A_setup():
        B, Sq, D = 1, 2048, 512
        Hq, Hkv, Sk, Dh = 32, 32, 2048, 128
        assert Hq % Hkv == 0, (Hq, Hkv)
        return {
            "x": _w((lambda *s: torch.randn(*s, dtype=torch.bfloat16) * 0.05)(B, Sq, D)),
            "k_cache": _w((lambda *s: torch.randn(*s, dtype=torch.bfloat16) * 1.6)(B, Hkv, Sk, Dh)),
            "v_cache": _w((lambda *s: torch.randn(*s, dtype=torch.bfloat16) * 1.6)(B, Hkv, Sk, Dh)),
            "wq": _w((lambda *s: torch.randn(*s, dtype=torch.bfloat16) * 1.6)(D, Hq * Dh) * (D ** -0.5)),
            "wo": _w((lambda *s: torch.randn(*s, dtype=torch.bfloat16) * 1.6)(Hq * Dh, D) * ((Hq * Dh) ** -0.5)),
        }
    _A_in = _A_setup()

    def _B_setup():
        B, S, D, F = 1, 2048, 512, 1376
        return {
            "x": _w((lambda *s: torch.randn(*s, dtype=torch.bfloat16) * 0.05)(B, S, D)),
            "w_gate": _w((lambda *s: torch.randn(*s, dtype=torch.bfloat16) * 0.2)(D, F) * (D ** -0.5)),
            "w_up": _w((lambda *s: torch.randn(*s, dtype=torch.bfloat16) * 0.2)(D, F) * (D ** -0.5)),
            "w_down": _w((lambda *s: torch.randn(*s, dtype=torch.bfloat16) * 0.2)(F, D) * (F ** -0.5)),
        }
    _B_in = _B_setup()

    return {
        "A_x": _A_in["x"],
        "A_k_cache": _A_in["k_cache"],
        "A_v_cache": _A_in["v_cache"],
        "A_wq": _A_in["wq"],
        "A_wo": _A_in["wo"],
        "B_x": _B_in["x"],
        "B_w_gate": _B_in["w_gate"],
        "B_w_up": _B_in["w_up"],
        "B_w_down": _B_in["w_down"],
    }

def reference(A_x, A_k_cache, A_v_cache, A_wq, A_wo, B_x, B_w_gate, B_w_up, B_w_down):
    def _A_ref(x, k_cache, v_cache, wq, wo):
        B, Sq, D = x.shape
        Hq, Dh = 32, 128
        Hkv = k_cache.shape[1]
        rep = Hq // Hkv
        q = (lambda x, *d: x.permute(*d))((x @ wq).reshape(B, Sq, Hq, Dh), 0, 2, 1, 3)
        k = (lambda x, n, axis: torch.repeat_interleave(x, n, dim=axis))(k_cache, rep, axis=1)
        v = (lambda x, n, axis: torch.repeat_interleave(x, n, dim=axis))(v_cache, rep, axis=1)
        scores = torch.einsum("bhqd,bhkd->bhqk", q, k) * (Dh ** -0.5)
        p = _softmax(scores, axis=-1)
        o = torch.einsum("bhqk,bhkd->bhqd", p, v)
        return (lambda x, *d: x.permute(*d))(o, 0, 2, 1, 3).reshape(B, Sq, Hq * Dh) @ wo

    def _B_ref(x, w_gate, w_up, w_down):
        g = torch.einsum("bsd,df->bsf", x, w_gate)
        u = torch.einsum("bsd,df->bsf", x, w_up)
        h = g * u
        return torch.einsum("bsf,fd->bsd", h, w_down)

    x = A_x
    xn = _layernorm(x, axis=-1)
    s = _A_ref(xn, A_k_cache, A_v_cache, A_wq, A_wo)
    g = _silu(_B_ref(xn, B_w_gate, B_w_up, B_w_down))
    return x + s * g
```

```asm
; @launch grid=(256,1,1) block=(256,1,1) lds=163840
.amdgcn_target "amdgcn-amd-amdhsa--gfx950"
.text
.globl recurrent_scan__gqa_block_cached__glu_gated_bilinear__prompt_kernel
.p2align 8
.type recurrent_scan__gqa_block_cached__glu_gated_bilinear__prompt_kernel,@function
recurrent_scan__gqa_block_cached__glu_gated_bilinear__prompt_kernel:
    s_cmp_ge_u32 s2, 256
    s_cbranch_scc1 L_done
    s_load_dwordx16 s[64:79], s[0:1], 0
    s_load_dwordx8 s[80:87], s[0:1], 64
    v_lshrrev_b32 v1, 6, v0
    v_and_b32 v0, 63, v0
    v_readfirstlane_b32 s36, v1
    s_and_b32 s48, s2, 7
    s_lshr_b32 s49, s2, 3
    s_lshl_b32 s59, s49, 2
    s_add_u32 s59, s59, s36
    s_and_b32 s38, s49, 7
    s_lshr_b32 s49, s49, 3
    s_lshl_b32 s50, s48, 2
    s_add_u32 s37, s50, s49
    s_and_b32 s39, s37, 1
    s_add_u32 s3, s38, s37
    s_and_b32 s100, s3, 1
    s_and_b32 s3, s3, 6
    s_getpc_b64 s[20:21]
L_pc0:
    s_mov_b32 s22, L_code_end - L_pc0
    s_mov_b32 s23, 0x00020000
    v_lshlrev_b32 v7, 7, v0
    s_lshl_b32 s89, s59, 13
    buffer_load_dword v39, v7, s[20:23], s89 offen
    v_lshrrev_b32 v1, 4, v0
    v_and_b32 v2, 15, v0
    v_bfe_u32 v3, v0, 2, 2
    v_and_b32 v4, 3, v0
    v_lshrrev_b32 v5, 3, v0
    v_and_b32 v6, 7, v0
    s_waitcnt lgkmcnt(0)
    s_mov_b32 s4, s64
    s_mov_b32 s5, s65
    s_mov_b32 s6, 2097152
    s_mov_b32 s7, 0x00020000
    s_lshl_b32 s50, s48, 10
    s_sub_u32 s89, 0x400000, s50
    s_add_u32 s8, s70, s50
    s_addc_u32 s9, s71, 0
    s_mov_b32 s10, s89
    s_mov_b32 s11, 0x00020000
    s_mul_i32 s50, s48, 384
    s_sub_u32 s89, 1409024, s50
    s_add_u32 s12, s76, s50
    s_addc_u32 s13, s77, 0
    s_mov_b32 s14, s89
    s_mov_b32 s15, 0x00020000
    s_add_u32 s16, s78, s50
    s_addc_u32 s17, s79, 0
    s_mov_b32 s18, s89
    s_mov_b32 s19, 0x00020000
    s_add_u32 s60, s86, 33554432
    s_addc_u32 s61, s87, 0
    s_mov_b32 s62, 32768
    s_mov_b32 s63, 0x00020000
    s_lshl_b32 s88, s38, 2
    s_add_u32 s88, s88, s36
    s_lshl_b32 s88, s88, 8
    s_lshl_b32 s50, s37, 2
    s_add_u32 s88, s88, s50
    v_lshlrev_b32 v7, 13, v0
    v_mov_b32 v9, 0
    buffer_store_dword v9, v7, s[60:63], s88 offen sc1
    s_lshl_b32 s40, s36, 10
    s_lshl_b32 s41, s36, 11
    s_lshl_b32 s42, s36, 12
    s_lshl_b32 s43, s36, 13
    s_lshl_b32 s48, s38, 4
    s_lshl_b32 s49, s36, 2
    s_add_u32 s48, s48, s49
    s_lshl_b32 s49, s39, 1
    s_xor_b32 s50, s49, 0
    s_add_u32 s54, s48, s50
    s_lshl_b32 s44, s54, 14
    s_xor_b32 s50, s49, 1
    s_add_u32 s55, s48, s50
    s_lshl_b32 s45, s55, 14
    s_xor_b32 s50, s49, 2
    s_add_u32 s56, s48, s50
    s_lshl_b32 s46, s56, 14
    s_xor_b32 s50, s49, 3
    s_add_u32 s57, s48, s50
    s_lshl_b32 s47, s57, 14
    s_mov_b32 s58, 0x3e0293ee
    v_xor_b32 v7, v6, v1
    v_lshlrev_b32 v7, 4, v7
    v_lshl_add_u32 v10, v5, 10, v7
    v_xor_b32 v11, 64, v10
    v_add_u32 v11, 8192, v11
    v_lshlrev_b32 v7, 2, v1
    v_xor_b32 v7, v7, v2
    v_lshlrev_b32 v7, 4, v7
    v_lshl_add_u32 v12, v1, 13, v7
    s_lshl_b32 s48, s36, 16
    s_and_b32 s49, s37, 3
    s_lshl_b32 s49, s49, 8
    s_add_u32 s48, s48, s49
    v_add_u32 v12, s48, v12
    v_and_b32 v7, 1, v1
    s_and_b32 s48, s36, 1
    s_lshl_b32 s48, s48, 1
    v_or_b32 v7, s48, v7
    v_lshlrev_b32 v7, 1, v7
    v_xor_b32 v7, v7, v6
    v_lshlrev_b32 v7, 4, v7
    s_lshl_b32 s48, s36, 3
    v_add_u32 v8, s48, v5
    v_mul_u32_u24 v8, 2752, v8
    v_add_u32 v13, v8, v7
    s_bfe_u32 s48, s37, 0x10001
    s_mul_i32 s48, s48, 192
    s_lshl_b32 s49, s39, 6
    s_add_u32 s48, s48, s49
    v_add_u32 v13, s48, v13
    s_add_u32 s49, s3, 0
    s_and_b32 s49, s49, 7
    s_lshl_b32 s48, s49, 19
    s_add_u32 m0, s41, 65536
    s_nop 0
    buffer_load_dwordx4 v12, s[8:11], s48 offen lds
    s_add_u32 s48, s48, 32768
    s_add_u32 m0, s41, 66560
    s_nop 0
    buffer_load_dwordx4 v12, s[8:11], s48 offen lds
    s_mul_i32 s48, s49, 176128
    s_add_u32 m0, s40, 73728
    s_nop 0
    buffer_load_dwordx4 v13, s[12:15], s48 offen lds
    s_add_u32 m0, s40, 77824
    s_nop 0
    buffer_load_dwordx4 v13, s[16:19], s48 offen lds
    s_add_u32 s49, s3, 0
    s_and_b32 s49, s49, 7
    s_lshl_b32 s49, s49, 7
    s_add_u32 s48, s44, s49
    s_add_u32 m0, s43, 0
    s_nop 0
    buffer_load_dwordx4 v10, s[4:7], s48 offen lds
    s_add_u32 m0, s43, 1024
    s_nop 0
    buffer_load_dwordx4 v11, s[4:7], s48 offen lds
    s_add_u32 s48, s45, s49
    s_add_u32 m0, s43, 2048
    s_nop 0
    buffer_load_dwordx4 v10, s[4:7], s48 offen lds
    s_add_u32 m0, s43, 3072
    s_nop 0
    buffer_load_dwordx4 v11, s[4:7], s48 offen lds
    s_add_u32 s48, s46, s49
    s_add_u32 m0, s43, 4096
    s_nop 0
    buffer_load_dwordx4 v10, s[4:7], s48 offen lds
    s_add_u32 m0, s43, 5120
    s_nop 0
    buffer_load_dwordx4 v11, s[4:7], s48 offen lds
    s_add_u32 s48, s47, s49
    s_add_u32 m0, s43, 6144
    s_nop 0
    buffer_load_dwordx4 v10, s[4:7], s48 offen lds
    s_add_u32 m0, s43, 7168
    s_nop 0
    buffer_load_dwordx4 v11, s[4:7], s48 offen lds
    s_lshl_b32 s48, s36, 2
    v_or_b32 v7, s48, v1
    v_xor_b32 v7, v7, v2
    v_lshlrev_b32 v7, 4, v7
    v_lshl_add_u32 v14, v1, 8, v7
    v_add_u32 v14, s42, v14
    s_and_b32 s48, s36, 1
    s_lshl_b32 s48, s48, 2
    v_or_b32 v7, s48, v1
    v_lshlrev_b32 v7, 1, v7
    v_xor_b32 v7, v7, v2
    v_lshlrev_b32 v7, 4, v7
    v_lshl_add_u32 v15, v1, 8, v7
    v_add_u32 v15, s42, v15
    s_lshl_b32 s48, s37, 19
    s_add_u32 s20, s66, s48
    s_addc_u32 s21, s67, 0
    s_mov_b32 s22, 524288
    s_mov_b32 s23, 0x00020000
    s_add_u32 s24, s68, s48
    s_addc_u32 s25, s69, 0
    s_mov_b32 s26, 524288
    s_mov_b32 s27, 0x00020000
    s_add_u32 s28, s86, 34603008
    s_addc_u32 s29, s87, 0
    s_mov_b32 s30, 2097152
    s_mov_b32 s31, 0x00020000
    s_add_u32 s32, s86, 25165824
    s_addc_u32 s33, s87, 0
    s_mov_b32 s34, 5636096
    s_mov_b32 s35, 0x00020000
    v_lshlrev_b32 v7, 3, v1
    v_add_u32 v7, v7, v3
    v_lshlrev_b32 v8, 8, v7
    v_lshl_add_u32 v8, v4, 4, v8
    v_add_u32 v8, 65536, v8
    v_xor_b32 v9, 0, v3
    v_lshl_add_u32 v16, v9, 6, v8
    v_add_u32 v48, 49152, v16
    v_xor_b32 v9, 1, v3
    v_lshl_add_u32 v17, v9, 6, v8
    v_add_u32 v49, 49152, v17
    v_xor_b32 v9, 2, v3
    v_lshl_add_u32 v18, v9, 6, v8
    v_add_u32 v50, 49152, v18
    v_xor_b32 v9, 3, v3
    v_lshl_add_u32 v19, v9, 6, v8
    v_add_u32 v51, 49152, v19
    v_xor_b32 v9, s36, v3
    v_lshl_add_u32 v56, v9, 6, v8
    v_add_u32 v58, 49152, v56
    v_lshlrev_b32 v8, 7, v7
    v_lshl_add_u32 v8, v4, 3, v8
    v_add_u32 v8, 65536, v8
    v_and_b32 v9, 1, v1
    v_lshlrev_b32 v9, 1, v9
    v_lshrrev_b32 v7, 1, v3
    v_or_b32 v9, v9, v7
    s_lshl_b32 s48, s39, 1
    v_xor_b32 v9, s48, v9
    v_xor_b32 v7, 0, v9
    v_lshl_add_u32 v20, v7, 5, v8
    v_add_u32 v52, 49152, v20
    v_xor_b32 v7, 1, v9
    v_lshl_add_u32 v21, v7, 5, v8
    v_add_u32 v53, 49152, v21
    v_xor_b32 v7, 2, v9
    v_lshl_add_u32 v22, v7, 5, v8
    v_add_u32 v54, 49152, v22
    v_xor_b32 v7, 3, v9
    v_lshl_add_u32 v23, v7, 5, v8
    v_add_u32 v55, 49152, v23
    v_xor_b32 v7, s36, v9
    v_lshl_add_u32 v57, v7, 5, v8
    v_add_u32 v59, 49152, v57
    v_lshrrev_b32 v7, 1, v2
    v_xor_b32 v7, v7, v1
    v_lshlrev_b32 v7, 4, v7
    v_lshl_add_u32 v24, v2, 7, v7
    v_add_u32 v24, s43, v24
    v_xor_b32 v25, 64, v24
    v_lshlrev_b32 v38, 4, v0
    v_mov_b32 v40, 0x3f803f80
    v_mov_b32 v41, 0x3f803f80
    v_mov_b32 v42, 0x3f803f80
    v_mov_b32 v43, 0x3f803f80
    v_mov_b32 v8, 0x40000000
    s_and_b32 s48, s37, 7
    s_lshl_b32 s48, s48, 3
    v_cmp_eq_u32 vcc, v1, v3
    v_lshl_add_u32 v7, v2, 6, s48
    s_lshr_b32 s51, s37, 3
    v_cndmask_b32 v60, v8, v7, vcc
    s_lshl_b32 s51, s51, 17
    v_lshlrev_b32 v7, 6, v2
    v_lshl_add_u32 v63, v1, 4, v7
    v_cmp_eq_u32 vcc, 0, v2
    v_lshlrev_b32 v7, 4, v1
    s_lshl_b32 s52, s37, 13
    s_lshl_b32 s48, s36, 8
    s_add_u32 s52, s52, s48
    s_add_u32 s52, s52, 1048576
    s_lshl_b32 s48, s38, 10
    v_add_u32 v7, s48, v7
    v_cndmask_b32 v61, v8, v7, vcc
    v_lshlrev_b32 v7, 4, v2
    v_lshl_add_u32 v44, v1, 10, v7
    s_and_b32 s48, s88, 0xffffffe0
    v_lshl_add_u32 v7, v6, 2, s48
    s_lshl_b32 s48, s36, 8
    s_lshl_b32 s49, s37, 2
    s_add_u32 s48, s48, s49
    v_lshl_add_u32 v9, v6, 10, s48
    v_cmp_gt_u32 vcc, 8, v2
    s_nop 1
    v_cndmask_b32 v62, v9, v7, vcc
    v_add_u32 v62, 0x6000, v62
    s_lshl_b32 s53, s36, 8
    s_add_u32 s53, s53, 16384
    v_accvgpr_write_b32 a0, 0
    v_accvgpr_write_b32 a1, 0
    v_accvgpr_write_b32 a2, 0
    v_accvgpr_write_b32 a3, 0
    v_accvgpr_write_b32 a4, 0
    v_accvgpr_write_b32 a5, 0
    v_accvgpr_write_b32 a6, 0
    v_accvgpr_write_b32 a7, 0
    v_accvgpr_write_b32 a8, 0
    v_accvgpr_write_b32 a9, 0
    v_accvgpr_write_b32 a10, 0
    v_accvgpr_write_b32 a11, 0
    v_accvgpr_write_b32 a12, 0
    v_accvgpr_write_b32 a13, 0
    v_accvgpr_write_b32 a14, 0
    v_accvgpr_write_b32 a15, 0
    v_accvgpr_write_b32 a16, 0
    v_accvgpr_write_b32 a17, 0
    v_accvgpr_write_b32 a18, 0
    v_accvgpr_write_b32 a19, 0
    v_accvgpr_write_b32 a20, 0
    v_accvgpr_write_b32 a21, 0
    v_accvgpr_write_b32 a22, 0
    v_accvgpr_write_b32 a23, 0
    v_accvgpr_write_b32 a24, 0
    v_accvgpr_write_b32 a25, 0
    v_accvgpr_write_b32 a26, 0
    v_accvgpr_write_b32 a27, 0
    v_accvgpr_write_b32 a28, 0
    v_accvgpr_write_b32 a29, 0
    v_accvgpr_write_b32 a30, 0
    v_accvgpr_write_b32 a31, 0
    v_accvgpr_write_b32 a32, 0
    v_accvgpr_write_b32 a33, 0
    v_accvgpr_write_b32 a34, 0
    v_accvgpr_write_b32 a35, 0
    v_accvgpr_write_b32 a36, 0
    v_accvgpr_write_b32 a37, 0
    v_accvgpr_write_b32 a38, 0
    v_accvgpr_write_b32 a39, 0
    v_accvgpr_write_b32 a40, 0
    v_accvgpr_write_b32 a41, 0
    v_accvgpr_write_b32 a42, 0
    v_accvgpr_write_b32 a43, 0
    v_accvgpr_write_b32 a44, 0
    v_accvgpr_write_b32 a45, 0
    v_accvgpr_write_b32 a46, 0
    v_accvgpr_write_b32 a47, 0
    v_accvgpr_write_b32 a48, 0
    v_accvgpr_write_b32 a49, 0
    v_accvgpr_write_b32 a50, 0
    v_accvgpr_write_b32 a51, 0
    v_accvgpr_write_b32 a52, 0
    v_accvgpr_write_b32 a53, 0
    v_accvgpr_write_b32 a54, 0
    v_accvgpr_write_b32 a55, 0
    v_accvgpr_write_b32 a56, 0
    v_accvgpr_write_b32 a57, 0
    v_accvgpr_write_b32 a58, 0
    v_accvgpr_write_b32 a59, 0
    v_accvgpr_write_b32 a60, 0
    v_accvgpr_write_b32 a61, 0
    v_accvgpr_write_b32 a62, 0
    v_accvgpr_write_b32 a63, 0
    v_accvgpr_write_b32 a80, 0
    v_accvgpr_write_b32 a81, 0
    v_accvgpr_write_b32 a82, 0
    v_accvgpr_write_b32 a83, 0
    v_accvgpr_write_b32 a84, 0
    v_accvgpr_write_b32 a85, 0
    v_accvgpr_write_b32 a86, 0
    v_accvgpr_write_b32 a87, 0
    v_accvgpr_write_b32 a88, 0
    v_accvgpr_write_b32 a89, 0
    v_accvgpr_write_b32 a90, 0
    v_accvgpr_write_b32 a91, 0
    v_accvgpr_write_b32 a92, 0
    v_accvgpr_write_b32 a93, 0
    v_accvgpr_write_b32 a94, 0
    v_accvgpr_write_b32 a95, 0
    v_accvgpr_write_b32 a96, 0
    v_accvgpr_write_b32 a97, 0
    v_accvgpr_write_b32 a98, 0
    v_accvgpr_write_b32 a99, 0
    v_accvgpr_write_b32 a100, 0
    v_accvgpr_write_b32 a101, 0
    v_accvgpr_write_b32 a102, 0
    v_accvgpr_write_b32 a103, 0
    v_accvgpr_write_b32 a104, 0
    v_accvgpr_write_b32 a105, 0
    v_accvgpr_write_b32 a106, 0
    v_accvgpr_write_b32 a107, 0
    v_accvgpr_write_b32 a108, 0
    v_accvgpr_write_b32 a109, 0
    v_accvgpr_write_b32 a110, 0
    v_accvgpr_write_b32 a111, 0
    v_accvgpr_write_b32 a112, 0
    v_accvgpr_write_b32 a113, 0
    v_accvgpr_write_b32 a114, 0
    v_accvgpr_write_b32 a115, 0
    v_accvgpr_write_b32 a116, 0
    v_accvgpr_write_b32 a117, 0
    v_accvgpr_write_b32 a118, 0
    v_accvgpr_write_b32 a119, 0
    v_accvgpr_write_b32 a120, 0
    v_accvgpr_write_b32 a121, 0
    v_accvgpr_write_b32 a122, 0
    v_accvgpr_write_b32 a123, 0
    v_accvgpr_write_b32 a124, 0
    v_accvgpr_write_b32 a125, 0
    v_accvgpr_write_b32 a126, 0
    v_accvgpr_write_b32 a127, 0
    s_add_u32 s49, s3, 0
    s_and_b32 s49, s49, 7
    s_lshl_b32 s48, s49, 19
    s_add_u32 s48, s48, 262144
    s_add_u32 m0, s41, 81920
    s_nop 0
    buffer_load_dwordx4 v12, s[8:11], s48 offen lds
    s_add_u32 s48, s48, 32768
    s_add_u32 m0, s41, 82944
    s_nop 0
    buffer_load_dwordx4 v12, s[8:11], s48 offen lds
    s_mul_i32 s48, s49, 176128
    s_add_u32 s48, s48, 88064
    s_add_u32 m0, s40, 90112
    s_nop 0
    buffer_load_dwordx4 v13, s[12:15], s48 offen lds
    s_add_u32 m0, s40, 94208
    s_nop 0
    buffer_load_dwordx4 v13, s[16:19], s48 offen lds
    s_waitcnt vmcnt(4)
    s_barrier
    s_cmp_eq_u32 s36, 0
    s_cselect_b32 s101, s38, 99
    ds_read_b128 v[64:67], v24 offset:0
    ds_read_b128 v[68:71], v24 offset:2048
    ds_read_b128 v[72:75], v24 offset:4096
    ds_read_b128 v[76:79], v24 offset:6144
    ds_read_b128 v[80:83], v25 offset:0
    ds_read_b128 v[84:87], v25 offset:2048
    ds_read_b128 v[88:91], v25 offset:4096
    ds_read_b128 v[92:95], v25 offset:6144
    ds_read_b64_tr_b16 a[224:225], v16 offset:0
    ds_read_b64_tr_b16 a[226:227], v16 offset:1024
    ds_read_b64_tr_b16 a[228:229], v16 offset:8
    ds_read_b64_tr_b16 a[230:231], v16 offset:1032
    ds_read_b64_tr_b16 a[232:233], v17 offset:0
    ds_read_b64_tr_b16 a[234:235], v17 offset:1024
    ds_read_b64_tr_b16 a[236:237], v22 offset:8192
    ds_read_b64_tr_b16 a[238:239], v22 offset:8704
    s_waitcnt lgkmcnt(6)
    v_mfma_f32_16x16x32_bf16 v[128:131], a[224:227], v[64:67], 0
    s_add_u32 s49, s3, 1
    ds_read_b64_tr_b16 a[240:241], v17 offset:8
    v_mfma_f32_16x16x32_bf16 v[132:135], a[224:227], v[68:71], 0
    s_and_b32 s49, s49, 7
    ds_read_b64_tr_b16 a[242:243], v17 offset:1032
    v_mfma_f32_16x16x32_bf16 v[136:139], a[224:227], v[72:75], 0
    s_lshl_b32 s49, s49, 7
    v_mfma_f32_16x16x32_bf16 v[140:143], a[224:227], v[76:79], 0
    s_waitcnt lgkmcnt(6)
    s_cmp_lg_u32 s100, 0
    s_cbranch_scc1 L_np0
    ds_read_b64_tr_b16 a[64:65], v56 offset:0
    ds_read_b64_tr_b16 a[66:67], v56 offset:1024
    ds_read_b64_tr_b16 a[68:69], v56 offset:8
    ds_read_b64_tr_b16 a[70:71], v56 offset:1032
    ds_read_b64_tr_b16 a[72:73], v57 offset:8192
    ds_read_b64_tr_b16 a[74:75], v57 offset:8704
    ds_read_b64_tr_b16 a[76:77], v57 offset:12288
    ds_read_b64_tr_b16 a[78:79], v57 offset:12800
    v_mfma_f32_16x16x32_bf16 a[80:83], v[40:43], v[64:67], a[80:83]
    v_mfma_f32_16x16x32_bf16 a[96:99], v[64:67], v[64:67], a[96:99]
    v_mfma_f32_16x16x32_bf16 a[84:87], v[40:43], v[68:71], a[84:87]
    v_mfma_f32_16x16x32_bf16 a[100:103], v[68:71], v[68:71], a[100:103]
    v_mfma_f32_16x16x32_bf16 a[88:91], v[40:43], v[72:75], a[88:91]
    v_mfma_f32_16x16x32_bf16 a[104:107], v[72:75], v[72:75], a[104:107]
    v_mfma_f32_16x16x32_bf16 a[92:95], v[40:43], v[76:79], a[92:95]
    v_mfma_f32_16x16x32_bf16 a[108:111], v[76:79], v[76:79], a[108:111]
    s_waitcnt lgkmcnt(0)
    v_mfma_f32_16x16x32_bf16 a[112:115], a[64:67], v[40:43], a[112:115]
    v_mfma_f32_16x16x32_bf16 a[116:119], a[68:71], v[40:43], a[116:119]
    v_mfma_f32_16x16x32_bf16 a[120:123], a[72:75], v[40:43], a[120:123]
    v_mfma_f32_16x16x32_bf16 a[124:127], a[76:79], v[40:43], a[124:127]
L_np0:
    v_mfma_f32_16x16x32_bf16 v[144:147], a[228:231], v[64:67], 0
    s_add_u32 s48, s44, s49
    ds_read_b64_tr_b16 a[244:245], v18 offset:0
    v_mfma_f32_16x16x32_bf16 v[148:151], a[228:231], v[68:71], 0
    s_add_u32 m0, s43, 32768
    ds_read_b64_tr_b16 a[246:247], v18 offset:1024
    v_mfma_f32_16x16x32_bf16 v[152:155], a[228:231], v[72:75], 0
    buffer_load_dwordx4 v10, s[4:7], s48 offen lds
    v_mfma_f32_16x16x32_bf16 v[156:159], a[228:231], v[76:79], 0
    s_waitcnt lgkmcnt(6)
    v_mfma_f32_16x16x32_bf16 v[160:163], a[232:235], v[64:67], 0
    s_add_u32 m0, s43, 33792
    ds_read_b64_tr_b16 a[248:249], v18 offset:8
    v_mfma_f32_16x16x32_bf16 v[164:167], a[232:235], v[68:71], 0
    ds_read_b64_tr_b16 a[250:251], v18 offset:1032
    v_mfma_f32_16x16x32_bf16 v[168:171], a[232:235], v[72:75], 0
    buffer_load_dwordx4 v11, s[4:7], s48 offen lds
    v_mfma_f32_16x16x32_bf16 v[172:175], a[232:235], v[76:79], 0
    s_waitcnt lgkmcnt(6)
    v_mfma_f32_16x16x32_bf16 a[192:195], a[236:239], v[64:67], 0
    s_add_u32 s48, s45, s49
    ds_read_b64_tr_b16 a[252:253], v23 offset:8192
    v_mfma_f32_16x16x32_bf16 a[196:199], a[236:239], v[68:71], 0
    s_waitcnt lgkmcnt(5)
    ds_read_b64_tr_b16 a[254:255], v23 offset:8704
    v_mfma_f32_16x16x32_bf16 v[176:179], a[240:243], v[64:67], 0
    s_add_u32 m0, s43, 34816
    ds_read_b64_tr_b16 a[224:225], v19 offset:0
    v_mfma_f32_16x16x32_bf16 v[180:183], a[240:243], v[68:71], 0
    ds_read_b64_tr_b16 a[226:227], v19 offset:1024
    v_mfma_f32_16x16x32_bf16 v[184:187], a[240:243], v[72:75], 0
    buffer_load_dwordx4 v10, s[4:7], s48 offen lds
    v_mfma_f32_16x16x32_bf16 v[188:191], a[240:243], v[76:79], 0
    s_waitcnt lgkmcnt(6)
    v_mfma_f32_16x16x32_bf16 v[192:195], a[244:247], v[64:67], 0
    s_add_u32 m0, s43, 35840
    ds_read_b64_tr_b16 a[228:229], v19 offset:8
    v_mfma_f32_16x16x32_bf16 v[196:199], a[244:247], v[68:71], 0
    ds_read_b64_tr_b16 a[230:231], v19 offset:1032
    v_mfma_f32_16x16x32_bf16 v[200:203], a[244:247], v[72:75], 0
    buffer_load_dwordx4 v11, s[4:7], s48 offen lds
    v_mfma_f32_16x16x32_bf16 v[204:207], a[244:247], v[76:79], 0
    s_waitcnt lgkmcnt(6)
    v_mfma_f32_16x16x32_bf16 v[208:211], a[248:251], v[64:67], 0
    s_add_u32 s48, s46, s49
    ds_read_b64_tr_b16 a[232:233], v20 offset:8192
    v_mfma_f32_16x16x32_bf16 v[212:215], a[248:251], v[68:71], 0
    s_add_u32 m0, s43, 36864
    ds_read_b64_tr_b16 a[234:235], v20 offset:8704
    v_mfma_f32_16x16x32_bf16 v[216:219], a[248:251], v[72:75], 0
    buffer_load_dwordx4 v10, s[4:7], s48 offen lds
    v_mfma_f32_16x16x32_bf16 v[220:223], a[248:251], v[76:79], 0
    s_waitcnt lgkmcnt(6)
    v_mfma_f32_16x16x32_bf16 a[200:203], a[252:255], v[64:67], 0
    s_add_u32 m0, s43, 37888
    ds_read_b64_tr_b16 a[236:237], v22 offset:12288
    s_cmp_lg_u32 s101, 0
    s_cbranch_scc1 L_ni0
    s_mov_b64 exec, 1
    v_mov_b32 v45, 0
    v_mov_b32 v46, 1
    global_atomic_add v45, v46, s[84:85] sc1
    s_mov_b64 exec, -1
    s_nop 3
L_ni0:
    v_mfma_f32_16x16x32_bf16 a[204:207], a[252:255], v[68:71], 0
    s_waitcnt lgkmcnt(5)
    ds_read_b64_tr_b16 a[238:239], v22 offset:12800
    v_mfma_f32_16x16x32_bf16 v[224:227], a[224:227], v[64:67], 0
    ds_read_b64_tr_b16 a[240:241], v21 offset:8192
    v_mfma_f32_16x16x32_bf16 v[228:231], a[224:227], v[68:71], 0
    ds_read_b64_tr_b16 a[242:243], v21 offset:8704
    v_mfma_f32_16x16x32_bf16 v[232:235], a[224:227], v[72:75], 0
    buffer_load_dwordx4 v11, s[4:7], s48 offen lds
    v_mfma_f32_16x16x32_bf16 v[236:239], a[224:227], v[76:79], 0
    s_waitcnt lgkmcnt(6)
    v_mfma_f32_16x16x32_bf16 v[240:243], a[228:231], v[64:67], 0
    s_add_u32 s48, s47, s49
    ds_read_b64_tr_b16 a[244:245], v20 offset:12288
    v_mfma_f32_16x16x32_bf16 v[244:247], a[228:231], v[68:71], 0
    s_add_u32 m0, s43, 38912
    ds_read_b64_tr_b16 a[246:247], v20 offset:12800
    v_mfma_f32_16x16x32_bf16 v[248:251], a[228:231], v[72:75], 0
    buffer_load_dwordx4 v10, s[4:7], s48 offen lds
    v_mfma_f32_16x16x32_bf16 v[252:255], a[228:231], v[76:79], 0
    s_waitcnt lgkmcnt(6)
    v_mfma_f32_16x16x32_bf16 a[128:131], a[232:235], v[64:67], 0
    s_waitcnt vmcnt(7)
    ds_read_b64_tr_b16 a[248:249], v21 offset:12288
    v_mfma_f32_16x16x32_bf16 a[132:135], a[232:235], v[68:71], 0
    s_barrier
    ds_read_b64_tr_b16 a[250:251], v21 offset:12800
    v_mfma_f32_16x16x32_bf16 a[136:139], a[232:235], v[72:75], 0
    s_add_u32 m0, s43, 39936
    v_mfma_f32_16x16x32_bf16 a[140:143], a[232:235], v[76:79], 0
    s_waitcnt lgkmcnt(6)
    buffer_load_dwordx4 v11, s[4:7], s48 offen lds
    v_mfma_f32_16x16x32_bf16 a[208:211], a[236:239], v[64:67], 0
    s_add_u32 s49, s3, 1
    ds_read_b64_tr_b16 a[252:253], v23 offset:12288
    v_mfma_f32_16x16x32_bf16 a[212:215], a[236:239], v[68:71], 0
    s_waitcnt lgkmcnt(5)
    ds_read_b64_tr_b16 a[254:255], v23 offset:12800
    v_mfma_f32_16x16x32_bf16 a[144:147], a[240:243], v[64:67], 0
    s_and_b32 s49, s49, 7
    ds_read_b64_tr_b16 a[224:225], v16 offset:16384
    v_mfma_f32_16x16x32_bf16 a[148:151], a[240:243], v[68:71], 0
    s_lshl_b32 s48, s49, 19
    ds_read_b64_tr_b16 a[226:227], v16 offset:17408
    v_mfma_f32_16x16x32_bf16 a[152:155], a[240:243], v[72:75], 0
    s_add_u32 m0, s41, 98304
    v_mfma_f32_16x16x32_bf16 a[156:159], a[240:243], v[76:79], 0
    s_waitcnt lgkmcnt(6)
    buffer_load_dwordx4 v12, s[8:11], s48 offen lds
    v_mfma_f32_16x16x32_bf16 a[160:163], a[244:247], v[64:67], 0
    s_add_u32 s48, s48, 32768
    ds_read_b64_tr_b16 a[228:229], v16 offset:16392
    v_mfma_f32_16x16x32_bf16 a[164:167], a[244:247], v[68:71], 0
    s_add_u32 m0, s41, 99328
    ds_read_b64_tr_b16 a[230:231], v16 offset:17416
    v_mfma_f32_16x16x32_bf16 a[168:171], a[244:247], v[72:75], 0
    buffer_load_dwordx4 v12, s[8:11], s48 offen lds
    v_mfma_f32_16x16x32_bf16 a[172:175], a[244:247], v[76:79], 0
    s_waitcnt lgkmcnt(6)
    v_mfma_f32_16x16x32_bf16 a[176:179], a[248:251], v[64:67], 0
    s_mul_i32 s48, s49, 176128
    ds_read_b64_tr_b16 a[232:233], v17 offset:16384
    v_mfma_f32_16x16x32_bf16 a[180:183], a[248:251], v[68:71], 0
    s_add_u32 m0, s40, 106496
    ds_read_b64_tr_b16 a[234:235], v17 offset:17408
    v_mfma_f32_16x16x32_bf16 a[184:187], a[248:251], v[72:75], 0
    buffer_load_dwordx4 v13, s[12:15], s48 offen lds
    v_mfma_f32_16x16x32_bf16 a[188:191], a[248:251], v[76:79], 0
    s_waitcnt lgkmcnt(6)
    v_mfma_f32_16x16x32_bf16 a[216:219], a[252:255], v[64:67], 0
    s_add_u32 m0, s40, 110592
    ds_read_b64_tr_b16 a[236:237], v22 offset:24576
    s_cmp_lg_u32 s101, 1
    s_cbranch_scc1 L_ni1
    s_mov_b64 exec, 1
    v_mov_b32 v45, 0
    v_mov_b32 v46, 1
    global_atomic_add v45, v46, s[84:85] sc1
    s_mov_b64 exec, -1
    s_nop 3
L_ni1:
    v_mfma_f32_16x16x32_bf16 a[220:223], a[252:255], v[68:71], 0
    s_waitcnt lgkmcnt(5)
    ds_read_b64_tr_b16 a[238:239], v22 offset:25088
    v_mfma_f32_16x16x32_bf16 v[128:131], a[224:227], v[80:83], v[128:131]
    ds_read_b64_tr_b16 a[240:241], v17 offset:16392
    v_mfma_f32_16x16x32_bf16 v[132:135], a[224:227], v[84:87], v[132:135]
    ds_read_b64_tr_b16 a[242:243], v17 offset:17416
    v_mfma_f32_16x16x32_bf16 v[136:139], a[224:227], v[88:91], v[136:139]
    buffer_load_dwordx4 v13, s[16:19], s48 offen lds
    v_mfma_f32_16x16x32_bf16 v[140:143], a[224:227], v[92:95], v[140:143]
    s_waitcnt lgkmcnt(6)
    s_cmp_lg_u32 s100, 0
    s_cbranch_scc1 L_np1
    ds_read_b64_tr_b16 a[64:65], v56 offset:16384
    ds_read_b64_tr_b16 a[66:67], v56 offset:17408
    ds_read_b64_tr_b16 a[68:69], v56 offset:16392
    ds_read_b64_tr_b16 a[70:71], v56 offset:17416
    ds_read_b64_tr_b16 a[72:73], v57 offset:24576
    ds_read_b64_tr_b16 a[74:75], v57 offset:25088
    ds_read_b64_tr_b16 a[76:77], v57 offset:28672
    ds_read_b64_tr_b16 a[78:79], v57 offset:29184
    v_mfma_f32_16x16x32_bf16 a[80:83], v[40:43], v[80:83], a[80:83]
    v_mfma_f32_16x16x32_bf16 a[96:99], v[80:83], v[80:83], a[96:99]
    v_mfma_f32_16x16x32_bf16 a[84:87], v[40:43], v[84:87], a[84:87]
    v_mfma_f32_16x16x32_bf16 a[100:103], v[84:87], v[84:87], a[100:103]
    v_mfma_f32_16x16x32_bf16 a[88:91], v[40:43], v[88:91], a[88:91]
    v_mfma_f32_16x16x32_bf16 a[104:107], v[88:91], v[88:91], a[104:107]
    v_mfma_f32_16x16x32_bf16 a[92:95], v[40:43], v[92:95], a[92:95]
    v_mfma_f32_16x16x32_bf16 a[108:111], v[92:95], v[92:95], a[108:111]
    s_waitcnt lgkmcnt(0)
    v_mfma_f32_16x16x32_bf16 a[112:115], a[64:67], v[40:43], a[112:115]
    v_mfma_f32_16x16x32_bf16 a[116:119], a[68:71], v[40:43], a[116:119]
    v_mfma_f32_16x16x32_bf16 a[120:123], a[72:75], v[40:43], a[120:123]
    v_mfma_f32_16x16x32_bf16 a[124:127], a[76:79], v[40:43], a[124:127]
L_np1:
    v_mfma_f32_16x16x32_bf16 v[144:147], a[228:231], v[80:83], v[144:147]
    s_add_u32 s49, s3, 1
    ds_read_b64_tr_b16 a[244:245], v18 offset:16384
    v_mfma_f32_16x16x32_bf16 v[148:151], a[228:231], v[84:87], v[148:151]
    s_and_b32 s49, s49, 7
    ds_read_b64_tr_b16 a[246:247], v18 offset:17408
    v_mfma_f32_16x16x32_bf16 v[152:155], a[228:231], v[88:91], v[152:155]
    s_lshl_b32 s48, s49, 19
    v_mfma_f32_16x16x32_bf16 v[156:159], a[228:231], v[92:95], v[156:159]
    s_waitcnt lgkmcnt(6)
    v_mfma_f32_16x16x32_bf16 v[160:163], a[232:235], v[80:83], v[160:163]
    s_add_u32 s48, s48, 262144
    ds_read_b64_tr_b16 a[248:249], v18 offset:16392
    v_mfma_f32_16x16x32_bf16 v[164:167], a[232:235], v[84:87], v[164:167]
    s_add_u32 m0, s41, 114688
    ds_read_b64_tr_b16 a[250:251], v18 offset:17416
    v_mfma_f32_16x16x32_bf16 v[168:171], a[232:235], v[88:91], v[168:171]
    buffer_load_dwordx4 v12, s[8:11], s48 offen lds
    v_mfma_f32_16x16x32_bf16 v[172:175], a[232:235], v[92:95], v[172:175]
    s_waitcnt lgkmcnt(6)
    v_mfma_f32_16x16x32_bf16 a[192:195], a[236:239], v[80:83], a[192:195]
    s_add_u32 s48, s48, 32768
    ds_read_b64_tr_b16 a[252:253], v23 offset:24576
    v_mfma_f32_16x16x32_bf16 a[196:199], a[236:239], v[84:87], a[196:199]
    s_waitcnt lgkmcnt(5)
    ds_read_b64_tr_b16 a[254:255], v23 offset:25088
    v_mfma_f32_16x16x32_bf16 v[176:179], a[240:243], v[80:83], v[176:179]
    s_add_u32 m0, s41, 115712
    ds_read_b64_tr_b16 a[224:225], v19 offset:16384
    v_mfma_f32_16x16x32_bf16 v[180:183], a[240:243], v[84:87], v[180:183]
    ds_read_b64_tr_b16 a[226:227], v19 offset:17408
    v_mfma_f32_16x16x32_bf16 v[184:187], a[240:243], v[88:91], v[184:187]
    buffer_load_dwordx4 v12, s[8:11], s48 offen lds
    v_mfma_f32_16x16x32_bf16 v[188:191], a[240:243], v[92:95], v[188:191]
    s_waitcnt lgkmcnt(6)
    v_mfma_f32_16x16x32_bf16 v[192:195], a[244:247], v[80:83], v[192:195]
    s_mul_i32 s48, s49, 176128
    ds_read_b64_tr_b16 a[228:229], v19 offset:16392
    v_mfma_f32_16x16x32_bf16 v[196:199], a[244:247], v[84:87], v[196:199]
    s_add_u32 s48, s48, 88064
    ds_read_b64_tr_b16 a[230:231], v19 offset:17416
    v_mfma_f32_16x16x32_bf16 v[200:203], a[244:247], v[88:91], v[200:203]
    s_add_u32 m0, s40, 122880
    v_mfma_f32_16x16x32_bf16 v[204:207], a[244:247], v[92:95], v[204:207]
    s_waitcnt lgkmcnt(6)
    buffer_load_dwordx4 v13, s[12:15], s48 offen lds
    v_mfma_f32_16x16x32_bf16 v[208:211], a[248:251], v[80:83], v[208:211]
    s_add_u32 m0, s40, 126976
    ds_read_b64_tr_b16 a[232:233], v20 offset:24576
    v_mfma_f32_16x16x32_bf16 v[212:215], a[248:251], v[84:87], v[212:215]
    ds_read_b64_tr_b16 a[234:235], v20 offset:25088
    v_mfma_f32_16x16x32_bf16 v[216:219], a[248:251], v[88:91], v[216:219]
    buffer_load_dwordx4 v13, s[16:19], s48 offen lds
    v_mfma_f32_16x16x32_bf16 v[220:223], a[248:251], v[92:95], v[220:223]
    s_waitcnt lgkmcnt(6)
    v_mfma_f32_16x16x32_bf16 a[200:203], a[252:255], v[80:83], a[200:203]
    s_add_u32 s49, s3, 2
    ds_read_b64_tr_b16 a[236:237], v22 offset:28672
    s_cmp_lg_u32 s101, 2
    s_cbranch_scc1 L_ni2
    s_mov_b64 exec, 1
    v_mov_b32 v45, 0
    v_mov_b32 v46, 1
    global_atomic_add v45, v46, s[84:85] sc1
    s_mov_b64 exec, -1
    s_nop 3
L_ni2:
    v_mfma_f32_16x16x32_bf16 a[204:207], a[252:255], v[84:87], a[204:207]
    s_waitcnt lgkmcnt(5)
    ds_read_b64_tr_b16 a[238:239], v22 offset:29184
    v_mfma_f32_16x16x32_bf16 v[224:227], a[224:227], v[80:83], v[224:227]
    s_waitcnt vmcnt(8)
    ds_read_b64_tr_b16 a[240:241], v21 offset:24576
    v_mfma_f32_16x16x32_bf16 v[228:231], a[224:227], v[84:87], v[228:231]
    s_and_b32 s49, s49, 7
    ds_read_b64_tr_b16 a[242:243], v21 offset:25088
    v_mfma_f32_16x16x32_bf16 v[232:235], a[224:227], v[88:91], v[232:235]
    s_lshl_b32 s49, s49, 7
    ds_read_b128 v[96:99], v24 offset:32768
    v_mfma_f32_16x16x32_bf16 v[236:239], a[224:227], v[92:95], v[236:239]
    s_waitcnt lgkmcnt(7)
    ds_read_b128 v[100:103], v24 offset:34816
    v_mfma_f32_16x16x32_bf16 v[240:243], a[228:231], v[80:83], v[240:243]
    s_add_u32 s48, s44, s49
    ds_read_b64_tr_b16 a[244:245], v20 offset:28672
    v_mfma_f32_16x16x32_bf16 v[244:247], a[228:231], v[84:87], v[244:247]
    s_add_u32 m0, s43, 0
    ds_read_b64_tr_b16 a[246:247], v20 offset:29184
    v_mfma_f32_16x16x32_bf16 v[248:251], a[228:231], v[88:91], v[248:251]
    ds_read_b128 v[104:107], v24 offset:36864
    v_mfma_f32_16x16x32_bf16 v[252:255], a[228:231], v[92:95], v[252:255]
    s_waitcnt lgkmcnt(9)
    ds_read_b128 v[108:111], v24 offset:38912
    v_mfma_f32_16x16x32_bf16 a[128:131], a[232:235], v[80:83], a[128:131]
    s_waitcnt vmcnt(4)
    ds_read_b64_tr_b16 a[248:249], v21 offset:28672
    v_mfma_f32_16x16x32_bf16 a[132:135], a[232:235], v[84:87], a[132:135]
    s_barrier
    ds_read_b64_tr_b16 a[250:251], v21 offset:29184
    v_mfma_f32_16x16x32_bf16 a[136:139], a[232:235], v[88:91], a[136:139]
    ds_read_b128 v[112:115], v25 offset:32768
    v_mfma_f32_16x16x32_bf16 a[140:143], a[232:235], v[92:95], a[140:143]
    s_waitcnt lgkmcnt(11)
    ds_read_b128 v[116:119], v25 offset:34816
    v_mfma_f32_16x16x32_bf16 a[208:211], a[236:239], v[80:83], a[208:211]
    ds_read_b64_tr_b16 a[252:253], v23 offset:28672
    v_mfma_f32_16x16x32_bf16 a[212:215], a[236:239], v[84:87], a[212:215]
    s_waitcnt lgkmcnt(11)
    ds_read_b64_tr_b16 a[254:255], v23 offset:29184
    v_mfma_f32_16x16x32_bf16 a[144:147], a[240:243], v[80:83], a[144:147]
    ds_read_b64_tr_b16 a[224:225], v16 offset:32768
    v_mfma_f32_16x16x32_bf16 a[148:151], a[240:243], v[84:87], a[148:151]
    ds_read_b64_tr_b16 a[226:227], v16 offset:33792
    v_mfma_f32_16x16x32_bf16 a[152:155], a[240:243], v[88:91], a[152:155]
    ds_read_b128 v[120:123], v25 offset:36864
    v_mfma_f32_16x16x32_bf16 a[156:159], a[240:243], v[92:95], a[156:159]
    s_waitcnt lgkmcnt(11)
    ds_read_b128 v[124:127], v25 offset:38912
    v_mfma_f32_16x16x32_bf16 a[160:163], a[244:247], v[80:83], a[160:163]
    ds_read_b64_tr_b16 a[228:229], v16 offset:32776
    v_mfma_f32_16x16x32_bf16 a[164:167], a[244:247], v[84:87], a[164:167]
    ds_read_b64_tr_b16 a[230:231], v16 offset:33800
    v_mfma_f32_16x16x32_bf16 a[168:171], a[244:247], v[88:91], a[168:171]
    buffer_load_dwordx4 v10, s[4:7], s48 offen lds
    v_mfma_f32_16x16x32_bf16 a[172:175], a[244:247], v[92:95], a[172:175]
    s_waitcnt lgkmcnt(10)
    v_mfma_f32_16x16x32_bf16 a[176:179], a[248:251], v[80:83], a[176:179]
    s_add_u32 m0, s43, 1024
    ds_read_b64_tr_b16 a[232:233], v17 offset:32768
    v_mfma_f32_16x16x32_bf16 a[180:183], a[248:251], v[84:87], a[180:183]
    ds_read_b64_tr_b16 a[234:235], v17 offset:33792
    v_mfma_f32_16x16x32_bf16 a[184:187], a[248:251], v[88:91], a[184:187]
    buffer_load_dwordx4 v11, s[4:7], s48 offen lds
    v_mfma_f32_16x16x32_bf16 a[188:191], a[248:251], v[92:95], a[188:191]
    s_waitcnt lgkmcnt(8)
    v_mfma_f32_16x16x32_bf16 a[216:219], a[252:255], v[80:83], a[216:219]
    s_add_u32 s48, s45, s49
    ds_read_b64_tr_b16 a[236:237], v22 offset:40960
    s_cmp_lg_u32 s101, 3
    s_cbranch_scc1 L_ni3
    s_mov_b64 exec, 1
    v_mov_b32 v45, 0
    v_mov_b32 v46, 1
    global_atomic_add v45, v46, s[84:85] sc1
    s_mov_b64 exec, -1
    s_nop 3
L_ni3:
    v_mfma_f32_16x16x32_bf16 a[220:223], a[252:255], v[84:87], a[220:223]
    s_waitcnt lgkmcnt(7)
    ds_read_b64_tr_b16 a[238:239], v22 offset:41472
    v_mfma_f32_16x16x32_bf16 v[128:131], a[224:227], v[96:99], v[128:131]
    s_add_u32 m0, s43, 2048
    ds_read_b64_tr_b16 a[240:241], v17 offset:32776
    v_mfma_f32_16x16x32_bf16 v[132:135], a[224:227], v[100:103], v[132:135]
    ds_read_b64_tr_b16 a[242:243], v17 offset:33800
    v_mfma_f32_16x16x32_bf16 v[136:139], a[224:227], v[104:107], v[136:139]
    buffer_load_dwordx4 v10, s[4:7], s48 offen lds
    v_mfma_f32_16x16x32_bf16 v[140:143], a[224:227], v[108:111], v[140:143]
    s_waitcnt lgkmcnt(6)
    s_cmp_lg_u32 s100, 1
    s_cbranch_scc1 L_np2
    ds_read_b64_tr_b16 a[64:65], v56 offset:32768
    ds_read_b64_tr_b16 a[66:67], v56 offset:33792
    ds_read_b64_tr_b16 a[68:69], v56 offset:32776
    ds_read_b64_tr_b16 a[70:71], v56 offset:33800
    ds_read_b64_tr_b16 a[72:73], v57 offset:40960
    ds_read_b64_tr_b16 a[74:75], v57 offset:41472
    ds_read_b64_tr_b16 a[76:77], v57 offset:45056
    ds_read_b64_tr_b16 a[78:79], v57 offset:45568
    v_mfma_f32_16x16x32_bf16 a[80:83], v[40:43], v[96:99], a[80:83]
    v_mfma_f32_16x16x32_bf16 a[96:99], v[96:99], v[96:99], a[96:99]
    v_mfma_f32_16x16x32_bf16 a[84:87], v[40:43], v[100:103], a[84:87]
    v_mfma_f32_16x16x32_bf16 a[100:103], v[100:103], v[100:103], a[100:103]
    v_mfma_f32_16x16x32_bf16 a[88:91], v[40:43], v[104:107], a[88:91]
    v_mfma_f32_16x16x32_bf16 a[104:107], v[104:107], v[104:107], a[104:107]
    v_mfma_f32_16x16x32_bf16 a[92:95], v[40:43], v[108:111], a[92:95]
    v_mfma_f32_16x16x32_bf16 a[108:111], v[108:111], v[108:111], a[108:111]
    s_waitcnt lgkmcnt(0)
    v_mfma_f32_16x16x32_bf16 a[112:115], a[64:67], v[40:43], a[112:115]
    v_mfma_f32_16x16x32_bf16 a[116:119], a[68:71], v[40:43], a[116:119]
    v_mfma_f32_16x16x32_bf16 a[120:123], a[72:75], v[40:43], a[120:123]
    v_mfma_f32_16x16x32_bf16 a[124:127], a[76:79], v[40:43], a[124:127]
L_np2:
    v_mfma_f32_16x16x32_bf16 v[144:147], a[228:231], v[96:99], v[144:147]
    s_add_u32 m0, s43, 3072
    ds_read_b64_tr_b16 a[244:245], v18 offset:32768
    v_mfma_f32_16x16x32_bf16 v[148:151], a[228:231], v[100:103], v[148:151]
    ds_read_b64_tr_b16 a[246:247], v18 offset:33792
    v_mfma_f32_16x16x32_bf16 v[152:155], a[228:231], v[104:107], v[152:155]
    buffer_load_dwordx4 v11, s[4:7], s48 offen lds
    v_mfma_f32_16x16x32_bf16 v[156:159], a[228:231], v[108:111], v[156:159]
    s_waitcnt lgkmcnt(6)
    v_mfma_f32_16x16x32_bf16 v[160:163], a[232:235], v[96:99], v[160:163]
    s_add_u32 s48, s46, s49
    ds_read_b64_tr_b16 a[248:249], v18 offset:32776
    v_mfma_f32_16x16x32_bf16 v[164:167], a[232:235], v[100:103], v[164:167]
    s_add_u32 m0, s43, 4096
    ds_read_b64_tr_b16 a[250:251], v18 offset:33800
    v_mfma_f32_16x16x32_bf16 v[168:171], a[232:235], v[104:107], v[168:171]
    buffer_load_dwordx4 v10, s[4:7], s48 offen lds
    v_mfma_f32_16x16x32_bf16 v[172:175], a[232:235], v[108:111], v[172:175]
    s_waitcnt lgkmcnt(6)
    v_mfma_f32_16x16x32_bf16 a[192:195], a[236:239], v[96:99], a[192:195]
    s_add_u32 m0, s43, 5120
    ds_read_b64_tr_b16 a[252:253], v23 offset:40960
    v_mfma_f32_16x16x32_bf16 a[196:199], a[236:239], v[100:103], a[196:199]
    s_waitcnt lgkmcnt(5)
    ds_read_b64_tr_b16 a[254:255], v23 offset:41472
    v_mfma_f32_16x16x32_bf16 v[176:179], a[240:243], v[96:99], v[176:179]
    ds_read_b64_tr_b16 a[224:225], v19 offset:32768
    v_mfma_f32_16x16x32_bf16 v[180:183], a[240:243], v[100:103], v[180:183]
    ds_read_b64_tr_b16 a[226:227], v19 offset:33792
    v_mfma_f32_16x16x32_bf16 v[184:187], a[240:243], v[104:107], v[184:187]
    buffer_load_dwordx4 v11, s[4:7], s48 offen lds
    v_mfma_f32_16x16x32_bf16 v[188:191], a[240:243], v[108:111], v[188:191]
    s_waitcnt lgkmcnt(6)
    v_mfma_f32_16x16x32_bf16 v[192:195], a[244:247], v[96:99], v[192:195]
    s_add_u32 s48, s47, s49
    ds_read_b64_tr_b16 a[228:229], v19 offset:32776
    v_mfma_f32_16x16x32_bf16 v[196:199], a[244:247], v[100:103], v[196:199]
    s_add_u32 m0, s43, 6144
    ds_read_b64_tr_b16 a[230:231], v19 offset:33800
    v_mfma_f32_16x16x32_bf16 v[200:203], a[244:247], v[104:107], v[200:203]
    buffer_load_dwordx4 v10, s[4:7], s48 offen lds
    v_mfma_f32_16x16x32_bf16 v[204:207], a[244:247], v[108:111], v[204:207]
    s_waitcnt lgkmcnt(6)
    v_mfma_f32_16x16x32_bf16 v[208:211], a[248:251], v[96:99], v[208:211]
    s_add_u32 m0, s43, 7168
    ds_read_b64_tr_b16 a[232:233], v20 offset:40960
    v_mfma_f32_16x16x32_bf16 v[212:215], a[248:251], v[100:103], v[212:215]
    ds_read_b64_tr_b16 a[234:235], v20 offset:41472
    v_mfma_f32_16x16x32_bf16 v[216:219], a[248:251], v[104:107], v[216:219]
    buffer_load_dwordx4 v11, s[4:7], s48 offen lds
    v_mfma_f32_16x16x32_bf16 v[220:223], a[248:251], v[108:111], v[220:223]
    s_waitcnt lgkmcnt(6)
    v_mfma_f32_16x16x32_bf16 a[200:203], a[252:255], v[96:99], a[200:203]
    s_add_u32 s49, s3, 2
    ds_read_b64_tr_b16 a[236:237], v22 offset:45056
    s_cmp_lg_u32 s101, 4
    s_cbranch_scc1 L_ni4
    s_mov_b64 exec, 1
    v_mov_b32 v45, 0
    v_mov_b32 v46, 1
    global_atomic_add v45, v46, s[84:85] sc1
    s_mov_b64 exec, -1
    s_nop 3
L_ni4:
    v_mfma_f32_16x16x32_bf16 a[204:207], a[252:255], v[100:103], a[204:207]
    s_waitcnt lgkmcnt(5)
    ds_read_b64_tr_b16 a[238:239], v22 offset:45568
    v_mfma_f32_16x16x32_bf16 v[224:227], a[224:227], v[96:99], v[224:227]
    s_and_b32 s49, s49, 7
    ds_read_b64_tr_b16 a[240:241], v21 offset:40960
    v_mfma_f32_16x16x32_bf16 v[228:231], a[224:227], v[100:103], v[228:231]
    s_lshl_b32 s48, s49, 19
    ds_read_b64_tr_b16 a[242:243], v21 offset:41472
    v_mfma_f32_16x16x32_bf16 v[232:235], a[224:227], v[104:107], v[232:235]
    s_add_u32 m0, s41, 131072
    v_mfma_f32_16x16x32_bf16 v[236:239], a[224:227], v[108:111], v[236:239]
    s_waitcnt lgkmcnt(6)
    buffer_load_dwordx4 v12, s[8:11], s48 offen lds
    v_mfma_f32_16x16x32_bf16 v[240:243], a[228:231], v[96:99], v[240:243]
    s_add_u32 s48, s48, 32768
    ds_read_b64_tr_b16 a[244:245], v20 offset:45056
    v_mfma_f32_16x16x32_bf16 v[244:247], a[228:231], v[100:103], v[244:247]
    s_add_u32 m0, s41, 132096
    ds_read_b64_tr_b16 a[246:247], v20 offset:45568
    v_mfma_f32_16x16x32_bf16 v[248:251], a[228:231], v[104:107], v[248:251]
    buffer_load_dwordx4 v12, s[8:11], s48 offen lds
    v_mfma_f32_16x16x32_bf16 v[252:255], a[228:231], v[108:111], v[252:255]
    s_waitcnt lgkmcnt(6)
    v_mfma_f32_16x16x32_bf16 a[128:131], a[232:235], v[96:99], a[128:131]
    s_waitcnt vmcnt(10)
    ds_read_b64_tr_b16 a[248:249], v21 offset:45056
    v_mfma_f32_16x16x32_bf16 a[132:135], a[232:235], v[100:103], a[132:135]
    s_barrier
    ds_read_b64_tr_b16 a[250:251], v21 offset:45568
    v_mfma_f32_16x16x32_bf16 a[136:139], a[232:235], v[104:107], a[136:139]
    s_mul_i32 s48, s49, 176128
    v_mfma_f32_16x16x32_bf16 a[140:143], a[232:235], v[108:111], a[140:143]
    s_waitcnt lgkmcnt(6)
    v_mfma_f32_16x16x32_bf16 a[208:211], a[236:239], v[96:99], a[208:211]
    s_add_u32 m0, s40, 139264
    ds_read_b64_tr_b16 a[252:253], v23 offset:45056
    v_mfma_f32_16x16x32_bf16 a[212:215], a[236:239], v[100:103], a[212:215]
    s_waitcnt lgkmcnt(5)
    ds_read_b64_tr_b16 a[254:255], v23 offset:45568
    v_mfma_f32_16x16x32_bf16 a[144:147], a[240:243], v[96:99], a[144:147]
    ds_read_b64_tr_b16 a[224:225], v48 offset:0
    v_mfma_f32_16x16x32_bf16 a[148:151], a[240:243], v[100:103], a[148:151]
    ds_read_b64_tr_b16 a[226:227], v48 offset:1024
    v_mfma_f32_16x16x32_bf16 a[152:155], a[240:243], v[104:107], a[152:155]
    buffer_load_dwordx4 v13, s[12:15], s48 offen lds
    v_mfma_f32_16x16x32_bf16 a[156:159], a[240:243], v[108:111], a[156:159]
    s_waitcnt lgkmcnt(6)
    v_mfma_f32_16x16x32_bf16 a[160:163], a[244:247], v[96:99], a[160:163]
    s_add_u32 m0, s40, 143360
    ds_read_b64_tr_b16 a[228:229], v48 offset:8
    v_mfma_f32_16x16x32_bf16 a[164:167], a[244:247], v[100:103], a[164:167]
    ds_read_b64_tr_b16 a[230:231], v48 offset:1032
    v_mfma_f32_16x16x32_bf16 a[168:171], a[244:247], v[104:107], a[168:171]
    buffer_load_dwordx4 v13, s[16:19], s48 offen lds
    v_mfma_f32_16x16x32_bf16 a[172:175], a[244:247], v[108:111], a[172:175]
    s_waitcnt lgkmcnt(6)
    v_mfma_f32_16x16x32_bf16 a[176:179], a[248:251], v[96:99], a[176:179]
    s_add_u32 s49, s3, 3
    ds_read_b64_tr_b16 a[232:233], v49 offset:0
    v_mfma_f32_16x16x32_bf16 a[180:183], a[248:251], v[100:103], a[180:183]
    s_and_b32 s49, s49, 7
    ds_read_b64_tr_b16 a[234:235], v49 offset:1024
    v_mfma_f32_16x16x32_bf16 a[184:187], a[248:251], v[104:107], a[184:187]
    s_lshl_b32 s49, s49, 7
    v_mfma_f32_16x16x32_bf16 a[188:191], a[248:251], v[108:111], a[188:191]
    s_waitcnt lgkmcnt(6)
    v_mfma_f32_16x16x32_bf16 a[216:219], a[252:255], v[96:99], a[216:219]
    s_add_u32 s48, s44, s49
    ds_read_b64_tr_b16 a[236:237], v54 offset:8192
    s_cmp_lg_u32 s101, 5
    s_cbranch_scc1 L_ni5
    s_mov_b64 exec, 1
    v_mov_b32 v45, 0
    v_mov_b32 v46, 1
    global_atomic_add v45, v46, s[84:85] sc1
    s_mov_b64 exec, -1
    s_nop 3
L_ni5:
    v_mfma_f32_16x16x32_bf16 a[220:223], a[252:255], v[100:103], a[220:223]
    s_waitcnt lgkmcnt(5)
    ds_read_b64_tr_b16 a[238:239], v54 offset:8704
    v_mfma_f32_16x16x32_bf16 v[128:131], a[224:227], v[112:115], v[128:131]
    s_add_u32 m0, s43, 32768
    ds_read_b64_tr_b16 a[240:241], v49 offset:8
    v_mfma_f32_16x16x32_bf16 v[132:135], a[224:227], v[116:119], v[132:135]
    ds_read_b64_tr_b16 a[242:243], v49 offset:1032
    v_mfma_f32_16x16x32_bf16 v[136:139], a[224:227], v[120:123], v[136:139]
    buffer_load_dwordx4 v10, s[4:7], s48 offen lds
    v_mfma_f32_16x16x32_bf16 v[140:143], a[224:227], v[124:127], v[140:143]
    s_waitcnt lgkmcnt(6)
    s_cmp_lg_u32 s100, 1
    s_cbranch_scc1 L_np3
    ds_read_b64_tr_b16 a[64:65], v58 offset:0
    ds_read_b64_tr_b16 a[66:67], v58 offset:1024
    ds_read_b64_tr_b16 a[68:69], v58 offset:8
    ds_read_b64_tr_b16 a[70:71], v58 offset:1032
    ds_read_b64_tr_b16 a[72:73], v59 offset:8192
    ds_read_b64_tr_b16 a[74:75], v59 offset:8704
    ds_read_b64_tr_b16 a[76:77], v59 offset:12288
    ds_read_b64_tr_b16 a[78:79], v59 offset:12800
    v_mfma_f32_16x16x32_bf16 a[80:83], v[40:43], v[112:115], a[80:83]
    v_mfma_f32_16x16x32_bf16 a[96:99], v[112:115], v[112:115], a[96:99]
    v_mfma_f32_16x16x32_bf16 a[84:87], v[40:43], v[116:119], a[84:87]
    v_mfma_f32_16x16x32_bf16 a[100:103], v[116:119], v[116:119], a[100:103]
    v_mfma_f32_16x16x32_bf16 a[88:91], v[40:43], v[120:123], a[88:91]
    v_mfma_f32_16x16x32_bf16 a[104:107], v[120:123], v[120:123], a[104:107]
    v_mfma_f32_16x16x32_bf16 a[92:95], v[40:43], v[124:127], a[92:95]
    v_mfma_f32_16x16x32_bf16 a[108:111], v[124:127], v[124:127], a[108:111]
    s_waitcnt lgkmcnt(0)
    v_mfma_f32_16x16x32_bf16 a[112:115], a[64:67], v[40:43], a[112:115]
    v_mfma_f32_16x16x32_bf16 a[116:119], a[68:71], v[40:43], a[116:119]
    v_mfma_f32_16x16x32_bf16 a[120:123], a[72:75], v[40:43], a[120:123]
    v_mfma_f32_16x16x32_bf16 a[124:127], a[76:79], v[40:43], a[124:127]
L_np3:
    v_mfma_f32_16x16x32_bf16 v[144:147], a[228:231], v[112:115], v[144:147]
    s_waitcnt vmcnt(5)
    ds_read_b64_tr_b16 a[244:245], v50 offset:0
    v_mfma_f32_16x16x32_bf16 v[148:151], a[228:231], v[116:119], v[148:151]
    s_add_u32 m0, s43, 33792
    ds_read_b64_tr_b16 a[246:247], v50 offset:1024
    v_mfma_f32_16x16x32_bf16 v[152:155], a[228:231], v[120:123], v[152:155]
    ds_read_b128 v[64:67], v24 offset:0
    v_mfma_f32_16x16x32_bf16 v[156:159], a[228:231], v[124:127], v[156:159]
    s_waitcnt lgkmcnt(7)
    buffer_load_dwordx4 v11, s[4:7], s48 offen lds
    v_mfma_f32_16x16x32_bf16 v[160:163], a[232:235], v[112:115], v[160:163]
    s_add_u32 s48, s45, s49
    ds_read_b64_tr_b16 a[248:249], v50 offset:8
    v_mfma_f32_16x16x32_bf16 v[164:167], a[232:235], v[116:119], v[164:167]
    s_add_u32 m0, s43, 34816
    ds_read_b64_tr_b16 a[250:251], v50 offset:1032
    v_mfma_f32_16x16x32_bf16 v[168:171], a[232:235], v[120:123], v[168:171]
    ds_read_b128 v[68:71], v24 offset:2048
    v_mfma_f32_16x16x32_bf16 v[172:175], a[232:235], v[124:127], v[172:175]
    s_waitcnt lgkmcnt(8)
    buffer_load_dwordx4 v10, s[4:7], s48 offen lds
    v_mfma_f32_16x16x32_bf16 a[192:195], a[236:239], v[112:115], a[192:195]
    s_add_u32 m0, s43, 35840
    ds_read_b64_tr_b16 a[252:253], v55 offset:8192
    v_mfma_f32_16x16x32_bf16 a[196:199], a[236:239], v[116:119], a[196:199]
    s_waitcnt lgkmcnt(7)
    ds_read_b64_tr_b16 a[254:255], v55 offset:8704
    v_mfma_f32_16x16x32_bf16 v[176:179], a[240:243], v[112:115], v[176:179]
    ds_read_b64_tr_b16 a[224:225], v51 offset:0
    v_accvgpr_read_b32 v57, a96
    v_mfma_f32_16x16x32_bf16 v[180:183], a[240:243], v[116:119], v[180:183]
    ds_read_b64_tr_b16 a[226:227], v51 offset:1024
    v_accvgpr_read_b32 v56, a80
    v_mfma_f32_16x16x32_bf16 v[184:187], a[240:243], v[120:123], v[184:187]
    ds_read_b128 v[72:75], v24 offset:4096
    v_cmp_eq_u32 vcc, 1, v4
    v_mfma_f32_16x16x32_bf16 v[188:191], a[240:243], v[124:127], v[188:191]
    s_waitcnt lgkmcnt(9)
    buffer_load_dwordx4 v11, s[4:7], s48 offen lds
    v_mfma_f32_16x16x32_bf16 v[192:195], a[244:247], v[112:115], v[192:195]
    s_add_u32 s48, s46, s49
    ds_read_b64_tr_b16 a[228:229], v51 offset:8
    v_accvgpr_read_b32 v7, a97
    v_mfma_f32_16x16x32_bf16 v[196:199], a[244:247], v[116:119], v[196:199]
    s_add_u32 m0, s43, 36864
    ds_read_b64_tr_b16 a[230:231], v51 offset:1032
    v_cndmask_b32 v57, v57, v7, vcc
    v_mfma_f32_16x16x32_bf16 v[200:203], a[244:247], v[120:123], v[200:203]
    ds_read_b128 v[76:79], v24 offset:6144
    v_cmp_eq_u32 vcc, 2, v4
    v_mfma_f32_16x16x32_bf16 v[204:207], a[244:247], v[124:127], v[204:207]
    s_waitcnt lgkmcnt(9)
    buffer_load_dwordx4 v10, s[4:7], s48 offen lds
    v_mfma_f32_16x16x32_bf16 v[208:211], a[248:251], v[112:115], v[208:211]
    s_add_u32 m0, s43, 37888
    ds_read_b64_tr_b16 a[232:233], v52 offset:8192
    v_accvgpr_read_b32 v7, a98
    v_mfma_f32_16x16x32_bf16 v[212:215], a[248:251], v[116:119], v[212:215]
    ds_read_b64_tr_b16 a[234:235], v52 offset:8704
    v_cndmask_b32 v57, v57, v7, vcc
    v_mfma_f32_16x16x32_bf16 v[216:219], a[248:251], v[120:123], v[216:219]
    ds_read_b128 v[80:83], v25 offset:0
    v_cmp_eq_u32 vcc, 3, v4
    v_mfma_f32_16x16x32_bf16 v[220:223], a[248:251], v[124:127], v[220:223]
    s_waitcnt lgkmcnt(9)
    buffer_load_dwordx4 v11, s[4:7], s48 offen lds
    v_mfma_f32_16x16x32_bf16 a[200:203], a[252:255], v[112:115], a[200:203]
    s_add_u32 s48, s47, s49
    ds_read_b64_tr_b16 a[236:237], v54 offset:12288
    s_cmp_lg_u32 s101, 6
    s_cbranch_scc1 L_ni6
    s_mov_b64 exec, 1
    v_mov_b32 v45, 0
    v_mov_b32 v46, 1
    global_atomic_add v45, v46, s[84:85] sc1
    s_mov_b64 exec, -1
    s_nop 3
L_ni6:
    v_accvgpr_read_b32 v7, a99
    v_mfma_f32_16x16x32_bf16 a[204:207], a[252:255], v[116:119], a[204:207]
    s_waitcnt lgkmcnt(8)
    ds_read_b64_tr_b16 a[238:239], v54 offset:12800
    v_cndmask_b32 v57, v57, v7, vcc
    v_mfma_f32_16x16x32_bf16 v[224:227], a[224:227], v[112:115], v[224:227]
    s_add_u32 m0, s43, 38912
    ds_read_b64_tr_b16 a[240:241], v53 offset:8192
    v_mfma_f32_16x16x32_bf16 v[228:231], a[224:227], v[116:119], v[228:231]
    s_lshl_b32 s50, s54, 10
    ds_read_b64_tr_b16 a[242:243], v53 offset:8704
    v_mfma_f32_16x16x32_bf16 v[232:235], a[224:227], v[120:123], v[232:235]
    s_add_u32 s50, s50, s51
    ds_read_b128 v[84:87], v25 offset:2048
    v_mfma_f32_16x16x32_bf16 v[236:239], a[224:227], v[124:127], v[236:239]
    s_waitcnt lgkmcnt(9)
    buffer_load_dwordx4 v10, s[4:7], s48 offen lds
    v_mfma_f32_16x16x32_bf16 v[240:243], a[228:231], v[112:115], v[240:243]
    s_add_u32 m0, s43, 39936
    ds_read_b64_tr_b16 a[244:245], v52 offset:12288
    v_mfma_f32_16x16x32_bf16 v[244:247], a[228:231], v[116:119], v[244:247]
    ds_read_b64_tr_b16 a[246:247], v52 offset:12800
    v_mfma_f32_16x16x32_bf16 v[248:251], a[228:231], v[120:123], v[248:251]
    ds_read_b128 v[88:91], v25 offset:4096
    v_mfma_f32_16x16x32_bf16 v[252:255], a[228:231], v[124:127], v[252:255]
    s_waitcnt lgkmcnt(9)
    buffer_load_dwordx4 v11, s[4:7], s48 offen lds
    v_mfma_f32_16x16x32_bf16 a[128:131], a[232:235], v[112:115], a[128:131]
    s_waitcnt vmcnt(8)
    ds_read_b64_tr_b16 a[248:249], v53 offset:12288
    v_mfma_f32_16x16x32_bf16 a[132:135], a[232:235], v[116:119], a[132:135]
    s_barrier
    ds_read_b64_tr_b16 a[250:251], v53 offset:12800
    v_mfma_f32_16x16x32_bf16 a[136:139], a[232:235], v[120:123], a[136:139]
    s_add_u32 s49, s3, 2
    ds_read_b128 v[92:95], v25 offset:6144
    v_mfma_f32_16x16x32_bf16 a[140:143], a[232:235], v[124:127], a[140:143]
    s_waitcnt lgkmcnt(9)
    buffer_store_dwordx4 a[112:115], v61, s[28:31], s52 offen offset:0 sc1
    v_mfma_f32_16x16x32_bf16 a[208:211], a[236:239], v[112:115], a[208:211]
    s_and_b32 s49, s49, 7
    ds_read_b64_tr_b16 a[252:253], v55 offset:12288
    v_mfma_f32_16x16x32_bf16 a[212:215], a[236:239], v[116:119], a[212:215]
    s_waitcnt lgkmcnt(8)
    ds_read_b64_tr_b16 a[254:255], v55 offset:12800
    v_mfma_f32_16x16x32_bf16 a[144:147], a[240:243], v[112:115], a[144:147]
    s_lshl_b32 s48, s49, 19
    ds_read_b64_tr_b16 a[224:225], v48 offset:16384
    v_mfma_f32_16x16x32_bf16 a[148:151], a[240:243], v[116:119], a[148:151]
    s_add_u32 s48, s48, 262144
    ds_read_b64_tr_b16 a[226:227], v48 offset:17408
    v_mfma_f32_16x16x32_bf16 a[152:155], a[240:243], v[120:123], a[152:155]
    s_add_u32 m0, s41, 147456
    buffer_store_dwordx4 a[116:119], v61, s[28:31], s52 offen offset:64 sc1
    v_mfma_f32_16x16x32_bf16 a[156:159], a[240:243], v[124:127], a[156:159]
    s_waitcnt lgkmcnt(8)
    buffer_load_dwordx4 v12, s[8:11], s48 offen lds
    v_mfma_f32_16x16x32_bf16 a[160:163], a[244:247], v[112:115], a[160:163]
    s_add_u32 s48, s48, 32768
    ds_read_b64_tr_b16 a[228:229], v48 offset:16392
    v_mfma_f32_16x16x32_bf16 a[164:167], a[244:247], v[116:119], a[164:167]
    s_add_u32 m0, s41, 148480
    ds_read_b64_tr_b16 a[230:231], v48 offset:17416
    v_mfma_f32_16x16x32_bf16 a[168:171], a[244:247], v[120:123], a[168:171]
    buffer_load_dwordx4 v12, s[8:11], s48 offen lds
    v_mfma_f32_16x16x32_bf16 a[172:175], a[244:247], v[124:127], a[172:175]
    s_waitcnt lgkmcnt(7)
    buffer_store_dwordx4 a[120:123], v61, s[28:31], s52 offen offset:128 sc1
    v_mfma_f32_16x16x32_bf16 a[176:179], a[248:251], v[112:115], a[176:179]
    s_mul_i32 s48, s49, 176128
    ds_read_b64_tr_b16 a[232:233], v49 offset:16384
    v_mfma_f32_16x16x32_bf16 a[180:183], a[248:251], v[116:119], a[180:183]
    s_add_u32 s48, s48, 88064
    ds_read_b64_tr_b16 a[234:235], v49 offset:17408
    v_mfma_f32_16x16x32_bf16 a[184:187], a[248:251], v[120:123], a[184:187]
    s_add_u32 m0, s40, 155648
    buffer_store_dwordx4 a[124:127], v61, s[28:31], s52 offen offset:192 sc1
    v_mfma_f32_16x16x32_bf16 a[188:191], a[248:251], v[124:127], a[188:191]
    s_waitcnt lgkmcnt(6)
    buffer_load_dwordx4 v13, s[12:15], s48 offen lds
    v_mfma_f32_16x16x32_bf16 a[216:219], a[252:255], v[112:115], a[216:219]
    s_add_u32 m0, s40, 159744
    ds_read_b64_tr_b16 a[236:237], v54 offset:24576
    s_cmp_lg_u32 s101, 7
    s_cbranch_scc1 L_ni7
    s_mov_b64 exec, 1
    v_mov_b32 v45, 0
    v_mov_b32 v46, 1
    global_atomic_add v45, v46, s[84:85] sc1
    s_mov_b64 exec, -1
    s_nop 3
L_ni7:
    v_mfma_f32_16x16x32_bf16 a[220:223], a[252:255], v[116:119], a[220:223]
    s_waitcnt lgkmcnt(5)
    ds_read_b64_tr_b16 a[238:239], v54 offset:25088
    v_mfma_f32_16x16x32_bf16 v[128:131], a[224:227], v[64:67], v[128:131]
    ds_read_b64_tr_b16 a[240:241], v49 offset:16392
    v_mfma_f32_16x16x32_bf16 v[132:135], a[224:227], v[68:71], v[132:135]
    ds_read_b64_tr_b16 a[242:243], v49 offset:17416
    v_mfma_f32_16x16x32_bf16 v[136:139], a[224:227], v[72:75], v[136:139]
    buffer_load_dwordx4 v13, s[16:19], s48 offen lds
    v_mfma_f32_16x16x32_bf16 v[140:143], a[224:227], v[76:79], v[140:143]
    s_waitcnt lgkmcnt(6)
    buffer_store_dwordx2 v[56:57], v60, s[28:31], s50 offen sc1
    v_mfma_f32_16x16x32_bf16 v[144:147], a[228:231], v[64:67], v[144:147]
    s_add_u32 s49, s3, 3
    ds_read_b64_tr_b16 a[244:245], v50 offset:16384
    v_accvgpr_read_b32 v59, a100
    v_mfma_f32_16x16x32_bf16 v[148:151], a[228:231], v[68:71], v[148:151]
    s_and_b32 s49, s49, 7
    ds_read_b64_tr_b16 a[246:247], v50 offset:17408
    v_accvgpr_read_b32 v58, a84
    v_mfma_f32_16x16x32_bf16 v[152:155], a[228:231], v[72:75], v[152:155]
    s_lshl_b32 s48, s49, 19
    v_cmp_eq_u32 vcc, 1, v4
    v_accvgpr_read_b32 v7, a101
    v_mfma_f32_16x16x32_bf16 v[156:159], a[228:231], v[76:79], v[156:159]
    s_waitcnt lgkmcnt(6)
    v_cndmask_b32 v59, v59, v7, vcc
    v_cmp_eq_u32 vcc, 2, v4
    v_mfma_f32_16x16x32_bf16 v[160:163], a[232:235], v[64:67], v[160:163]
    s_add_u32 m0, s41, 65536
    ds_read_b64_tr_b16 a[248:249], v50 offset:16392
    v_accvgpr_read_b32 v7, a102
    v_mfma_f32_16x16x32_bf16 v[164:167], a[232:235], v[68:71], v[164:167]
    ds_read_b64_tr_b16 a[250:251], v50 offset:17416
    v_cndmask_b32 v59, v59, v7, vcc
    v_mfma_f32_16x16x32_bf16 v[168:171], a[232:235], v[72:75], v[168:171]
    buffer_load_dwordx4 v12, s[8:11], s48 offen lds
    v_mfma_f32_16x16x32_bf16 v[172:175], a[232:235], v[76:79], v[172:175]
    s_waitcnt lgkmcnt(6)
    v_cmp_eq_u32 vcc, 3, v4
    v_accvgpr_read_b32 v7, a103
    v_mfma_f32_16x16x32_bf16 a[192:195], a[236:239], v[64:67], a[192:195]
    s_add_u32 s48, s48, 32768
    ds_read_b64_tr_b16 a[252:253], v55 offset:24576
    v_cndmask_b32 v59, v59, v7, vcc
    v_mfma_f32_16x16x32_bf16 a[196:199], a[236:239], v[68:71], a[196:199]
    s_waitcnt lgkmcnt(5)
    ds_read_b64_tr_b16 a[254:255], v55 offset:25088
    v_mfma_f32_16x16x32_bf16 v[176:179], a[240:243], v[64:67], v[176:179]
    s_add_u32 m0, s41, 66560
    ds_read_b64_tr_b16 a[224:225], v51 offset:16384
    v_mfma_f32_16x16x32_bf16 v[180:183], a[240:243], v[68:71], v[180:183]
    s_lshl_b32 s50, s55, 10
    ds_read_b64_tr_b16 a[226:227], v51 offset:17408
    v_mfma_f32_16x16x32_bf16 v[184:187], a[240:243], v[72:75], v[184:187]
    s_add_u32 s50, s50, s51
    buffer_load_dwordx4 v12, s[8:11], s48 offen lds
    v_mfma_f32_16x16x32_bf16 v[188:191], a[240:243], v[76:79], v[188:191]
    s_waitcnt lgkmcnt(6)
    buffer_store_dwordx2 v[58:59], v60, s[28:31], s50 offen sc1
    v_mfma_f32_16x16x32_bf16 v[192:195], a[244:247], v[64:67], v[192:195]
    s_mul_i32 s48, s49, 176128
    ds_read_b64_tr_b16 a[228:229], v51 offset:16392
    v_accvgpr_read_b32 v57, a104
    v_mfma_f32_16x16x32_bf16 v[196:199], a[244:247], v[68:71], v[196:199]
    s_add_u32 m0, s40, 73728
    ds_read_b64_tr_b16 a[230:231], v51 offset:17416
    v_accvgpr_read_b32 v56, a88
    v_mfma_f32_16x16x32_bf16 v[200:203], a[244:247], v[72:75], v[200:203]
    buffer_load_dwordx4 v13, s[12:15], s48 offen lds
    v_mfma_f32_16x16x32_bf16 v[204:207], a[244:247], v[76:79], v[204:207]
    s_waitcnt lgkmcnt(6)
    v_cmp_eq_u32 vcc, 1, v4
    v_accvgpr_read_b32 v7, a105
    v_mfma_f32_16x16x32_bf16 v[208:211], a[248:251], v[64:67], v[208:211]
    s_add_u32 m0, s40, 77824
    ds_read_b64_tr_b16 a[232:233], v52 offset:24576
    v_cndmask_b32 v57, v57, v7, vcc
    v_mfma_f32_16x16x32_bf16 v[212:215], a[248:251], v[68:71], v[212:215]
    ds_read_b64_tr_b16 a[234:235], v52 offset:25088
    v_cmp_eq_u32 vcc, 2, v4
    v_mfma_f32_16x16x32_bf16 v[216:219], a[248:251], v[72:75], v[216:219]
    buffer_load_dwordx4 v13, s[16:19], s48 offen lds
    v_mfma_f32_16x16x32_bf16 v[220:223], a[248:251], v[76:79], v[220:223]
    s_waitcnt lgkmcnt(6)
    v_accvgpr_read_b32 v7, a106
    v_mfma_f32_16x16x32_bf16 a[200:203], a[252:255], v[64:67], a[200:203]
    s_add_u32 s49, s3, 4
    ds_read_b64_tr_b16 a[236:237], v54 offset:28672
    v_cndmask_b32 v57, v57, v7, vcc
    v_mfma_f32_16x16x32_bf16 a[204:207], a[252:255], v[68:71], a[204:207]
    s_waitcnt lgkmcnt(5)
    ds_read_b64_tr_b16 a[238:239], v54 offset:29184
    v_cmp_eq_u32 vcc, 3, v4
    v_mfma_f32_16x16x32_bf16 v[224:227], a[224:227], v[64:67], v[224:227]
    s_and_b32 s49, s49, 7
    ds_read_b64_tr_b16 a[240:241], v53 offset:24576
    v_accvgpr_read_b32 v7, a107
    v_mfma_f32_16x16x32_bf16 v[228:231], a[224:227], v[68:71], v[228:231]
    s_lshl_b32 s49, s49, 7
    ds_read_b64_tr_b16 a[242:243], v53 offset:25088
    v_cndmask_b32 v57, v57, v7, vcc
    v_mfma_f32_16x16x32_bf16 v[232:235], a[224:227], v[72:75], v[232:235]
    s_add_u32 s48, s44, s49
    v_mfma_f32_16x16x32_bf16 v[236:239], a[224:227], v[76:79], v[236:239]
    s_waitcnt lgkmcnt(6)
    v_mfma_f32_16x16x32_bf16 v[240:243], a[228:231], v[64:67], v[240:243]
    s_add_u32 m0, s43, 0
    ds_read_b64_tr_b16 a[244:245], v52 offset:28672
    v_mfma_f32_16x16x32_bf16 v[244:247], a[228:231], v[68:71], v[244:247]
    s_lshl_b32 s50, s56, 10
    ds_read_b64_tr_b16 a[246:247], v52 offset:29184
    v_mfma_f32_16x16x32_bf16 v[248:251], a[228:231], v[72:75], v[248:251]
    s_add_u32 s50, s50, s51
    buffer_load_dwordx4 v10, s[4:7], s48 offen lds
    v_mfma_f32_16x16x32_bf16 v[252:255], a[228:231], v[76:79], v[252:255]
    s_waitcnt lgkmcnt(6)
    buffer_store_dwordx2 v[56:57], v60, s[28:31], s50 offen sc1
    v_mfma_f32_16x16x32_bf16 a[128:131], a[232:235], v[64:67], a[128:131]
    s_waitcnt vmcnt(8)
    ds_read_b64_tr_b16 a[248:249], v53 offset:28672
    v_accvgpr_read_b32 v59, a108
    v_mfma_f32_16x16x32_bf16 a[132:135], a[232:235], v[68:71], a[132:135]
    s_barrier
    ds_read_b64_tr_b16 a[250:251], v53 offset:29184
    v_accvgpr_read_b32 v58, a92
    v_mfma_f32_16x16x32_bf16 a[136:139], a[232:235], v[72:75], a[136:139]
    s_add_u32 m0, s43, 1024
    v_cmp_eq_u32 vcc, 1, v4
    v_accvgpr_read_b32 v7, a109
    v_mfma_f32_16x16x32_bf16 a[140:143], a[232:235], v[76:79], a[140:143]
    s_waitcnt lgkmcnt(6)
    buffer_load_dwordx4 v11, s[4:7], s48 offen lds
    v_mfma_f32_16x16x32_bf16 a[208:211], a[236:239], v[64:67], a[208:211]
    s_add_u32 s48, s45, s49
    ds_read_b64_tr_b16 a[252:253], v55 offset:28672
    v_cndmask_b32 v59, v59, v7, vcc
    v_mfma_f32_16x16x32_bf16 a[212:215], a[236:239], v[68:71], a[212:215]
    s_waitcnt lgkmcnt(5)
    ds_read_b64_tr_b16 a[254:255], v55 offset:29184
    v_cmp_eq_u32 vcc, 2, v4
    v_mfma_f32_16x16x32_bf16 a[144:147], a[240:243], v[64:67], a[144:147]
    s_add_u32 m0, s43, 2048
    ds_read_b64_tr_b16 a[224:225], v48 offset:32768
    v_accvgpr_read_b32 v7, a110
    v_mfma_f32_16x16x32_bf16 a[148:151], a[240:243], v[68:71], a[148:151]
    ds_read_b64_tr_b16 a[226:227], v48 offset:33792
    v_cndmask_b32 v59, v59, v7, vcc
    v_mfma_f32_16x16x32_bf16 a[152:155], a[240:243], v[72:75], a[152:155]
    buffer_load_dwordx4 v10, s[4:7], s48 offen lds
    v_mfma_f32_16x16x32_bf16 a[156:159], a[240:243], v[76:79], a[156:159]
    s_waitcnt lgkmcnt(6)
    v_cmp_eq_u32 vcc, 3, v4
    v_accvgpr_read_b32 v7, a111
    v_mfma_f32_16x16x32_bf16 a[160:163], a[244:247], v[64:67], a[160:163]
    s_add_u32 m0, s43, 3072
    ds_read_b64_tr_b16 a[228:229], v48 offset:32776
    v_cndmask_b32 v59, v59, v7, vcc
    v_mfma_f32_16x16x32_bf16 a[164:167], a[244:247], v[68:71], a[164:167]
    s_lshl_b32 s50, s57, 10
    ds_read_b64_tr_b16 a[230:231], v48 offset:33800
    v_mfma_f32_16x16x32_bf16 a[168:171], a[244:247], v[72:75], a[168:171]
    s_add_u32 s50, s50, s51
    buffer_load_dwordx4 v11, s[4:7], s48 offen lds
    v_mfma_f32_16x16x32_bf16 a[172:175], a[244:247], v[76:79], a[172:175]
    s_waitcnt lgkmcnt(6)
    buffer_store_dwordx2 v[58:59], v60, s[28:31], s50 offen sc1
    v_mfma_f32_16x16x32_bf16 a[176:179], a[248:251], v[64:67], a[176:179]
    s_add_u32 s48, s46, s49
    ds_read_b64_tr_b16 a[232:233], v49 offset:32768
    v_mfma_f32_16x16x32_bf16 a[180:183], a[248:251], v[68:71], a[180:183]
    s_add_u32 m0, s43, 4096
    ds_read_b64_tr_b16 a[234:235], v49 offset:33792
    v_mfma_f32_16x16x32_bf16 a[184:187], a[248:251], v[72:75], a[184:187]
    buffer_load_dwordx4 v10, s[4:7], s48 offen lds
    v_mfma_f32_16x16x32_bf16 a[188:191], a[248:251], v[76:79], a[188:191]
    s_waitcnt lgkmcnt(6)
    v_mfma_f32_16x16x32_bf16 a[216:219], a[252:255], v[64:67], a[216:219]
    s_add_u32 m0, s43, 5120
    ds_read_b64_tr_b16 a[236:237], v54 offset:40960
    v_mfma_f32_16x16x32_bf16 a[220:223], a[252:255], v[68:71], a[220:223]
    s_waitcnt lgkmcnt(5)
    ds_read_b64_tr_b16 a[238:239], v54 offset:41472
    v_mfma_f32_16x16x32_bf16 v[128:131], a[224:227], v[80:83], v[128:131]
    ds_read_b64_tr_b16 a[240:241], v49 offset:32776
    v_mfma_f32_16x16x32_bf16 v[132:135], a[224:227], v[84:87], v[132:135]
    ds_read_b64_tr_b16 a[242:243], v49 offset:33800
    v_mfma_f32_16x16x32_bf16 v[136:139], a[224:227], v[88:91], v[136:139]
    buffer_load_dwordx4 v11, s[4:7], s48 offen lds
    v_mfma_f32_16x16x32_bf16 v[140:143], a[224:227], v[92:95], v[140:143]
    s_waitcnt lgkmcnt(6)
    v_mfma_f32_16x16x32_bf16 v[144:147], a[228:231], v[80:83], v[144:147]
    ds_read_b64_tr_b16 a[244:245], v50 offset:32768
    v_mfma_f32_16x16x32_bf16 v[148:151], a[228:231], v[84:87], v[148:151]
    s_add_u32 s48, s47, s49
    ds_read_b64_tr_b16 a[246:247], v50 offset:33792
    v_mfma_f32_16x16x32_bf16 v[152:155], a[228:231], v[88:91], v[152:155]
    s_add_u32 m0, s43, 6144
    ds_read_b128 v[96:99], v24 offset:32768
    v_mfma_f32_16x16x32_bf16 v[156:159], a[228:231], v[92:95], v[156:159]
    s_waitcnt lgkmcnt(7)
    buffer_load_dwordx4 v10, s[4:7], s48 offen lds
    v_mfma_f32_16x16x32_bf16 v[160:163], a[232:235], v[80:83], v[160:163]
    s_add_u32 m0, s43, 7168
    ds_read_b64_tr_b16 a[248:249], v50 offset:32776
    v_mfma_f32_16x16x32_bf16 v[164:167], a[232:235], v[84:87], v[164:167]
    ds_read_b64_tr_b16 a[250:251], v50 offset:33800
    v_mfma_f32_16x16x32_bf16 v[168:171], a[232:235], v[88:91], v[168:171]
    ds_read_b128 v[100:103], v24 offset:34816
    v_mfma_f32_16x16x32_bf16 v[172:175], a[232:235], v[92:95], v[172:175]
    s_waitcnt lgkmcnt(8)
    buffer_load_dwordx4 v11, s[4:7], s48 offen lds
    v_mfma_f32_16x16x32_bf16 a[192:195], a[236:239], v[80:83], a[192:195]
    s_add_u32 s49, s3, 3
    ds_read_b64_tr_b16 a[252:253], v55 offset:40960
    v_mfma_f32_16x16x32_bf16 a[196:199], a[236:239], v[84:87], a[196:199]
    s_waitcnt lgkmcnt(7)
    ds_read_b64_tr_b16 a[254:255], v55 offset:41472
    v_mfma_f32_16x16x32_bf16 v[176:179], a[240:243], v[80:83], v[176:179]
    s_and_b32 s49, s49, 7
    ds_read_b64_tr_b16 a[224:225], v51 offset:32768
    v_mfma_f32_16x16x32_bf16 v[180:183], a[240:243], v[84:87], v[180:183]
    s_lshl_b32 s48, s49, 19
    ds_read_b64_tr_b16 a[226:227], v51 offset:33792
    v_mfma_f32_16x16x32_bf16 v[184:187], a[240:243], v[88:91], v[184:187]
    s_add_u32 s48, s48, 262144
    ds_read_b128 v[104:107], v24 offset:36864
    v_mfma_f32_16x16x32_bf16 v[188:191], a[240:243], v[92:95], v[188:191]
    s_waitcnt lgkmcnt(9)
    v_mfma_f32_16x16x32_bf16 v[192:195], a[244:247], v[80:83], v[192:195]
    s_add_u32 m0, s41, 81920
    ds_read_b64_tr_b16 a[228:229], v51 offset:32776
    v_mfma_f32_16x16x32_bf16 v[196:199], a[244:247], v[84:87], v[196:199]
    ds_read_b64_tr_b16 a[230:231], v51 offset:33800
    v_mfma_f32_16x16x32_bf16 v[200:203], a[244:247], v[88:91], v[200:203]
    ds_read_b128 v[108:111], v24 offset:38912
    v_mfma_f32_16x16x32_bf16 v[204:207], a[244:247], v[92:95], v[204:207]
    s_waitcnt lgkmcnt(9)
    buffer_load_dwordx4 v12, s[8:11], s48 offen lds
    v_mfma_f32_16x16x32_bf16 v[208:211], a[248:251], v[80:83], v[208:211]
    s_add_u32 s48, s48, 32768
    ds_read_b64_tr_b16 a[232:233], v52 offset:40960
    v_mfma_f32_16x16x32_bf16 v[212:215], a[248:251], v[84:87], v[212:215]
    s_add_u32 m0, s41, 82944
    ds_read_b64_tr_b16 a[234:235], v52 offset:41472
    v_mfma_f32_16x16x32_bf16 v[216:219], a[248:251], v[88:91], v[216:219]
    ds_read_b128 v[112:115], v25 offset:32768
    v_mfma_f32_16x16x32_bf16 v[220:223], a[248:251], v[92:95], v[220:223]
    s_waitcnt lgkmcnt(9)
    buffer_load_dwordx4 v12, s[8:11], s48 offen lds
    v_mfma_f32_16x16x32_bf16 a[200:203], a[252:255], v[80:83], a[200:203]
    s_mul_i32 s48, s49, 176128
    ds_read_b64_tr_b16 a[236:237], v54 offset:45056
    v_mfma_f32_16x16x32_bf16 a[204:207], a[252:255], v[84:87], a[204:207]
    s_waitcnt lgkmcnt(8)
    ds_read_b64_tr_b16 a[238:239], v54 offset:45568
    v_mfma_f32_16x16x32_bf16 v[224:227], a[224:227], v[80:83], v[224:227]
    s_add_u32 s48, s48, 88064
    ds_read_b64_tr_b16 a[240:241], v53 offset:40960
    v_mfma_f32_16x16x32_bf16 v[228:231], a[224:227], v[84:87], v[228:231]
    s_add_u32 m0, s40, 90112
    ds_read_b64_tr_b16 a[242:243], v53 offset:41472
    v_mfma_f32_16x16x32_bf16 v[232:235], a[224:227], v[88:91], v[232:235]
    ds_read_b128 v[116:119], v25 offset:34816
    v_mfma_f32_16x16x32_bf16 v[236:239], a[224:227], v[92:95], v[236:239]
    s_waitcnt lgkmcnt(9)
    buffer_load_dwordx4 v13, s[12:15], s48 offen lds
    v_mfma_f32_16x16x32_bf16 v[240:243], a[228:231], v[80:83], v[240:243]
    s_add_u32 m0, s40, 94208
    ds_read_b64_tr_b16 a[244:245], v52 offset:45056
    v_mfma_f32_16x16x32_bf16 v[244:247], a[228:231], v[84:87], v[244:247]
    ds_read_b64_tr_b16 a[246:247], v52 offset:45568
    v_mfma_f32_16x16x32_bf16 v[248:251], a[228:231], v[88:91], v[248:251]
    ds_read_b128 v[120:123], v25 offset:36864
    v_mfma_f32_16x16x32_bf16 v[252:255], a[228:231], v[92:95], v[252:255]
    s_waitcnt lgkmcnt(9)
    buffer_load_dwordx4 v13, s[16:19], s48 offen lds
    v_mfma_f32_16x16x32_bf16 a[128:131], a[232:235], v[80:83], a[128:131]
    s_waitcnt vmcnt(14)
    ds_read_b64_tr_b16 a[248:249], v53 offset:45056
    v_lshlrev_b32 v7, 15, v0
    v_mfma_f32_16x16x32_bf16 a[132:135], a[232:235], v[84:87], a[132:135]
    s_barrier
    ds_read_b64_tr_b16 a[250:251], v53 offset:45568
    v_add_u32 v7, 0x6000, v7
    v_mfma_f32_16x16x32_bf16 a[136:139], a[232:235], v[88:91], a[136:139]
    ds_read_b128 v[124:127], v25 offset:38912
    v_mov_b32 v8, 1
    v_mfma_f32_16x16x32_bf16 a[140:143], a[232:235], v[92:95], a[140:143]
    s_waitcnt lgkmcnt(9)
    v_mov_b32 v9, 0
    v_mfma_f32_16x16x32_bf16 a[208:211], a[236:239], v[80:83], a[208:211]
    s_waitcnt vmcnt(8)
    ds_read_b64_tr_b16 a[252:253], v55 offset:45056
    v_mfma_f32_16x16x32_bf16 a[212:215], a[236:239], v[84:87], a[212:215]
    s_waitcnt lgkmcnt(8)
    ds_read_b64_tr_b16 a[254:255], v55 offset:45568
    v_mfma_f32_16x16x32_bf16 a[144:147], a[240:243], v[80:83], a[144:147]
    s_add_u32 s49, s3, 4
    ds_read_b64_tr_b16 a[224:225], v16 offset:0
    v_mfma_f32_16x16x32_bf16 a[148:151], a[240:243], v[84:87], a[148:151]
    s_and_b32 s49, s49, 7
    ds_read_b64_tr_b16 a[226:227], v16 offset:1024
    v_mfma_f32_16x16x32_bf16 a[152:155], a[240:243], v[88:91], a[152:155]
    s_lshl_b32 s48, s49, 19
    buffer_store_dword v8, v7, s[60:63], s88 offen sc1
    v_mfma_f32_16x16x32_bf16 a[156:159], a[240:243], v[92:95], a[156:159]
    s_waitcnt lgkmcnt(8)
    global_load_dword v45, v9, s[84:85] sc1
    v_mfma_f32_16x16x32_bf16 a[160:163], a[244:247], v[80:83], a[160:163]
    s_add_u32 m0, s41, 98304
    ds_read_b64_tr_b16 a[228:229], v16 offset:8
    v_accvgpr_write_b32 a88, 0
    v_mfma_f32_16x16x32_bf16 a[164:167], a[244:247], v[84:87], a[164:167]
    ds_read_b64_tr_b16 a[230:231], v16 offset:1032
    v_accvgpr_write_b32 a89, 0
    v_mfma_f32_16x16x32_bf16 a[168:171], a[244:247], v[88:91], a[168:171]
    buffer_load_dwordx4 v12, s[8:11], s48 offen lds
    v_mfma_f32_16x16x32_bf16 a[172:175], a[244:247], v[92:95], a[172:175]
    s_waitcnt lgkmcnt(7)
    v_accvgpr_write_b32 a90, 0
    v_accvgpr_write_b32 a91, 0
    v_mfma_f32_16x16x32_bf16 a[176:179], a[248:251], v[80:83], a[176:179]
    s_add_u32 s48, s48, 32768
    ds_read_b64_tr_b16 a[232:233], v17 offset:0
    v_accvgpr_write_b32 a92, 0
    v_mfma_f32_16x16x32_bf16 a[180:183], a[248:251], v[84:87], a[180:183]
    s_add_u32 m0, s41, 99328
    ds_read_b64_tr_b16 a[234:235], v17 offset:1024
    v_accvgpr_write_b32 a93, 0
    v_mfma_f32_16x16x32_bf16 a[184:187], a[248:251], v[88:91], a[184:187]
    buffer_load_dwordx4 v12, s[8:11], s48 offen lds
    v_mfma_f32_16x16x32_bf16 a[188:191], a[248:251], v[92:95], a[188:191]
    s_waitcnt lgkmcnt(6)
    v_accvgpr_write_b32 a94, 0
    v_accvgpr_write_b32 a95, 0
    v_mfma_f32_16x16x32_bf16 a[216:219], a[252:255], v[80:83], a[216:219]
    s_mul_i32 s48, s49, 176128
    ds_read_b64_tr_b16 a[236:237], v22 offset:8192
    v_accvgpr_write_b32 a96, 0
    v_mfma_f32_16x16x32_bf16 a[220:223], a[252:255], v[84:87], a[220:223]
    s_waitcnt lgkmcnt(5)
    ds_read_b64_tr_b16 a[238:239], v22 offset:8704
    v_accvgpr_write_b32 a97, 0
    v_mfma_f32_16x16x32_bf16 v[128:131], a[224:227], v[96:99], v[128:131]
    s_add_u32 m0, s40, 106496
    ds_read_b64_tr_b16 a[240:241], v17 offset:8
    v_accvgpr_write_b32 a98, 0
    v_mfma_f32_16x16x32_bf16 v[132:135], a[224:227], v[100:103], v[132:135]
    ds_read_b64_tr_b16 a[242:243], v17 offset:1032
    v_accvgpr_write_b32 a99, 0
    v_mfma_f32_16x16x32_bf16 v[136:139], a[224:227], v[104:107], v[136:139]
    buffer_load_dwordx4 v13, s[12:15], s48 offen lds
    v_mfma_f32_16x16x32_bf16 v[140:143], a[224:227], v[108:111], v[140:143]
    s_waitcnt lgkmcnt(6)
    v_accvgpr_write_b32 a100, 0
    v_accvgpr_write_b32 a101, 0
    v_mfma_f32_16x16x32_bf16 v[144:147], a[228:231], v[96:99], v[144:147]
    s_add_u32 m0, s40, 110592
    ds_read_b64_tr_b16 a[244:245], v18 offset:0
    v_accvgpr_write_b32 a102, 0
    v_mfma_f32_16x16x32_bf16 v[148:151], a[228:231], v[100:103], v[148:151]
    ds_read_b64_tr_b16 a[246:247], v18 offset:1024
    v_accvgpr_write_b32 a103, 0
    v_mfma_f32_16x16x32_bf16 v[152:155], a[228:231], v[104:107], v[152:155]
    buffer_load_dwordx4 v13, s[16:19], s48 offen lds
    v_mfma_f32_16x16x32_bf16 v[156:159], a[228:231], v[108:111], v[156:159]
    s_waitcnt lgkmcnt(6)
    v_accvgpr_write_b32 a104, 0
    v_accvgpr_write_b32 a105, 0
    v_mfma_f32_16x16x32_bf16 v[160:163], a[232:235], v[96:99], v[160:163]
    ds_read_b64_tr_b16 a[248:249], v18 offset:8
    v_accvgpr_write_b32 a106, 0
    v_mfma_f32_16x16x32_bf16 v[164:167], a[232:235], v[100:103], v[164:167]
    s_add_u32 s49, s3, 5
    ds_read_b64_tr_b16 a[250:251], v18 offset:1032
    v_accvgpr_write_b32 a107, 0
    v_mfma_f32_16x16x32_bf16 v[168:171], a[232:235], v[104:107], v[168:171]
    s_and_b32 s49, s49, 7
    v_accvgpr_write_b32 a108, 0
    v_accvgpr_write_b32 a109, 0
    v_mfma_f32_16x16x32_bf16 v[172:175], a[232:235], v[108:111], v[172:175]
    s_waitcnt lgkmcnt(6)
    v_accvgpr_write_b32 a110, 0
    v_accvgpr_write_b32 a111, 0
    v_mfma_f32_16x16x32_bf16 a[192:195], a[236:239], v[96:99], a[192:195]
    s_lshl_b32 s49, s49, 7
    ds_read_b64_tr_b16 a[252:253], v23 offset:8192
    v_accvgpr_write_b32 a112, 0
    v_mfma_f32_16x16x32_bf16 a[196:199], a[236:239], v[100:103], a[196:199]
    s_waitcnt lgkmcnt(5)
    ds_read_b64_tr_b16 a[254:255], v23 offset:8704
    v_accvgpr_write_b32 a113, 0
    v_mfma_f32_16x16x32_bf16 v[176:179], a[240:243], v[96:99], v[176:179]
    s_add_u32 s48, s44, s49
    ds_read_b64_tr_b16 a[224:225], v19 offset:0
    v_accvgpr_write_b32 a114, 0
    v_mfma_f32_16x16x32_bf16 v[180:183], a[240:243], v[100:103], v[180:183]
    s_add_u32 m0, s43, 32768
    ds_read_b64_tr_b16 a[226:227], v19 offset:1024
    v_accvgpr_write_b32 a115, 0
    v_mfma_f32_16x16x32_bf16 v[184:187], a[240:243], v[104:107], v[184:187]
    buffer_load_dwordx4 v10, s[4:7], s48 offen lds
    v_mfma_f32_16x16x32_bf16 v[188:191], a[240:243], v[108:111], v[188:191]
    s_waitcnt lgkmcnt(6)
    v_accvgpr_write_b32 a116, 0
    v_accvgpr_write_b32 a117, 0
    v_mfma_f32_16x16x32_bf16 v[192:195], a[244:247], v[96:99], v[192:195]
    s_add_u32 m0, s43, 33792
    ds_read_b64_tr_b16 a[228:229], v19 offset:8
    v_accvgpr_write_b32 a118, 0
    v_mfma_f32_16x16x32_bf16 v[196:199], a[244:247], v[100:103], v[196:199]
    ds_read_b64_tr_b16 a[230:231], v19 offset:1032
    v_accvgpr_write_b32 a119, 0
    v_mfma_f32_16x16x32_bf16 v[200:203], a[244:247], v[104:107], v[200:203]
    buffer_load_dwordx4 v11, s[4:7], s48 offen lds
    v_mfma_f32_16x16x32_bf16 v[204:207], a[244:247], v[108:111], v[204:207]
    s_waitcnt lgkmcnt(6)
    v_accvgpr_write_b32 a120, 0
    v_accvgpr_write_b32 a121, 0
    v_mfma_f32_16x16x32_bf16 v[208:211], a[248:251], v[96:99], v[208:211]
    s_add_u32 s48, s45, s49
    ds_read_b64_tr_b16 a[232:233], v20 offset:8192
    v_accvgpr_write_b32 a122, 0
    v_mfma_f32_16x16x32_bf16 v[212:215], a[248:251], v[100:103], v[212:215]
    s_add_u32 m0, s43, 34816
    ds_read_b64_tr_b16 a[234:235], v20 offset:8704
    v_accvgpr_write_b32 a123, 0
    v_mfma_f32_16x16x32_bf16 v[216:219], a[248:251], v[104:107], v[216:219]
    buffer_load_dwordx4 v10, s[4:7], s48 offen lds
    v_mfma_f32_16x16x32_bf16 v[220:223], a[248:251], v[108:111], v[220:223]
    s_waitcnt lgkmcnt(6)
    v_accvgpr_write_b32 a124, 0
    v_accvgpr_write_b32 a125, 0
    v_mfma_f32_16x16x32_bf16 a[200:203], a[252:255], v[96:99], a[200:203]
    s_add_u32 m0, s43, 35840
    ds_read_b64_tr_b16 a[236:237], v22 offset:12288
    v_accvgpr_write_b32 a126, 0
    v_mfma_f32_16x16x32_bf16 a[204:207], a[252:255], v[100:103], a[204:207]
    s_waitcnt lgkmcnt(5)
    ds_read_b64_tr_b16 a[238:239], v22 offset:12800
    v_accvgpr_write_b32 a127, 0
    v_mfma_f32_16x16x32_bf16 v[224:227], a[224:227], v[96:99], v[224:227]
    ds_read_b64_tr_b16 a[240:241], v21 offset:8192
    v_lshlrev_b32 v5, 12, v3
    v_mfma_f32_16x16x32_bf16 v[228:231], a[224:227], v[100:103], v[228:231]
    ds_read_b64_tr_b16 a[242:243], v21 offset:8704
    v_lshl_add_u32 v5, v4, 8, v5
    v_mfma_f32_16x16x32_bf16 v[232:235], a[224:227], v[104:107], v[232:235]
    buffer_load_dwordx4 v11, s[4:7], s48 offen lds
    v_mfma_f32_16x16x32_bf16 v[236:239], a[224:227], v[108:111], v[236:239]
    s_waitcnt lgkmcnt(6)
    v_add_u32 v5, 98304, v5
    v_xor_b32 v6, v1, v2
    v_mfma_f32_16x16x32_bf16 v[240:243], a[228:231], v[96:99], v[240:243]
    s_add_u32 s48, s46, s49
    ds_read_b64_tr_b16 a[244:245], v20 offset:12288
    v_xor_b32 v7, 0, v6
    v_mfma_f32_16x16x32_bf16 v[244:247], a[228:231], v[100:103], v[244:247]
    s_add_u32 m0, s43, 36864
    ds_read_b64_tr_b16 a[246:247], v20 offset:12800
    v_lshl_add_u32 v26, v7, 4, v5
    v_mfma_f32_16x16x32_bf16 v[248:251], a[228:231], v[104:107], v[248:251]
    buffer_load_dwordx4 v10, s[4:7], s48 offen lds
    v_mfma_f32_16x16x32_bf16 v[252:255], a[228:231], v[108:111], v[252:255]
    s_waitcnt lgkmcnt(6)
    v_xor_b32 v7, 4, v6
    v_lshl_add_u32 v27, v7, 4, v5
    v_mfma_f32_16x16x32_bf16 a[128:131], a[232:235], v[96:99], a[128:131]
    s_waitcnt vmcnt(11)
    ds_read_b64_tr_b16 a[248:249], v21 offset:12288
    v_xor_b32 v7, 8, v6
    v_mfma_f32_16x16x32_bf16 a[132:135], a[232:235], v[100:103], a[132:135]
    s_barrier
    ds_read_b64_tr_b16 a[250:251], v21 offset:12800
    v_lshl_add_u32 v28, v7, 4, v5
    v_mfma_f32_16x16x32_bf16 a[136:139], a[232:235], v[104:107], a[136:139]
    s_add_u32 m0, s43, 37888
    v_xor_b32 v7, 12, v6
    v_lshl_add_u32 v29, v7, 4, v5
    v_mfma_f32_16x16x32_bf16 a[140:143], a[232:235], v[108:111], a[140:143]
    s_waitcnt lgkmcnt(6)
    buffer_load_dwordx4 v11, s[4:7], s48 offen lds
    v_mfma_f32_16x16x32_bf16 a[208:211], a[236:239], v[96:99], a[208:211]
    s_add_u32 s48, s47, s49
    ds_read_b64_tr_b16 a[252:253], v23 offset:12288
    v_lshlrev_b32 v5, 12, v1
    v_mfma_f32_16x16x32_bf16 a[212:215], a[236:239], v[100:103], a[212:215]
    s_waitcnt lgkmcnt(5)
    ds_read_b64_tr_b16 a[254:255], v23 offset:12800
    v_lshl_add_u32 v5, v3, 8, v5
    v_mfma_f32_16x16x32_bf16 a[144:147], a[240:243], v[96:99], a[144:147]
    s_add_u32 m0, s43, 38912
    ds_read_b64_tr_b16 a[224:225], v16 offset:16384
    v_lshl_add_u32 v5, v4, 3, v5
    v_mfma_f32_16x16x32_bf16 a[148:151], a[240:243], v[100:103], a[148:151]
    ds_read_b64_tr_b16 a[226:227], v16 offset:17408
    v_add_u32 v5, 0, v5
    v_mfma_f32_16x16x32_bf16 a[152:155], a[240:243], v[104:107], a[152:155]
    buffer_load_dwordx4 v10, s[4:7], s48 offen lds
    v_mfma_f32_16x16x32_bf16 a[156:159], a[240:243], v[108:111], a[156:159]
    s_waitcnt lgkmcnt(6)
    v_and_b32 v6, 1, v1
    v_lshlrev_b32 v6, 2, v6
    v_mfma_f32_16x16x32_bf16 a[160:163], a[244:247], v[96:99], a[160:163]
    s_add_u32 m0, s43, 39936
    ds_read_b64_tr_b16 a[228:229], v16 offset:16392
    v_or_b32 v6, v6, v3
    v_mfma_f32_16x16x32_bf16 a[164:167], a[244:247], v[100:103], a[164:167]
    ds_read_b64_tr_b16 a[230:231], v16 offset:17416
    v_xor_b32 v7, 0, v6
    v_mfma_f32_16x16x32_bf16 a[168:171], a[244:247], v[104:107], a[168:171]
    buffer_load_dwordx4 v11, s[4:7], s48 offen lds
    v_mfma_f32_16x16x32_bf16 a[172:175], a[244:247], v[108:111], a[172:175]
    s_waitcnt lgkmcnt(6)
    v_lshl_add_u32 v30, v7, 5, v5
    v_xor_b32 v7, 1, v6
    v_mfma_f32_16x16x32_bf16 a[176:179], a[248:251], v[96:99], a[176:179]
    s_add_u32 s49, s3, 4
    ds_read_b64_tr_b16 a[232:233], v17 offset:16384
    v_lshl_add_u32 v31, v7, 5, v5
    v_mfma_f32_16x16x32_bf16 a[180:183], a[248:251], v[100:103], a[180:183]
    s_and_b32 s49, s49, 7
    ds_read_b64_tr_b16 a[234:235], v17 offset:17408
    v_xor_b32 v7, 2, v6
    v_mfma_f32_16x16x32_bf16 a[184:187], a[248:251], v[104:107], a[184:187]
    s_lshl_b32 s48, s49, 19
    v_lshl_add_u32 v32, v7, 5, v5
    v_xor_b32 v7, 3, v6
    v_mfma_f32_16x16x32_bf16 a[188:191], a[248:251], v[108:111], a[188:191]
    s_waitcnt lgkmcnt(6)
    v_lshl_add_u32 v33, v7, 5, v5
    v_xor_b32 v7, 4, v6
    v_mfma_f32_16x16x32_bf16 a[216:219], a[252:255], v[96:99], a[216:219]
    s_add_u32 s48, s48, 262144
    ds_read_b64_tr_b16 a[236:237], v22 offset:24576
    v_lshl_add_u32 v34, v7, 5, v5
    v_mfma_f32_16x16x32_bf16 a[220:223], a[252:255], v[100:103], a[220:223]
    s_waitcnt lgkmcnt(5)
    ds_read_b64_tr_b16 a[238:239], v22 offset:25088
    v_xor_b32 v7, 5, v6
    v_mfma_f32_16x16x32_bf16 v[128:131], a[224:227], v[112:115], v[128:131]
    s_add_u32 m0, s41, 114688
    ds_read_b64_tr_b16 a[240:241], v17 offset:16392
    v_lshl_add_u32 v35, v7, 5, v5
    v_mfma_f32_16x16x32_bf16 v[132:135], a[224:227], v[116:119], v[132:135]
    ds_read_b64_tr_b16 a[242:243], v17 offset:17416
    v_xor_b32 v7, 6, v6
    v_mfma_f32_16x16x32_bf16 v[136:139], a[224:227], v[120:123], v[136:139]
    buffer_load_dwordx4 v12, s[8:11], s48 offen lds
    v_mfma_f32_16x16x32_bf16 v[140:143], a[224:227], v[124:127], v[140:143]
    s_waitcnt lgkmcnt(6)
    v_lshl_add_u32 v36, v7, 5, v5
    v_xor_b32 v7, 7, v6
    v_mfma_f32_16x16x32_bf16 v[144:147], a[228:231], v[112:115], v[144:147]
    ds_read_b64_tr_b16 a[244:245], v18 offset:16384
    v_lshl_add_u32 v37, v7, 5, v5
    v_mfma_f32_16x16x32_bf16 v[148:151], a[228:231], v[116:119], v[148:151]
    s_add_u32 s48, s48, 32768
    ds_read_b64_tr_b16 a[246:247], v18 offset:17408
    v_lshlrev_b32 v8, 4, v2
    v_mfma_f32_16x16x32_bf16 v[152:155], a[228:231], v[120:123], v[152:155]
    s_add_u32 m0, s41, 115712
    ds_read_b128 v[64:67], v24 offset:0
    v_add_u32 v8, s53, v8
    v_mfma_f32_16x16x32_bf16 v[156:159], a[228:231], v[124:127], v[156:159]
    s_waitcnt lgkmcnt(7)
    buffer_load_dwordx4 v12, s[8:11], s48 offen lds
    v_mfma_f32_16x16x32_bf16 v[160:163], a[232:235], v[112:115], v[160:163]
    s_mul_i32 s48, s49, 176128
    ds_read_b64_tr_b16 a[248:249], v18 offset:16392
    v_lshlrev_b32 v9, 4, v1
    v_mfma_f32_16x16x32_bf16 v[164:167], a[232:235], v[116:119], v[164:167]
    s_add_u32 s48, s48, 88064
    ds_read_b64_tr_b16 a[250:251], v18 offset:17416
    v_add_u32 v9, 16384, v9
    v_mfma_f32_16x16x32_bf16 v[168:171], a[232:235], v[120:123], v[168:171]
    s_add_u32 m0, s40, 122880
    ds_read_b128 v[68:71], v24 offset:2048
    v_mfma_f32_16x16x32_bf16 v[172:175], a[232:235], v[124:127], v[172:175]
    s_waitcnt lgkmcnt(8)
    buffer_load_dwordx4 v13, s[12:15], s48 offen lds
    v_mfma_f32_16x16x32_bf16 a[192:195], a[236:239], v[112:115], a[192:195]
    s_add_u32 m0, s40, 126976
    ds_read_b64_tr_b16 a[252:253], v23 offset:24576
    v_mfma_f32_16x16x32_bf16 a[196:199], a[236:239], v[116:119], a[196:199]
    s_waitcnt lgkmcnt(7)
    ds_read_b64_tr_b16 a[254:255], v23 offset:25088
    v_mfma_f32_16x16x32_bf16 v[176:179], a[240:243], v[112:115], v[176:179]
    ds_read_b64_tr_b16 a[224:225], v19 offset:16384
    v_mfma_f32_16x16x32_bf16 v[180:183], a[240:243], v[116:119], v[180:183]
    ds_read_b64_tr_b16 a[226:227], v19 offset:17408
    v_mfma_f32_16x16x32_bf16 v[184:187], a[240:243], v[120:123], v[184:187]
    ds_read_b128 v[72:75], v24 offset:4096
    v_mfma_f32_16x16x32_bf16 v[188:191], a[240:243], v[124:127], v[188:191]
    s_waitcnt lgkmcnt(9)
    buffer_load_dwordx4 v13, s[16:19], s48 offen lds
    v_mfma_f32_16x16x32_bf16 v[192:195], a[244:247], v[112:115], v[192:195]
    ds_read_b64_tr_b16 a[228:229], v19 offset:16392
    v_mfma_f32_16x16x32_bf16 v[196:199], a[244:247], v[116:119], v[196:199]
    ds_read_b64_tr_b16 a[230:231], v19 offset:17416
    v_mfma_f32_16x16x32_bf16 v[200:203], a[244:247], v[120:123], v[200:203]
    ds_read_b128 v[76:79], v24 offset:6144
    v_mfma_f32_16x16x32_bf16 v[204:207], a[244:247], v[124:127], v[204:207]
    s_waitcnt lgkmcnt(9)
    v_mfma_f32_16x16x32_bf16 v[208:211], a[248:251], v[112:115], v[208:211]
    ds_read_b64_tr_b16 a[232:233], v20 offset:24576
    v_mfma_f32_16x16x32_bf16 v[212:215], a[248:251], v[116:119], v[212:215]
    ds_read_b64_tr_b16 a[234:235], v20 offset:25088
    v_mfma_f32_16x16x32_bf16 v[216:219], a[248:251], v[120:123], v[216:219]
    ds_read_b128 v[80:83], v25 offset:0
    v_mfma_f32_16x16x32_bf16 v[220:223], a[248:251], v[124:127], v[220:223]
    s_waitcnt lgkmcnt(9)
    v_mfma_f32_16x16x32_bf16 a[200:203], a[252:255], v[112:115], a[200:203]
    ds_read_b64_tr_b16 a[236:237], v22 offset:28672
    v_mfma_f32_16x16x32_bf16 a[204:207], a[252:255], v[116:119], a[204:207]
    s_waitcnt lgkmcnt(8)
    ds_read_b64_tr_b16 a[238:239], v22 offset:29184
    v_mfma_f32_16x16x32_bf16 v[224:227], a[224:227], v[112:115], v[224:227]
    ds_read_b64_tr_b16 a[240:241], v21 offset:24576
    v_mfma_f32_16x16x32_bf16 v[228:231], a[224:227], v[116:119], v[228:231]
    ds_read_b64_tr_b16 a[242:243], v21 offset:25088
    v_mfma_f32_16x16x32_bf16 v[232:235], a[224:227], v[120:123], v[232:235]
    ds_read_b128 v[84:87], v25 offset:2048
    v_mfma_f32_16x16x32_bf16 v[236:239], a[224:227], v[124:127], v[236:239]
    s_waitcnt lgkmcnt(9)
    v_mfma_f32_16x16x32_bf16 v[240:243], a[228:231], v[112:115], v[240:243]
    ds_read_b64_tr_b16 a[244:245], v20 offset:28672
    v_mfma_f32_16x16x32_bf16 v[244:247], a[228:231], v[116:119], v[244:247]
    ds_read_b64_tr_b16 a[246:247], v20 offset:29184
    v_mfma_f32_16x16x32_bf16 v[248:251], a[228:231], v[120:123], v[248:251]
    ds_read_b128 v[88:91], v25 offset:4096
    v_mfma_f32_16x16x32_bf16 v[252:255], a[228:231], v[124:127], v[252:255]
    s_waitcnt lgkmcnt(9)
    v_mfma_f32_16x16x32_bf16 a[128:131], a[232:235], v[112:115], a[128:131]
    s_waitcnt vmcnt(12)
    ds_read_b64_tr_b16 a[248:249], v21 offset:28672
    v_mfma_f32_16x16x32_bf16 a[132:135], a[232:235], v[116:119], a[132:135]
    s_barrier
    ds_read_b64_tr_b16 a[250:251], v21 offset:29184
    v_mfma_f32_16x16x32_bf16 a[136:139], a[232:235], v[120:123], a[136:139]
    ds_read_b128 v[92:95], v25 offset:6144
    v_mfma_f32_16x16x32_bf16 a[140:143], a[232:235], v[124:127], a[140:143]
    s_waitcnt lgkmcnt(9)
    v_mfma_f32_16x16x32_bf16 a[208:211], a[236:239], v[112:115], a[208:211]
    ds_read_b64_tr_b16 a[252:253], v23 offset:28672
    v_mfma_f32_16x16x32_bf16 a[212:215], a[236:239], v[116:119], a[212:215]
    s_waitcnt lgkmcnt(8)
    ds_read_b64_tr_b16 a[254:255], v23 offset:29184
    v_mfma_f32_16x16x32_bf16 a[144:147], a[240:243], v[112:115], a[144:147]
    s_add_u32 s49, s3, 5
    ds_read_b64_tr_b16 a[224:225], v16 offset:32768
    v_mfma_f32_16x16x32_bf16 a[148:151], a[240:243], v[116:119], a[148:151]
    s_and_b32 s49, s49, 7
    ds_read_b64_tr_b16 a[226:227], v16 offset:33792
    v_mfma_f32_16x16x32_bf16 a[152:155], a[240:243], v[120:123], a[152:155]
    s_lshl_b32 s48, s49, 19
    v_mfma_f32_16x16x32_bf16 a[156:159], a[240:243], v[124:127], a[156:159]
    s_waitcnt lgkmcnt(8)
    v_mfma_f32_16x16x32_bf16 a[160:163], a[244:247], v[112:115], a[160:163]
    s_add_u32 m0, s41, 131072
    ds_read_b64_tr_b16 a[228:229], v16 offset:32776
    v_mfma_f32_16x16x32_bf16 a[164:167], a[244:247], v[116:119], a[164:167]
    ds_read_b64_tr_b16 a[230:231], v16 offset:33800
    v_mfma_f32_16x16x32_bf16 a[168:171], a[244:247], v[120:123], a[168:171]
    buffer_load_dwordx4 v12, s[8:11], s48 offen lds
    v_mfma_f32_16x16x32_bf16 a[172:175], a[244:247], v[124:127], a[172:175]
    s_waitcnt lgkmcnt(7)
    buffer_load_dword v46, v62, s[60:63], 0 offen sc1
    v_mfma_f32_16x16x32_bf16 a[176:179], a[248:251], v[112:115], a[176:179]
    s_add_u32 s48, s48, 32768
    ds_read_b64_tr_b16 a[232:233], v17 offset:32768
    v_mfma_f32_16x16x32_bf16 a[180:183], a[248:251], v[116:119], a[180:183]
    s_add_u32 m0, s41, 132096
    ds_read_b64_tr_b16 a[234:235], v17 offset:33792
    v_mfma_f32_16x16x32_bf16 a[184:187], a[248:251], v[120:123], a[184:187]
    buffer_load_dwordx4 v12, s[8:11], s48 offen lds
    v_mfma_f32_16x16x32_bf16 a[188:191], a[248:251], v[124:127], a[188:191]
    s_waitcnt lgkmcnt(6)
    v_mfma_f32_16x16x32_bf16 a[216:219], a[252:255], v[112:115], a[216:219]
    s_mul_i32 s48, s49, 176128
    ds_read_b64_tr_b16 a[236:237], v22 offset:40960
    v_mfma_f32_16x16x32_bf16 a[220:223], a[252:255], v[116:119], a[220:223]
    s_waitcnt lgkmcnt(5)
    ds_read_b64_tr_b16 a[238:239], v22 offset:41472
    v_mfma_f32_16x16x32_bf16 v[128:131], a[224:227], v[64:67], v[128:131]
    s_add_u32 m0, s40, 139264
    ds_read_b64_tr_b16 a[240:241], v17 offset:32776
    v_mfma_f32_16x16x32_bf16 v[132:135], a[224:227], v[68:71], v[132:135]
    ds_read_b64_tr_b16 a[242:243], v17 offset:33800
    v_mfma_f32_16x16x32_bf16 v[136:139], a[224:227], v[72:75], v[136:139]
    buffer_load_dwordx4 v13, s[12:15], s48 offen lds
    v_mfma_f32_16x16x32_bf16 v[140:143], a[224:227], v[76:79], v[140:143]
    s_waitcnt lgkmcnt(6)
    v_mfma_f32_16x16x32_bf16 v[144:147], a[228:231], v[64:67], v[144:147]
    s_add_u32 m0, s40, 143360
    ds_read_b64_tr_b16 a[244:245], v18 offset:32768
    v_mfma_f32_16x16x32_bf16 v[148:151], a[228:231], v[68:71], v[148:151]
    ds_read_b64_tr_b16 a[246:247], v18 offset:33792
    v_mfma_f32_16x16x32_bf16 v[152:155], a[228:231], v[72:75], v[152:155]
    buffer_load_dwordx4 v13, s[16:19], s48 offen lds
    v_mfma_f32_16x16x32_bf16 v[156:159], a[228:231], v[76:79], v[156:159]
    s_waitcnt lgkmcnt(6)
    v_mfma_f32_16x16x32_bf16 v[160:163], a[232:235], v[64:67], v[160:163]
    ds_read_b64_tr_b16 a[248:249], v18 offset:32776
    v_mfma_f32_16x16x32_bf16 v[164:167], a[232:235], v[68:71], v[164:167]
    s_add_u32 s49, s3, 6
    ds_read_b64_tr_b16 a[250:251], v18 offset:33800
    v_mfma_f32_16x16x32_bf16 v[168:171], a[232:235], v[72:75], v[168:171]
    s_and_b32 s49, s49, 7
    v_mfma_f32_16x16x32_bf16 v[172:175], a[232:235], v[76:79], v[172:175]
    s_waitcnt lgkmcnt(6)
    v_mfma_f32_16x16x32_bf16 a[192:195], a[236:239], v[64:67], a[192:195]
    s_lshl_b32 s49, s49, 7
    ds_read_b64_tr_b16 a[252:253], v23 offset:40960
    v_mfma_f32_16x16x32_bf16 a[196:199], a[236:239], v[68:71], a[196:199]
    s_waitcnt lgkmcnt(5)
    ds_read_b64_tr_b16 a[254:255], v23 offset:41472
    v_mfma_f32_16x16x32_bf16 v[176:179], a[240:243], v[64:67], v[176:179]
    s_add_u32 s48, s44, s49
    ds_read_b64_tr_b16 a[224:225], v19 offset:32768
    v_mfma_f32_16x16x32_bf16 v[180:183], a[240:243], v[68:71], v[180:183]
    s_add_u32 m0, s43, 0
    ds_read_b64_tr_b16 a[226:227], v19 offset:33792
    v_mfma_f32_16x16x32_bf16 v[184:187], a[240:243], v[72:75], v[184:187]
    buffer_load_dwordx4 v10, s[4:7], s48 offen lds
    v_mfma_f32_16x16x32_bf16 v[188:191], a[240:243], v[76:79], v[188:191]
    s_waitcnt lgkmcnt(6)
    v_mfma_f32_16x16x32_bf16 v[192:195], a[244:247], v[64:67], v[192:195]
    s_add_u32 m0, s43, 1024
    ds_read_b64_tr_b16 a[228:229], v19 offset:32776
    v_mfma_f32_16x16x32_bf16 v[196:199], a[244:247], v[68:71], v[196:199]
    ds_read_b64_tr_b16 a[230:231], v19 offset:33800
    v_mfma_f32_16x16x32_bf16 v[200:203], a[244:247], v[72:75], v[200:203]
    buffer_load_dwordx4 v11, s[4:7], s48 offen lds
    v_mfma_f32_16x16x32_bf16 v[204:207], a[244:247], v[76:79], v[204:207]
    s_waitcnt lgkmcnt(6)
    v_mfma_f32_16x16x32_bf16 v[208:211], a[248:251], v[64:67], v[208:211]
    s_add_u32 s48, s45, s49
    ds_read_b64_tr_b16 a[232:233], v20 offset:40960
    v_mfma_f32_16x16x32_bf16 v[212:215], a[248:251], v[68:71], v[212:215]
    s_add_u32 m0, s43, 2048
    ds_read_b64_tr_b16 a[234:235], v20 offset:41472
    v_mfma_f32_16x16x32_bf16 v[216:219], a[248:251], v[72:75], v[216:219]
    buffer_load_dwordx4 v10, s[4:7], s48 offen lds
    v_mfma_f32_16x16x32_bf16 v[220:223], a[248:251], v[76:79], v[220:223]
    s_waitcnt lgkmcnt(6)
    v_mfma_f32_16x16x32_bf16 a[200:203], a[252:255], v[64:67], a[200:203]
    s_add_u32 m0, s43, 3072
    ds_read_b64_tr_b16 a[236:237], v22 offset:45056
    v_mfma_f32_16x16x32_bf16 a[204:207], a[252:255], v[68:71], a[204:207]
    s_waitcnt lgkmcnt(5)
    ds_read_b64_tr_b16 a[238:239], v22 offset:45568
    v_mfma_f32_16x16x32_bf16 v[224:227], a[224:227], v[64:67], v[224:227]
    ds_read_b64_tr_b16 a[240:241], v21 offset:40960
    v_mfma_f32_16x16x32_bf16 v[228:231], a[224:227], v[68:71], v[228:231]
    ds_read_b64_tr_b16 a[242:243], v21 offset:41472
    v_mfma_f32_16x16x32_bf16 v[232:235], a[224:227], v[72:75], v[232:235]
    buffer_load_dwordx4 v11, s[4:7], s48 offen lds
    v_mfma_f32_16x16x32_bf16 v[236:239], a[224:227], v[76:79], v[236:239]
    s_waitcnt lgkmcnt(6)
    v_mfma_f32_16x16x32_bf16 v[240:243], a[228:231], v[64:67], v[240:243]
    s_add_u32 s48, s46, s49
    ds_read_b64_tr_b16 a[244:245], v20 offset:45056
    v_mfma_f32_16x16x32_bf16 v[244:247], a[228:231], v[68:71], v[244:247]
    s_add_u32 m0, s43, 4096
    ds_read_b64_tr_b16 a[246:247], v20 offset:45568
    v_mfma_f32_16x16x32_bf16 v[248:251], a[228:231], v[72:75], v[248:251]
    buffer_load_dwordx4 v10, s[4:7], s48 offen lds
    v_mfma_f32_16x16x32_bf16 v[252:255], a[228:231], v[76:79], v[252:255]
    s_waitcnt lgkmcnt(6)
    v_mfma_f32_16x16x32_bf16 a[128:131], a[232:235], v[64:67], a[128:131]
    s_waitcnt vmcnt(10)
    ds_read_b64_tr_b16 a[248:249], v21 offset:45056
    v_mfma_f32_16x16x32_bf16 a[132:135], a[232:235], v[68:71], a[132:135]
    s_barrier
    ds_read_b64_tr_b16 a[250:251], v21 offset:45568
    v_mfma_f32_16x16x32_bf16 a[136:139], a[232:235], v[72:75], a[136:139]
    s_add_u32 m0, s43, 5120
    v_mfma_f32_16x16x32_bf16 a[140:143], a[232:235], v[76:79], a[140:143]
    s_waitcnt lgkmcnt(6)
    buffer_load_dwordx4 v11, s[4:7], s48 offen lds
    v_mfma_f32_16x16x32_bf16 a[208:211], a[236:239], v[64:67], a[208:211]
    s_add_u32 s48, s47, s49
    ds_read_b64_tr_b16 a[252:253], v23 offset:45056
    v_mfma_f32_16x16x32_bf16 a[212:215], a[236:239], v[68:71], a[212:215]
    s_waitcnt lgkmcnt(5)
    ds_read_b64_tr_b16 a[254:255], v23 offset:45568
    v_mfma_f32_16x16x32_bf16 a[144:147], a[240:243], v[64:67], a[144:147]
    s_add_u32 m0, s43, 6144
    ds_read_b64_tr_b16 a[224:225], v48 offset:0
    v_mfma_f32_16x16x32_bf16 a[148:151], a[240:243], v[68:71], a[148:151]
    ds_read_b64_tr_b16 a[226:227], v48 offset:1024
    v_mfma_f32_16x16x32_bf16 a[152:155], a[240:243], v[72:75], a[152:155]
    buffer_load_dwordx4 v10, s[4:7], s48 offen lds
    v_mfma_f32_16x16x32_bf16 a[156:159], a[240:243], v[76:79], a[156:159]
    s_waitcnt lgkmcnt(6)
    v_mfma_f32_16x16x32_bf16 a[160:163], a[244:247], v[64:67], a[160:163]
    s_add_u32 m0, s43, 7168
    ds_read_b64_tr_b16 a[228:229], v48 offset:8
    v_mfma_f32_16x16x32_bf16 a[164:167], a[244:247], v[68:71], a[164:167]
    ds_read_b64_tr_b16 a[230:231], v48 offset:1032
    v_mfma_f32_16x16x32_bf16 a[168:171], a[244:247], v[72:75], a[168:171]
    buffer_load_dwordx4 v11, s[4:7], s48 offen lds
    v_mfma_f32_16x16x32_bf16 a[172:175], a[244:247], v[76:79], a[172:175]
    s_waitcnt lgkmcnt(6)
    v_mfma_f32_16x16x32_bf16 a[176:179], a[248:251], v[64:67], a[176:179]
    s_add_u32 s49, s3, 5
    ds_read_b64_tr_b16 a[232:233], v49 offset:0
    v_mfma_f32_16x16x32_bf16 a[180:183], a[248:251], v[68:71], a[180:183]
    s_and_b32 s49, s49, 7
    ds_read_b64_tr_b16 a[234:235], v49 offset:1024
    v_mfma_f32_16x16x32_bf16 a[184:187], a[248:251], v[72:75], a[184:187]
    s_lshl_b32 s48, s49, 19
    v_mfma_f32_16x16x32_bf16 a[188:191], a[248:251], v[76:79], a[188:191]
    s_waitcnt lgkmcnt(6)
    v_mfma_f32_16x16x32_bf16 a[216:219], a[252:255], v[64:67], a[216:219]
    s_add_u32 s48, s48, 262144
    ds_read_b64_tr_b16 a[236:237], v54 offset:8192
    v_mfma_f32_16x16x32_bf16 a[220:223], a[252:255], v[68:71], a[220:223]
    s_waitcnt lgkmcnt(5)
    ds_read_b64_tr_b16 a[238:239], v54 offset:8704
    v_mfma_f32_16x16x32_bf16 v[128:131], a[224:227], v[80:83], v[128:131]
    s_add_u32 m0, s41, 147456
    ds_read_b64_tr_b16 a[240:241], v49 offset:8
    v_mfma_f32_16x16x32_bf16 v[132:135], a[224:227], v[84:87], v[132:135]
    ds_read_b64_tr_b16 a[242:243], v49 offset:1032
    v_mfma_f32_16x16x32_bf16 v[136:139], a[224:227], v[88:91], v[136:139]
    buffer_load_dwordx4 v12, s[8:11], s48 offen lds
    v_mfma_f32_16x16x32_bf16 v[140:143], a[224:227], v[92:95], v[140:143]
    s_waitcnt lgkmcnt(6)
    v_mfma_f32_16x16x32_bf16 v[144:147], a[228:231], v[80:83], v[144:147]
    ds_read_b64_tr_b16 a[244:245], v50 offset:0
    v_mfma_f32_16x16x32_bf16 v[148:151], a[228:231], v[84:87], v[148:151]
    s_add_u32 s48, s48, 32768
    ds_read_b64_tr_b16 a[246:247], v50 offset:1024
    v_mfma_f32_16x16x32_bf16 v[152:155], a[228:231], v[88:91], v[152:155]
    s_add_u32 m0, s41, 148480
    ds_read_b128 v[96:99], v24 offset:32768
    v_mfma_f32_16x16x32_bf16 v[156:159], a[228:231], v[92:95], v[156:159]
    s_waitcnt lgkmcnt(7)
    buffer_load_dwordx4 v12, s[8:11], s48 offen lds
    v_mfma_f32_16x16x32_bf16 v[160:163], a[232:235], v[80:83], v[160:163]
    s_mul_i32 s48, s49, 176128
    ds_read_b64_tr_b16 a[248:249], v50 offset:8
    v_mfma_f32_16x16x32_bf16 v[164:167], a[232:235], v[84:87], v[164:167]
    s_add_u32 s48, s48, 88064
    ds_read_b64_tr_b16 a[250:251], v50 offset:1032
    v_mfma_f32_16x16x32_bf16 v[168:171], a[232:235], v[88:91], v[168:171]
    s_add_u32 m0, s40, 155648
    ds_read_b128 v[100:103], v24 offset:34816
    v_mfma_f32_16x16x32_bf16 v[172:175], a[232:235], v[92:95], v[172:175]
    s_waitcnt lgkmcnt(8)
    buffer_load_dwordx4 v13, s[12:15], s48 offen lds
    v_mfma_f32_16x16x32_bf16 a[192:195], a[236:239], v[80:83], a[192:195]
    s_add_u32 m0, s40, 159744
    ds_read_b64_tr_b16 a[252:253], v55 offset:8192
    v_mfma_f32_16x16x32_bf16 a[196:199], a[236:239], v[84:87], a[196:199]
    s_waitcnt lgkmcnt(7)
    ds_read_b64_tr_b16 a[254:255], v55 offset:8704
    v_mfma_f32_16x16x32_bf16 v[176:179], a[240:243], v[80:83], v[176:179]
    ds_read_b64_tr_b16 a[224:225], v51 offset:0
    v_mfma_f32_16x16x32_bf16 v[180:183], a[240:243], v[84:87], v[180:183]
    ds_read_b64_tr_b16 a[226:227], v51 offset:1024
    v_mfma_f32_16x16x32_bf16 v[184:187], a[240:243], v[88:91], v[184:187]
    ds_read_b128 v[104:107], v24 offset:36864
    v_mfma_f32_16x16x32_bf16 v[188:191], a[240:243], v[92:95], v[188:191]
    s_waitcnt lgkmcnt(9)
    buffer_load_dwordx4 v13, s[16:19], s48 offen lds
    v_mfma_f32_16x16x32_bf16 v[192:195], a[244:247], v[80:83], v[192:195]
    ds_read_b64_tr_b16 a[228:229], v51 offset:8
    v_mfma_f32_16x16x32_bf16 v[196:199], a[244:247], v[84:87], v[196:199]
    ds_read_b64_tr_b16 a[230:231], v51 offset:1032
    v_mfma_f32_16x16x32_bf16 v[200:203], a[244:247], v[88:91], v[200:203]
    ds_read_b128 v[108:111], v24 offset:38912
    v_mfma_f32_16x16x32_bf16 v[204:207], a[244:247], v[92:95], v[204:207]
    s_waitcnt lgkmcnt(9)
    v_mfma_f32_16x16x32_bf16 v[208:211], a[248:251], v[80:83], v[208:211]
    ds_read_b64_tr_b16 a[232:233], v52 offset:8192
    s_waitcnt vmcnt(15)
    v_cmp_gt_u32 vcc, 0x100, v45
    s_mov_b64 s[90:91], vcc
    v_cmp_eq_u32 vcc, 0, v46
    s_or_b64 vcc, vcc, s[90:91]
    s_cbranch_vccnz L_ew
L_er:
    v_mfma_f32_16x16x32_bf16 v[212:215], a[248:251], v[84:87], v[212:215]
    s_lshl_b32 s50, s54, 10
    ds_read_b64_tr_b16 a[234:235], v52 offset:8704
    v_mfma_f32_16x16x32_bf16 v[216:219], a[248:251], v[88:91], v[216:219]
    s_add_u32 s50, s50, s51
    ds_read_b128 v[112:115], v25 offset:32768
    v_mfma_f32_16x16x32_bf16 v[220:223], a[248:251], v[92:95], v[220:223]
    s_waitcnt lgkmcnt(9)
    buffer_load_dwordx4 a[64:67], v63, s[28:31], s50 offen sc1
    v_mfma_f32_16x16x32_bf16 a[200:203], a[252:255], v[80:83], a[200:203]
    s_lshl_b32 s50, s55, 10
    ds_read_b64_tr_b16 a[236:237], v54 offset:12288
    v_mfma_f32_16x16x32_bf16 a[204:207], a[252:255], v[84:87], a[204:207]
    s_waitcnt lgkmcnt(8)
    ds_read_b64_tr_b16 a[238:239], v54 offset:12800
    v_mfma_f32_16x16x32_bf16 v[224:227], a[224:227], v[80:83], v[224:227]
    s_add_u32 s50, s50, s51
    ds_read_b64_tr_b16 a[240:241], v53 offset:8192
    v_mfma_f32_16x16x32_bf16 v[228:231], a[224:227], v[84:87], v[228:231]
    ds_read_b64_tr_b16 a[242:243], v53 offset:8704
    v_mfma_f32_16x16x32_bf16 v[232:235], a[224:227], v[88:91], v[232:235]
    ds_read_b128 v[116:119], v25 offset:34816
    v_mfma_f32_16x16x32_bf16 v[236:239], a[224:227], v[92:95], v[236:239]
    s_waitcnt lgkmcnt(9)
    buffer_load_dwordx4 a[68:71], v63, s[28:31], s50 offen sc1
    v_mfma_f32_16x16x32_bf16 v[240:243], a[228:231], v[80:83], v[240:243]
    s_lshl_b32 s50, s56, 10
    ds_read_b64_tr_b16 a[244:245], v52 offset:12288
    v_mfma_f32_16x16x32_bf16 v[244:247], a[228:231], v[84:87], v[244:247]
    s_add_u32 s50, s50, s51
    ds_read_b64_tr_b16 a[246:247], v52 offset:12800
    v_mfma_f32_16x16x32_bf16 v[248:251], a[228:231], v[88:91], v[248:251]
    ds_read_b128 v[120:123], v25 offset:36864
    v_mfma_f32_16x16x32_bf16 v[252:255], a[228:231], v[92:95], v[252:255]
    s_waitcnt lgkmcnt(9)
    buffer_load_dwordx4 a[72:75], v63, s[28:31], s50 offen sc1
    v_mfma_f32_16x16x32_bf16 a[128:131], a[232:235], v[80:83], a[128:131]
    s_waitcnt vmcnt(15)
    ds_read_b64_tr_b16 a[248:249], v53 offset:12288
    v_mfma_f32_16x16x32_bf16 a[132:135], a[232:235], v[84:87], a[132:135]
    s_barrier
    ds_read_b64_tr_b16 a[250:251], v53 offset:12800
    v_mfma_f32_16x16x32_bf16 a[136:139], a[232:235], v[88:91], a[136:139]
    s_lshl_b32 s50, s57, 10
    ds_read_b128 v[124:127], v25 offset:38912
    v_mfma_f32_16x16x32_bf16 a[140:143], a[232:235], v[92:95], a[140:143]
    s_waitcnt lgkmcnt(9)
    v_mfma_f32_16x16x32_bf16 a[208:211], a[236:239], v[80:83], a[208:211]
    s_add_u32 s50, s50, s51
    ds_read_b64_tr_b16 a[252:253], v55 offset:12288
    v_mfma_f32_16x16x32_bf16 a[212:215], a[236:239], v[84:87], a[212:215]
    s_waitcnt lgkmcnt(8)
    ds_read_b64_tr_b16 a[254:255], v55 offset:12800
    v_mfma_f32_16x16x32_bf16 a[144:147], a[240:243], v[80:83], a[144:147]
    s_add_u32 s49, s3, 6
    ds_read_b64_tr_b16 a[224:225], v48 offset:16384
    v_mfma_f32_16x16x32_bf16 a[148:151], a[240:243], v[84:87], a[148:151]
    s_and_b32 s49, s49, 7
    ds_read_b64_tr_b16 a[226:227], v48 offset:17408
    v_mfma_f32_16x16x32_bf16 a[152:155], a[240:243], v[88:91], a[152:155]
    s_lshl_b32 s48, s49, 19
    buffer_load_dwordx4 a[76:79], v63, s[28:31], s50 offen sc1
    v_mfma_f32_16x16x32_bf16 a[156:159], a[240:243], v[92:95], a[156:159]
    s_waitcnt lgkmcnt(8)
    buffer_load_dwordx4 a[80:83], v44, s[28:31], s52 offen sc1
    v_mfma_f32_16x16x32_bf16 a[160:163], a[244:247], v[80:83], a[160:163]
    s_add_u32 m0, s41, 65536
    ds_read_b64_tr_b16 a[228:229], v48 offset:16392
    v_mfma_f32_16x16x32_bf16 a[164:167], a[244:247], v[84:87], a[164:167]
    s_add_u32 s52, s52, 4096
    ds_read_b64_tr_b16 a[230:231], v48 offset:17416
    v_mfma_f32_16x16x32_bf16 a[168:171], a[244:247], v[88:91], a[168:171]
    buffer_load_dwordx4 v12, s[8:11], s48 offen lds
    v_mfma_f32_16x16x32_bf16 a[172:175], a[244:247], v[92:95], a[172:175]
    s_waitcnt lgkmcnt(7)
    buffer_load_dwordx4 a[84:87], v44, s[28:31], s52 offen sc1
    v_mfma_f32_16x16x32_bf16 a[176:179], a[248:251], v[80:83], a[176:179]
    s_add_u32 s48, s48, 32768
    ds_read_b64_tr_b16 a[232:233], v49 offset:16384
    v_mfma_f32_16x16x32_bf16 a[180:183], a[248:251], v[84:87], a[180:183]
    s_add_u32 m0, s41, 66560
    ds_read_b64_tr_b16 a[234:235], v49 offset:17408
    v_mfma_f32_16x16x32_bf16 a[184:187], a[248:251], v[88:91], a[184:187]
    buffer_load_dwordx4 v12, s[8:11], s48 offen lds
    v_mfma_f32_16x16x32_bf16 a[188:191], a[248:251], v[92:95], a[188:191]
    s_waitcnt lgkmcnt(6)
    v_mfma_f32_16x16x32_bf16 a[216:219], a[252:255], v[80:83], a[216:219]
    s_mul_i32 s48, s49, 176128
    ds_read_b64_tr_b16 a[236:237], v54 offset:24576
    v_mfma_f32_16x16x32_bf16 a[220:223], a[252:255], v[84:87], a[220:223]
    s_waitcnt lgkmcnt(5)
    ds_read_b64_tr_b16 a[238:239], v54 offset:25088
    v_mfma_f32_16x16x32_bf16 v[128:131], a[224:227], v[96:99], v[128:131]
    s_add_u32 m0, s40, 73728
    ds_read_b64_tr_b16 a[240:241], v49 offset:16392
    v_mfma_f32_16x16x32_bf16 v[132:135], a[224:227], v[100:103], v[132:135]
    ds_read_b64_tr_b16 a[242:243], v49 offset:17416
    v_mfma_f32_16x16x32_bf16 v[136:139], a[224:227], v[104:107], v[136:139]
    buffer_load_dwordx4 v13, s[12:15], s48 offen lds
    v_mfma_f32_16x16x32_bf16 v[140:143], a[224:227], v[108:111], v[140:143]
    s_waitcnt lgkmcnt(6)
    v_mfma_f32_16x16x32_bf16 v[144:147], a[228:231], v[96:99], v[144:147]
    s_add_u32 m0, s40, 77824
    ds_read_b64_tr_b16 a[244:245], v50 offset:16384
    v_mfma_f32_16x16x32_bf16 v[148:151], a[228:231], v[100:103], v[148:151]
    ds_read_b64_tr_b16 a[246:247], v50 offset:17408
    v_mfma_f32_16x16x32_bf16 v[152:155], a[228:231], v[104:107], v[152:155]
    buffer_load_dwordx4 v13, s[16:19], s48 offen lds
    v_mfma_f32_16x16x32_bf16 v[156:159], a[228:231], v[108:111], v[156:159]
    s_waitcnt lgkmcnt(6)
    v_mfma_f32_16x16x32_bf16 v[160:163], a[232:235], v[96:99], v[160:163]
    ds_read_b64_tr_b16 a[248:249], v50 offset:16392
    v_mfma_f32_16x16x32_bf16 v[164:167], a[232:235], v[100:103], v[164:167]
    s_add_u32 s49, s3, 7
    ds_read_b64_tr_b16 a[250:251], v50 offset:17416
    v_mfma_f32_16x16x32_bf16 v[168:171], a[232:235], v[104:107], v[168:171]
    s_and_b32 s49, s49, 7
    v_mfma_f32_16x16x32_bf16 v[172:175], a[232:235], v[108:111], v[172:175]
    s_waitcnt lgkmcnt(6)
    v_mfma_f32_16x16x32_bf16 a[192:195], a[236:239], v[96:99], a[192:195]
    s_lshl_b32 s49, s49, 7
    ds_read_b64_tr_b16 a[252:253], v55 offset:24576
    v_mfma_f32_16x16x32_bf16 a[196:199], a[236:239], v[100:103], a[196:199]
    s_waitcnt lgkmcnt(5)
    ds_read_b64_tr_b16 a[254:255], v55 offset:25088
    v_mfma_f32_16x16x32_bf16 v[176:179], a[240:243], v[96:99], v[176:179]
    s_add_u32 s48, s44, s49
    ds_read_b64_tr_b16 a[224:225], v51 offset:16384
    v_mfma_f32_16x16x32_bf16 v[180:183], a[240:243], v[100:103], v[180:183]
    s_add_u32 m0, s43, 32768
    ds_read_b64_tr_b16 a[226:227], v51 offset:17408
    v_mfma_f32_16x16x32_bf16 v[184:187], a[240:243], v[104:107], v[184:187]
    buffer_load_dwordx4 v10, s[4:7], s48 offen lds
    v_mfma_f32_16x16x32_bf16 v[188:191], a[240:243], v[108:111], v[188:191]
    s_waitcnt lgkmcnt(6)
    v_mfma_f32_16x16x32_bf16 v[192:195], a[244:247], v[96:99], v[192:195]
    s_add_u32 m0, s43, 33792
    ds_read_b64_tr_b16 a[228:229], v51 offset:16392
    v_mfma_f32_16x16x32_bf16 v[196:199], a[244:247], v[100:103], v[196:199]
    ds_read_b64_tr_b16 a[230:231], v51 offset:17416
    v_mfma_f32_16x16x32_bf16 v[200:203], a[244:247], v[104:107], v[200:203]
    buffer_load_dwordx4 v11, s[4:7], s48 offen lds
    v_mfma_f32_16x16x32_bf16 v[204:207], a[244:247], v[108:111], v[204:207]
    s_waitcnt lgkmcnt(6)
    v_mfma_f32_16x16x32_bf16 v[208:211], a[248:251], v[96:99], v[208:211]
    s_add_u32 s48, s45, s49
    ds_read_b64_tr_b16 a[232:233], v52 offset:24576
    v_mfma_f32_16x16x32_bf16 v[212:215], a[248:251], v[100:103], v[212:215]
    s_add_u32 m0, s43, 34816
    ds_read_b64_tr_b16 a[234:235], v52 offset:25088
    v_mfma_f32_16x16x32_bf16 v[216:219], a[248:251], v[104:107], v[216:219]
    buffer_load_dwordx4 v10, s[4:7], s48 offen lds
    v_mfma_f32_16x16x32_bf16 v[220:223], a[248:251], v[108:111], v[220:223]
    s_waitcnt lgkmcnt(6)
    v_mfma_f32_16x16x32_bf16 a[200:203], a[252:255], v[96:99], a[200:203]
    s_add_u32 m0, s43, 35840
    ds_read_b64_tr_b16 a[236:237], v54 offset:28672
    v_mfma_f32_16x16x32_bf16 a[204:207], a[252:255], v[100:103], a[204:207]
    s_waitcnt lgkmcnt(5)
    ds_read_b64_tr_b16 a[238:239], v54 offset:29184
    v_mfma_f32_16x16x32_bf16 v[224:227], a[224:227], v[96:99], v[224:227]
    ds_read_b64_tr_b16 a[240:241], v53 offset:24576
    v_mfma_f32_16x16x32_bf16 v[228:231], a[224:227], v[100:103], v[228:231]
    ds_read_b64_tr_b16 a[242:243], v53 offset:25088
    v_mfma_f32_16x16x32_bf16 v[232:235], a[224:227], v[104:107], v[232:235]
    buffer_load_dwordx4 v11, s[4:7], s48 offen lds
    v_mfma_f32_16x16x32_bf16 v[236:239], a[224:227], v[108:111], v[236:239]
    s_waitcnt lgkmcnt(6)
    v_mfma_f32_16x16x32_bf16 v[240:243], a[228:231], v[96:99], v[240:243]
    s_add_u32 s48, s46, s49
    ds_read_b64_tr_b16 a[244:245], v52 offset:28672
    v_mfma_f32_16x16x32_bf16 v[244:247], a[228:231], v[100:103], v[244:247]
    s_add_u32 m0, s43, 36864
    ds_read_b64_tr_b16 a[246:247], v52 offset:29184
    v_mfma_f32_16x16x32_bf16 v[248:251], a[228:231], v[104:107], v[248:251]
    buffer_load_dwordx4 v10, s[4:7], s48 offen lds
    v_mfma_f32_16x16x32_bf16 v[252:255], a[228:231], v[108:111], v[252:255]
    s_waitcnt lgkmcnt(6)
    v_mfma_f32_16x16x32_bf16 a[128:131], a[232:235], v[96:99], a[128:131]
    s_waitcnt vmcnt(15)
    ds_read_b64_tr_b16 a[248:249], v53 offset:28672
    v_mfma_f32_16x16x32_bf16 a[132:135], a[232:235], v[100:103], a[132:135]
    s_barrier
    ds_read_b64_tr_b16 a[250:251], v53 offset:29184
    v_mfma_f32_16x16x32_bf16 a[136:139], a[232:235], v[104:107], a[136:139]
    s_add_u32 m0, s43, 37888
    v_mfma_f32_16x16x32_bf16 a[140:143], a[232:235], v[108:111], a[140:143]
    s_waitcnt lgkmcnt(6)
    buffer_load_dwordx4 v11, s[4:7], s48 offen lds
    v_mfma_f32_16x16x32_bf16 a[208:211], a[236:239], v[96:99], a[208:211]
    s_add_u32 s48, s47, s49
    ds_read_b64_tr_b16 a[252:253], v55 offset:28672
    v_mfma_f32_16x16x32_bf16 a[212:215], a[236:239], v[100:103], a[212:215]
    s_waitcnt lgkmcnt(5)
    ds_read_b64_tr_b16 a[254:255], v55 offset:29184
    v_mfma_f32_16x16x32_bf16 a[144:147], a[240:243], v[96:99], a[144:147]
    s_add_u32 m0, s43, 38912
    ds_read_b64_tr_b16 a[224:225], v48 offset:32768
    v_mfma_f32_16x16x32_bf16 a[148:151], a[240:243], v[100:103], a[148:151]
    s_waitcnt vmcnt(9)
    ds_read_b64_tr_b16 a[226:227], v48 offset:33792
    v_mfma_f32_16x16x32_bf16 a[152:155], a[240:243], v[104:107], a[152:155]
    buffer_load_dwordx4 v10, s[4:7], s48 offen lds
    v_mfma_f32_16x16x32_bf16 a[156:159], a[240:243], v[108:111], a[156:159]
    s_waitcnt lgkmcnt(6)
    v_accvgpr_read_b32 v40, a80
    v_accvgpr_read_b32 v56, a84
    v_mfma_f32_16x16x32_bf16 a[160:163], a[244:247], v[96:99], a[160:163]
    s_add_u32 m0, s43, 39936
    ds_read_b64_tr_b16 a[228:229], v48 offset:32776
    v_accvgpr_read_b32 v41, a81
    v_mfma_f32_16x16x32_bf16 a[164:167], a[244:247], v[100:103], a[164:167]
    ds_read_b64_tr_b16 a[230:231], v48 offset:33800
    v_accvgpr_read_b32 v57, a85
    v_mfma_f32_16x16x32_bf16 a[168:171], a[244:247], v[104:107], a[168:171]
    buffer_load_dwordx4 v11, s[4:7], s48 offen lds
    v_mfma_f32_16x16x32_bf16 a[172:175], a[244:247], v[108:111], a[172:175]
    s_waitcnt lgkmcnt(6)
    v_accvgpr_read_b32 v42, a82
    v_accvgpr_read_b32 v58, a86
    v_mfma_f32_16x16x32_bf16 a[176:179], a[248:251], v[96:99], a[176:179]
    s_add_u32 s49, s3, 6
    ds_read_b64_tr_b16 a[232:233], v49 offset:32768
    v_accvgpr_read_b32 v43, a83
    v_mfma_f32_16x16x32_bf16 a[180:183], a[248:251], v[100:103], a[180:183]
    s_and_b32 s49, s49, 7
    ds_read_b64_tr_b16 a[234:235], v49 offset:33792
    v_accvgpr_read_b32 v59, a87
    v_mfma_f32_16x16x32_bf16 a[184:187], a[248:251], v[104:107], a[184:187]
    s_lshl_b32 s48, s49, 19
    v_add_f32 v40, v40, v56
    v_add_f32 v41, v41, v57
    v_mfma_f32_16x16x32_bf16 a[188:191], a[248:251], v[108:111], a[188:191]
    s_waitcnt lgkmcnt(6)
    v_add_f32 v42, v42, v58
    v_add_f32 v43, v43, v59
    v_mfma_f32_16x16x32_bf16 a[216:219], a[252:255], v[96:99], a[216:219]
    s_add_u32 s48, s48, 262144
    ds_read_b64_tr_b16 a[236:237], v54 offset:40960
    v_mov_b32 v56, v40
    v_mfma_f32_16x16x32_bf16 a[220:223], a[252:255], v[100:103], a[220:223]
    s_waitcnt lgkmcnt(5)
    ds_read_b64_tr_b16 a[238:239], v54 offset:41472
    v_mov_b32 v57, v41
    v_mfma_f32_16x16x32_bf16 v[128:131], a[224:227], v[112:115], v[128:131]
    s_add_u32 m0, s41, 81920
    ds_read_b64_tr_b16 a[240:241], v49 offset:32776
    v_mov_b32 v58, v42
    v_mfma_f32_16x16x32_bf16 v[132:135], a[224:227], v[116:119], v[132:135]
    ds_read_b64_tr_b16 a[242:243], v49 offset:33800
    v_mov_b32 v59, v43
    v_mfma_f32_16x16x32_bf16 v[136:139], a[224:227], v[120:123], v[136:139]
    buffer_load_dwordx4 v12, s[8:11], s48 offen lds
    v_mfma_f32_16x16x32_bf16 v[140:143], a[224:227], v[124:127], v[140:143]
    s_waitcnt lgkmcnt(6)
    v_permlane16_swap_b32 v40, v56
    v_permlane16_swap_b32 v41, v57
    v_mfma_f32_16x16x32_bf16 v[144:147], a[228:231], v[112:115], v[144:147]
    ds_read_b64_tr_b16 a[244:245], v50 offset:32768
    v_permlane16_swap_b32 v42, v58
    v_mfma_f32_16x16x32_bf16 v[148:151], a[228:231], v[116:119], v[148:151]
    s_add_u32 s48, s48, 32768
    ds_read_b64_tr_b16 a[246:247], v50 offset:33792
    v_permlane16_swap_b32 v43, v59
    v_mfma_f32_16x16x32_bf16 v[152:155], a[228:231], v[120:123], v[152:155]
    s_add_u32 m0, s41, 82944
    ds_read_b128 v[64:67], v24 offset:0
    v_add_f32 v40, v40, v56
    v_mfma_f32_16x16x32_bf16 v[156:159], a[228:231], v[124:127], v[156:159]
    s_waitcnt lgkmcnt(7)
    buffer_load_dwordx4 v12, s[8:11], s48 offen lds
    v_mfma_f32_16x16x32_bf16 v[160:163], a[232:235], v[112:115], v[160:163]
    s_mul_i32 s48, s49, 176128
    ds_read_b64_tr_b16 a[248:249], v50 offset:32776
    v_add_f32 v41, v41, v57
    v_mfma_f32_16x16x32_bf16 v[164:167], a[232:235], v[116:119], v[164:167]
    s_add_u32 s48, s48, 88064
    ds_read_b64_tr_b16 a[250:251], v50 offset:33800
    v_add_f32 v42, v42, v58
    v_mfma_f32_16x16x32_bf16 v[168:171], a[232:235], v[120:123], v[168:171]
    s_add_u32 m0, s40, 90112
    ds_read_b128 v[68:71], v24 offset:2048
    v_add_f32 v43, v43, v59
    v_mfma_f32_16x16x32_bf16 v[172:175], a[232:235], v[124:127], v[172:175]
    s_waitcnt lgkmcnt(8)
    buffer_load_dwordx4 v13, s[12:15], s48 offen lds
    v_mfma_f32_16x16x32_bf16 a[192:195], a[236:239], v[112:115], a[192:195]
    s_add_u32 m0, s40, 94208
    ds_read_b64_tr_b16 a[252:253], v55 offset:40960
    v_mov_b32 v56, v40
    v_mfma_f32_16x16x32_bf16 a[196:199], a[236:239], v[116:119], a[196:199]
    s_waitcnt lgkmcnt(7)
    ds_read_b64_tr_b16 a[254:255], v55 offset:41472
    v_mov_b32 v57, v41
    v_mfma_f32_16x16x32_bf16 v[176:179], a[240:243], v[112:115], v[176:179]
    ds_read_b64_tr_b16 a[224:225], v51 offset:32768
    v_mov_b32 v58, v42
    v_mfma_f32_16x16x32_bf16 v[180:183], a[240:243], v[116:119], v[180:183]
    ds_read_b64_tr_b16 a[226:227], v51 offset:33792
    v_mov_b32 v59, v43
    v_mfma_f32_16x16x32_bf16 v[184:187], a[240:243], v[120:123], v[184:187]
    ds_read_b128 v[72:75], v24 offset:4096
    v_mfma_f32_16x16x32_bf16 v[188:191], a[240:243], v[124:127], v[188:191]
    s_waitcnt lgkmcnt(9)
    buffer_load_dwordx4 v13, s[16:19], s48 offen lds
    v_mfma_f32_16x16x32_bf16 v[192:195], a[244:247], v[112:115], v[192:195]
    ds_read_b64_tr_b16 a[228:229], v51 offset:32776
    v_permlane32_swap_b32 v40, v56
    v_mfma_f32_16x16x32_bf16 v[196:199], a[244:247], v[116:119], v[196:199]
    ds_read_b64_tr_b16 a[230:231], v51 offset:33800
    v_permlane32_swap_b32 v41, v57
    v_mfma_f32_16x16x32_bf16 v[200:203], a[244:247], v[120:123], v[200:203]
    ds_read_b128 v[76:79], v24 offset:6144
    v_permlane32_swap_b32 v42, v58
    v_mfma_f32_16x16x32_bf16 v[204:207], a[244:247], v[124:127], v[204:207]
    s_waitcnt lgkmcnt(9)
    v_permlane32_swap_b32 v43, v59
    v_add_f32 v40, v40, v56
    v_mfma_f32_16x16x32_bf16 v[208:211], a[248:251], v[112:115], v[208:211]
    ds_read_b64_tr_b16 a[232:233], v52 offset:40960
    v_add_f32 v41, v41, v57
    v_mfma_f32_16x16x32_bf16 v[212:215], a[248:251], v[116:119], v[212:215]
    ds_read_b64_tr_b16 a[234:235], v52 offset:41472
    v_add_f32 v42, v42, v58
    v_mfma_f32_16x16x32_bf16 v[216:219], a[248:251], v[120:123], v[216:219]
    ds_read_b128 v[80:83], v25 offset:0
    v_add_f32 v43, v43, v59
    v_mfma_f32_16x16x32_bf16 v[220:223], a[248:251], v[124:127], v[220:223]
    s_waitcnt lgkmcnt(9)
    v_accvgpr_read_b32 v4, a64
    v_accvgpr_read_b32 v5, a65
    v_mfma_f32_16x16x32_bf16 a[200:203], a[252:255], v[112:115], a[200:203]
    ds_read_b64_tr_b16 a[236:237], v54 offset:45056
    v_accvgpr_read_b32 v6, a66
    v_mfma_f32_16x16x32_bf16 a[204:207], a[252:255], v[116:119], a[204:207]
    s_waitcnt lgkmcnt(8)
    ds_read_b64_tr_b16 a[238:239], v54 offset:45568
    v_accvgpr_read_b32 v7, a67
    v_mfma_f32_16x16x32_bf16 v[224:227], a[224:227], v[112:115], v[224:227]
    ds_read_b64_tr_b16 a[240:241], v53 offset:40960
    v_add_f32 v4, v4, v6
    v_mfma_f32_16x16x32_bf16 v[228:231], a[224:227], v[116:119], v[228:231]
    ds_read_b64_tr_b16 a[242:243], v53 offset:41472
    v_add_f32 v5, v5, v7
    v_mfma_f32_16x16x32_bf16 v[232:235], a[224:227], v[120:123], v[232:235]
    ds_read_b128 v[84:87], v25 offset:2048
    v_mov_b32 v6, v4
    v_mfma_f32_16x16x32_bf16 v[236:239], a[224:227], v[124:127], v[236:239]
    s_waitcnt lgkmcnt(9)
    v_mov_b32 v7, v5
    v_mfma_f32_16x16x32_bf16 v[240:243], a[228:231], v[112:115], v[240:243]
    ds_read_b64_tr_b16 a[244:245], v52 offset:45056
    v_mfma_f32_16x16x32_bf16 v[244:247], a[228:231], v[116:119], v[244:247]
    ds_read_b64_tr_b16 a[246:247], v52 offset:45568
    v_permlane16_swap_b32 v4, v6
    v_mfma_f32_16x16x32_bf16 v[248:251], a[228:231], v[120:123], v[248:251]
    ds_read_b128 v[88:91], v25 offset:4096
    v_permlane16_swap_b32 v5, v7
    v_mfma_f32_16x16x32_bf16 v[252:255], a[228:231], v[124:127], v[252:255]
    s_waitcnt lgkmcnt(9)
    v_add_f32 v4, v4, v6
    v_add_f32 v5, v5, v7
    v_mfma_f32_16x16x32_bf16 a[128:131], a[232:235], v[112:115], a[128:131]
    s_waitcnt vmcnt(12)
    ds_read_b64_tr_b16 a[248:249], v53 offset:45056
    v_mov_b32 v6, v4
    v_mfma_f32_16x16x32_bf16 a[132:135], a[232:235], v[116:119], a[132:135]
    s_barrier
    ds_read_b64_tr_b16 a[250:251], v53 offset:45568
    v_mov_b32 v7, v5
    v_mfma_f32_16x16x32_bf16 a[136:139], a[232:235], v[120:123], a[136:139]
    ds_read_b128 v[92:95], v25 offset:6144
    v_mfma_f32_16x16x32_bf16 a[140:143], a[232:235], v[124:127], a[140:143]
    s_waitcnt lgkmcnt(9)
    v_permlane32_swap_b32 v4, v6
    v_permlane32_swap_b32 v5, v7
    v_mfma_f32_16x16x32_bf16 a[208:211], a[236:239], v[112:115], a[208:211]
    ds_read_b64_tr_b16 a[252:253], v55 offset:45056
    v_add_f32 v4, v4, v6
    v_mfma_f32_16x16x32_bf16 a[212:215], a[236:239], v[116:119], a[212:215]
    s_waitcnt lgkmcnt(8)
    ds_read_b64_tr_b16 a[254:255], v55 offset:45568
    v_add_f32 v5, v5, v7
    v_mfma_f32_16x16x32_bf16 a[144:147], a[240:243], v[112:115], a[144:147]
    s_add_u32 s49, s3, 7
    ds_read_b64_tr_b16 a[224:225], v16 offset:0
    v_mul_f32 v44, 0xbb000000, v4
    v_mfma_f32_16x16x32_bf16 a[148:151], a[240:243], v[116:119], a[148:151]
    s_and_b32 s49, s49, 7
    ds_read_b64_tr_b16 a[226:227], v16 offset:1024
    v_mul_f32 v5, 0x3b000000, v5
    v_mfma_f32_16x16x32_bf16 a[152:155], a[240:243], v[120:123], a[152:155]
    s_lshl_b32 s48, s49, 19
    v_fma_f32 v5, -v44, v44, v5
    v_max_f32 v5, 0, v5
    v_mfma_f32_16x16x32_bf16 a[156:159], a[240:243], v[124:127], a[156:159]
    s_waitcnt lgkmcnt(8)
    v_add_f32 v5, 0x3727c5ac, v5
    v_mfma_f32_16x16x32_bf16 a[160:163], a[244:247], v[112:115], a[160:163]
    s_add_u32 m0, s41, 98304
    ds_read_b64_tr_b16 a[228:229], v16 offset:8
    v_mfma_f32_16x16x32_bf16 a[164:167], a[244:247], v[116:119], a[164:167]
    ds_read_b64_tr_b16 a[230:231], v16 offset:1032
    v_mfma_f32_16x16x32_bf16 a[168:171], a[244:247], v[120:123], a[168:171]
    buffer_load_dwordx4 v12, s[8:11], s48 offen lds
    v_mfma_f32_16x16x32_bf16 a[172:175], a[244:247], v[124:127], a[172:175]
    s_waitcnt lgkmcnt(7)
    v_rsq_f32 v5, v5
    v_mfma_f32_16x16x32_bf16 a[176:179], a[248:251], v[112:115], a[176:179]
    s_add_u32 s48, s48, 32768
    ds_read_b64_tr_b16 a[232:233], v17 offset:0
    v_mul_f32 v60, s58, v5
    v_mfma_f32_16x16x32_bf16 a[180:183], a[248:251], v[116:119], a[180:183]
    s_add_u32 m0, s41, 99328
    ds_read_b64_tr_b16 a[234:235], v17 offset:1024
    v_mul_f32 v56, v5, v5
    v_mfma_f32_16x16x32_bf16 a[184:187], a[248:251], v[120:123], a[184:187]
    buffer_load_dwordx4 v12, s[8:11], s48 offen lds
    v_mfma_f32_16x16x32_bf16 a[188:191], a[248:251], v[124:127], a[188:191]
    s_waitcnt lgkmcnt(6)
    v_accvgpr_read_b32 v4, a68
    v_accvgpr_read_b32 v5, a69
    v_mfma_f32_16x16x32_bf16 a[216:219], a[252:255], v[112:115], a[216:219]
    s_mul_i32 s48, s49, 176128
    ds_read_b64_tr_b16 a[236:237], v22 offset:8192
    v_accvgpr_read_b32 v6, a70
    v_mfma_f32_16x16x32_bf16 a[220:223], a[252:255], v[116:119], a[220:223]
    s_waitcnt lgkmcnt(5)
    ds_read_b64_tr_b16 a[238:239], v22 offset:8704
    v_accvgpr_read_b32 v7, a71
    v_mfma_f32_16x16x32_bf16 v[128:131], a[224:227], v[64:67], v[128:131]
    s_add_u32 m0, s40, 106496
    ds_read_b64_tr_b16 a[240:241], v17 offset:8
    v_add_f32 v4, v4, v6
    v_mfma_f32_16x16x32_bf16 v[132:135], a[224:227], v[68:71], v[132:135]
    ds_read_b64_tr_b16 a[242:243], v17 offset:1032
    v_add_f32 v5, v5, v7
    v_mfma_f32_16x16x32_bf16 v[136:139], a[224:227], v[72:75], v[136:139]
    buffer_load_dwordx4 v13, s[12:15], s48 offen lds
    v_mfma_f32_16x16x32_bf16 v[140:143], a[224:227], v[76:79], v[140:143]
    s_waitcnt lgkmcnt(6)
    v_mov_b32 v6, v4
    v_mov_b32 v7, v5
    v_mfma_f32_16x16x32_bf16 v[144:147], a[228:231], v[64:67], v[144:147]
    s_add_u32 m0, s40, 110592
    ds_read_b64_tr_b16 a[244:245], v18 offset:0
    v_mfma_f32_16x16x32_bf16 v[148:151], a[228:231], v[68:71], v[148:151]
    ds_read_b64_tr_b16 a[246:247], v18 offset:1024
    v_permlane16_swap_b32 v4, v6
    v_mfma_f32_16x16x32_bf16 v[152:155], a[228:231], v[72:75], v[152:155]
    buffer_load_dwordx4 v13, s[16:19], s48 offen lds
    v_mfma_f32_16x16x32_bf16 v[156:159], a[228:231], v[76:79], v[156:159]
    s_waitcnt lgkmcnt(6)
    v_permlane16_swap_b32 v5, v7
    v_add_f32 v4, v4, v6
    v_mfma_f32_16x16x32_bf16 v[160:163], a[232:235], v[64:67], v[160:163]
    s_mov_b32 s48, 0
    ds_read_b64_tr_b16 a[248:249], v18 offset:8
    v_add_f32 v5, v5, v7
    v_mfma_f32_16x16x32_bf16 v[164:167], a[232:235], v[68:71], v[164:167]
    s_add_u32 m0, s42, 131072
    ds_read_b64_tr_b16 a[250:251], v18 offset:1032
    v_mov_b32 v6, v4
    v_mfma_f32_16x16x32_bf16 v[168:171], a[232:235], v[72:75], v[168:171]
    buffer_load_dwordx4 v14, s[20:23], s48 offen offset:0 lds
    v_mfma_f32_16x16x32_bf16 v[172:175], a[232:235], v[76:79], v[172:175]
    s_waitcnt lgkmcnt(6)
    buffer_load_dwordx4 v14, s[20:23], s48 offen offset:1024 lds
    v_mfma_f32_16x16x32_bf16 a[192:195], a[236:239], v[64:67], a[192:195]
    ds_read_b64_tr_b16 a[252:253], v23 offset:8192
    v_mov_b32 v7, v5
    v_mfma_f32_16x16x32_bf16 a[196:199], a[236:239], v[68:71], a[196:199]
    s_waitcnt lgkmcnt(5)
    ds_read_b64_tr_b16 a[254:255], v23 offset:8704
    v_mfma_f32_16x16x32_bf16 v[176:179], a[240:243], v[64:67], v[176:179]
    ds_read_b64_tr_b16 a[224:225], v19 offset:0
    v_permlane32_swap_b32 v4, v6
    v_mfma_f32_16x16x32_bf16 v[180:183], a[240:243], v[68:71], v[180:183]
    ds_read_b64_tr_b16 a[226:227], v19 offset:1024
    v_permlane32_swap_b32 v5, v7
    v_mfma_f32_16x16x32_bf16 v[184:187], a[240:243], v[72:75], v[184:187]
    buffer_load_dwordx4 v14, s[20:23], s48 offen offset:2048 lds
    v_mfma_f32_16x16x32_bf16 v[188:191], a[240:243], v[76:79], v[188:191]
    s_waitcnt lgkmcnt(6)
    buffer_load_dwordx4 v14, s[20:23], s48 offen offset:3072 lds
    v_mfma_f32_16x16x32_bf16 v[192:195], a[244:247], v[64:67], v[192:195]
    ds_read_b64_tr_b16 a[228:229], v19 offset:8
    v_add_f32 v4, v4, v6
    v_mfma_f32_16x16x32_bf16 v[196:199], a[244:247], v[68:71], v[196:199]
    ds_read_b64_tr_b16 a[230:231], v19 offset:1032
    v_add_f32 v5, v5, v7
    v_mfma_f32_16x16x32_bf16 v[200:203], a[244:247], v[72:75], v[200:203]
    v_mul_f32 v45, 0xbb000000, v4
    v_mul_f32 v5, 0x3b000000, v5
    v_mfma_f32_16x16x32_bf16 v[204:207], a[244:247], v[76:79], v[204:207]
    s_waitcnt lgkmcnt(6)
    v_fma_f32 v5, -v45, v45, v5
    v_max_f32 v5, 0, v5
    v_mfma_f32_16x16x32_bf16 v[208:211], a[248:251], v[64:67], v[208:211]
    ds_read_b64_tr_b16 a[232:233], v20 offset:8192
    v_add_f32 v5, 0x3727c5ac, v5
    v_mfma_f32_16x16x32_bf16 v[212:215], a[248:251], v[68:71], v[212:215]
    ds_read_b64_tr_b16 a[234:235], v20 offset:8704
    v_mfma_f32_16x16x32_bf16 v[216:219], a[248:251], v[72:75], v[216:219]
    v_rsq_f32 v5, v5
    v_mfma_f32_16x16x32_bf16 v[220:223], a[248:251], v[76:79], v[220:223]
    s_waitcnt lgkmcnt(6)
    v_mul_f32 v61, s58, v5
    v_mul_f32 v57, v5, v5
    v_mfma_f32_16x16x32_bf16 a[200:203], a[252:255], v[64:67], a[200:203]
    ds_read_b64_tr_b16 a[236:237], v22 offset:12288
    v_accvgpr_read_b32 v4, a72
    v_mfma_f32_16x16x32_bf16 a[204:207], a[252:255], v[68:71], a[204:207]
    s_waitcnt lgkmcnt(5)
    ds_read_b64_tr_b16 a[238:239], v22 offset:12800
    v_accvgpr_read_b32 v5, a73
    v_mfma_f32_16x16x32_bf16 v[224:227], a[224:227], v[64:67], v[224:227]
    ds_read_b64_tr_b16 a[240:241], v21 offset:8192
    v_accvgpr_read_b32 v6, a74
    v_mfma_f32_16x16x32_bf16 v[228:231], a[224:227], v[68:71], v[228:231]
    ds_read_b64_tr_b16 a[242:243], v21 offset:8704
    v_accvgpr_read_b32 v7, a75
    v_mfma_f32_16x16x32_bf16 v[232:235], a[224:227], v[72:75], v[232:235]
    v_add_f32 v4, v4, v6
    v_add_f32 v5, v5, v7
    v_mfma_f32_16x16x32_bf16 v[236:239], a[224:227], v[76:79], v[236:239]
    s_waitcnt lgkmcnt(6)
    v_mov_b32 v6, v4
    v_mov_b32 v7, v5
    v_mfma_f32_16x16x32_bf16 v[240:243], a[228:231], v[64:67], v[240:243]
    ds_read_b64_tr_b16 a[244:245], v20 offset:12288
    v_mfma_f32_16x16x32_bf16 v[244:247], a[228:231], v[68:71], v[244:247]
    ds_read_b64_tr_b16 a[246:247], v20 offset:12800
    v_permlane16_swap_b32 v4, v6
    v_mfma_f32_16x16x32_bf16 v[248:251], a[228:231], v[72:75], v[248:251]
    v_permlane16_swap_b32 v5, v7
    v_add_f32 v4, v4, v6
    v_mfma_f32_16x16x32_bf16 v[252:255], a[228:231], v[76:79], v[252:255]
    s_waitcnt lgkmcnt(6)
    v_add_f32 v5, v5, v7
    v_mov_b32 v6, v4
    v_mfma_f32_16x16x32_bf16 a[128:131], a[232:235], v[64:67], a[128:131]
    s_waitcnt vmcnt(8)
    ds_read_b64_tr_b16 a[248:249], v21 offset:12288
    v_mov_b32 v7, v5
    v_mfma_f32_16x16x32_bf16 a[132:135], a[232:235], v[68:71], a[132:135]
    s_barrier
    ds_read_b64_tr_b16 a[250:251], v21 offset:12800
    v_mfma_f32_16x16x32_bf16 a[136:139], a[232:235], v[72:75], a[136:139]
    v_permlane32_swap_b32 v4, v6
    v_permlane32_swap_b32 v5, v7
    v_mfma_f32_16x16x32_bf16 a[140:143], a[232:235], v[76:79], a[140:143]
    s_waitcnt lgkmcnt(6)
    v_add_f32 v4, v4, v6
    v_add_f32 v5, v5, v7
    v_mfma_f32_16x16x32_bf16 a[208:211], a[236:239], v[64:67], a[208:211]
    ds_read_b64_tr_b16 a[252:253], v23 offset:12288
    v_mul_f32 v46, 0xbb000000, v4
    v_mfma_f32_16x16x32_bf16 a[212:215], a[236:239], v[68:71], a[212:215]
    s_waitcnt lgkmcnt(5)
    ds_read_b64_tr_b16 a[254:255], v23 offset:12800
    v_mul_f32 v5, 0x3b000000, v5
    v_mfma_f32_16x16x32_bf16 a[144:147], a[240:243], v[64:67], a[144:147]
    s_add_u32 s49, s3, 7
    ds_read_b64_tr_b16 a[224:225], v16 offset:16384
    v_fma_f32 v5, -v46, v46, v5
    v_mfma_f32_16x16x32_bf16 a[148:151], a[240:243], v[68:71], a[148:151]
    s_and_b32 s49, s49, 7
    ds_read_b64_tr_b16 a[226:227], v16 offset:17408
    v_max_f32 v5, 0, v5
    v_mfma_f32_16x16x32_bf16 a[152:155], a[240:243], v[72:75], a[152:155]
    s_lshl_b32 s48, s49, 19
    ds_write_b128 v8, v[40:43]
    v_add_f32 v5, 0x3727c5ac, v5
    v_mfma_f32_16x16x32_bf16 a[156:159], a[240:243], v[76:79], a[156:159]
    s_waitcnt lgkmcnt(7)
    v_rsq_f32 v5, v5
    v_mfma_f32_16x16x32_bf16 a[160:163], a[244:247], v[64:67], a[160:163]
    s_add_u32 s48, s48, 262144
    ds_read_b64_tr_b16 a[228:229], v16 offset:16392
    v_mul_f32 v62, s58, v5
    v_mfma_f32_16x16x32_bf16 a[164:167], a[244:247], v[68:71], a[164:167]
    s_add_u32 m0, s41, 114688
    ds_read_b64_tr_b16 a[230:231], v16 offset:17416
    v_mul_f32 v58, v5, v5
    v_mfma_f32_16x16x32_bf16 a[168:171], a[244:247], v[72:75], a[168:171]
    buffer_load_dwordx4 v12, s[8:11], s48 offen lds
    v_mfma_f32_16x16x32_bf16 a[172:175], a[244:247], v[76:79], a[172:175]
    s_waitcnt lgkmcnt(7)
    v_accvgpr_read_b32 v4, a76
    v_accvgpr_read_b32 v5, a77
    v_mfma_f32_16x16x32_bf16 a[176:179], a[248:251], v[64:67], a[176:179]
    s_add_u32 s48, s48, 32768
    ds_read_b64_tr_b16 a[232:233], v17 offset:16384
    v_accvgpr_read_b32 v6, a78
    v_mfma_f32_16x16x32_bf16 a[180:183], a[248:251], v[68:71], a[180:183]
    s_add_u32 m0, s41, 115712
    ds_read_b64_tr_b16 a[234:235], v17 offset:17408
    v_accvgpr_read_b32 v7, a79
    v_mfma_f32_16x16x32_bf16 a[184:187], a[248:251], v[72:75], a[184:187]
    buffer_load_dwordx4 v12, s[8:11], s48 offen lds
    v_mfma_f32_16x16x32_bf16 a[188:191], a[248:251], v[76:79], a[188:191]
    s_waitcnt lgkmcnt(7)
    v_add_f32 v4, v4, v6
    v_add_f32 v5, v5, v7
    v_mfma_f32_16x16x32_bf16 a[216:219], a[252:255], v[64:67], a[216:219]
    s_mul_i32 s48, s49, 176128
    ds_read_b64_tr_b16 a[236:237], v22 offset:24576
    v_mov_b32 v6, v4
    v_mfma_f32_16x16x32_bf16 a[220:223], a[252:255], v[68:71], a[220:223]
    s_waitcnt lgkmcnt(6)
    ds_read_b64_tr_b16 a[238:239], v22 offset:25088
    v_mov_b32 v7, v5
    v_mfma_f32_16x16x32_bf16 v[128:131], a[224:227], v[80:83], v[128:131]
    s_add_u32 s48, s48, 88064
    ds_read_b64_tr_b16 a[240:241], v17 offset:16392
    v_mfma_f32_16x16x32_bf16 v[132:135], a[224:227], v[84:87], v[132:135]
    s_add_u32 m0, s40, 122880
    ds_read_b64_tr_b16 a[242:243], v17 offset:17416
    v_permlane16_swap_b32 v4, v6
    v_mfma_f32_16x16x32_bf16 v[136:139], a[224:227], v[88:91], v[136:139]
    buffer_load_dwordx4 v13, s[12:15], s48 offen lds
    v_mfma_f32_16x16x32_bf16 v[140:143], a[224:227], v[92:95], v[140:143]
    s_waitcnt lgkmcnt(6)
    v_permlane16_swap_b32 v5, v7
    v_add_f32 v4, v4, v6
    v_mfma_f32_16x16x32_bf16 v[144:147], a[228:231], v[80:83], v[144:147]
    ds_read_b64_tr_b16 a[244:245], v18 offset:16384
    v_add_f32 v5, v5, v7
    v_mfma_f32_16x16x32_bf16 v[148:151], a[228:231], v[84:87], v[148:151]
    s_add_u32 m0, s40, 126976
    ds_read_b64_tr_b16 a[246:247], v18 offset:17408
    v_mov_b32 v6, v4
    v_mfma_f32_16x16x32_bf16 v[152:155], a[228:231], v[88:91], v[152:155]
    ds_read_b128 v[96:99], v24 offset:32768
    v_mov_b32 v7, v5
    v_mfma_f32_16x16x32_bf16 v[156:159], a[228:231], v[92:95], v[156:159]
    s_waitcnt lgkmcnt(7)
    buffer_load_dwordx4 v13, s[16:19], s48 offen lds
    v_mfma_f32_16x16x32_bf16 v[160:163], a[232:235], v[80:83], v[160:163]
    s_mov_b32 s48, 16384
    ds_read_b64_tr_b16 a[248:249], v18 offset:16392
    v_permlane32_swap_b32 v4, v6
    v_mfma_f32_16x16x32_bf16 v[164:167], a[232:235], v[84:87], v[164:167]
    s_add_u32 m0, s42, 147456
    ds_read_b64_tr_b16 a[250:251], v18 offset:17416
    v_permlane32_swap_b32 v5, v7
    v_mfma_f32_16x16x32_bf16 v[168:171], a[232:235], v[88:91], v[168:171]
    ds_read_b128 v[100:103], v24 offset:34816
    v_add_f32 v4, v4, v6
    v_mfma_f32_16x16x32_bf16 v[172:175], a[232:235], v[92:95], v[172:175]
    s_waitcnt lgkmcnt(8)
    buffer_load_dwordx4 v14, s[20:23], s48 offen offset:0 lds
    v_mfma_f32_16x16x32_bf16 a[192:195], a[236:239], v[80:83], a[192:195]
    ds_read_b64_tr_b16 a[252:253], v23 offset:24576
    v_add_f32 v5, v5, v7
    v_mfma_f32_16x16x32_bf16 a[196:199], a[236:239], v[84:87], a[196:199]
    s_waitcnt lgkmcnt(7)
    ds_read_b64_tr_b16 a[254:255], v23 offset:25088
    v_mul_f32 v47, 0xbb000000, v4
    v_mfma_f32_16x16x32_bf16 v[176:179], a[240:243], v[80:83], v[176:179]
    ds_read_b64_tr_b16 a[224:225], v19 offset:16384
    v_mul_f32 v5, 0x3b000000, v5
    v_mfma_f32_16x16x32_bf16 v[180:183], a[240:243], v[84:87], v[180:183]
    ds_read_b64_tr_b16 a[226:227], v19 offset:17408
    v_fma_f32 v5, -v47, v47, v5
    v_mfma_f32_16x16x32_bf16 v[184:187], a[240:243], v[88:91], v[184:187]
    ds_read_b128 v[104:107], v24 offset:36864
    v_max_f32 v5, 0, v5
    v_mfma_f32_16x16x32_bf16 v[188:191], a[240:243], v[92:95], v[188:191]
    s_waitcnt lgkmcnt(9)
    buffer_load_dwordx4 v14, s[20:23], s48 offen offset:1024 lds
    v_mfma_f32_16x16x32_bf16 v[192:195], a[244:247], v[80:83], v[192:195]
    ds_read_b64_tr_b16 a[228:229], v19 offset:16392
    v_add_f32 v5, 0x3727c5ac, v5
    v_mfma_f32_16x16x32_bf16 v[196:199], a[244:247], v[84:87], v[196:199]
    ds_read_b64_tr_b16 a[230:231], v19 offset:17416
    v_mfma_f32_16x16x32_bf16 v[200:203], a[244:247], v[88:91], v[200:203]
    ds_read_b128 v[108:111], v24 offset:38912
    v_mfma_f32_16x16x32_bf16 v[204:207], a[244:247], v[92:95], v[204:207]
    s_waitcnt lgkmcnt(9)
    buffer_load_dwordx4 v14, s[20:23], s48 offen offset:2048 lds
    v_mfma_f32_16x16x32_bf16 v[208:211], a[248:251], v[80:83], v[208:211]
    ds_read_b64_tr_b16 a[232:233], v20 offset:24576
    v_mfma_f32_16x16x32_bf16 v[212:215], a[248:251], v[84:87], v[212:215]
    ds_read_b64_tr_b16 a[234:235], v20 offset:25088
    v_mfma_f32_16x16x32_bf16 v[216:219], a[248:251], v[88:91], v[216:219]
    ds_read_b128 v[112:115], v25 offset:32768
    v_mfma_f32_16x16x32_bf16 v[220:223], a[248:251], v[92:95], v[220:223]
    s_waitcnt lgkmcnt(9)
    buffer_load_dwordx4 v14, s[20:23], s48 offen offset:3072 lds
    v_mfma_f32_16x16x32_bf16 a[200:203], a[252:255], v[80:83], a[200:203]
    s_mov_b32 s8, s72
    ds_read_b64_tr_b16 a[236:237], v22 offset:28672
    v_and_b32 v11, 7, v0
    v_mfma_f32_16x16x32_bf16 a[204:207], a[252:255], v[84:87], a[204:207]
    s_waitcnt lgkmcnt(8)
    ds_read_b64_tr_b16 a[238:239], v22 offset:29184
    v_lshlrev_b32 v12, 1, v1
    v_mfma_f32_16x16x32_bf16 v[224:227], a[224:227], v[80:83], v[224:227]
    s_mov_b32 s9, s73
    ds_read_b64_tr_b16 a[240:241], v21 offset:24576
    v_xor_b32 v11, v11, v12
    v_mfma_f32_16x16x32_bf16 v[228:231], a[224:227], v[84:87], v[228:231]
    s_mov_b32 s10, 4194304
    ds_read_b64_tr_b16 a[242:243], v21 offset:25088
    v_lshlrev_b32 v11, 4, v11
    v_mfma_f32_16x16x32_bf16 v[232:235], a[224:227], v[88:91], v[232:235]
    s_mov_b32 s11, 0x00020000
    ds_read_b128 v[116:119], v25 offset:34816
    v_lshrrev_b32 v12, 3, v0
    v_mfma_f32_16x16x32_bf16 v[236:239], a[224:227], v[92:95], v[236:239]
    s_waitcnt lgkmcnt(9)
    v_lshl_add_u32 v10, v12, 10, v11
    v_add_u32 v11, 7168, v10
    v_mfma_f32_16x16x32_bf16 v[240:243], a[228:231], v[80:83], v[240:243]
    s_mov_b32 s12, s80
    ds_read_b64_tr_b16 a[244:245], v20 offset:28672
    v_add_u32 v12, 14336, v10
    v_mfma_f32_16x16x32_bf16 v[244:247], a[228:231], v[84:87], v[244:247]
    s_mov_b32 s13, s81
    ds_read_b64_tr_b16 a[246:247], v20 offset:29184
    v_add_u32 v13, 21504, v10
    v_mfma_f32_16x16x32_bf16 v[248:251], a[228:231], v[88:91], v[248:251]
    s_mov_b32 s14, 1409024
    ds_read_b128 v[120:123], v25 offset:36864
    v_mfma_f32_16x16x32_bf16 v[252:255], a[228:231], v[92:95], v[252:255]
    s_waitcnt lgkmcnt(9)
    v_rsq_f32 v5, v5
    v_mfma_f32_16x16x32_bf16 a[128:131], a[232:235], v[80:83], a[128:131]
    s_waitcnt vmcnt(12)
    ds_read_b64_tr_b16 a[248:249], v21 offset:28672
    v_mul_f32 v63, s58, v5
    v_mfma_f32_16x16x32_bf16 a[132:135], a[232:235], v[84:87], a[132:135]
    s_barrier
    ds_read_b64_tr_b16 a[250:251], v21 offset:29184
    v_mul_f32 v59, v5, v5
    v_mfma_f32_16x16x32_bf16 a[136:139], a[232:235], v[88:91], a[136:139]
    s_mov_b32 s15, 0x00020000
    ds_read_b128 v[124:127], v25 offset:38912
    v_accvgpr_write_b32 a64, 0
    v_mfma_f32_16x16x32_bf16 a[140:143], a[232:235], v[92:95], a[140:143]
    s_waitcnt lgkmcnt(9)
    v_accvgpr_write_b32 a65, 0
    v_accvgpr_write_b32 a66, 0
    v_mfma_f32_16x16x32_bf16 a[208:211], a[236:239], v[80:83], a[208:211]
    s_lshl_b32 s101, s37, 2
    ds_read_b64_tr_b16 a[252:253], v23 offset:28672
    v_accvgpr_write_b32 a67, 0
    v_mfma_f32_16x16x32_bf16 a[212:215], a[236:239], v[84:87], a[212:215]
    s_waitcnt lgkmcnt(8)
    ds_read_b64_tr_b16 a[254:255], v23 offset:29184
    v_accvgpr_write_b32 a68, 0
    v_mfma_f32_16x16x32_bf16 a[144:147], a[240:243], v[80:83], a[144:147]
    s_add_u32 s101, s101, s36
    ds_read_b64_tr_b16 a[224:225], v16 offset:32768
    v_accvgpr_write_b32 a69, 0
    v_mfma_f32_16x16x32_bf16 a[148:151], a[240:243], v[84:87], a[148:151]
    s_lshl_b32 s101, s101, 12
    ds_read_b64_tr_b16 a[226:227], v16 offset:33792
    v_accvgpr_write_b32 a70, 0
    v_mfma_f32_16x16x32_bf16 a[152:155], a[240:243], v[88:91], a[152:155]
    s_mov_b32 s48, 0
    v_accvgpr_write_b32 a71, 0
    v_accvgpr_write_b32 a72, 0
    v_mfma_f32_16x16x32_bf16 a[156:159], a[240:243], v[92:95], a[156:159]
    s_waitcnt lgkmcnt(8)
    v_accvgpr_write_b32 a73, 0
    v_accvgpr_write_b32 a74, 0
    v_mfma_f32_16x16x32_bf16 a[160:163], a[244:247], v[80:83], a[160:163]
    s_add_u32 m0, s42, 0
    ds_read_b64_tr_b16 a[228:229], v16 offset:32776
    v_accvgpr_write_b32 a75, 0
    v_mfma_f32_16x16x32_bf16 a[164:167], a[244:247], v[84:87], a[164:167]
    ds_read_b64_tr_b16 a[230:231], v16 offset:33800
    v_accvgpr_write_b32 a76, 0
    v_mfma_f32_16x16x32_bf16 a[168:171], a[244:247], v[88:91], a[168:171]
    buffer_load_dwordx4 v15, s[24:27], s48 offen offset:0 lds
    v_mfma_f32_16x16x32_bf16 a[172:175], a[244:247], v[92:95], a[172:175]
    s_waitcnt lgkmcnt(7)
    buffer_load_dwordx4 v15, s[24:27], s48 offen offset:1024 lds
    v_mfma_f32_16x16x32_bf16 a[176:179], a[248:251], v[80:83], a[176:179]
    ds_read_b64_tr_b16 a[232:233], v17 offset:32768
    v_accvgpr_write_b32 a77, 0
    v_mfma_f32_16x16x32_bf16 a[180:183], a[248:251], v[84:87], a[180:183]
    ds_read_b64_tr_b16 a[234:235], v17 offset:33792
    v_accvgpr_write_b32 a78, 0
    v_mfma_f32_16x16x32_bf16 a[184:187], a[248:251], v[88:91], a[184:187]
    buffer_load_dwordx4 v15, s[24:27], s48 offen offset:2048 lds
    v_mfma_f32_16x16x32_bf16 a[188:191], a[248:251], v[92:95], a[188:191]
    s_waitcnt lgkmcnt(6)
    buffer_load_dwordx4 v15, s[24:27], s48 offen offset:3072 lds
    v_mfma_f32_16x16x32_bf16 a[216:219], a[252:255], v[80:83], a[216:219]
    s_lshl_b32 s48, s101, 3
    ds_read_b64_tr_b16 a[236:237], v22 offset:40960
    v_accvgpr_write_b32 a79, 0
    v_mfma_f32_16x16x32_bf16 a[220:223], a[252:255], v[84:87], a[220:223]
    s_waitcnt lgkmcnt(5)
    ds_read_b64_tr_b16 a[238:239], v22 offset:41472
    v_accvgpr_write_b32 a80, 0
    v_mfma_f32_16x16x32_bf16 v[128:131], a[224:227], v[96:99], v[128:131]
    s_lshl_b32 s49, s38, 7
    ds_read_b64_tr_b16 a[240:241], v17 offset:32776
    v_accvgpr_write_b32 a81, 0
    v_mfma_f32_16x16x32_bf16 v[132:135], a[224:227], v[100:103], v[132:135]
    s_add_u32 s48, s48, s49
    ds_read_b64_tr_b16 a[242:243], v17 offset:33800
    v_accvgpr_write_b32 a82, 0
    v_mfma_f32_16x16x32_bf16 v[136:139], a[224:227], v[104:107], v[136:139]
    s_add_u32 m0, s42, 65536
    v_accvgpr_write_b32 a83, 0
    v_accvgpr_write_b32 a84, 0
    v_mfma_f32_16x16x32_bf16 v[140:143], a[224:227], v[108:111], v[140:143]
    s_waitcnt lgkmcnt(6)
    buffer_load_dwordx4 v10, s[12:15], s48 offen offset:0 lds
    v_mfma_f32_16x16x32_bf16 v[144:147], a[228:231], v[96:99], v[144:147]
    ds_read_b64_tr_b16 a[244:245], v18 offset:32768
    v_accvgpr_write_b32 a85, 0
    v_mfma_f32_16x16x32_bf16 v[148:151], a[228:231], v[100:103], v[148:151]
    ds_read_b64_tr_b16 a[246:247], v18 offset:33792
    v_accvgpr_write_b32 a86, 0
    v_mfma_f32_16x16x32_bf16 v[152:155], a[228:231], v[104:107], v[152:155]
    buffer_load_dwordx4 v11, s[12:15], s48 offen offset:1024 lds
    v_mfma_f32_16x16x32_bf16 v[156:159], a[228:231], v[108:111], v[156:159]
    s_waitcnt lgkmcnt(6)
    buffer_load_dwordx4 v12, s[12:15], s48 offen offset:2048 lds
    v_mfma_f32_16x16x32_bf16 v[160:163], a[232:235], v[96:99], v[160:163]
    ds_read_b64_tr_b16 a[248:249], v18 offset:32776
    v_accvgpr_write_b32 a87, 0
    v_mfma_f32_16x16x32_bf16 v[164:167], a[232:235], v[100:103], v[164:167]
    ds_read_b64_tr_b16 a[250:251], v18 offset:33800
    ds_read_b128 v[64:67], v9 offset:0
    v_mfma_f32_16x16x32_bf16 v[168:171], a[232:235], v[104:107], v[168:171]
    buffer_load_dwordx4 v13, s[12:15], s48 offen offset:3072 lds
    v_mfma_f32_16x16x32_bf16 v[172:175], a[232:235], v[108:111], v[172:175]
    s_waitcnt lgkmcnt(7)
    ds_read_b128 v[68:71], v9 offset:64
    ds_read_b128 v[72:75], v9 offset:256
    v_mfma_f32_16x16x32_bf16 a[192:195], a[236:239], v[96:99], a[192:195]
    ds_read_b64_tr_b16 a[252:253], v23 offset:40960
    ds_read_b128 v[76:79], v9 offset:320
    v_mfma_f32_16x16x32_bf16 a[196:199], a[236:239], v[100:103], a[196:199]
    s_waitcnt lgkmcnt(9)
    ds_read_b64_tr_b16 a[254:255], v23 offset:41472
    ds_read_b128 v[80:83], v9 offset:512
    v_mfma_f32_16x16x32_bf16 v[176:179], a[240:243], v[96:99], v[176:179]
    ds_read_b64_tr_b16 a[224:225], v19 offset:32768
    ds_read_b128 v[84:87], v9 offset:576
    v_mfma_f32_16x16x32_bf16 v[180:183], a[240:243], v[100:103], v[180:183]
    ds_read_b64_tr_b16 a[226:227], v19 offset:33792
    ds_read_b128 v[88:91], v9 offset:768
    v_mfma_f32_16x16x32_bf16 v[184:187], a[240:243], v[104:107], v[184:187]
    ds_read_b128 v[92:95], v9 offset:832
    v_mfma_f32_16x16x32_bf16 v[188:191], a[240:243], v[108:111], v[188:191]
    s_waitcnt lgkmcnt(14)
    v_mfma_f32_16x16x32_bf16 v[192:195], a[244:247], v[96:99], v[192:195]
    ds_read_b64_tr_b16 a[228:229], v19 offset:32776
    v_mfma_f32_16x16x32_bf16 v[196:199], a[244:247], v[100:103], v[196:199]
    ds_read_b64_tr_b16 a[230:231], v19 offset:33800
    v_mfma_f32_16x16x32_bf16 v[200:203], a[244:247], v[104:107], v[200:203]
    v_mfma_f32_16x16x32_bf16 v[204:207], a[244:247], v[108:111], v[204:207]
    s_waitcnt lgkmcnt(14)
    v_mfma_f32_16x16x32_bf16 v[208:211], a[248:251], v[96:99], v[208:211]
    s_waitcnt lgkmcnt(2)
    ds_read_b64_tr_b16 a[232:233], v20 offset:40960
    v_mfma_f32_16x16x32_bf16 v[212:215], a[248:251], v[100:103], v[212:215]
    ds_read_b64_tr_b16 a[234:235], v20 offset:41472
    v_fmac_f32 v128, v44, v64
    v_mfma_f32_16x16x32_bf16 v[216:219], a[248:251], v[104:107], v[216:219]
    v_fmac_f32 v129, v44, v65
    v_fmac_f32 v130, v44, v66
    v_mfma_f32_16x16x32_bf16 v[220:223], a[248:251], v[108:111], v[220:223]
    v_fmac_f32 v131, v44, v67
    v_fmac_f32 v132, v45, v64
    v_mfma_f32_16x16x32_bf16 a[200:203], a[252:255], v[96:99], a[200:203]
    ds_read_b64_tr_b16 a[236:237], v22 offset:45056
    v_fmac_f32 v133, v45, v65
    v_mfma_f32_16x16x32_bf16 a[204:207], a[252:255], v[100:103], a[204:207]
    ds_read_b64_tr_b16 a[238:239], v22 offset:45568
    v_fmac_f32 v134, v45, v66
    v_mfma_f32_16x16x32_bf16 v[224:227], a[224:227], v[96:99], v[224:227]
    ds_read_b64_tr_b16 a[240:241], v21 offset:40960
    v_fmac_f32 v135, v45, v67
    v_mfma_f32_16x16x32_bf16 v[228:231], a[224:227], v[100:103], v[228:231]
    ds_read_b64_tr_b16 a[242:243], v21 offset:41472
    v_fmac_f32 v136, v46, v64
    v_mfma_f32_16x16x32_bf16 v[232:235], a[224:227], v[104:107], v[232:235]
    v_fmac_f32 v137, v46, v65
    v_fmac_f32 v138, v46, v66
    v_mfma_f32_16x16x32_bf16 v[236:239], a[224:227], v[108:111], v[236:239]
    s_waitcnt lgkmcnt(6)
    v_fmac_f32 v139, v46, v67
    v_fmac_f32 v140, v47, v64
    v_mfma_f32_16x16x32_bf16 v[240:243], a[228:231], v[96:99], v[240:243]
    ds_read_b64_tr_b16 a[244:245], v20 offset:45056
    v_fmac_f32 v141, v47, v65
    v_mfma_f32_16x16x32_bf16 v[244:247], a[228:231], v[100:103], v[244:247]
    ds_read_b64_tr_b16 a[246:247], v20 offset:45568
    v_fmac_f32 v142, v47, v66
    v_mfma_f32_16x16x32_bf16 v[248:251], a[228:231], v[104:107], v[248:251]
    v_fmac_f32 v143, v47, v67
    v_fmac_f32 v144, v44, v68
    v_mfma_f32_16x16x32_bf16 v[252:255], a[228:231], v[108:111], v[252:255]
    s_waitcnt lgkmcnt(6)
    v_fmac_f32 v145, v44, v69
    v_fmac_f32 v146, v44, v70
    v_mfma_f32_16x16x32_bf16 a[128:131], a[232:235], v[96:99], a[128:131]
    s_waitcnt vmcnt(12)
    ds_read_b64_tr_b16 a[248:249], v21 offset:45056
    v_fmac_f32 v147, v44, v71
    v_mfma_f32_16x16x32_bf16 a[132:135], a[232:235], v[100:103], a[132:135]
    s_barrier
    ds_read_b64_tr_b16 a[250:251], v21 offset:45568
    v_fmac_f32 v148, v45, v68
    v_mfma_f32_16x16x32_bf16 a[136:139], a[232:235], v[104:107], a[136:139]
    v_fmac_f32 v149, v45, v69
    v_fmac_f32 v150, v45, v70
    v_mfma_f32_16x16x32_bf16 a[140:143], a[232:235], v[108:111], a[140:143]
    s_waitcnt lgkmcnt(6)
    v_fmac_f32 v151, v45, v71
    v_fmac_f32 v152, v46, v68
    v_mfma_f32_16x16x32_bf16 a[208:211], a[236:239], v[96:99], a[208:211]
    ds_read_b64_tr_b16 a[252:253], v23 offset:45056
    v_fmac_f32 v153, v46, v69
    v_mfma_f32_16x16x32_bf16 a[212:215], a[236:239], v[100:103], a[212:215]
    s_waitcnt lgkmcnt(5)
    ds_read_b64_tr_b16 a[254:255], v23 offset:45568
    v_fmac_f32 v154, v46, v70
    v_mfma_f32_16x16x32_bf16 a[144:147], a[240:243], v[96:99], a[144:147]
    s_mov_b32 s48, 16384
    ds_read_b64_tr_b16 a[224:225], v48 offset:0
    v_fmac_f32 v155, v46, v71
    v_mfma_f32_16x16x32_bf16 a[148:151], a[240:243], v[100:103], a[148:151]
    s_add_u32 m0, s42, 16384
    ds_read_b64_tr_b16 a[226:227], v48 offset:1024
    v_fmac_f32 v156, v47, v68
    v_mfma_f32_16x16x32_bf16 a[152:155], a[240:243], v[104:107], a[152:155]
    buffer_load_dwordx4 v15, s[24:27], s48 offen offset:0 lds
    v_mfma_f32_16x16x32_bf16 a[156:159], a[240:243], v[108:111], a[156:159]
    s_waitcnt lgkmcnt(6)
    buffer_load_dwordx4 v15, s[24:27], s48 offen offset:1024 lds
    v_mfma_f32_16x16x32_bf16 a[160:163], a[244:247], v[96:99], a[160:163]
    ds_read_b64_tr_b16 a[228:229], v48 offset:8
    v_fmac_f32 v157, v47, v69
    v_mfma_f32_16x16x32_bf16 a[164:167], a[244:247], v[100:103], a[164:167]
    ds_read_b64_tr_b16 a[230:231], v48 offset:1032
    v_fmac_f32 v158, v47, v70
    v_mfma_f32_16x16x32_bf16 a[168:171], a[244:247], v[104:107], a[168:171]
    buffer_load_dwordx4 v15, s[24:27], s48 offen offset:2048 lds
    v_mfma_f32_16x16x32_bf16 a[172:175], a[244:247], v[108:111], a[172:175]
    s_waitcnt lgkmcnt(6)
    buffer_load_dwordx4 v15, s[24:27], s48 offen offset:3072 lds
    v_mfma_f32_16x16x32_bf16 a[176:179], a[248:251], v[96:99], a[176:179]
    s_lshl_b32 s48, s101, 3
    ds_read_b64_tr_b16 a[232:233], v49 offset:0
    v_fmac_f32 v159, v47, v71
    v_mfma_f32_16x16x32_bf16 a[180:183], a[248:251], v[100:103], a[180:183]
    s_lshl_b32 s49, s38, 7
    ds_read_b64_tr_b16 a[234:235], v49 offset:1024
    v_fmac_f32 v160, v44, v72
    v_mfma_f32_16x16x32_bf16 a[184:187], a[248:251], v[104:107], a[184:187]
    s_add_u32 s48, s48, s49
    ds_write_b128 v8, v[40:43] offset:32768
    v_fmac_f32 v161, v44, v73
    v_mfma_f32_16x16x32_bf16 a[188:191], a[248:251], v[108:111], a[188:191]
    s_waitcnt lgkmcnt(7)
    v_fmac_f32 v162, v44, v74
    v_fmac_f32 v163, v44, v75
    v_mfma_f32_16x16x32_bf16 a[216:219], a[252:255], v[96:99], a[216:219]
    s_add_u32 m0, s42, 81920
    ds_read_b64_tr_b16 a[236:237], v54 offset:8192
    v_mov_b32 v40, 0x3f803f80
    v_mfma_f32_16x16x32_bf16 a[220:223], a[252:255], v[100:103], a[220:223]
    s_waitcnt lgkmcnt(6)
    ds_read_b64_tr_b16 a[238:239], v54 offset:8704
    v_mov_b32 v41, 0x3f803f80
    v_mfma_f32_16x16x32_bf16 v[128:131], a[224:227], v[112:115], v[128:131]
    ds_read_b64_tr_b16 a[240:241], v49 offset:8
    v_mov_b32 v42, 0x3f803f80
    v_mfma_f32_16x16x32_bf16 v[132:135], a[224:227], v[116:119], v[132:135]
    ds_read_b64_tr_b16 a[242:243], v49 offset:1032
    v_mov_b32 v43, 0x3f803f80
    v_mfma_f32_16x16x32_bf16 v[136:139], a[224:227], v[120:123], v[136:139]
    buffer_load_dwordx4 v10, s[8:11], s48 offen offset:0 lds
    v_mfma_f32_16x16x32_bf16 v[140:143], a[224:227], v[124:127], v[140:143]
    s_waitcnt lgkmcnt(7)
    buffer_load_dwordx4 v11, s[8:11], s48 offen offset:1024 lds
    v_mfma_f32_16x16x32_bf16 v[144:147], a[228:231], v[112:115], v[144:147]
    ds_read_b64_tr_b16 a[244:245], v50 offset:0
    v_fmac_f32 v164, v45, v72
    v_mfma_f32_16x16x32_bf16 v[148:151], a[228:231], v[116:119], v[148:151]
    ds_read_b64_tr_b16 a[246:247], v50 offset:1024
    v_fmac_f32 v165, v45, v73
    v_mfma_f32_16x16x32_bf16 v[152:155], a[228:231], v[120:123], v[152:155]
    buffer_load_dwordx4 v12, s[8:11], s48 offen offset:2048 lds
    v_mfma_f32_16x16x32_bf16 v[156:159], a[228:231], v[124:127], v[156:159]
    s_waitcnt lgkmcnt(7)
    buffer_load_dwordx4 v13, s[8:11], s48 offen offset:3072 lds
    v_mfma_f32_16x16x32_bf16 v[160:163], a[232:235], v[112:115], v[160:163]
    ds_read_b64_tr_b16 a[248:249], v50 offset:8
    v_fmac_f32 v168, v46, v72
    v_mfma_f32_16x16x32_bf16 v[164:167], a[232:235], v[116:119], v[164:167]
    ds_read_b64_tr_b16 a[250:251], v50 offset:1032
    v_fmac_f32 v172, v47, v72
    v_mfma_f32_16x16x32_bf16 v[168:171], a[232:235], v[120:123], v[168:171]
    v_fmac_f32 v176, v44, v76
    v_fmac_f32 v177, v44, v77
    v_mfma_f32_16x16x32_bf16 v[172:175], a[232:235], v[124:127], v[172:175]
    s_waitcnt lgkmcnt(6)
    v_fmac_f32 v178, v44, v78
    v_fmac_f32 v179, v44, v79
    v_mfma_f32_16x16x32_bf16 a[192:195], a[236:239], v[112:115], a[192:195]
    ds_read_b64_tr_b16 a[252:253], v55 offset:8192
    v_fmac_f32 v180, v45, v76
    v_mfma_f32_16x16x32_bf16 a[196:199], a[236:239], v[116:119], a[196:199]
    s_waitcnt lgkmcnt(5)
    ds_read_b64_tr_b16 a[254:255], v55 offset:8704
    v_fmac_f32 v181, v45, v77
    v_mfma_f32_16x16x32_bf16 v[176:179], a[240:243], v[112:115], v[176:179]
    ds_read_b64_tr_b16 a[224:225], v51 offset:0
    v_fmac_f32 v184, v46, v76
    v_mfma_f32_16x16x32_bf16 v[180:183], a[240:243], v[116:119], v[180:183]
    ds_read_b64_tr_b16 a[226:227], v51 offset:1024
    v_fmac_f32 v166, v45, v74
    v_mfma_f32_16x16x32_bf16 v[184:187], a[240:243], v[120:123], v[184:187]
    v_fmac_f32 v167, v45, v75
    v_fmac_f32 v169, v46, v73
    v_mfma_f32_16x16x32_bf16 v[188:191], a[240:243], v[124:127], v[188:191]
    s_waitcnt lgkmcnt(6)
    v_fmac_f32 v170, v46, v74
    v_fmac_f32 v171, v46, v75
    v_mfma_f32_16x16x32_bf16 v[192:195], a[244:247], v[112:115], v[192:195]
    ds_read_b64_tr_b16 a[228:229], v51 offset:8
    v_fmac_f32 v173, v47, v73
    v_mfma_f32_16x16x32_bf16 v[196:199], a[244:247], v[116:119], v[196:199]
    ds_read_b64_tr_b16 a[230:231], v51 offset:1032
    v_fmac_f32 v174, v47, v74
    v_mfma_f32_16x16x32_bf16 v[200:203], a[244:247], v[120:123], v[200:203]
    v_fmac_f32 v175, v47, v75
    v_fmac_f32 v208, v44, v84
    v_mfma_f32_16x16x32_bf16 v[204:207], a[244:247], v[124:127], v[204:207]
    s_waitcnt lgkmcnt(6)
    v_fmac_f32 v182, v45, v78
    v_fmac_f32 v183, v45, v79
    v_mfma_f32_16x16x32_bf16 v[208:211], a[248:251], v[112:115], v[208:211]
    ds_read_b64_tr_b16 a[232:233], v52 offset:8192
    v_fmac_f32 v185, v46, v77
    v_mfma_f32_16x16x32_bf16 v[212:215], a[248:251], v[116:119], v[212:215]
    ds_read_b64_tr_b16 a[234:235], v52 offset:8704
    v_fmac_f32 v186, v46, v78
    v_mfma_f32_16x16x32_bf16 v[216:219], a[248:251], v[120:123], v[216:219]
    v_fmac_f32 v187, v46, v79
    v_fmac_f32 v188, v47, v76
    v_mfma_f32_16x16x32_bf16 v[220:223], a[248:251], v[124:127], v[220:223]
    s_waitcnt lgkmcnt(6)
    v_fmac_f32 v189, v47, v77
    v_fmac_f32 v190, v47, v78
    v_mfma_f32_16x16x32_bf16 a[200:203], a[252:255], v[112:115], a[200:203]
    ds_read_b64_tr_b16 a[236:237], v54 offset:12288
    v_fmac_f32 v191, v47, v79
    v_mfma_f32_16x16x32_bf16 a[204:207], a[252:255], v[116:119], a[204:207]
    s_waitcnt lgkmcnt(5)
    ds_read_b64_tr_b16 a[238:239], v54 offset:12800
    v_fmac_f32 v192, v44, v80
    v_mfma_f32_16x16x32_bf16 v[224:227], a[224:227], v[112:115], v[224:227]
    ds_read_b64_tr_b16 a[240:241], v53 offset:8192
    v_fmac_f32 v193, v44, v81
    v_mfma_f32_16x16x32_bf16 v[228:231], a[224:227], v[116:119], v[228:231]
    ds_read_b64_tr_b16 a[242:243], v53 offset:8704
    v_fmac_f32 v194, v44, v82
    v_mfma_f32_16x16x32_bf16 v[232:235], a[224:227], v[120:123], v[232:235]
    v_fmac_f32 v195, v44, v83
    v_fmac_f32 v196, v45, v80
    v_mfma_f32_16x16x32_bf16 v[236:239], a[224:227], v[124:127], v[236:239]
    s_waitcnt lgkmcnt(6)
    v_fmac_f32 v197, v45, v81
    v_fmac_f32 v198, v45, v82
    v_mfma_f32_16x16x32_bf16 v[240:243], a[228:231], v[112:115], v[240:243]
    ds_read_b64_tr_b16 a[244:245], v52 offset:12288
    v_fmac_f32 v199, v45, v83
    v_mfma_f32_16x16x32_bf16 v[244:247], a[228:231], v[116:119], v[244:247]
    ds_read_b64_tr_b16 a[246:247], v52 offset:12800
    v_fmac_f32 v200, v46, v80
    v_mfma_f32_16x16x32_bf16 v[248:251], a[228:231], v[120:123], v[248:251]
    v_fmac_f32 v201, v46, v81
    v_fmac_f32 v202, v46, v82
    v_mfma_f32_16x16x32_bf16 v[252:255], a[228:231], v[124:127], v[252:255]
    s_waitcnt lgkmcnt(6)
    v_fmac_f32 v203, v46, v83
    v_fmac_f32 v204, v47, v80
    v_mfma_f32_16x16x32_bf16 a[128:131], a[232:235], v[112:115], a[128:131]
    ds_read_b64_tr_b16 a[248:249], v53 offset:12288
    v_fmac_f32 v205, v47, v81
    v_mfma_f32_16x16x32_bf16 a[132:135], a[232:235], v[116:119], a[132:135]
    ds_read_b64_tr_b16 a[250:251], v53 offset:12800
    v_fmac_f32 v206, v47, v82
    v_mfma_f32_16x16x32_bf16 a[136:139], a[232:235], v[120:123], a[136:139]
    v_fmac_f32 v207, v47, v83
    v_fmac_f32 v209, v44, v85
    v_mfma_f32_16x16x32_bf16 a[140:143], a[232:235], v[124:127], a[140:143]
    s_waitcnt lgkmcnt(6)
    v_fmac_f32 v210, v44, v86
    v_fmac_f32 v211, v44, v87
    v_mfma_f32_16x16x32_bf16 a[208:211], a[236:239], v[112:115], a[208:211]
    ds_read_b64_tr_b16 a[252:253], v55 offset:12288
    v_fmac_f32 v212, v45, v84
    v_mfma_f32_16x16x32_bf16 a[212:215], a[236:239], v[116:119], a[212:215]
    s_waitcnt lgkmcnt(5)
    ds_read_b64_tr_b16 a[254:255], v55 offset:12800
    v_fmac_f32 v213, v45, v85
    v_mfma_f32_16x16x32_bf16 a[144:147], a[240:243], v[112:115], a[144:147]
    v_fmac_f32 v214, v45, v86
    v_fmac_f32 v215, v45, v87
    v_mfma_f32_16x16x32_bf16 a[148:151], a[240:243], v[116:119], a[148:151]
    v_fmac_f32 v216, v46, v84
    v_fmac_f32 v217, v46, v85
    v_mfma_f32_16x16x32_bf16 a[152:155], a[240:243], v[120:123], a[152:155]
    v_fmac_f32 v218, v46, v86
    v_fmac_f32 v219, v46, v87
    v_mfma_f32_16x16x32_bf16 a[156:159], a[240:243], v[124:127], a[156:159]
    s_waitcnt lgkmcnt(4)
    v_fmac_f32 v220, v47, v84
    v_fmac_f32 v221, v47, v85
    v_mfma_f32_16x16x32_bf16 a[160:163], a[244:247], v[112:115], a[160:163]
    v_fmac_f32 v222, v47, v86
    v_fmac_f32 v223, v47, v87
    v_mfma_f32_16x16x32_bf16 a[164:167], a[244:247], v[116:119], a[164:167]
    v_fmac_f32 v224, v44, v88
    v_fmac_f32 v225, v44, v89
    v_mfma_f32_16x16x32_bf16 a[168:171], a[244:247], v[120:123], a[168:171]
    v_fmac_f32 v226, v44, v90
    v_fmac_f32 v227, v44, v91
    v_mfma_f32_16x16x32_bf16 a[172:175], a[244:247], v[124:127], a[172:175]
    s_waitcnt lgkmcnt(2)
    v_fmac_f32 v228, v45, v88
    v_fmac_f32 v229, v45, v89
    v_mfma_f32_16x16x32_bf16 a[176:179], a[248:251], v[112:115], a[176:179]
    v_fmac_f32 v230, v45, v90
    v_fmac_f32 v231, v45, v91
    v_mfma_f32_16x16x32_bf16 a[180:183], a[248:251], v[116:119], a[180:183]
    v_fmac_f32 v232, v46, v88
    v_fmac_f32 v233, v46, v89
    v_mfma_f32_16x16x32_bf16 a[184:187], a[248:251], v[120:123], a[184:187]
    v_fmac_f32 v234, v46, v90
    v_fmac_f32 v235, v46, v91
    v_mfma_f32_16x16x32_bf16 a[188:191], a[248:251], v[124:127], a[188:191]
    s_waitcnt lgkmcnt(0)
    v_fmac_f32 v236, v47, v88
    v_fmac_f32 v237, v47, v89
    v_mfma_f32_16x16x32_bf16 a[216:219], a[252:255], v[112:115], a[216:219]
    v_fmac_f32 v238, v47, v90
    v_fmac_f32 v239, v47, v91
    v_mfma_f32_16x16x32_bf16 a[220:223], a[252:255], v[116:119], a[220:223]
    v_fmac_f32 v240, v44, v92
    v_fmac_f32 v241, v44, v93
    s_waitcnt vmcnt(12)
    s_barrier
    ds_read_b128 v[48:51], v9 offset:32896
    ds_read_b128 v[52:55], v9 offset:32960
    ds_read_b128 v[16:19], v9 offset:33152
    ds_read_b128 v[20:23], v9 offset:33216
    s_mov_b32 s48, 32768
    s_add_u32 m0, s42, 98304
    s_nop 0
    buffer_load_dwordx4 v14, s[20:23], s48 offen offset:0 lds
    buffer_load_dwordx4 v14, s[20:23], s48 offen offset:1024 lds
    buffer_load_dwordx4 v14, s[20:23], s48 offen offset:2048 lds
    buffer_load_dwordx4 v14, s[20:23], s48 offen offset:3072 lds
    s_mov_b32 s48, 49152
    s_add_u32 m0, s42, 114688
    s_nop 0
    buffer_load_dwordx4 v14, s[20:23], s48 offen offset:0 lds
    buffer_load_dwordx4 v14, s[20:23], s48 offen offset:1024 lds
    s_add_u32 s28, s86, 4194304
    s_addc_u32 s29, s87, 0
    s_mov_b32 s30, 16777216
    s_mov_b32 s31, 0x00020000
    v_fmac_f32 v242, v44, v94
    v_fmac_f32 v243, v44, v95
    v_fmac_f32 v244, v45, v92
    v_fmac_f32 v245, v45, v93
    v_fmac_f32 v246, v45, v94
    v_fmac_f32 v247, v45, v95
    v_fmac_f32 v248, v46, v92
    v_fmac_f32 v249, v46, v93
    v_fmac_f32 v250, v46, v94
    v_fmac_f32 v251, v46, v95
    v_fmac_f32 v252, v47, v92
    v_fmac_f32 v253, v47, v93
    v_fmac_f32 v254, v47, v94
    v_fmac_f32 v255, v47, v95
    v_pk_mul_f32 v[128:129], v[128:129], v[60:61] op_sel:[0,0] op_sel_hi:[1,0]
    v_pk_mul_f32 v[130:131], v[130:131], v[60:61] op_sel:[0,0] op_sel_hi:[1,0]
    v_pk_mul_f32 v[144:145], v[144:145], v[60:61] op_sel:[0,0] op_sel_hi:[1,0]
    v_pk_mul_f32 v[146:147], v[146:147], v[60:61] op_sel:[0,0] op_sel_hi:[1,0]
    v_cvt_pk_bf16_f32 v64, v128, v129
    v_cvt_pk_bf16_f32 v65, v130, v131
    v_cvt_pk_bf16_f32 v66, v144, v145
    v_cvt_pk_bf16_f32 v67, v146, v147
    v_pk_mul_f32 v[132:133], v[132:133], v[60:61] op_sel:[0,1] op_sel_hi:[1,1]
    v_pk_mul_f32 v[134:135], v[134:135], v[60:61] op_sel:[0,1] op_sel_hi:[1,1]
    v_pk_mul_f32 v[148:149], v[148:149], v[60:61] op_sel:[0,1] op_sel_hi:[1,1]
    v_pk_mul_f32 v[150:151], v[150:151], v[60:61] op_sel:[0,1] op_sel_hi:[1,1]
    v_cvt_pk_bf16_f32 v80, v132, v133
    v_cvt_pk_bf16_f32 v81, v134, v135
    v_cvt_pk_bf16_f32 v82, v148, v149
    v_cvt_pk_bf16_f32 v83, v150, v151
    v_pk_mul_f32 v[136:137], v[136:137], v[62:63] op_sel:[0,0] op_sel_hi:[1,0]
    v_pk_mul_f32 v[138:139], v[138:139], v[62:63] op_sel:[0,0] op_sel_hi:[1,0]
    v_pk_mul_f32 v[152:153], v[152:153], v[62:63] op_sel:[0,0] op_sel_hi:[1,0]
    v_pk_mul_f32 v[154:155], v[154:155], v[62:63] op_sel:[0,0] op_sel_hi:[1,0]
    v_cvt_pk_bf16_f32 v96, v136, v137
    v_cvt_pk_bf16_f32 v97, v138, v139
    v_cvt_pk_bf16_f32 v98, v152, v153
    v_cvt_pk_bf16_f32 v99, v154, v155
    v_pk_mul_f32 v[140:141], v[140:141], v[62:63] op_sel:[0,1] op_sel_hi:[1,1]
    v_pk_mul_f32 v[142:143], v[142:143], v[62:63] op_sel:[0,1] op_sel_hi:[1,1]
    v_pk_mul_f32 v[156:157], v[156:157], v[62:63] op_sel:[0,1] op_sel_hi:[1,1]
    v_pk_mul_f32 v[158:159], v[158:159], v[62:63] op_sel:[0,1] op_sel_hi:[1,1]
    v_cvt_pk_bf16_f32 v112, v140, v141
    v_cvt_pk_bf16_f32 v113, v142, v143
    v_cvt_pk_bf16_f32 v114, v156, v157
    v_cvt_pk_bf16_f32 v115, v158, v159
    v_pk_mul_f32 v[160:161], v[160:161], v[60:61] op_sel:[0,0] op_sel_hi:[1,0]
    v_pk_mul_f32 v[162:163], v[162:163], v[60:61] op_sel:[0,0] op_sel_hi:[1,0]
    v_pk_mul_f32 v[176:177], v[176:177], v[60:61] op_sel:[0,0] op_sel_hi:[1,0]
    v_pk_mul_f32 v[178:179], v[178:179], v[60:61] op_sel:[0,0] op_sel_hi:[1,0]
    v_cvt_pk_bf16_f32 v68, v160, v161
    v_cvt_pk_bf16_f32 v69, v162, v163
    v_cvt_pk_bf16_f32 v70, v176, v177
    v_cvt_pk_bf16_f32 v71, v178, v179
    v_pk_mul_f32 v[164:165], v[164:165], v[60:61] op_sel:[0,1] op_sel_hi:[1,1]
    v_pk_mul_f32 v[166:167], v[166:167], v[60:61] op_sel:[0,1] op_sel_hi:[1,1]
    v_pk_mul_f32 v[180:181], v[180:181], v[60:61] op_sel:[0,1] op_sel_hi:[1,1]
    v_pk_mul_f32 v[182:183], v[182:183], v[60:61] op_sel:[0,1] op_sel_hi:[1,1]
    v_cvt_pk_bf16_f32 v84, v164, v165
    v_cvt_pk_bf16_f32 v85, v166, v167
    v_cvt_pk_bf16_f32 v86, v180, v181
    v_cvt_pk_bf16_f32 v87, v182, v183
    v_pk_mul_f32 v[168:169], v[168:169], v[62:63] op_sel:[0,0] op_sel_hi:[1,0]
    v_pk_mul_f32 v[170:171], v[170:171], v[62:63] op_sel:[0,0] op_sel_hi:[1,0]
    v_pk_mul_f32 v[184:185], v[184:185], v[62:63] op_sel:[0,0] op_sel_hi:[1,0]
    v_pk_mul_f32 v[186:187], v[186:187], v[62:63] op_sel:[0,0] op_sel_hi:[1,0]
    v_cvt_pk_bf16_f32 v100, v168, v169
    v_cvt_pk_bf16_f32 v101, v170, v171
    v_cvt_pk_bf16_f32 v102, v184, v185
    v_cvt_pk_bf16_f32 v103, v186, v187
    v_pk_mul_f32 v[172:173], v[172:173], v[62:63] op_sel:[0,1] op_sel_hi:[1,1]
    v_pk_mul_f32 v[174:175], v[174:175], v[62:63] op_sel:[0,1] op_sel_hi:[1,1]
    v_pk_mul_f32 v[188:189], v[188:189], v[62:63] op_sel:[0,1] op_sel_hi:[1,1]
    v_pk_mul_f32 v[190:191], v[190:191], v[62:63] op_sel:[0,1] op_sel_hi:[1,1]
    v_cvt_pk_bf16_f32 v116, v172, v173
    v_cvt_pk_bf16_f32 v117, v174, v175
    v_cvt_pk_bf16_f32 v118, v188, v189
    v_cvt_pk_bf16_f32 v119, v190, v191
    v_pk_mul_f32 v[192:193], v[192:193], v[60:61] op_sel:[0,0] op_sel_hi:[1,0]
    v_pk_mul_f32 v[194:195], v[194:195], v[60:61] op_sel:[0,0] op_sel_hi:[1,0]
    v_pk_mul_f32 v[208:209], v[208:209], v[60:61] op_sel:[0,0] op_sel_hi:[1,0]
    v_pk_mul_f32 v[210:211], v[210:211], v[60:61] op_sel:[0,0] op_sel_hi:[1,0]
    v_cvt_pk_bf16_f32 v72, v192, v193
    v_cvt_pk_bf16_f32 v73, v194, v195
    v_cvt_pk_bf16_f32 v74, v208, v209
    v_cvt_pk_bf16_f32 v75, v210, v211
    v_pk_mul_f32 v[196:197], v[196:197], v[60:61] op_sel:[0,1] op_sel_hi:[1,1]
    v_pk_mul_f32 v[198:199], v[198:199], v[60:61] op_sel:[0,1] op_sel_hi:[1,1]
    v_pk_mul_f32 v[212:213], v[212:213], v[60:61] op_sel:[0,1] op_sel_hi:[1,1]
    v_pk_mul_f32 v[214:215], v[214:215], v[60:61] op_sel:[0,1] op_sel_hi:[1,1]
    v_cvt_pk_bf16_f32 v88, v196, v197
    v_cvt_pk_bf16_f32 v89, v198, v199
    v_cvt_pk_bf16_f32 v90, v212, v213
    v_cvt_pk_bf16_f32 v91, v214, v215
    v_pk_mul_f32 v[200:201], v[200:201], v[62:63] op_sel:[0,0] op_sel_hi:[1,0]
    v_pk_mul_f32 v[202:203], v[202:203], v[62:63] op_sel:[0,0] op_sel_hi:[1,0]
    v_pk_mul_f32 v[216:217], v[216:217], v[62:63] op_sel:[0,0] op_sel_hi:[1,0]
    v_pk_mul_f32 v[218:219], v[218:219], v[62:63] op_sel:[0,0] op_sel_hi:[1,0]
    v_cvt_pk_bf16_f32 v104, v200, v201
    v_cvt_pk_bf16_f32 v105, v202, v203
    v_cvt_pk_bf16_f32 v106, v216, v217
    v_cvt_pk_bf16_f32 v107, v218, v219
    v_pk_mul_f32 v[204:205], v[204:205], v[62:63] op_sel:[0,1] op_sel_hi:[1,1]
    v_pk_mul_f32 v[206:207], v[206:207], v[62:63] op_sel:[0,1] op_sel_hi:[1,1]
    v_pk_mul_f32 v[220:221], v[220:221], v[62:63] op_sel:[0,1] op_sel_hi:[1,1]
    v_pk_mul_f32 v[222:223], v[222:223], v[62:63] op_sel:[0,1] op_sel_hi:[1,1]
    v_cvt_pk_bf16_f32 v120, v204, v205
    v_cvt_pk_bf16_f32 v121, v206, v207
    v_cvt_pk_bf16_f32 v122, v220, v221
    v_cvt_pk_bf16_f32 v123, v222, v223
    v_pk_mul_f32 v[224:225], v[224:225], v[60:61] op_sel:[0,0] op_sel_hi:[1,0]
    v_pk_mul_f32 v[226:227], v[226:227], v[60:61] op_sel:[0,0] op_sel_hi:[1,0]
    v_pk_mul_f32 v[240:241], v[240:241], v[60:61] op_sel:[0,0] op_sel_hi:[1,0]
    v_pk_mul_f32 v[242:243], v[242:243], v[60:61] op_sel:[0,0] op_sel_hi:[1,0]
    v_cvt_pk_bf16_f32 v76, v224, v225
    v_cvt_pk_bf16_f32 v77, v226, v227
    v_cvt_pk_bf16_f32 v78, v240, v241
    v_cvt_pk_bf16_f32 v79, v242, v243
    v_pk_mul_f32 v[228:229], v[228:229], v[60:61] op_sel:[0,1] op_sel_hi:[1,1]
    v_pk_mul_f32 v[230:231], v[230:231], v[60:61] op_sel:[0,1] op_sel_hi:[1,1]
    v_pk_mul_f32 v[244:245], v[244:245], v[60:61] op_sel:[0,1] op_sel_hi:[1,1]
    v_pk_mul_f32 v[246:247], v[246:247], v[60:61] op_sel:[0,1] op_sel_hi:[1,1]
    v_cvt_pk_bf16_f32 v92, v228, v229
    v_cvt_pk_bf16_f32 v93, v230, v231
    v_cvt_pk_bf16_f32 v94, v244, v245
    v_cvt_pk_bf16_f32 v95, v246, v247
    v_pk_mul_f32 v[232:233], v[232:233], v[62:63] op_sel:[0,0] op_sel_hi:[1,0]
    v_pk_mul_f32 v[234:235], v[234:235], v[62:63] op_sel:[0,0] op_sel_hi:[1,0]
    v_pk_mul_f32 v[248:249], v[248:249], v[62:63] op_sel:[0,0] op_sel_hi:[1,0]
    v_pk_mul_f32 v[250:251], v[250:251], v[62:63] op_sel:[0,0] op_sel_hi:[1,0]
    v_cvt_pk_bf16_f32 v108, v232, v233
    v_cvt_pk_bf16_f32 v109, v234, v235
    v_cvt_pk_bf16_f32 v110, v248, v249
    v_cvt_pk_bf16_f32 v111, v250, v251
    v_pk_mul_f32 v[236:237], v[236:237], v[62:63] op_sel:[0,1] op_sel_hi:[1,1]
    v_pk_mul_f32 v[238:239], v[238:239], v[62:63] op_sel:[0,1] op_sel_hi:[1,1]
    v_pk_mul_f32 v[252:253], v[252:253], v[62:63] op_sel:[0,1] op_sel_hi:[1,1]
    v_pk_mul_f32 v[254:255], v[254:255], v[62:63] op_sel:[0,1] op_sel_hi:[1,1]
    v_cvt_pk_bf16_f32 v124, v236, v237
    v_cvt_pk_bf16_f32 v125, v238, v239
    v_cvt_pk_bf16_f32 v126, v252, v253
    v_cvt_pk_bf16_f32 v127, v254, v255
    s_lshr_b32 s48, s37, 1
    s_mul_i32 s48, s48, 3
    s_lshl_b32 s49, s39, 1
    s_add_u32 s49, s49, s48
    s_add_u32 s48, s48, 1
    s_cmp_lt_u32 s48, 43
    s_cselect_b32 s48, s48, 0x100000
    s_lshl_b32 s3, s48, 10
    s_cmp_lt_u32 s49, 43
    s_cselect_b32 s49, s49, 0x100000
    s_lshl_b32 s100, s49, 10
    ds_read_b128 a[224:227], v26 offset:32768
    ds_read_b128 a[228:231], v27 offset:32768
    ds_read_b128 a[232:235], v28 offset:32768
    ds_read_b128 a[236:239], v29 offset:32768
    ds_read_b128 a[240:243], v26 offset:33792
    ds_read_b128 a[244:247], v27 offset:33792
    ds_read_b128 a[248:251], v28 offset:33792
    ds_read_b128 a[252:255], v29 offset:33792
    s_waitcnt lgkmcnt(10)
    v_accvgpr_read_b32 v192, a128
    v_accvgpr_read_b32 v196, a160
    v_accvgpr_read_b32 v193, a129
    v_accvgpr_read_b32 v197, a161
    v_accvgpr_read_b32 v194, a130
    v_accvgpr_read_b32 v198, a162
    v_accvgpr_read_b32 v195, a131
    v_accvgpr_read_b32 v199, a163
    v_pk_fma_f32 v[192:193], v[48:49], v[44:45], v[192:193] op_sel:[0,0,0] op_sel_hi:[1,0,1]
    v_pk_fma_f32 v[194:195], v[50:51], v[44:45], v[194:195] op_sel:[0,0,0] op_sel_hi:[1,0,1]
    v_pk_fma_f32 v[196:197], v[52:53], v[44:45], v[196:197] op_sel:[0,0,0] op_sel_hi:[1,0,1]
    v_pk_fma_f32 v[198:199], v[54:55], v[44:45], v[198:199] op_sel:[0,0,0] op_sel_hi:[1,0,1]
    v_pk_mul_f32 v[192:193], v[192:193], v[56:57] op_sel:[0,0] op_sel_hi:[1,0]
    v_pk_mul_f32 v[194:195], v[194:195], v[56:57] op_sel:[0,0] op_sel_hi:[1,0]
    v_pk_mul_f32 v[192:193], v[192:193], v[196:197]
    v_pk_mul_f32 v[194:195], v[194:195], v[198:199]
    v_cvt_pk_bf16_f32 v240, v192, v193
    v_cvt_pk_bf16_f32 v241, v194, v195
    v_accvgpr_read_b32 v200, a132
    v_accvgpr_read_b32 v204, a164
    v_accvgpr_read_b32 v201, a133
    v_accvgpr_read_b32 v205, a165
    v_accvgpr_read_b32 v202, a134
    v_accvgpr_read_b32 v206, a166
    v_accvgpr_read_b32 v203, a135
    v_accvgpr_read_b32 v207, a167
    v_pk_fma_f32 v[200:201], v[48:49], v[44:45], v[200:201] op_sel:[0,1,0] op_sel_hi:[1,1,1]
    v_pk_fma_f32 v[202:203], v[50:51], v[44:45], v[202:203] op_sel:[0,1,0] op_sel_hi:[1,1,1]
    v_pk_fma_f32 v[204:205], v[52:53], v[44:45], v[204:205] op_sel:[0,1,0] op_sel_hi:[1,1,1]
    v_pk_fma_f32 v[206:207], v[54:55], v[44:45], v[206:207] op_sel:[0,1,0] op_sel_hi:[1,1,1]
    v_pk_mul_f32 v[200:201], v[200:201], v[56:57] op_sel:[0,1] op_sel_hi:[1,1]
    v_pk_mul_f32 v[202:203], v[202:203], v[56:57] op_sel:[0,1] op_sel_hi:[1,1]
    v_pk_mul_f32 v[200:201], v[200:201], v[204:205]
    v_pk_mul_f32 v[202:203], v[202:203], v[206:207]
    v_cvt_pk_bf16_f32 v244, v200, v201
    v_cvt_pk_bf16_f32 v245, v202, v203
    v_accvgpr_read_b32 v208, a136
    v_accvgpr_read_b32 v212, a168
    v_accvgpr_read_b32 v209, a137
    v_accvgpr_read_b32 v213, a169
    v_accvgpr_read_b32 v210, a138
    v_accvgpr_read_b32 v214, a170
    v_accvgpr_read_b32 v211, a139
    v_accvgpr_read_b32 v215, a171
    v_pk_fma_f32 v[208:209], v[48:49], v[46:47], v[208:209] op_sel:[0,0,0] op_sel_hi:[1,0,1]
    v_pk_fma_f32 v[210:211], v[50:51], v[46:47], v[210:211] op_sel:[0,0,0] op_sel_hi:[1,0,1]
    v_pk_fma_f32 v[212:213], v[52:53], v[46:47], v[212:213] op_sel:[0,0,0] op_sel_hi:[1,0,1]
    v_pk_fma_f32 v[214:215], v[54:55], v[46:47], v[214:215] op_sel:[0,0,0] op_sel_hi:[1,0,1]
    v_pk_mul_f32 v[208:209], v[208:209], v[58:59] op_sel:[0,0] op_sel_hi:[1,0]
    v_pk_mul_f32 v[210:211], v[210:211], v[58:59] op_sel:[0,0] op_sel_hi:[1,0]
    v_pk_mul_f32 v[208:209], v[208:209], v[212:213]
    v_pk_mul_f32 v[210:211], v[210:211], v[214:215]
    v_cvt_pk_bf16_f32 v248, v208, v209
    v_cvt_pk_bf16_f32 v249, v210, v211
    v_accvgpr_read_b32 v216, a140
    v_accvgpr_read_b32 v220, a172
    v_accvgpr_read_b32 v217, a141
    v_accvgpr_read_b32 v221, a173
    v_accvgpr_read_b32 v218, a142
    v_accvgpr_read_b32 v222, a174
    v_accvgpr_read_b32 v219, a143
    v_accvgpr_read_b32 v223, a175
    v_pk_fma_f32 v[216:217], v[48:49], v[46:47], v[216:217] op_sel:[0,1,0] op_sel_hi:[1,1,1]
    v_pk_fma_f32 v[218:219], v[50:51], v[46:47], v[218:219] op_sel:[0,1,0] op_sel_hi:[1,1,1]
    v_pk_fma_f32 v[220:221], v[52:53], v[46:47], v[220:221] op_sel:[0,1,0] op_sel_hi:[1,1,1]
    v_pk_fma_f32 v[222:223], v[54:55], v[46:47], v[222:223] op_sel:[0,1,0] op_sel_hi:[1,1,1]
    v_pk_mul_f32 v[216:217], v[216:217], v[58:59] op_sel:[0,1] op_sel_hi:[1,1]
    v_pk_mul_f32 v[218:219], v[218:219], v[58:59] op_sel:[0,1] op_sel_hi:[1,1]
    v_pk_mul_f32 v[216:217], v[216:217], v[220:221]
    v_pk_mul_f32 v[218:219], v[218:219], v[222:223]
    v_cvt_pk_bf16_f32 v252, v216, v217
    v_cvt_pk_bf16_f32 v253, v218, v219
    ds_read_b128 v[48:51], v9 offset:33408
    ds_read_b128 v[52:55], v9 offset:33472
    s_waitcnt lgkmcnt(10)
    v_accvgpr_read_b32 v192, a144
    v_accvgpr_read_b32 v196, a176
    v_accvgpr_read_b32 v193, a145
    v_accvgpr_read_b32 v197, a177
    v_accvgpr_read_b32 v194, a146
    v_accvgpr_read_b32 v198, a178
    v_accvgpr_read_b32 v195, a147
    v_accvgpr_read_b32 v199, a179
    v_pk_fma_f32 v[192:193], v[16:17], v[44:45], v[192:193] op_sel:[0,0,0] op_sel_hi:[1,0,1]
    v_pk_fma_f32 v[194:195], v[18:19], v[44:45], v[194:195] op_sel:[0,0,0] op_sel_hi:[1,0,1]
    v_pk_fma_f32 v[196:197], v[20:21], v[44:45], v[196:197] op_sel:[0,0,0] op_sel_hi:[1,0,1]
    v_pk_fma_f32 v[198:199], v[22:23], v[44:45], v[198:199] op_sel:[0,0,0] op_sel_hi:[1,0,1]
    v_pk_mul_f32 v[192:193], v[192:193], v[56:57] op_sel:[0,0] op_sel_hi:[1,0]
    v_pk_mul_f32 v[194:195], v[194:195], v[56:57] op_sel:[0,0] op_sel_hi:[1,0]
    v_pk_mul_f32 v[192:193], v[192:193], v[196:197]
    v_pk_mul_f32 v[194:195], v[194:195], v[198:199]
    v_cvt_pk_bf16_f32 v242, v192, v193
    v_cvt_pk_bf16_f32 v243, v194, v195
    v_accvgpr_read_b32 v200, a148
    v_accvgpr_read_b32 v204, a180
    v_accvgpr_read_b32 v201, a149
    v_accvgpr_read_b32 v205, a181
    v_accvgpr_read_b32 v202, a150
    v_accvgpr_read_b32 v206, a182
    v_accvgpr_read_b32 v203, a151
    v_accvgpr_read_b32 v207, a183
    v_pk_fma_f32 v[200:201], v[16:17], v[44:45], v[200:201] op_sel:[0,1,0] op_sel_hi:[1,1,1]
    v_pk_fma_f32 v[202:203], v[18:19], v[44:45], v[202:203] op_sel:[0,1,0] op_sel_hi:[1,1,1]
    v_pk_fma_f32 v[204:205], v[20:21], v[44:45], v[204:205] op_sel:[0,1,0] op_sel_hi:[1,1,1]
    v_pk_fma_f32 v[206:207], v[22:23], v[44:45], v[206:207] op_sel:[0,1,0] op_sel_hi:[1,1,1]
    v_pk_mul_f32 v[200:201], v[200:201], v[56:57] op_sel:[0,1] op_sel_hi:[1,1]
    v_pk_mul_f32 v[202:203], v[202:203], v[56:57] op_sel:[0,1] op_sel_hi:[1,1]
    v_pk_mul_f32 v[200:201], v[200:201], v[204:205]
    v_pk_mul_f32 v[202:203], v[202:203], v[206:207]
    v_cvt_pk_bf16_f32 v246, v200, v201
    v_cvt_pk_bf16_f32 v247, v202, v203
    v_accvgpr_read_b32 v208, a152
    v_accvgpr_read_b32 v212, a184
    v_accvgpr_read_b32 v209, a153
    v_accvgpr_read_b32 v213, a185
    v_accvgpr_read_b32 v210, a154
    v_accvgpr_read_b32 v214, a186
    v_accvgpr_read_b32 v211, a155
    v_accvgpr_read_b32 v215, a187
    v_pk_fma_f32 v[208:209], v[16:17], v[46:47], v[208:209] op_sel:[0,0,0] op_sel_hi:[1,0,1]
    v_pk_fma_f32 v[210:211], v[18:19], v[46:47], v[210:211] op_sel:[0,0,0] op_sel_hi:[1,0,1]
    v_pk_fma_f32 v[212:213], v[20:21], v[46:47], v[212:213] op_sel:[0,0,0] op_sel_hi:[1,0,1]
    v_pk_fma_f32 v[214:215], v[22:23], v[46:47], v[214:215] op_sel:[0,0,0] op_sel_hi:[1,0,1]
    v_pk_mul_f32 v[208:209], v[208:209], v[58:59] op_sel:[0,0] op_sel_hi:[1,0]
    v_pk_mul_f32 v[210:211], v[210:211], v[58:59] op_sel:[0,0] op_sel_hi:[1,0]
    v_pk_mul_f32 v[208:209], v[208:209], v[212:213]
    v_pk_mul_f32 v[210:211], v[210:211], v[214:215]
    v_cvt_pk_bf16_f32 v250, v208, v209
    v_cvt_pk_bf16_f32 v251, v210, v211
    v_accvgpr_read_b32 v216, a156
    v_accvgpr_read_b32 v220, a188
    v_accvgpr_read_b32 v217, a157
    v_accvgpr_read_b32 v221, a189
    v_accvgpr_read_b32 v218, a158
    v_accvgpr_read_b32 v222, a190
    v_accvgpr_read_b32 v219, a159
    v_accvgpr_read_b32 v223, a191
    v_pk_fma_f32 v[216:217], v[16:17], v[46:47], v[216:217] op_sel:[0,1,0] op_sel_hi:[1,1,1]
    v_pk_fma_f32 v[218:219], v[18:19], v[46:47], v[218:219] op_sel:[0,1,0] op_sel_hi:[1,1,1]
    v_pk_fma_f32 v[220:221], v[20:21], v[46:47], v[220:221] op_sel:[0,1,0] op_sel_hi:[1,1,1]
    v_pk_fma_f32 v[222:223], v[22:23], v[46:47], v[222:223] op_sel:[0,1,0] op_sel_hi:[1,1,1]
    v_pk_mul_f32 v[216:217], v[216:217], v[58:59] op_sel:[0,1] op_sel_hi:[1,1]
    v_pk_mul_f32 v[218:219], v[218:219], v[58:59] op_sel:[0,1] op_sel_hi:[1,1]
    v_pk_mul_f32 v[216:217], v[216:217], v[220:221]
    v_pk_mul_f32 v[218:219], v[218:219], v[222:223]
    v_cvt_pk_bf16_f32 v254, v216, v217
    v_cvt_pk_bf16_f32 v255, v218, v219
    ds_read_b128 v[16:19], v9 offset:33664
    ds_read_b128 v[20:23], v9 offset:33728
    s_waitcnt lgkmcnt(2)
    v_accvgpr_read_b32 v192, a192
    v_accvgpr_read_b32 v196, a208
    v_accvgpr_read_b32 v193, a193
    v_accvgpr_read_b32 v197, a209
    v_accvgpr_read_b32 v194, a194
    v_accvgpr_read_b32 v198, a210
    v_accvgpr_read_b32 v195, a195
    v_accvgpr_read_b32 v199, a211
    v_pk_fma_f32 v[192:193], v[48:49], v[44:45], v[192:193] op_sel:[0,0,0] op_sel_hi:[1,0,1]
    v_pk_fma_f32 v[194:195], v[50:51], v[44:45], v[194:195] op_sel:[0,0,0] op_sel_hi:[1,0,1]
    v_pk_fma_f32 v[196:197], v[52:53], v[44:45], v[196:197] op_sel:[0,0,0] op_sel_hi:[1,0,1]
    v_pk_fma_f32 v[198:199], v[54:55], v[44:45], v[198:199] op_sel:[0,0,0] op_sel_hi:[1,0,1]
    v_pk_mul_f32 v[192:193], v[192:193], v[56:57] op_sel:[0,0] op_sel_hi:[1,0]
    v_pk_mul_f32 v[194:195], v[194:195], v[56:57] op_sel:[0,0] op_sel_hi:[1,0]
    v_pk_mul_f32 v[192:193], v[192:193], v[196:197]
    v_pk_mul_f32 v[194:195], v[194:195], v[198:199]
    v_cvt_pk_bf16_f32 v196, v192, v193
    v_cvt_pk_bf16_f32 v197, v194, v195
    v_accvgpr_write_b32 a176, v196
    v_accvgpr_write_b32 a177, v197
    v_accvgpr_read_b32 v200, a196
    v_accvgpr_read_b32 v204, a212
    v_accvgpr_read_b32 v201, a197
    v_accvgpr_read_b32 v205, a213
    v_accvgpr_read_b32 v202, a198
    v_accvgpr_read_b32 v206, a214
    v_accvgpr_read_b32 v203, a199
    v_accvgpr_read_b32 v207, a215
    v_pk_fma_f32 v[200:201], v[48:49], v[44:45], v[200:201] op_sel:[0,1,0] op_sel_hi:[1,1,1]
    v_pk_fma_f32 v[202:203], v[50:51], v[44:45], v[202:203] op_sel:[0,1,0] op_sel_hi:[1,1,1]
    v_pk_fma_f32 v[204:205], v[52:53], v[44:45], v[204:205] op_sel:[0,1,0] op_sel_hi:[1,1,1]
    v_pk_fma_f32 v[206:207], v[54:55], v[44:45], v[206:207] op_sel:[0,1,0] op_sel_hi:[1,1,1]
    v_pk_mul_f32 v[200:201], v[200:201], v[56:57] op_sel:[0,1] op_sel_hi:[1,1]
    v_pk_mul_f32 v[202:203], v[202:203], v[56:57] op_sel:[0,1] op_sel_hi:[1,1]
    v_pk_mul_f32 v[200:201], v[200:201], v[204:205]
    v_pk_mul_f32 v[202:203], v[202:203], v[206:207]
    v_cvt_pk_bf16_f32 v204, v200, v201
    v_cvt_pk_bf16_f32 v205, v202, v203
    v_accvgpr_write_b32 a180, v204
    v_accvgpr_write_b32 a181, v205
    s_waitcnt lgkmcnt(0)
    v_accvgpr_read_b32 v192, a200
    v_accvgpr_read_b32 v196, a216
    v_accvgpr_read_b32 v193, a201
    v_accvgpr_read_b32 v197, a217
    v_accvgpr_read_b32 v194, a202
    v_accvgpr_read_b32 v198, a218
    v_accvgpr_read_b32 v195, a203
    v_accvgpr_read_b32 v199, a219
    v_pk_fma_f32 v[192:193], v[16:17], v[44:45], v[192:193] op_sel:[0,0,0] op_sel_hi:[1,0,1]
    v_pk_fma_f32 v[194:195], v[18:19], v[44:45], v[194:195] op_sel:[0,0,0] op_sel_hi:[1,0,1]
    v_pk_fma_f32 v[196:197], v[20:21], v[44:45], v[196:197] op_sel:[0,0,0] op_sel_hi:[1,0,1]
    v_pk_fma_f32 v[198:199], v[22:23], v[44:45], v[198:199] op_sel:[0,0,0] op_sel_hi:[1,0,1]
    v_pk_mul_f32 v[192:193], v[192:193], v[56:57] op_sel:[0,0] op_sel_hi:[1,0]
    v_pk_mul_f32 v[194:195], v[194:195], v[56:57] op_sel:[0,0] op_sel_hi:[1,0]
    v_pk_mul_f32 v[192:193], v[192:193], v[196:197]
    v_pk_mul_f32 v[194:195], v[194:195], v[198:199]
    v_cvt_pk_bf16_f32 v196, v192, v193
    v_cvt_pk_bf16_f32 v197, v194, v195
    v_accvgpr_write_b32 a178, v196
    v_accvgpr_write_b32 a179, v197
    v_accvgpr_read_b32 v200, a204
    v_accvgpr_read_b32 v204, a220
    v_accvgpr_read_b32 v201, a205
    v_accvgpr_read_b32 v205, a221
    v_accvgpr_read_b32 v202, a206
    v_accvgpr_read_b32 v206, a222
    v_accvgpr_read_b32 v203, a207
    v_accvgpr_read_b32 v207, a223
    v_pk_fma_f32 v[200:201], v[16:17], v[44:45], v[200:201] op_sel:[0,1,0] op_sel_hi:[1,1,1]
    v_pk_fma_f32 v[202:203], v[18:19], v[44:45], v[202:203] op_sel:[0,1,0] op_sel_hi:[1,1,1]
    v_pk_fma_f32 v[204:205], v[20:21], v[44:45], v[204:205] op_sel:[0,1,0] op_sel_hi:[1,1,1]
    v_pk_fma_f32 v[206:207], v[22:23], v[44:45], v[206:207] op_sel:[0,1,0] op_sel_hi:[1,1,1]
    v_pk_mul_f32 v[200:201], v[200:201], v[56:57] op_sel:[0,1] op_sel_hi:[1,1]
    v_pk_mul_f32 v[202:203], v[202:203], v[56:57] op_sel:[0,1] op_sel_hi:[1,1]
    v_pk_mul_f32 v[200:201], v[200:201], v[204:205]
    v_pk_mul_f32 v[202:203], v[202:203], v[206:207]
    v_cvt_pk_bf16_f32 v204, v200, v201
    v_cvt_pk_bf16_f32 v205, v202, v203
    v_accvgpr_write_b32 a182, v204
    v_accvgpr_write_b32 a183, v205
    v_mfma_f32_16x16x32_bf16 v[128:131], a[224:227], v[64:67], 0
    s_and_b32 s48, s2, 7
    s_lshr_b32 s49, s2, 3
    s_lshl_b32 s39, s49, 12
    s_and_b32 s45, s49, 7
    s_lshl_b32 s41, s48, 10
    s_add_u32 s41, s41, 0x2000
    s_lshl_b32 s43, s38, 10
    s_add_u32 s43, s43, 0x2000
    s_lshr_b32 s49, s49, 3
    s_lshl_b32 s48, s48, 2
    s_add_u32 s44, s48, s49
    s_lshl_b32 s48, s45, 19
    s_add_u32 s48, s48, 37748736
    s_add_u32 s8, s86, s48
    s_addc_u32 s9, s87, 0
    s_mov_b32 s10, 524288
    s_mov_b32 s11, 0x00020000
    s_mul_i32 s48, s45, 176128
    s_add_u32 s48, s48, 41943040
    s_add_u32 s12, s86, s48
    s_addc_u32 s13, s87, 0
    s_mov_b32 s14, 176128
    s_mov_b32 s15, 0x00020000
    s_lshl_b32 s48, s44, 2
    s_add_u32 s48, s48, s36
    s_mul_i32 s48, s48, 44032
    s_add_u32 s48, s48, 25165824
    s_add_u32 s16, s86, s48
    s_addc_u32 s17, s87, 0
    s_mov_b32 s18, 44032
    s_mov_b32 s19, 0x00020000
    s_lshl_b32 s59, s36, 12
    s_mov_b32 s58, 0
    s_lshl_b32 s40, s44, 8
    s_add_u32 s40, s40, 0x4000
    v_lshrrev_b32 v1, 4, v0
    v_and_b32 v2, 15, v0
    v_mfma_f32_16x16x32_bf16 v[128:131], a[228:231], v[68:71], v[128:131]
    v_bfe_u32 v3, v0, 2, 2
    v_and_b32 v4, 3, v0
    v_mfma_f32_16x16x32_bf16 v[128:131], a[232:235], v[72:75], v[128:131]
    v_lshrrev_b32 v5, 3, v0
    v_and_b32 v6, 7, v0
    v_mfma_f32_16x16x32_bf16 v[128:131], a[236:239], v[76:79], v[128:131]
    v_lshlrev_b32 v7, 2, v1
    v_add_u32 v7, v7, v3
    v_mfma_f32_16x16x32_bf16 v[132:135], a[224:227], v[80:83], 0
    v_bfe_u32 v8, v7, 1, 2
    v_lshlrev_b32 v7, 7, v7
    v_mfma_f32_16x16x32_bf16 v[132:135], a[228:231], v[84:87], v[132:135]
    v_lshl_add_u32 v7, v4, 3, v7
    s_add_u32 s48, s42, 65536
    v_add_u32 v7, s48, v7
    v_mfma_f32_16x16x32_bf16 v[132:135], a[232:235], v[88:91], v[132:135]
    v_xor_b32 v9, 0, v8
    v_lshl_add_u32 v16, v9, 5, v7
    v_mfma_f32_16x16x32_bf16 v[132:135], a[236:239], v[92:95], v[132:135]
    v_xor_b32 v9, 1, v8
    v_lshl_add_u32 v17, v9, 5, v7
    v_mfma_f32_16x16x32_bf16 v[136:139], a[224:227], v[96:99], 0
    v_xor_b32 v9, 2, v8
    v_lshl_add_u32 v18, v9, 5, v7
    v_mfma_f32_16x16x32_bf16 v[136:139], a[228:231], v[100:103], v[136:139]
    v_xor_b32 v9, 3, v8
    v_lshl_add_u32 v19, v9, 5, v7
    v_mfma_f32_16x16x32_bf16 v[136:139], a[232:235], v[104:107], v[136:139]
    v_add_u32 v13, 65536, v38
    s_lshl_b32 s48, s45, 10
    s_add_u32 s48, s48, 0x4000
    v_lshlrev_b32 v7, 3, v2
    v_mfma_f32_16x16x32_bf16 v[136:139], a[236:239], v[108:111], v[136:139]
    v_lshl_add_u32 v7, v1, 8, v7
    v_add_u32 v12, s48, v7
    v_mfma_f32_16x16x32_bf16 v[140:143], a[224:227], v[112:115], 0
    v_and_b32 v20, 31, v0
    v_lshlrev_b32 v20, 2, v20
    v_mfma_f32_16x16x32_bf16 v[140:143], a[228:231], v[116:119], v[140:143]
    v_lshlrev_b32 v23, 15, v0
    v_add_u32 v23, 0x4000, v23
    v_mfma_f32_16x16x32_bf16 v[140:143], a[232:235], v[120:123], v[140:143]
    v_mov_b32 v24, 0
    v_mov_b32 v9, 0
    v_mfma_f32_16x16x32_bf16 v[140:143], a[236:239], v[124:127], v[140:143]
    v_lshlrev_b32 v25, 7, v0
    s_and_b32 s48, s44, 3
    s_lshl_b32 s48, s48, 1
    s_add_u32 s48, s48, s45
    v_add_u32 v7, s48, v2
    v_mfma_f32_16x16x32_bf16 v[144:147], a[240:243], v[64:67], 0
    ds_read_b128 a[224:227], v26 offset:34816
    v_and_b32 v7, 7, v7
    v_mfma_f32_16x16x32_bf16 v[144:147], a[244:247], v[68:71], v[144:147]
    ds_read_b128 a[228:231], v27 offset:34816
    v_and_b32 v8, 8, v2
    v_mfma_f32_16x16x32_bf16 v[144:147], a[248:251], v[72:75], v[144:147]
    ds_read_b128 a[232:235], v28 offset:34816
    v_and_b32 v6, 1, v7
    v_mfma_f32_16x16x32_bf16 v[144:147], a[252:255], v[76:79], v[144:147]
    ds_read_b128 a[236:239], v29 offset:34816
    v_lshlrev_b32 v6, 11, v6
    v_mfma_f32_16x16x32_bf16 v[148:151], a[240:243], v[80:83], 0
    v_and_b32 v7, 6, v7
    v_add_u32 v7, v7, v8
    s_lshl_b32 s48, s36, 2
    v_mfma_f32_16x16x32_bf16 v[148:151], a[244:247], v[84:87], v[148:151]
    v_lshl_add_u32 v4, v7, 3, s48
    v_mov_b32 v1, 0x10000000
    s_add_u32 s48, s37, 1
    v_mfma_f32_16x16x32_bf16 v[148:151], a[248:251], v[88:91], v[148:151]
    v_mov_b32 v5, s48
    v_mfma_f32_16x16x32_bf16 v[148:151], a[252:255], v[92:95], v[148:151]
    v_mfma_f32_16x16x32_bf16 v[152:155], a[240:243], v[96:99], 0
    v_mov_b32 v224, 0
    v_mov_b32 v225, 0
    v_mfma_f32_16x16x32_bf16 v[152:155], a[244:247], v[100:103], v[152:155]
    v_mov_b32 v226, 0
    v_mov_b32 v227, 0
    v_mfma_f32_16x16x32_bf16 v[152:155], a[248:251], v[104:107], v[152:155]
    v_mov_b32 v228, 0
    v_mov_b32 v229, 0
    v_mfma_f32_16x16x32_bf16 v[152:155], a[252:255], v[108:111], v[152:155]
    v_mov_b32 v230, 0
    v_mov_b32 v231, 0
    v_mfma_f32_16x16x32_bf16 v[156:159], a[240:243], v[112:115], 0
    v_mov_b32 v232, 0
    v_mov_b32 v233, 0
    v_mfma_f32_16x16x32_bf16 v[156:159], a[244:247], v[116:119], v[156:159]
    v_mov_b32 v234, 0
    v_mov_b32 v235, 0
    v_mfma_f32_16x16x32_bf16 v[156:159], a[248:251], v[120:123], v[156:159]
    v_mov_b32 v236, 0
    v_mov_b32 v237, 0
    v_mfma_f32_16x16x32_bf16 v[156:159], a[252:255], v[124:127], v[156:159]
    v_mov_b32 v238, 0
    v_mov_b32 v239, 0
    s_nop 5
    v_max3_f32 v208, v128, v129, v130
    v_max3_f32 v208, v208, v131, v144
    v_max3_f32 v208, v208, v145, v146
    v_max_f32 v208, v208, v147
    v_max3_f32 v209, v132, v133, v134
    v_max3_f32 v209, v209, v135, v148
    v_max3_f32 v209, v209, v149, v150
    v_max_f32 v209, v209, v151
    v_max3_f32 v210, v136, v137, v138
    v_max3_f32 v210, v210, v139, v152
    v_max3_f32 v210, v210, v153, v154
    v_max_f32 v210, v210, v155
    v_max3_f32 v211, v140, v141, v142
    v_max3_f32 v211, v211, v143, v156
    v_max3_f32 v211, v211, v157, v158
    v_max_f32 v211, v211, v159
    v_mov_b32 v212, v208
    v_mov_b32 v213, v209
    v_mov_b32 v214, v210
    v_mov_b32 v215, v211
    s_nop 0
    v_permlane16_swap_b32 v208, v212
    v_permlane16_swap_b32 v209, v213
    v_permlane16_swap_b32 v210, v214
    v_permlane16_swap_b32 v211, v215
    v_max_f32 v208, v208, v212
    v_max_f32 v209, v209, v213
    v_max_f32 v210, v210, v214
    v_max_f32 v211, v211, v215
    v_mov_b32 v212, v208
    v_mov_b32 v213, v209
    v_mov_b32 v214, v210
    v_mov_b32 v215, v211
    s_nop 0
    v_permlane32_swap_b32 v208, v212
    v_permlane32_swap_b32 v209, v213
    v_permlane32_swap_b32 v210, v214
    v_permlane32_swap_b32 v211, v215
    v_max_f32 v208, v208, v212
    v_max_f32 v209, v209, v213
    v_max_f32 v210, v210, v214
    v_max_f32 v211, v211, v215
    v_sub_f32 v48, 0, v208
    v_sub_f32 v49, 0, v208
    v_sub_f32 v50, 0, v208
    v_sub_f32 v51, 0, v208
    v_sub_f32 v52, 0, v209
    v_sub_f32 v53, 0, v209
    v_sub_f32 v54, 0, v209
    v_sub_f32 v55, 0, v209
    v_sub_f32 v56, 0, v210
    v_sub_f32 v57, 0, v210
    v_sub_f32 v58, 0, v210
    v_sub_f32 v59, 0, v210
    v_sub_f32 v60, 0, v211
    v_sub_f32 v61, 0, v211
    v_sub_f32 v62, 0, v211
    v_sub_f32 v63, 0, v211
    v_pk_add_f32 v[128:129], v[128:129], v[48:49]
    v_pk_add_f32 v[130:131], v[130:131], v[48:49]
    v_pk_add_f32 v[132:133], v[132:133], v[52:53]
    v_pk_add_f32 v[134:135], v[134:135], v[52:53]
    v_pk_add_f32 v[136:137], v[136:137], v[56:57]
    v_pk_add_f32 v[138:139], v[138:139], v[56:57]
    v_pk_add_f32 v[140:141], v[140:141], v[60:61]
    v_pk_add_f32 v[142:143], v[142:143], v[60:61]
    v_pk_add_f32 v[144:145], v[144:145], v[48:49]
    v_pk_add_f32 v[146:147], v[146:147], v[48:49]
    v_pk_add_f32 v[148:149], v[148:149], v[52:53]
    v_pk_add_f32 v[150:151], v[150:151], v[52:53]
    v_pk_add_f32 v[152:153], v[152:153], v[56:57]
    v_pk_add_f32 v[154:155], v[154:155], v[56:57]
    v_pk_add_f32 v[156:157], v[156:157], v[60:61]
    v_pk_add_f32 v[158:159], v[158:159], v[60:61]
    s_waitcnt lgkmcnt(0)
    v_mfma_f32_16x16x32_bf16 v[160:163], a[224:227], v[64:67], v[48:51]
    v_exp_f32 v44, v128
    v_exp_f32 v45, v129
    v_mfma_f32_16x16x32_bf16 v[160:163], a[228:231], v[68:71], v[160:163]
    v_cvt_pk_bf16_f32 v192, v44, v45
    v_exp_f32 v46, v130
    v_mfma_f32_16x16x32_bf16 v[160:163], a[232:235], v[72:75], v[160:163]
    v_exp_f32 v47, v131
    v_mfma_f32_16x16x32_bf16 v[160:163], a[236:239], v[76:79], v[160:163]
    v_cvt_pk_bf16_f32 v193, v46, v47
    v_exp_f32 v44, v132
    v_mfma_f32_16x16x32_bf16 v[164:167], a[224:227], v[80:83], v[52:55]
    ds_read_b128 a[240:243], v26 offset:35840
    ds_read_b128 a[244:247], v27 offset:35840
    v_exp_f32 v45, v133
    v_mfma_f32_16x16x32_bf16 v[164:167], a[228:231], v[84:87], v[164:167]
    v_cvt_pk_bf16_f32 v196, v44, v45
    v_exp_f32 v46, v134
    v_mfma_f32_16x16x32_bf16 v[164:167], a[232:235], v[88:91], v[164:167]
    v_exp_f32 v47, v135
    v_mfma_f32_16x16x32_bf16 v[164:167], a[236:239], v[92:95], v[164:167]
    v_cvt_pk_bf16_f32 v197, v46, v47
    v_exp_f32 v44, v136
    v_mfma_f32_16x16x32_bf16 v[168:171], a[224:227], v[96:99], v[56:59]
    ds_read_b128 a[248:251], v28 offset:35840
    ds_read_b128 a[252:255], v29 offset:35840
    v_exp_f32 v45, v137
    v_mfma_f32_16x16x32_bf16 v[168:171], a[228:231], v[100:103], v[168:171]
    v_cvt_pk_bf16_f32 v200, v44, v45
    v_exp_f32 v46, v138
    v_mfma_f32_16x16x32_bf16 v[168:171], a[232:235], v[104:107], v[168:171]
    v_exp_f32 v47, v139
    v_mfma_f32_16x16x32_bf16 v[168:171], a[236:239], v[108:111], v[168:171]
    v_cvt_pk_bf16_f32 v201, v46, v47
    v_exp_f32 v44, v140
    v_mfma_f32_16x16x32_bf16 v[172:175], a[224:227], v[112:115], v[60:63]
    v_exp_f32 v45, v141
    v_mfma_f32_16x16x32_bf16 v[172:175], a[228:231], v[116:119], v[172:175]
    v_cvt_pk_bf16_f32 v204, v44, v45
    v_exp_f32 v46, v142
    v_mfma_f32_16x16x32_bf16 v[172:175], a[232:235], v[120:123], v[172:175]
    v_exp_f32 v47, v143
    v_mfma_f32_16x16x32_bf16 v[172:175], a[236:239], v[124:127], v[172:175]
    s_waitcnt lgkmcnt(0)
    v_cvt_pk_bf16_f32 v205, v46, v47
    v_exp_f32 v44, v144
    v_mfma_f32_16x16x32_bf16 v[176:179], a[240:243], v[64:67], v[48:51]
    v_exp_f32 v45, v145
    v_exp_f32 v46, v146
    v_mfma_f32_16x16x32_bf16 v[176:179], a[244:247], v[68:71], v[176:179]
    v_cvt_pk_bf16_f32 v194, v44, v45
    v_exp_f32 v47, v147
    v_mfma_f32_16x16x32_bf16 v[176:179], a[248:251], v[72:75], v[176:179]
    v_cvt_pk_bf16_f32 v195, v46, v47
    v_exp_f32 v44, v148
    v_mfma_f32_16x16x32_bf16 v[176:179], a[252:255], v[76:79], v[176:179]
    v_exp_f32 v45, v149
    v_mfma_f32_16x16x32_bf16 v[180:183], a[240:243], v[80:83], v[52:55]
    ds_read_b128 a[224:227], v26 offset:49152
    ds_read_b128 a[228:231], v27 offset:49152
    v_cvt_pk_bf16_f32 v198, v44, v45
    v_mfma_f32_16x16x32_bf16 v[180:183], a[244:247], v[84:87], v[180:183]
    v_exp_f32 v46, v150
    v_exp_f32 v47, v151
    v_mfma_f32_16x16x32_bf16 v[180:183], a[248:251], v[88:91], v[180:183]
    v_cvt_pk_bf16_f32 v199, v46, v47
    v_exp_f32 v44, v152
    v_mfma_f32_16x16x32_bf16 v[180:183], a[252:255], v[92:95], v[180:183]
    v_exp_f32 v45, v153
    v_mfma_f32_16x16x32_bf16 v[184:187], a[240:243], v[96:99], v[56:59]
    ds_read_b128 a[232:235], v28 offset:49152
    ds_read_b128 a[236:239], v29 offset:49152
    v_cvt_pk_bf16_f32 v202, v44, v45
    v_mfma_f32_16x16x32_bf16 v[184:187], a[244:247], v[100:103], v[184:187]
    ds_read_b64_tr_b16 a[128:129], v30 offset:0
    ds_read_b64_tr_b16 a[130:131], v30 offset:1024
    v_exp_f32 v46, v154
    v_mfma_f32_16x16x32_bf16 v[184:187], a[248:251], v[104:107], v[184:187]
    v_exp_f32 v47, v155
    v_exp_f32 v44, v156
    v_mfma_f32_16x16x32_bf16 v[184:187], a[252:255], v[108:111], v[184:187]
    v_cvt_pk_bf16_f32 v203, v46, v47
    v_exp_f32 v45, v157
    v_mfma_f32_16x16x32_bf16 v[188:191], a[240:243], v[112:115], v[60:63]
    ds_read_b64_tr_b16 a[132:133], v31 offset:0
    ds_read_b64_tr_b16 a[134:135], v31 offset:1024
    v_cvt_pk_bf16_f32 v206, v44, v45
    v_mfma_f32_16x16x32_bf16 v[188:191], a[244:247], v[116:119], v[188:191]
    v_exp_f32 v46, v158
    v_exp_f32 v47, v159
    v_mfma_f32_16x16x32_bf16 v[188:191], a[248:251], v[120:123], v[188:191]
    v_cvt_pk_bf16_f32 v207, v46, v47
    v_mfma_f32_16x16x32_bf16 v[188:191], a[252:255], v[124:127], v[188:191]
    s_waitcnt lgkmcnt(4)
    s_mov_b32 s51, 49152
    s_mov_b32 s52, 32768
    s_add_u32 m0, s42, 114688
    s_mov_b32 s53, 4
.p2align 3
L_loopA:
    v_mfma_f32_16x16x32_bf16 v[128:131], a[224:227], v[64:67], v[48:51]
    v_exp_f32 v44, v160
    v_mfma_f32_16x16x32_bf16 v[128:131], a[228:231], v[68:71], v[128:131]
    v_exp_f32 v45, v161
    v_mfma_f32_16x16x32_bf16 v[128:131], a[232:235], v[72:75], v[128:131]
    s_mul_i32 s50, s54, 44032
    ds_read_b64_tr_b16 a[136:137], v32 offset:0
    v_mfma_f32_16x16x32_bf16 v[128:131], a[236:239], v[76:79], v[128:131]
    s_waitcnt lgkmcnt(3)
    ds_read_b64_tr_b16 a[138:139], v32 offset:1024
    v_cvt_pk_bf16_f32 v208, v44, v45
    v_mfma_f32_16x16x32_bf16 a[0:3], a[128:131], v[192:195], a[0:3]
    s_add_u32 s50, s50, s100
    v_exp_f32 v46, v162
    v_mfma_f32_16x16x32_bf16 a[4:7], a[128:131], v[196:199], a[4:7]
    v_exp_f32 v47, v163
    v_mfma_f32_16x16x32_bf16 a[8:11], a[128:131], v[200:203], a[8:11]
    ds_read_b128 a[240:243], v26 offset:50176
    v_mfma_f32_16x16x32_bf16 a[12:15], a[128:131], v[204:207], a[12:15]
    ds_read_b128 a[244:247], v27 offset:50176
    v_cvt_pk_bf16_f32 v209, v46, v47
    v_mfma_f32_16x16x32_bf16 v[224:227], v[40:43], v[192:195], v[224:227]
    buffer_store_dwordx4 v[240:243], v38, s[32:35], s50 offen sc1
    v_mfma_f32_16x16x32_bf16 v[132:135], a[224:227], v[80:83], v[52:55]
    v_exp_f32 v44, v164
    v_mfma_f32_16x16x32_bf16 v[132:135], a[228:231], v[84:87], v[132:135]
    v_exp_f32 v45, v165
    v_mfma_f32_16x16x32_bf16 v[132:135], a[232:235], v[88:91], v[132:135]
    ds_read_b64_tr_b16 a[140:141], v33 offset:0
    v_mfma_f32_16x16x32_bf16 v[132:135], a[236:239], v[92:95], v[132:135]
    s_waitcnt lgkmcnt(5)
    ds_read_b64_tr_b16 a[142:143], v33 offset:1024
    v_cvt_pk_bf16_f32 v212, v44, v45
    v_mfma_f32_16x16x32_bf16 a[16:19], a[132:135], v[192:195], a[16:19]
    v_exp_f32 v46, v166
    v_mfma_f32_16x16x32_bf16 a[20:23], a[132:135], v[196:199], a[20:23]
    v_exp_f32 v47, v167
    v_mfma_f32_16x16x32_bf16 a[24:27], a[132:135], v[200:203], a[24:27]
    ds_read_b128 a[248:251], v28 offset:50176
    v_mfma_f32_16x16x32_bf16 a[28:31], a[132:135], v[204:207], a[28:31]
    ds_read_b128 a[252:255], v29 offset:50176
    v_cvt_pk_bf16_f32 v213, v46, v47
    v_mfma_f32_16x16x32_bf16 v[228:231], v[40:43], v[196:199], v[228:231]
    v_mfma_f32_16x16x32_bf16 v[136:139], a[224:227], v[96:99], v[56:59]
    v_exp_f32 v44, v168
    v_mfma_f32_16x16x32_bf16 v[136:139], a[228:231], v[100:103], v[136:139]
    v_exp_f32 v45, v169
    v_mfma_f32_16x16x32_bf16 v[136:139], a[232:235], v[104:107], v[136:139]
    ds_read_b64_tr_b16 a[128:129], v34 offset:0
    v_mfma_f32_16x16x32_bf16 v[136:139], a[236:239], v[108:111], v[136:139]
    s_waitcnt lgkmcnt(7)
    ds_read_b64_tr_b16 a[130:131], v34 offset:1024
    v_cvt_pk_bf16_f32 v216, v44, v45
    v_mfma_f32_16x16x32_bf16 a[32:35], a[136:139], v[192:195], a[32:35]
    v_exp_f32 v46, v170
    v_mfma_f32_16x16x32_bf16 a[36:39], a[136:139], v[196:199], a[36:39]
    v_exp_f32 v47, v171
    v_mfma_f32_16x16x32_bf16 a[40:43], a[136:139], v[200:203], a[40:43]
    buffer_load_dwordx4 v14, s[20:23], s51 offen offset:2048 lds
    v_mfma_f32_16x16x32_bf16 a[44:47], a[136:139], v[204:207], a[44:47]
    v_cvt_pk_bf16_f32 v217, v46, v47
    v_mfma_f32_16x16x32_bf16 v[140:143], a[224:227], v[112:115], v[60:63]
    v_exp_f32 v44, v172
    v_mfma_f32_16x16x32_bf16 v[140:143], a[228:231], v[116:119], v[140:143]
    v_exp_f32 v45, v173
    v_mfma_f32_16x16x32_bf16 v[140:143], a[232:235], v[120:123], v[140:143]
    s_mul_i32 s50, s55, 44032
    ds_read_b64_tr_b16 a[132:133], v35 offset:0
    v_mfma_f32_16x16x32_bf16 v[140:143], a[236:239], v[124:127], v[140:143]
    s_waitcnt lgkmcnt(5)
    ds_read_b64_tr_b16 a[134:135], v35 offset:1024
    v_cvt_pk_bf16_f32 v220, v44, v45
    v_mfma_f32_16x16x32_bf16 a[48:51], a[140:143], v[192:195], a[48:51]
    s_add_u32 s50, s50, s100
    v_exp_f32 v46, v174
    v_mfma_f32_16x16x32_bf16 a[52:55], a[140:143], v[196:199], a[52:55]
    v_exp_f32 v47, v175
    v_mfma_f32_16x16x32_bf16 a[56:59], a[140:143], v[200:203], a[56:59]
    buffer_load_dwordx4 v14, s[20:23], s51 offen offset:3072 lds
    v_mfma_f32_16x16x32_bf16 a[60:63], a[140:143], v[204:207], a[60:63]
    v_cvt_pk_bf16_f32 v221, v46, v47
    v_mfma_f32_16x16x32_bf16 v[232:235], v[40:43], v[200:203], v[232:235]
    s_waitcnt lgkmcnt(4)
    buffer_store_dwordx4 v[244:247], v38, s[32:35], s50 offen sc1
    v_mfma_f32_16x16x32_bf16 v[144:147], a[240:243], v[64:67], v[48:51]
    v_exp_f32 v44, v176
    v_mfma_f32_16x16x32_bf16 v[144:147], a[244:247], v[68:71], v[144:147]
    v_exp_f32 v45, v177
    v_mfma_f32_16x16x32_bf16 v[144:147], a[248:251], v[72:75], v[144:147]
    ds_read_b64_tr_b16 a[136:137], v36 offset:0
    v_mfma_f32_16x16x32_bf16 v[144:147], a[252:255], v[76:79], v[144:147]
    s_waitcnt lgkmcnt(3)
    ds_read_b64_tr_b16 a[138:139], v36 offset:1024
    v_cvt_pk_bf16_f32 v210, v44, v45
    v_mfma_f32_16x16x32_bf16 a[64:67], a[128:131], v[192:195], a[64:67]
    v_exp_f32 v46, v178
    v_mfma_f32_16x16x32_bf16 a[68:71], a[128:131], v[196:199], a[68:71]
    v_exp_f32 v47, v179
    v_mfma_f32_16x16x32_bf16 a[72:75], a[128:131], v[200:203], a[72:75]
    ds_read_b128 a[224:227], v26 offset:51200
    v_mfma_f32_16x16x32_bf16 a[76:79], a[128:131], v[204:207], a[76:79]
    ds_read_b128 a[228:231], v27 offset:51200
    v_cvt_pk_bf16_f32 v211, v46, v47
    v_mfma_f32_16x16x32_bf16 v[148:151], a[240:243], v[80:83], v[52:55]
    s_add_u32 s51, s51, 16384
    v_exp_f32 v44, v180
    v_mfma_f32_16x16x32_bf16 v[148:151], a[244:247], v[84:87], v[148:151]
    v_exp_f32 v45, v181
    v_mfma_f32_16x16x32_bf16 v[148:151], a[248:251], v[88:91], v[148:151]
    ds_read_b64_tr_b16 a[140:141], v37 offset:0
    v_mfma_f32_16x16x32_bf16 v[148:151], a[252:255], v[92:95], v[148:151]
    ds_read_b64_tr_b16 a[142:143], v37 offset:1024
    v_cvt_pk_bf16_f32 v214, v44, v45
    v_mfma_f32_16x16x32_bf16 v[236:239], v[40:43], v[204:207], v[236:239]
    s_waitcnt lgkmcnt(6)
    v_mfma_f32_16x16x32_bf16 a[80:83], a[132:135], v[192:195], a[80:83]
    v_exp_f32 v46, v182
    v_mfma_f32_16x16x32_bf16 a[84:87], a[132:135], v[196:199], a[84:87]
    v_exp_f32 v47, v183
    v_mfma_f32_16x16x32_bf16 a[88:91], a[132:135], v[200:203], a[88:91]
    ds_read_b128 a[232:235], v28 offset:51200
    v_mfma_f32_16x16x32_bf16 a[92:95], a[132:135], v[204:207], a[92:95]
    ds_read_b128 a[236:239], v29 offset:51200
    v_cvt_pk_bf16_f32 v215, v46, v47
    v_mfma_f32_16x16x32_bf16 v[152:155], a[240:243], v[96:99], v[56:59]
    v_exp_f32 v44, v184
    v_mfma_f32_16x16x32_bf16 v[152:155], a[244:247], v[100:103], v[152:155]
    v_exp_f32 v45, v185
    v_mfma_f32_16x16x32_bf16 v[152:155], a[248:251], v[104:107], v[152:155]
    ds_read_b64_tr_b16 a[128:129], v30 offset:2048
    v_mfma_f32_16x16x32_bf16 v[152:155], a[252:255], v[108:111], v[152:155]
    s_waitcnt lgkmcnt(7)
    ds_read_b64_tr_b16 a[130:131], v30 offset:3072
    v_cvt_pk_bf16_f32 v218, v44, v45
    v_mfma_f32_16x16x32_bf16 a[96:99], a[136:139], v[192:195], a[96:99]
    v_exp_f32 v46, v186
    v_mfma_f32_16x16x32_bf16 a[100:103], a[136:139], v[196:199], a[100:103]
    s_add_u32 m0, s42, 32768
    v_exp_f32 v47, v187
    v_mfma_f32_16x16x32_bf16 a[104:107], a[136:139], v[200:203], a[104:107]
    buffer_load_dwordx4 v15, s[24:27], s52 offen offset:0 lds
    v_mfma_f32_16x16x32_bf16 a[108:111], a[136:139], v[204:207], a[108:111]
    v_cvt_pk_bf16_f32 v219, v46, v47
    v_mfma_f32_16x16x32_bf16 v[156:159], a[240:243], v[112:115], v[60:63]
    v_exp_f32 v44, v188
    v_mfma_f32_16x16x32_bf16 v[156:159], a[244:247], v[116:119], v[156:159]
    v_exp_f32 v45, v189
    v_mfma_f32_16x16x32_bf16 v[156:159], a[248:251], v[120:123], v[156:159]
    ds_read_b64_tr_b16 a[132:133], v31 offset:2048
    v_mfma_f32_16x16x32_bf16 v[156:159], a[252:255], v[124:127], v[156:159]
    s_waitcnt lgkmcnt(5)
    ds_read_b64_tr_b16 a[134:135], v31 offset:3072
    v_cvt_pk_bf16_f32 v222, v44, v45
    v_mfma_f32_16x16x32_bf16 a[112:115], a[140:143], v[192:195], a[112:115]
    v_exp_f32 v46, v190
    v_mfma_f32_16x16x32_bf16 a[116:119], a[140:143], v[196:199], a[116:119]
    v_exp_f32 v47, v191
    v_mfma_f32_16x16x32_bf16 a[120:123], a[140:143], v[200:203], a[120:123]
    buffer_load_dwordx4 v15, s[24:27], s52 offen offset:1024 lds
    v_mfma_f32_16x16x32_bf16 a[124:127], a[140:143], v[204:207], a[124:127]
    s_waitcnt lgkmcnt(4)
    v_cvt_pk_bf16_f32 v223, v46, v47
    v_mfma_f32_16x16x32_bf16 v[160:163], a[224:227], v[64:67], v[48:51]
    v_exp_f32 v44, v128
    v_mfma_f32_16x16x32_bf16 v[160:163], a[228:231], v[68:71], v[160:163]
    v_exp_f32 v45, v129
    v_mfma_f32_16x16x32_bf16 v[160:163], a[232:235], v[72:75], v[160:163]
    ds_read_b64_tr_b16 a[136:137], v32 offset:2048
    v_mfma_f32_16x16x32_bf16 v[160:163], a[236:239], v[76:79], v[160:163]
    s_waitcnt lgkmcnt(3)
    ds_read_b64_tr_b16 a[138:139], v32 offset:3072
    v_cvt_pk_bf16_f32 v192, v44, v45
    v_mfma_f32_16x16x32_bf16 a[0:3], a[128:131], v[208:211], a[0:3]
    v_exp_f32 v46, v130
    v_mfma_f32_16x16x32_bf16 a[4:7], a[128:131], v[212:215], a[4:7]
    v_exp_f32 v47, v131
    v_mfma_f32_16x16x32_bf16 a[8:11], a[128:131], v[216:219], a[8:11]
    ds_read_b128 a[240:243], v26 offset:52224
    v_mfma_f32_16x16x32_bf16 a[12:15], a[128:131], v[220:223], a[12:15]
    ds_read_b128 a[244:247], v27 offset:52224
    v_cvt_pk_bf16_f32 v193, v46, v47
    v_mfma_f32_16x16x32_bf16 v[164:167], a[224:227], v[80:83], v[52:55]
    v_exp_f32 v44, v132
    v_mfma_f32_16x16x32_bf16 v[164:167], a[228:231], v[84:87], v[164:167]
    v_exp_f32 v45, v133
    v_mfma_f32_16x16x32_bf16 v[164:167], a[232:235], v[88:91], v[164:167]
    ds_read_b64_tr_b16 a[140:141], v33 offset:2048
    v_mfma_f32_16x16x32_bf16 v[164:167], a[236:239], v[92:95], v[164:167]
    s_waitcnt lgkmcnt(5)
    ds_read_b64_tr_b16 a[142:143], v33 offset:3072
    v_cvt_pk_bf16_f32 v196, v44, v45
    v_mfma_f32_16x16x32_bf16 a[16:19], a[132:135], v[208:211], a[16:19]
    v_exp_f32 v46, v134
    v_mfma_f32_16x16x32_bf16 a[20:23], a[132:135], v[212:215], a[20:23]
    v_exp_f32 v47, v135
    v_mfma_f32_16x16x32_bf16 a[24:27], a[132:135], v[216:219], a[24:27]
    ds_read_b128 a[248:251], v28 offset:52224
    v_mfma_f32_16x16x32_bf16 a[28:31], a[132:135], v[220:223], a[28:31]
    ds_read_b128 a[252:255], v29 offset:52224
    v_cvt_pk_bf16_f32 v197, v46, v47
    v_mfma_f32_16x16x32_bf16 v[168:171], a[224:227], v[96:99], v[56:59]
    v_exp_f32 v44, v136
    v_mfma_f32_16x16x32_bf16 v[168:171], a[228:231], v[100:103], v[168:171]
    v_exp_f32 v45, v137
    v_mfma_f32_16x16x32_bf16 v[168:171], a[232:235], v[104:107], v[168:171]
    ds_read_b64_tr_b16 a[128:129], v34 offset:2048
    v_mfma_f32_16x16x32_bf16 v[168:171], a[236:239], v[108:111], v[168:171]
    s_waitcnt lgkmcnt(7)
    ds_read_b64_tr_b16 a[130:131], v34 offset:3072
    v_cvt_pk_bf16_f32 v200, v44, v45
    v_mfma_f32_16x16x32_bf16 a[32:35], a[136:139], v[208:211], a[32:35]
    v_exp_f32 v46, v138
    v_mfma_f32_16x16x32_bf16 a[36:39], a[136:139], v[212:215], a[36:39]
    v_exp_f32 v47, v139
    v_mfma_f32_16x16x32_bf16 a[40:43], a[136:139], v[216:219], a[40:43]
    buffer_load_dwordx4 v15, s[24:27], s52 offen offset:2048 lds
    v_mfma_f32_16x16x32_bf16 a[44:47], a[136:139], v[220:223], a[44:47]
    v_cvt_pk_bf16_f32 v201, v46, v47
    v_mfma_f32_16x16x32_bf16 v[172:175], a[224:227], v[112:115], v[60:63]
    v_exp_f32 v44, v140
    v_mfma_f32_16x16x32_bf16 v[172:175], a[228:231], v[116:119], v[172:175]
    v_exp_f32 v45, v141
    v_mfma_f32_16x16x32_bf16 v[172:175], a[232:235], v[120:123], v[172:175]
    ds_read_b64_tr_b16 a[132:133], v35 offset:2048
    v_mfma_f32_16x16x32_bf16 v[172:175], a[236:239], v[124:127], v[172:175]
    s_waitcnt lgkmcnt(5)
    ds_read_b64_tr_b16 a[134:135], v35 offset:3072
    v_cvt_pk_bf16_f32 v204, v44, v45
    v_mfma_f32_16x16x32_bf16 a[48:51], a[140:143], v[208:211], a[48:51]
    v_exp_f32 v46, v142
    v_mfma_f32_16x16x32_bf16 a[52:55], a[140:143], v[212:215], a[52:55]
    v_exp_f32 v47, v143
    v_mfma_f32_16x16x32_bf16 a[56:59], a[140:143], v[216:219], a[56:59]
    buffer_load_dwordx4 v15, s[24:27], s52 offen offset:3072 lds
    v_mfma_f32_16x16x32_bf16 a[60:63], a[140:143], v[220:223], a[60:63]
    s_waitcnt lgkmcnt(4)
    v_cvt_pk_bf16_f32 v205, v46, v47
    v_mfma_f32_16x16x32_bf16 v[176:179], a[240:243], v[64:67], v[48:51]
    s_waitcnt vmcnt(10)
    v_exp_f32 v44, v144
    v_mfma_f32_16x16x32_bf16 v[176:179], a[244:247], v[68:71], v[176:179]
    s_barrier
    v_exp_f32 v45, v145
    v_mfma_f32_16x16x32_bf16 v[176:179], a[248:251], v[72:75], v[176:179]
    ds_read_b64_tr_b16 a[136:137], v36 offset:2048
    v_mfma_f32_16x16x32_bf16 v[176:179], a[252:255], v[76:79], v[176:179]
    ds_read_b64_tr_b16 a[138:139], v36 offset:3072
    v_cvt_pk_bf16_f32 v194, v44, v45
    v_mfma_f32_16x16x32_bf16 v[224:227], v[40:43], v[208:211], v[224:227]
    s_waitcnt lgkmcnt(4)
    global_load_dword v22, v9, s[84:85] sc1
    v_mfma_f32_16x16x32_bf16 a[64:67], a[128:131], v[208:211], a[64:67]
    v_exp_f32 v46, v146
    v_mfma_f32_16x16x32_bf16 a[68:71], a[128:131], v[212:215], a[68:71]
    v_exp_f32 v47, v147
    v_mfma_f32_16x16x32_bf16 a[72:75], a[128:131], v[216:219], a[72:75]
    ds_read_b128 a[224:227], v26 offset:0
    v_mfma_f32_16x16x32_bf16 a[76:79], a[128:131], v[220:223], a[76:79]
    s_mul_i32 s50, s56, 44032
    ds_read_b128 a[228:231], v27 offset:0
    v_cvt_pk_bf16_f32 v195, v46, v47
    v_mfma_f32_16x16x32_bf16 v[228:231], v[40:43], v[212:215], v[228:231]
    s_add_u32 s50, s50, s100
    v_mfma_f32_16x16x32_bf16 v[180:183], a[240:243], v[80:83], v[52:55]
    s_add_u32 s52, s52, 16384
    v_exp_f32 v44, v148
    v_mfma_f32_16x16x32_bf16 v[180:183], a[244:247], v[84:87], v[180:183]
    v_exp_f32 v45, v149
    v_mfma_f32_16x16x32_bf16 v[180:183], a[248:251], v[88:91], v[180:183]
    ds_read_b64_tr_b16 a[140:141], v37 offset:2048
    v_mfma_f32_16x16x32_bf16 v[180:183], a[252:255], v[92:95], v[180:183]
    ds_read_b64_tr_b16 a[142:143], v37 offset:3072
    v_cvt_pk_bf16_f32 v198, v44, v45
    v_mfma_f32_16x16x32_bf16 v[232:235], v[40:43], v[216:219], v[232:235]
    s_waitcnt lgkmcnt(6)
    buffer_store_dwordx4 v[248:251], v38, s[32:35], s50 offen sc1
    v_mfma_f32_16x16x32_bf16 a[80:83], a[132:135], v[208:211], a[80:83]
    v_exp_f32 v46, v150
    v_mfma_f32_16x16x32_bf16 a[84:87], a[132:135], v[212:215], a[84:87]
    v_exp_f32 v47, v151
    v_mfma_f32_16x16x32_bf16 a[88:91], a[132:135], v[216:219], a[88:91]
    ds_read_b128 a[232:235], v28 offset:0
    v_mfma_f32_16x16x32_bf16 a[92:95], a[132:135], v[220:223], a[92:95]
    ds_read_b128 a[236:239], v29 offset:0
    v_cvt_pk_bf16_f32 v199, v46, v47
    v_mfma_f32_16x16x32_bf16 v[236:239], v[40:43], v[220:223], v[236:239]
    v_mfma_f32_16x16x32_bf16 v[184:187], a[240:243], v[96:99], v[56:59]
    v_exp_f32 v44, v152
    v_mfma_f32_16x16x32_bf16 v[184:187], a[244:247], v[100:103], v[184:187]
    v_exp_f32 v45, v153
    v_mfma_f32_16x16x32_bf16 v[184:187], a[248:251], v[104:107], v[184:187]
    ds_read_b64_tr_b16 a[128:129], v30 offset:16384
    v_mfma_f32_16x16x32_bf16 v[184:187], a[252:255], v[108:111], v[184:187]
    s_waitcnt lgkmcnt(7)
    ds_read_b64_tr_b16 a[130:131], v30 offset:17408
    v_cvt_pk_bf16_f32 v202, v44, v45
    v_mfma_f32_16x16x32_bf16 a[96:99], a[136:139], v[208:211], a[96:99]
    v_exp_f32 v46, v154
    v_mfma_f32_16x16x32_bf16 a[100:103], a[136:139], v[212:215], a[100:103]
    s_add_u32 m0, s42, 131072
    v_exp_f32 v47, v155
    v_mfma_f32_16x16x32_bf16 a[104:107], a[136:139], v[216:219], a[104:107]
    buffer_load_dwordx4 v14, s[20:23], s51 offen offset:0 lds
    v_mfma_f32_16x16x32_bf16 a[108:111], a[136:139], v[220:223], a[108:111]
    v_cvt_pk_bf16_f32 v203, v46, v47
    v_mfma_f32_16x16x32_bf16 v[188:191], a[240:243], v[112:115], v[60:63]
    v_exp_f32 v44, v156
    v_mfma_f32_16x16x32_bf16 v[188:191], a[244:247], v[116:119], v[188:191]
    v_exp_f32 v45, v157
    v_mfma_f32_16x16x32_bf16 v[188:191], a[248:251], v[120:123], v[188:191]
    ds_read_b64_tr_b16 a[132:133], v31 offset:16384
    v_mfma_f32_16x16x32_bf16 v[188:191], a[252:255], v[124:127], v[188:191]
    s_waitcnt lgkmcnt(5)
    ds_read_b64_tr_b16 a[134:135], v31 offset:17408
    v_cvt_pk_bf16_f32 v206, v44, v45
    v_mfma_f32_16x16x32_bf16 a[112:115], a[140:143], v[208:211], a[112:115]
    v_exp_f32 v46, v158
    v_mfma_f32_16x16x32_bf16 a[116:119], a[140:143], v[212:215], a[116:119]
    v_exp_f32 v47, v159
    v_mfma_f32_16x16x32_bf16 a[120:123], a[140:143], v[216:219], a[120:123]
    buffer_load_dwordx4 v14, s[20:23], s51 offen offset:1024 lds
    v_mfma_f32_16x16x32_bf16 a[124:127], a[140:143], v[220:223], a[124:127]
    s_waitcnt lgkmcnt(4)
    v_cvt_pk_bf16_f32 v207, v46, v47
    v_mfma_f32_16x16x32_bf16 v[128:131], a[224:227], v[64:67], v[48:51]
    v_exp_f32 v44, v160
    v_mfma_f32_16x16x32_bf16 v[128:131], a[228:231], v[68:71], v[128:131]
    v_exp_f32 v45, v161
    v_mfma_f32_16x16x32_bf16 v[128:131], a[232:235], v[72:75], v[128:131]
    s_mul_i32 s50, s57, 44032
    ds_read_b64_tr_b16 a[136:137], v32 offset:16384
    ds_read_b64_tr_b16 a[160:161], v16 offset:0
    v_mfma_f32_16x16x32_bf16 v[128:131], a[236:239], v[76:79], v[128:131]
    s_waitcnt lgkmcnt(4)
    ds_read_b64_tr_b16 a[138:139], v32 offset:17408
    v_cvt_pk_bf16_f32 v208, v44, v45
    v_mfma_f32_16x16x32_bf16 a[0:3], a[128:131], v[192:195], a[0:3]
    s_add_u32 s50, s50, s100
    v_exp_f32 v46, v162
    v_mfma_f32_16x16x32_bf16 a[4:7], a[128:131], v[196:199], a[4:7]
    v_exp_f32 v47, v163
    v_mfma_f32_16x16x32_bf16 a[8:11], a[128:131], v[200:203], a[8:11]
    ds_read_b128 a[240:243], v26 offset:1024
    ds_read_b64_tr_b16 a[162:163], v16 offset:2048
    v_mfma_f32_16x16x32_bf16 a[12:15], a[128:131], v[204:207], a[12:15]
    ds_read_b128 a[244:247], v27 offset:1024
    v_cvt_pk_bf16_f32 v209, v46, v47
    v_mfma_f32_16x16x32_bf16 v[224:227], v[40:43], v[192:195], v[224:227]
    buffer_store_dwordx4 v[252:255], v38, s[32:35], s50 offen sc1
    v_mfma_f32_16x16x32_bf16 v[132:135], a[224:227], v[80:83], v[52:55]
    v_exp_f32 v44, v164
    v_mfma_f32_16x16x32_bf16 v[132:135], a[228:231], v[84:87], v[132:135]
    v_exp_f32 v45, v165
    v_mfma_f32_16x16x32_bf16 v[132:135], a[232:235], v[88:91], v[132:135]
    ds_read_b64_tr_b16 a[140:141], v33 offset:16384
    ds_read_b64_tr_b16 a[164:165], v17 offset:0
    v_mfma_f32_16x16x32_bf16 v[132:135], a[236:239], v[92:95], v[132:135]
    s_waitcnt lgkmcnt(8)
    ds_read_b64_tr_b16 a[142:143], v33 offset:17408
    v_cvt_pk_bf16_f32 v212, v44, v45
    v_mfma_f32_16x16x32_bf16 a[16:19], a[132:135], v[192:195], a[16:19]
    v_exp_f32 v46, v166
    v_mfma_f32_16x16x32_bf16 a[20:23], a[132:135], v[196:199], a[20:23]
    v_exp_f32 v47, v167
    v_mfma_f32_16x16x32_bf16 a[24:27], a[132:135], v[200:203], a[24:27]
    ds_read_b128 a[248:251], v28 offset:1024
    v_mfma_f32_16x16x32_bf16 a[28:31], a[132:135], v[204:207], a[28:31]
    ds_read_b128 a[252:255], v29 offset:1024
    v_cvt_pk_bf16_f32 v213, v46, v47
    v_mfma_f32_16x16x32_bf16 v[228:231], v[40:43], v[196:199], v[228:231]
    ds_read_b64_tr_b16 a[166:167], v17 offset:2048
    v_mfma_f32_16x16x32_bf16 v[136:139], a[224:227], v[96:99], v[56:59]
    v_exp_f32 v44, v168
    v_mfma_f32_16x16x32_bf16 v[136:139], a[228:231], v[100:103], v[136:139]
    v_exp_f32 v45, v169
    v_mfma_f32_16x16x32_bf16 v[136:139], a[232:235], v[104:107], v[136:139]
    ds_read_b64_tr_b16 a[128:129], v34 offset:16384
    v_mfma_f32_16x16x32_bf16 v[136:139], a[236:239], v[108:111], v[136:139]
    s_waitcnt lgkmcnt(10)
    ds_read_b64_tr_b16 a[130:131], v34 offset:17408
    v_cvt_pk_bf16_f32 v216, v44, v45
    v_mfma_f32_16x16x32_bf16 a[32:35], a[136:139], v[192:195], a[32:35]
    v_exp_f32 v46, v170
    v_mfma_f32_16x16x32_bf16 a[36:39], a[136:139], v[196:199], a[36:39]
    v_exp_f32 v47, v171
    v_mfma_f32_16x16x32_bf16 a[40:43], a[136:139], v[200:203], a[40:43]
    buffer_load_dwordx4 v14, s[20:23], s51 offen offset:2048 lds
    v_mfma_f32_16x16x32_bf16 a[44:47], a[136:139], v[204:207], a[44:47]
    ds_read_b64_tr_b16 a[168:169], v18 offset:0
    v_cvt_pk_bf16_f32 v217, v46, v47
    v_mfma_f32_16x16x32_bf16 v[140:143], a[224:227], v[112:115], v[60:63]
    v_exp_f32 v44, v172
    v_mfma_f32_16x16x32_bf16 v[140:143], a[228:231], v[116:119], v[140:143]
    v_exp_f32 v45, v173
    v_mfma_f32_16x16x32_bf16 v[140:143], a[232:235], v[120:123], v[140:143]
    s_mul_i32 s50, s54, 44032
    ds_read_b64_tr_b16 a[132:133], v35 offset:16384
    v_mfma_f32_16x16x32_bf16 v[140:143], a[236:239], v[124:127], v[140:143]
    s_waitcnt lgkmcnt(7)
    ds_read_b64_tr_b16 a[134:135], v35 offset:17408
    v_cvt_pk_bf16_f32 v220, v44, v45
    v_mfma_f32_16x16x32_bf16 a[48:51], a[140:143], v[192:195], a[48:51]
    s_add_u32 s50, s50, s3
    v_exp_f32 v46, v174
    v_mfma_f32_16x16x32_bf16 a[52:55], a[140:143], v[196:199], a[52:55]
    v_exp_f32 v47, v175
    v_mfma_f32_16x16x32_bf16 a[56:59], a[140:143], v[200:203], a[56:59]
    buffer_load_dwordx4 v14, s[20:23], s51 offen offset:3072 lds
    v_mfma_f32_16x16x32_bf16 a[60:63], a[140:143], v[204:207], a[60:63]
    ds_read_b64_tr_b16 a[170:171], v18 offset:2048
    v_cvt_pk_bf16_f32 v221, v46, v47
    v_mfma_f32_16x16x32_bf16 v[232:235], v[40:43], v[200:203], v[232:235]
    s_waitcnt lgkmcnt(7)
    buffer_store_dwordx4 a[176:179], v38, s[32:35], s50 offen sc1
    v_mfma_f32_16x16x32_bf16 v[144:147], a[240:243], v[64:67], v[48:51]
    v_exp_f32 v44, v176
    v_mfma_f32_16x16x32_bf16 v[144:147], a[244:247], v[68:71], v[144:147]
    v_exp_f32 v45, v177
    v_mfma_f32_16x16x32_bf16 v[144:147], a[248:251], v[72:75], v[144:147]
    ds_read_b64_tr_b16 a[136:137], v36 offset:16384
    ds_read_b64_tr_b16 a[172:173], v19 offset:0
    v_mfma_f32_16x16x32_bf16 v[144:147], a[252:255], v[76:79], v[144:147]
    s_waitcnt lgkmcnt(6)
    ds_read_b64_tr_b16 a[138:139], v36 offset:17408
    v_cvt_pk_bf16_f32 v210, v44, v45
    v_mfma_f32_16x16x32_bf16 a[64:67], a[128:131], v[192:195], a[64:67]
    v_exp_f32 v46, v178
    v_mfma_f32_16x16x32_bf16 a[68:71], a[128:131], v[196:199], a[68:71]
    v_exp_f32 v47, v179
    v_mfma_f32_16x16x32_bf16 a[72:75], a[128:131], v[200:203], a[72:75]
    ds_read_b128 a[224:227], v26 offset:2048
    ds_read_b64_tr_b16 a[174:175], v19 offset:2048
    v_mfma_f32_16x16x32_bf16 a[76:79], a[128:131], v[204:207], a[76:79]
    ds_read_b128 a[228:231], v27 offset:2048
    v_cvt_pk_bf16_f32 v211, v46, v47
    v_mfma_f32_16x16x32_bf16 v[148:151], a[240:243], v[80:83], v[52:55]
    s_add_u32 s51, s51, 16384
    v_exp_f32 v44, v180
    v_mfma_f32_16x16x32_bf16 v[148:151], a[244:247], v[84:87], v[148:151]
    v_exp_f32 v45, v181
    v_mfma_f32_16x16x32_bf16 v[148:151], a[248:251], v[88:91], v[148:151]
    ds_read_b64_tr_b16 a[140:141], v37 offset:16384
    v_mfma_f32_16x16x32_bf16 v[148:151], a[252:255], v[92:95], v[148:151]
    ds_read_b64_tr_b16 a[142:143], v37 offset:17408
    v_cvt_pk_bf16_f32 v214, v44, v45
    v_mfma_f32_16x16x32_bf16 v[236:239], v[40:43], v[204:207], v[236:239]
    s_waitcnt lgkmcnt(9)
    ds_read_b64_tr_b16 a[144:145], v16 offset:16384
    ds_read_b64_tr_b16 a[146:147], v16 offset:18432
    v_mfma_f32_16x16x32_bf16 a[80:83], a[132:135], v[192:195], a[80:83]
    v_exp_f32 v46, v182
    v_mfma_f32_16x16x32_bf16 a[84:87], a[132:135], v[196:199], a[84:87]
    v_exp_f32 v47, v183
    v_mfma_f32_16x16x32_bf16 a[88:91], a[132:135], v[200:203], a[88:91]
    ds_read_b128 a[232:235], v28 offset:2048
    ds_read_b64_tr_b16 a[148:149], v17 offset:16384
    v_mfma_f32_16x16x32_bf16 a[92:95], a[132:135], v[204:207], a[92:95]
    ds_read_b128 a[236:239], v29 offset:2048
    v_cvt_pk_bf16_f32 v215, v46, v47
    v_mfma_f32_16x16x32_bf16 v[152:155], a[240:243], v[96:99], v[56:59]
    v_exp_f32 v44, v184
    v_mfma_f32_16x16x32_bf16 v[152:155], a[244:247], v[100:103], v[152:155]
    v_exp_f32 v45, v185
    v_mfma_f32_16x16x32_bf16 v[152:155], a[248:251], v[104:107], v[152:155]
    ds_read_b64_tr_b16 a[128:129], v30 offset:18432
    v_mfma_f32_16x16x32_bf16 v[152:155], a[252:255], v[108:111], v[152:155]
    s_waitcnt lgkmcnt(11)
    ds_read_b64_tr_b16 a[130:131], v30 offset:19456
    v_cvt_pk_bf16_f32 v218, v44, v45
    v_mfma_f32_16x16x32_bf16 a[96:99], a[136:139], v[192:195], a[96:99]
    v_exp_f32 v46, v186
    v_mfma_f32_16x16x32_bf16 a[100:103], a[136:139], v[196:199], a[100:103]
    s_add_u32 m0, s42, 49152
    v_exp_f32 v47, v187
    v_mfma_f32_16x16x32_bf16 a[104:107], a[136:139], v[200:203], a[104:107]
    buffer_load_dwordx4 v15, s[24:27], s52 offen offset:0 lds
    v_mfma_f32_16x16x32_bf16 a[108:111], a[136:139], v[204:207], a[108:111]
    ds_read_b64_tr_b16 a[150:151], v17 offset:18432
    v_cvt_pk_bf16_f32 v219, v46, v47
    v_mfma_f32_16x16x32_bf16 v[156:159], a[240:243], v[112:115], v[60:63]
    v_exp_f32 v44, v188
    v_mfma_f32_16x16x32_bf16 v[156:159], a[244:247], v[116:119], v[156:159]
    v_exp_f32 v45, v189
    v_mfma_f32_16x16x32_bf16 v[156:159], a[248:251], v[120:123], v[156:159]
    ds_read_b64_tr_b16 a[132:133], v31 offset:18432
    v_mfma_f32_16x16x32_bf16 v[156:159], a[252:255], v[124:127], v[156:159]
    s_waitcnt lgkmcnt(9)
    ds_read_b64_tr_b16 a[134:135], v31 offset:19456
    v_cvt_pk_bf16_f32 v222, v44, v45
    v_mfma_f32_16x16x32_bf16 a[112:115], a[140:143], v[192:195], a[112:115]
    v_exp_f32 v46, v190
    v_mfma_f32_16x16x32_bf16 a[116:119], a[140:143], v[196:199], a[116:119]
    v_exp_f32 v47, v191
    v_mfma_f32_16x16x32_bf16 a[120:123], a[140:143], v[200:203], a[120:123]
    buffer_load_dwordx4 v15, s[24:27], s52 offen offset:1024 lds
    v_mfma_f32_16x16x32_bf16 a[124:127], a[140:143], v[204:207], a[124:127]
    s_waitcnt lgkmcnt(5)
    ds_read_b64_tr_b16 a[152:153], v18 offset:16384
    v_cvt_pk_bf16_f32 v223, v46, v47
    v_mfma_f32_16x16x32_bf16 v[160:163], a[224:227], v[64:67], v[48:51]
    v_exp_f32 v44, v128
    v_mfma_f32_16x16x32_bf16 v[160:163], a[228:231], v[68:71], v[160:163]
    v_exp_f32 v45, v129
    v_mfma_f32_16x16x32_bf16 v[160:163], a[232:235], v[72:75], v[160:163]
    ds_read_b64_tr_b16 a[136:137], v32 offset:18432
    ds_read_b64_tr_b16 a[154:155], v18 offset:18432
    v_mfma_f32_16x16x32_bf16 v[160:163], a[236:239], v[76:79], v[160:163]
    s_waitcnt lgkmcnt(6)
    ds_read_b64_tr_b16 a[138:139], v32 offset:19456
    v_cvt_pk_bf16_f32 v192, v44, v45
    v_mfma_f32_16x16x32_bf16 a[0:3], a[128:131], v[208:211], a[0:3]
    v_exp_f32 v46, v130
    v_mfma_f32_16x16x32_bf16 a[4:7], a[128:131], v[212:215], a[4:7]
    v_exp_f32 v47, v131
    v_mfma_f32_16x16x32_bf16 a[8:11], a[128:131], v[216:219], a[8:11]
    ds_read_b128 a[240:243], v26 offset:3072
    ds_read_b64_tr_b16 a[156:157], v19 offset:16384
    v_mfma_f32_16x16x32_bf16 a[12:15], a[128:131], v[220:223], a[12:15]
    ds_read_b128 a[244:247], v27 offset:3072
    v_cvt_pk_bf16_f32 v193, v46, v47
    v_mfma_f32_16x16x32_bf16 v[164:167], a[224:227], v[80:83], v[52:55]
    v_exp_f32 v44, v132
    v_mfma_f32_16x16x32_bf16 v[164:167], a[228:231], v[84:87], v[164:167]
    v_exp_f32 v45, v133
    v_mfma_f32_16x16x32_bf16 v[164:167], a[232:235], v[88:91], v[164:167]
    ds_read_b64_tr_b16 a[140:141], v33 offset:18432
    ds_read_b64_tr_b16 a[158:159], v19 offset:18432
    v_mfma_f32_16x16x32_bf16 v[164:167], a[236:239], v[92:95], v[164:167]
    s_waitcnt lgkmcnt(9)
    ds_read_b64_tr_b16 a[142:143], v33 offset:19456
    v_cvt_pk_bf16_f32 v196, v44, v45
    v_mfma_f32_16x16x32_bf16 a[16:19], a[132:135], v[208:211], a[16:19]
    v_exp_f32 v46, v134
    v_mfma_f32_16x16x32_bf16 a[20:23], a[132:135], v[212:215], a[20:23]
    v_exp_f32 v47, v135
    v_mfma_f32_16x16x32_bf16 a[24:27], a[132:135], v[216:219], a[24:27]
    ds_read_b128 a[248:251], v28 offset:3072
    v_mfma_f32_16x16x32_bf16 a[28:31], a[132:135], v[220:223], a[28:31]
    ds_read_b128 a[252:255], v29 offset:3072
    v_cvt_pk_bf16_f32 v197, v46, v47
    v_mfma_f32_16x16x32_bf16 v[168:171], a[224:227], v[96:99], v[56:59]
    v_exp_f32 v44, v136
    v_mfma_f32_16x16x32_bf16 v[168:171], a[228:231], v[100:103], v[168:171]
    v_exp_f32 v45, v137
    v_mfma_f32_16x16x32_bf16 v[168:171], a[232:235], v[104:107], v[168:171]
    ds_read_b64_tr_b16 a[128:129], v34 offset:18432
    v_mfma_f32_16x16x32_bf16 v[168:171], a[236:239], v[108:111], v[168:171]
    s_waitcnt lgkmcnt(9)
    ds_read_b64_tr_b16 a[130:131], v34 offset:19456
    v_cvt_pk_bf16_f32 v200, v44, v45
    v_mfma_f32_16x16x32_bf16 a[32:35], a[136:139], v[208:211], a[32:35]
    v_exp_f32 v46, v138
    v_mfma_f32_16x16x32_bf16 a[36:39], a[136:139], v[212:215], a[36:39]
    v_exp_f32 v47, v139
    v_mfma_f32_16x16x32_bf16 a[40:43], a[136:139], v[216:219], a[40:43]
    buffer_load_dwordx4 v15, s[24:27], s52 offen offset:2048 lds
    v_mfma_f32_16x16x32_bf16 a[44:47], a[136:139], v[220:223], a[44:47]
    v_cvt_pk_bf16_f32 v201, v46, v47
    v_mfma_f32_16x16x32_bf16 v[172:175], a[224:227], v[112:115], v[60:63]
    v_exp_f32 v44, v140
    v_mfma_f32_16x16x32_bf16 v[172:175], a[228:231], v[116:119], v[172:175]
    v_exp_f32 v45, v141
    v_mfma_f32_16x16x32_bf16 v[172:175], a[232:235], v[120:123], v[172:175]
    ds_read_b64_tr_b16 a[132:133], v35 offset:18432
    v_mfma_f32_16x16x32_bf16 v[172:175], a[236:239], v[124:127], v[172:175]
    s_waitcnt lgkmcnt(5)
    ds_read_b64_tr_b16 a[134:135], v35 offset:19456
    v_cvt_pk_bf16_f32 v204, v44, v45
    v_mfma_f32_16x16x32_bf16 a[48:51], a[140:143], v[208:211], a[48:51]
    v_exp_f32 v46, v142
    v_mfma_f32_16x16x32_bf16 a[52:55], a[140:143], v[212:215], a[52:55]
    v_exp_f32 v47, v143
    v_mfma_f32_16x16x32_bf16 a[56:59], a[140:143], v[216:219], a[56:59]
    buffer_load_dwordx4 v15, s[24:27], s52 offen offset:3072 lds
    v_mfma_f32_16x16x32_bf16 a[60:63], a[140:143], v[220:223], a[60:63]
    s_waitcnt lgkmcnt(4)
    v_cvt_pk_bf16_f32 v205, v46, v47
    v_mfma_f32_16x16x32_bf16 v[176:179], a[240:243], v[64:67], v[48:51]
    s_waitcnt vmcnt(10)
    v_exp_f32 v44, v144
    v_mfma_f32_16x16x32_bf16 v[176:179], a[244:247], v[68:71], v[176:179]
    s_barrier
    v_exp_f32 v45, v145
    v_mfma_f32_16x16x32_bf16 v[176:179], a[248:251], v[72:75], v[176:179]
    ds_read_b64_tr_b16 a[136:137], v36 offset:18432
    v_mfma_f32_16x16x32_bf16 v[176:179], a[252:255], v[76:79], v[176:179]
    ds_read_b64_tr_b16 a[138:139], v36 offset:19456
    v_cvt_pk_bf16_f32 v194, v44, v45
    v_mfma_f32_16x16x32_bf16 v[224:227], v[40:43], v[208:211], v[224:227]
    s_waitcnt lgkmcnt(4)
    buffer_store_dword v24, v23, s[60:63], s88 offen sc1
    v_mfma_f32_16x16x32_bf16 a[64:67], a[128:131], v[208:211], a[64:67]
    v_exp_f32 v46, v146
    v_mfma_f32_16x16x32_bf16 a[68:71], a[128:131], v[212:215], a[68:71]
    v_exp_f32 v47, v147
    v_mfma_f32_16x16x32_bf16 a[72:75], a[128:131], v[216:219], a[72:75]
    ds_read_b128 a[224:227], v26 offset:16384
    v_mfma_f32_16x16x32_bf16 a[76:79], a[128:131], v[220:223], a[76:79]
    s_mul_i32 s50, s55, 44032
    ds_read_b128 a[228:231], v27 offset:16384
    v_cvt_pk_bf16_f32 v195, v46, v47
    v_mfma_f32_16x16x32_bf16 v[228:231], v[40:43], v[212:215], v[228:231]
    s_add_u32 s50, s50, s3
    v_mfma_f32_16x16x32_bf16 v[180:183], a[240:243], v[80:83], v[52:55]
    s_add_u32 s52, s52, 16384
    v_exp_f32 v44, v148
    v_mfma_f32_16x16x32_bf16 v[180:183], a[244:247], v[84:87], v[180:183]
    v_exp_f32 v45, v149
    v_mfma_f32_16x16x32_bf16 v[180:183], a[248:251], v[88:91], v[180:183]
    ds_read_b64_tr_b16 a[140:141], v37 offset:18432
    v_mfma_f32_16x16x32_bf16 v[180:183], a[252:255], v[92:95], v[180:183]
    ds_read_b64_tr_b16 a[142:143], v37 offset:19456
    v_cvt_pk_bf16_f32 v198, v44, v45
    v_mfma_f32_16x16x32_bf16 v[232:235], v[40:43], v[216:219], v[232:235]
    s_waitcnt lgkmcnt(6)
    buffer_store_dwordx4 a[180:183], v38, s[32:35], s50 offen sc1
    v_mfma_f32_16x16x32_bf16 a[80:83], a[132:135], v[208:211], a[80:83]
    v_exp_f32 v46, v150
    v_mfma_f32_16x16x32_bf16 a[84:87], a[132:135], v[212:215], a[84:87]
    v_exp_f32 v47, v151
    v_mfma_f32_16x16x32_bf16 a[88:91], a[132:135], v[216:219], a[88:91]
    ds_read_b128 a[232:235], v28 offset:16384
    v_mfma_f32_16x16x32_bf16 a[92:95], a[132:135], v[220:223], a[92:95]
    ds_read_b128 a[236:239], v29 offset:16384
    v_cvt_pk_bf16_f32 v199, v46, v47
    v_mfma_f32_16x16x32_bf16 v[236:239], v[40:43], v[220:223], v[236:239]
    v_mfma_f32_16x16x32_bf16 v[184:187], a[240:243], v[96:99], v[56:59]
    v_exp_f32 v44, v152
    v_mfma_f32_16x16x32_bf16 v[184:187], a[244:247], v[100:103], v[184:187]
    v_exp_f32 v45, v153
    v_mfma_f32_16x16x32_bf16 v[184:187], a[248:251], v[104:107], v[184:187]
    ds_read_b64_tr_b16 a[128:129], v30 offset:32768
    v_mfma_f32_16x16x32_bf16 v[184:187], a[252:255], v[108:111], v[184:187]
    s_waitcnt lgkmcnt(7)
    ds_read_b64_tr_b16 a[130:131], v30 offset:33792
    v_cvt_pk_bf16_f32 v202, v44, v45
    v_mfma_f32_16x16x32_bf16 a[96:99], a[136:139], v[208:211], a[96:99]
    v_exp_f32 v46, v154
    v_mfma_f32_16x16x32_bf16 a[100:103], a[136:139], v[212:215], a[100:103]
    s_add_u32 m0, s42, 147456
    v_exp_f32 v47, v155
    v_mfma_f32_16x16x32_bf16 a[104:107], a[136:139], v[216:219], a[104:107]
    buffer_load_dwordx4 v14, s[20:23], s51 offen offset:0 lds
    v_mfma_f32_16x16x32_bf16 a[108:111], a[136:139], v[220:223], a[108:111]
    v_cvt_pk_bf16_f32 v203, v46, v47
    v_mfma_f32_16x16x32_bf16 v[188:191], a[240:243], v[112:115], v[60:63]
    v_exp_f32 v44, v156
    v_mfma_f32_16x16x32_bf16 v[188:191], a[244:247], v[116:119], v[188:191]
    v_exp_f32 v45, v157
    v_mfma_f32_16x16x32_bf16 v[188:191], a[248:251], v[120:123], v[188:191]
    ds_read_b64_tr_b16 a[132:133], v31 offset:32768
    v_mfma_f32_16x16x32_bf16 v[188:191], a[252:255], v[124:127], v[188:191]
    s_waitcnt lgkmcnt(5)
    ds_read_b64_tr_b16 a[134:135], v31 offset:33792
    v_cvt_pk_bf16_f32 v206, v44, v45
    v_mfma_f32_16x16x32_bf16 a[112:115], a[140:143], v[208:211], a[112:115]
    v_exp_f32 v46, v158
    v_mfma_f32_16x16x32_bf16 a[116:119], a[140:143], v[212:215], a[116:119]
    v_exp_f32 v47, v159
    v_mfma_f32_16x16x32_bf16 a[120:123], a[140:143], v[216:219], a[120:123]
    buffer_load_dwordx4 v14, s[20:23], s51 offen offset:1024 lds
    v_mfma_f32_16x16x32_bf16 a[124:127], a[140:143], v[220:223], a[124:127]
    s_waitcnt lgkmcnt(4)
    v_cvt_pk_bf16_f32 v207, v46, v47
    v_mfma_f32_16x16x32_bf16 v[128:131], a[224:227], v[64:67], v[48:51]
    v_exp_f32 v44, v160
    v_mfma_f32_16x16x32_bf16 v[128:131], a[228:231], v[68:71], v[128:131]
    v_exp_f32 v45, v161
    v_mfma_f32_16x16x32_bf16 v[128:131], a[232:235], v[72:75], v[128:131]
    ds_read_b64_tr_b16 a[136:137], v32 offset:32768
    v_mfma_f32_16x16x32_bf16 v[128:131], a[236:239], v[76:79], v[128:131]
    s_waitcnt lgkmcnt(3)
    ds_read_b64_tr_b16 a[138:139], v32 offset:33792
    v_cvt_pk_bf16_f32 v208, v44, v45
    v_mfma_f32_16x16x32_bf16 a[0:3], a[128:131], v[192:195], a[0:3]
    v_exp_f32 v46, v162
    v_mfma_f32_16x16x32_bf16 a[4:7], a[128:131], v[196:199], a[4:7]
    v_exp_f32 v47, v163
    v_mfma_f32_16x16x32_bf16 a[8:11], a[128:131], v[200:203], a[8:11]
    ds_read_b128 a[240:243], v26 offset:17408
    v_mfma_f32_16x16x32_bf16 a[12:15], a[128:131], v[204:207], a[12:15]
    ds_read_b128 a[244:247], v27 offset:17408
    v_cvt_pk_bf16_f32 v209, v46, v47
    v_mfma_f32_16x16x32_bf16 v[224:227], v[40:43], v[192:195], v[224:227]
    v_mfma_f32_16x16x32_bf16 v[132:135], a[224:227], v[80:83], v[52:55]
    v_exp_f32 v44, v164
    v_mfma_f32_16x16x32_bf16 v[132:135], a[228:231], v[84:87], v[132:135]
    v_exp_f32 v45, v165
    v_mfma_f32_16x16x32_bf16 v[132:135], a[232:235], v[88:91], v[132:135]
    ds_read_b64_tr_b16 a[140:141], v33 offset:32768
    v_mfma_f32_16x16x32_bf16 v[132:135], a[236:239], v[92:95], v[132:135]
    s_waitcnt lgkmcnt(5)
    ds_read_b64_tr_b16 a[142:143], v33 offset:33792
    v_cvt_pk_bf16_f32 v212, v44, v45
    v_mfma_f32_16x16x32_bf16 a[16:19], a[132:135], v[192:195], a[16:19]
    v_exp_f32 v46, v166
    v_mfma_f32_16x16x32_bf16 a[20:23], a[132:135], v[196:199], a[20:23]
    v_exp_f32 v47, v167
    v_mfma_f32_16x16x32_bf16 a[24:27], a[132:135], v[200:203], a[24:27]
    ds_read_b128 a[248:251], v28 offset:17408
    v_mfma_f32_16x16x32_bf16 a[28:31], a[132:135], v[204:207], a[28:31]
    ds_read_b128 a[252:255], v29 offset:17408
    v_cvt_pk_bf16_f32 v213, v46, v47
    v_mfma_f32_16x16x32_bf16 v[228:231], v[40:43], v[196:199], v[228:231]
    buffer_store_dwordx4 a[160:163], v38, s[12:15], s101 offen offset:0 sc1
    v_mfma_f32_16x16x32_bf16 v[136:139], a[224:227], v[96:99], v[56:59]
    v_exp_f32 v44, v168
    v_mfma_f32_16x16x32_bf16 v[136:139], a[228:231], v[100:103], v[136:139]
    v_exp_f32 v45, v169
    v_mfma_f32_16x16x32_bf16 v[136:139], a[232:235], v[104:107], v[136:139]
    ds_read_b64_tr_b16 a[128:129], v34 offset:32768
    v_mfma_f32_16x16x32_bf16 v[136:139], a[236:239], v[108:111], v[136:139]
    s_waitcnt lgkmcnt(7)
    ds_read_b64_tr_b16 a[130:131], v34 offset:33792
    v_cvt_pk_bf16_f32 v216, v44, v45
    v_mfma_f32_16x16x32_bf16 a[32:35], a[136:139], v[192:195], a[32:35]
    v_exp_f32 v46, v170
    v_mfma_f32_16x16x32_bf16 a[36:39], a[136:139], v[196:199], a[36:39]
    v_exp_f32 v47, v171
    v_mfma_f32_16x16x32_bf16 a[40:43], a[136:139], v[200:203], a[40:43]
    buffer_load_dwordx4 v14, s[20:23], s51 offen offset:2048 lds
    v_mfma_f32_16x16x32_bf16 a[44:47], a[136:139], v[204:207], a[44:47]
    v_cvt_pk_bf16_f32 v217, v46, v47
    v_mfma_f32_16x16x32_bf16 v[140:143], a[224:227], v[112:115], v[60:63]
    v_exp_f32 v44, v172
    v_mfma_f32_16x16x32_bf16 v[140:143], a[228:231], v[116:119], v[140:143]
    v_exp_f32 v45, v173
    v_mfma_f32_16x16x32_bf16 v[140:143], a[232:235], v[120:123], v[140:143]
    ds_read_b64_tr_b16 a[132:133], v35 offset:32768
    v_mfma_f32_16x16x32_bf16 v[140:143], a[236:239], v[124:127], v[140:143]
    s_waitcnt lgkmcnt(5)
    ds_read_b64_tr_b16 a[134:135], v35 offset:33792
    v_cvt_pk_bf16_f32 v220, v44, v45
    v_mfma_f32_16x16x32_bf16 a[48:51], a[140:143], v[192:195], a[48:51]
    v_exp_f32 v46, v174
    v_mfma_f32_16x16x32_bf16 a[52:55], a[140:143], v[196:199], a[52:55]
    v_exp_f32 v47, v175
    v_mfma_f32_16x16x32_bf16 a[56:59], a[140:143], v[200:203], a[56:59]
    buffer_load_dwordx4 v14, s[20:23], s51 offen offset:3072 lds
    v_mfma_f32_16x16x32_bf16 a[60:63], a[140:143], v[204:207], a[60:63]
    v_cvt_pk_bf16_f32 v221, v46, v47
    v_mfma_f32_16x16x32_bf16 v[232:235], v[40:43], v[200:203], v[232:235]
    s_waitcnt lgkmcnt(4)
    v_mfma_f32_16x16x32_bf16 v[144:147], a[240:243], v[64:67], v[48:51]
    v_exp_f32 v44, v176
    v_mfma_f32_16x16x32_bf16 v[144:147], a[244:247], v[68:71], v[144:147]
    v_exp_f32 v45, v177
    v_mfma_f32_16x16x32_bf16 v[144:147], a[248:251], v[72:75], v[144:147]
    ds_read_b64_tr_b16 a[136:137], v36 offset:32768
    v_mfma_f32_16x16x32_bf16 v[144:147], a[252:255], v[76:79], v[144:147]
    s_waitcnt lgkmcnt(3)
    ds_read_b64_tr_b16 a[138:139], v36 offset:33792
    v_cvt_pk_bf16_f32 v210, v44, v45
    v_mfma_f32_16x16x32_bf16 a[64:67], a[128:131], v[192:195], a[64:67]
    v_exp_f32 v46, v178
    v_mfma_f32_16x16x32_bf16 a[68:71], a[128:131], v[196:199], a[68:71]
    v_exp_f32 v47, v179
    v_mfma_f32_16x16x32_bf16 a[72:75], a[128:131], v[200:203], a[72:75]
    ds_read_b128 a[224:227], v26 offset:18432
    v_mfma_f32_16x16x32_bf16 a[76:79], a[128:131], v[204:207], a[76:79]
    ds_read_b128 a[228:231], v27 offset:18432
    v_cvt_pk_bf16_f32 v211, v46, v47
    v_mfma_f32_16x16x32_bf16 v[148:151], a[240:243], v[80:83], v[52:55]
    s_add_u32 s51, s51, 16384
    v_exp_f32 v44, v180
    v_mfma_f32_16x16x32_bf16 v[148:151], a[244:247], v[84:87], v[148:151]
    v_exp_f32 v45, v181
    v_mfma_f32_16x16x32_bf16 v[148:151], a[248:251], v[88:91], v[148:151]
    ds_read_b64_tr_b16 a[140:141], v37 offset:32768
    v_mfma_f32_16x16x32_bf16 v[148:151], a[252:255], v[92:95], v[148:151]
    ds_read_b64_tr_b16 a[142:143], v37 offset:33792
    v_cvt_pk_bf16_f32 v214, v44, v45
    v_mfma_f32_16x16x32_bf16 v[236:239], v[40:43], v[204:207], v[236:239]
    s_waitcnt lgkmcnt(6)
    buffer_store_dwordx4 a[164:167], v38, s[12:15], s101 offen offset:1024 sc1
    v_mfma_f32_16x16x32_bf16 a[80:83], a[132:135], v[192:195], a[80:83]
    v_exp_f32 v46, v182
    v_mfma_f32_16x16x32_bf16 a[84:87], a[132:135], v[196:199], a[84:87]
    v_exp_f32 v47, v183
    v_mfma_f32_16x16x32_bf16 a[88:91], a[132:135], v[200:203], a[88:91]
    ds_read_b128 a[232:235], v28 offset:18432
    v_mfma_f32_16x16x32_bf16 a[92:95], a[132:135], v[204:207], a[92:95]
    ds_read_b128 a[236:239], v29 offset:18432
    v_cvt_pk_bf16_f32 v215, v46, v47
    v_mfma_f32_16x16x32_bf16 v[152:155], a[240:243], v[96:99], v[56:59]
    v_exp_f32 v44, v184
    v_mfma_f32_16x16x32_bf16 v[152:155], a[244:247], v[100:103], v[152:155]
    v_exp_f32 v45, v185
    v_mfma_f32_16x16x32_bf16 v[152:155], a[248:251], v[104:107], v[152:155]
    ds_read_b64_tr_b16 a[128:129], v30 offset:34816
    v_mfma_f32_16x16x32_bf16 v[152:155], a[252:255], v[108:111], v[152:155]
    s_waitcnt lgkmcnt(7)
    ds_read_b64_tr_b16 a[130:131], v30 offset:35840
    v_cvt_pk_bf16_f32 v218, v44, v45
    v_mfma_f32_16x16x32_bf16 a[96:99], a[136:139], v[192:195], a[96:99]
    v_exp_f32 v46, v186
    v_mfma_f32_16x16x32_bf16 a[100:103], a[136:139], v[196:199], a[100:103]
    s_add_u32 m0, s42, 0
    v_exp_f32 v47, v187
    v_mfma_f32_16x16x32_bf16 a[104:107], a[136:139], v[200:203], a[104:107]
    buffer_load_dwordx4 v15, s[24:27], s52 offen offset:0 lds
    v_mfma_f32_16x16x32_bf16 a[108:111], a[136:139], v[204:207], a[108:111]
    v_cvt_pk_bf16_f32 v219, v46, v47
    v_mfma_f32_16x16x32_bf16 v[156:159], a[240:243], v[112:115], v[60:63]
    v_exp_f32 v44, v188
    v_mfma_f32_16x16x32_bf16 v[156:159], a[244:247], v[116:119], v[156:159]
    v_exp_f32 v45, v189
    v_mfma_f32_16x16x32_bf16 v[156:159], a[248:251], v[120:123], v[156:159]
    ds_read_b64_tr_b16 a[132:133], v31 offset:34816
    v_mfma_f32_16x16x32_bf16 v[156:159], a[252:255], v[124:127], v[156:159]
    s_waitcnt lgkmcnt(5)
    ds_read_b64_tr_b16 a[134:135], v31 offset:35840
    v_cvt_pk_bf16_f32 v222, v44, v45
    v_mfma_f32_16x16x32_bf16 a[112:115], a[140:143], v[192:195], a[112:115]
    v_exp_f32 v46, v190
    v_mfma_f32_16x16x32_bf16 a[116:119], a[140:143], v[196:199], a[116:119]
    v_exp_f32 v47, v191
    v_mfma_f32_16x16x32_bf16 a[120:123], a[140:143], v[200:203], a[120:123]
    buffer_load_dwordx4 v15, s[24:27], s52 offen offset:1024 lds
    v_mfma_f32_16x16x32_bf16 a[124:127], a[140:143], v[204:207], a[124:127]
    s_waitcnt lgkmcnt(4)
    v_cvt_pk_bf16_f32 v223, v46, v47
    v_mfma_f32_16x16x32_bf16 v[160:163], a[224:227], v[64:67], v[48:51]
    v_exp_f32 v44, v128
    v_mfma_f32_16x16x32_bf16 v[160:163], a[228:231], v[68:71], v[160:163]
    v_exp_f32 v45, v129
    v_mfma_f32_16x16x32_bf16 v[160:163], a[232:235], v[72:75], v[160:163]
    ds_read_b64_tr_b16 a[136:137], v32 offset:34816
    v_mfma_f32_16x16x32_bf16 v[160:163], a[236:239], v[76:79], v[160:163]
    s_waitcnt lgkmcnt(3)
    ds_read_b64_tr_b16 a[138:139], v32 offset:35840
    v_cvt_pk_bf16_f32 v192, v44, v45
    v_mfma_f32_16x16x32_bf16 a[0:3], a[128:131], v[208:211], a[0:3]
    v_exp_f32 v46, v130
    v_mfma_f32_16x16x32_bf16 a[4:7], a[128:131], v[212:215], a[4:7]
    v_exp_f32 v47, v131
    v_mfma_f32_16x16x32_bf16 a[8:11], a[128:131], v[216:219], a[8:11]
    ds_read_b128 a[240:243], v26 offset:19456
    v_mfma_f32_16x16x32_bf16 a[12:15], a[128:131], v[220:223], a[12:15]
    ds_read_b128 a[244:247], v27 offset:19456
    v_cvt_pk_bf16_f32 v193, v46, v47
    v_mfma_f32_16x16x32_bf16 v[164:167], a[224:227], v[80:83], v[52:55]
    v_exp_f32 v44, v132
    v_mfma_f32_16x16x32_bf16 v[164:167], a[228:231], v[84:87], v[164:167]
    v_exp_f32 v45, v133
    v_mfma_f32_16x16x32_bf16 v[164:167], a[232:235], v[88:91], v[164:167]
    ds_read_b64_tr_b16 a[140:141], v33 offset:34816
    v_mfma_f32_16x16x32_bf16 v[164:167], a[236:239], v[92:95], v[164:167]
    s_waitcnt lgkmcnt(5)
    ds_read_b64_tr_b16 a[142:143], v33 offset:35840
    v_cvt_pk_bf16_f32 v196, v44, v45
    v_mfma_f32_16x16x32_bf16 a[16:19], a[132:135], v[208:211], a[16:19]
    v_exp_f32 v46, v134
    v_mfma_f32_16x16x32_bf16 a[20:23], a[132:135], v[212:215], a[20:23]
    v_exp_f32 v47, v135
    v_mfma_f32_16x16x32_bf16 a[24:27], a[132:135], v[216:219], a[24:27]
    ds_read_b128 a[248:251], v28 offset:19456
    v_mfma_f32_16x16x32_bf16 a[28:31], a[132:135], v[220:223], a[28:31]
    ds_read_b128 a[252:255], v29 offset:19456
    v_cvt_pk_bf16_f32 v197, v46, v47
    v_mfma_f32_16x16x32_bf16 v[168:171], a[224:227], v[96:99], v[56:59]
    v_exp_f32 v44, v136
    v_mfma_f32_16x16x32_bf16 v[168:171], a[228:231], v[100:103], v[168:171]
    v_exp_f32 v45, v137
    v_mfma_f32_16x16x32_bf16 v[168:171], a[232:235], v[104:107], v[168:171]
    ds_read_b64_tr_b16 a[128:129], v34 offset:34816
    v_mfma_f32_16x16x32_bf16 v[168:171], a[236:239], v[108:111], v[168:171]
    s_waitcnt lgkmcnt(7)
    ds_read_b64_tr_b16 a[130:131], v34 offset:35840
    v_cvt_pk_bf16_f32 v200, v44, v45
    v_mfma_f32_16x16x32_bf16 a[32:35], a[136:139], v[208:211], a[32:35]
    v_exp_f32 v46, v138
    v_mfma_f32_16x16x32_bf16 a[36:39], a[136:139], v[212:215], a[36:39]
    v_exp_f32 v47, v139
    v_mfma_f32_16x16x32_bf16 a[40:43], a[136:139], v[216:219], a[40:43]
    buffer_load_dwordx4 v15, s[24:27], s52 offen offset:2048 lds
    v_mfma_f32_16x16x32_bf16 a[44:47], a[136:139], v[220:223], a[44:47]
    v_cvt_pk_bf16_f32 v201, v46, v47
    v_mfma_f32_16x16x32_bf16 v[172:175], a[224:227], v[112:115], v[60:63]
    v_exp_f32 v44, v140
    v_mfma_f32_16x16x32_bf16 v[172:175], a[228:231], v[116:119], v[172:175]
    v_exp_f32 v45, v141
    v_mfma_f32_16x16x32_bf16 v[172:175], a[232:235], v[120:123], v[172:175]
    ds_read_b64_tr_b16 a[132:133], v35 offset:34816
    v_mfma_f32_16x16x32_bf16 v[172:175], a[236:239], v[124:127], v[172:175]
    s_waitcnt lgkmcnt(5)
    ds_read_b64_tr_b16 a[134:135], v35 offset:35840
    v_cvt_pk_bf16_f32 v204, v44, v45
    v_mfma_f32_16x16x32_bf16 a[48:51], a[140:143], v[208:211], a[48:51]
    v_exp_f32 v46, v142
    v_mfma_f32_16x16x32_bf16 a[52:55], a[140:143], v[212:215], a[52:55]
    v_exp_f32 v47, v143
    v_mfma_f32_16x16x32_bf16 a[56:59], a[140:143], v[216:219], a[56:59]
    buffer_load_dwordx4 v15, s[24:27], s52 offen offset:3072 lds
    v_mfma_f32_16x16x32_bf16 a[60:63], a[140:143], v[220:223], a[60:63]
    s_waitcnt lgkmcnt(4)
    v_cvt_pk_bf16_f32 v205, v46, v47
    v_mfma_f32_16x16x32_bf16 v[176:179], a[240:243], v[64:67], v[48:51]
    s_waitcnt vmcnt(10)
    v_exp_f32 v44, v144
    v_mfma_f32_16x16x32_bf16 v[176:179], a[244:247], v[68:71], v[176:179]
    s_barrier
    v_exp_f32 v45, v145
    v_mfma_f32_16x16x32_bf16 v[176:179], a[248:251], v[72:75], v[176:179]
    ds_read_b64_tr_b16 a[136:137], v36 offset:34816
    v_mfma_f32_16x16x32_bf16 v[176:179], a[252:255], v[76:79], v[176:179]
    ds_read_b64_tr_b16 a[138:139], v36 offset:35840
    v_cvt_pk_bf16_f32 v194, v44, v45
    v_mfma_f32_16x16x32_bf16 v[224:227], v[40:43], v[208:211], v[224:227]
    s_waitcnt lgkmcnt(4)
    buffer_load_dword v21, v20, s[60:63], s40 offen sc1
    v_mfma_f32_16x16x32_bf16 a[64:67], a[128:131], v[208:211], a[64:67]
    v_exp_f32 v46, v146
    v_mfma_f32_16x16x32_bf16 a[68:71], a[128:131], v[212:215], a[68:71]
    v_exp_f32 v47, v147
    v_mfma_f32_16x16x32_bf16 a[72:75], a[128:131], v[216:219], a[72:75]
    ds_read_b128 a[224:227], v26 offset:32768
    v_mfma_f32_16x16x32_bf16 a[76:79], a[128:131], v[220:223], a[76:79]
    ds_read_b128 a[228:231], v27 offset:32768
    v_cvt_pk_bf16_f32 v195, v46, v47
    v_mfma_f32_16x16x32_bf16 v[228:231], v[40:43], v[212:215], v[228:231]
    buffer_load_dwordx2 v[10:11], v12, s[60:63], 0 offen sc1
    v_mfma_f32_16x16x32_bf16 v[180:183], a[240:243], v[80:83], v[52:55]
    s_add_u32 s52, s52, 16384
    v_exp_f32 v44, v148
    v_mfma_f32_16x16x32_bf16 v[180:183], a[244:247], v[84:87], v[180:183]
    v_exp_f32 v45, v149
    v_mfma_f32_16x16x32_bf16 v[180:183], a[248:251], v[88:91], v[180:183]
    ds_read_b64_tr_b16 a[140:141], v37 offset:34816
    v_mfma_f32_16x16x32_bf16 v[180:183], a[252:255], v[92:95], v[180:183]
    ds_read_b64_tr_b16 a[142:143], v37 offset:35840
    v_cvt_pk_bf16_f32 v198, v44, v45
    v_mfma_f32_16x16x32_bf16 v[232:235], v[40:43], v[216:219], v[232:235]
    s_waitcnt lgkmcnt(6)
    buffer_store_dwordx4 a[168:171], v38, s[12:15], s101 offen offset:2048 sc1
    v_mfma_f32_16x16x32_bf16 a[80:83], a[132:135], v[208:211], a[80:83]
    v_exp_f32 v46, v150
    v_mfma_f32_16x16x32_bf16 a[84:87], a[132:135], v[212:215], a[84:87]
    v_exp_f32 v47, v151
    v_mfma_f32_16x16x32_bf16 a[88:91], a[132:135], v[216:219], a[88:91]
    ds_read_b128 a[232:235], v28 offset:32768
    v_mfma_f32_16x16x32_bf16 a[92:95], a[132:135], v[220:223], a[92:95]
    ds_read_b128 a[236:239], v29 offset:32768
    v_cvt_pk_bf16_f32 v199, v46, v47
    v_mfma_f32_16x16x32_bf16 v[236:239], v[40:43], v[220:223], v[236:239]
    buffer_store_dwordx4 a[172:175], v38, s[12:15], s101 offen offset:3072 sc1
    v_mfma_f32_16x16x32_bf16 v[184:187], a[240:243], v[96:99], v[56:59]
    v_exp_f32 v44, v152
    v_mfma_f32_16x16x32_bf16 v[184:187], a[244:247], v[100:103], v[184:187]
    v_exp_f32 v45, v153
    v_mfma_f32_16x16x32_bf16 v[184:187], a[248:251], v[104:107], v[184:187]
    ds_read_b64_tr_b16 a[128:129], v30 offset:49152
    v_mfma_f32_16x16x32_bf16 v[184:187], a[252:255], v[108:111], v[184:187]
    s_waitcnt lgkmcnt(7)
    ds_read_b64_tr_b16 a[130:131], v30 offset:50176
    v_cvt_pk_bf16_f32 v202, v44, v45
    v_mfma_f32_16x16x32_bf16 a[96:99], a[136:139], v[208:211], a[96:99]
    v_exp_f32 v46, v154
    v_mfma_f32_16x16x32_bf16 a[100:103], a[136:139], v[212:215], a[100:103]
    s_add_u32 m0, s42, 98304
    v_exp_f32 v47, v155
    v_mfma_f32_16x16x32_bf16 a[104:107], a[136:139], v[216:219], a[104:107]
    buffer_load_dwordx4 v14, s[20:23], s51 offen offset:0 lds
    v_mfma_f32_16x16x32_bf16 a[108:111], a[136:139], v[220:223], a[108:111]
    v_cvt_pk_bf16_f32 v203, v46, v47
    v_mfma_f32_16x16x32_bf16 v[188:191], a[240:243], v[112:115], v[60:63]
    v_exp_f32 v44, v156
    v_mfma_f32_16x16x32_bf16 v[188:191], a[244:247], v[116:119], v[188:191]
    v_exp_f32 v45, v157
    v_mfma_f32_16x16x32_bf16 v[188:191], a[248:251], v[120:123], v[188:191]
    ds_read_b64_tr_b16 a[132:133], v31 offset:49152
    v_mfma_f32_16x16x32_bf16 v[188:191], a[252:255], v[124:127], v[188:191]
    s_waitcnt lgkmcnt(5)
    ds_read_b64_tr_b16 a[134:135], v31 offset:50176
    v_cvt_pk_bf16_f32 v206, v44, v45
    v_mfma_f32_16x16x32_bf16 a[112:115], a[140:143], v[208:211], a[112:115]
    v_exp_f32 v46, v158
    v_mfma_f32_16x16x32_bf16 a[116:119], a[140:143], v[212:215], a[116:119]
    v_exp_f32 v47, v159
    v_mfma_f32_16x16x32_bf16 a[120:123], a[140:143], v[216:219], a[120:123]
    buffer_load_dwordx4 v14, s[20:23], s51 offen offset:1024 lds
    v_mfma_f32_16x16x32_bf16 a[124:127], a[140:143], v[220:223], a[124:127]
    s_waitcnt lgkmcnt(4)
    v_cvt_pk_bf16_f32 v207, v46, v47
    v_mfma_f32_16x16x32_bf16 v[128:131], a[224:227], v[64:67], v[48:51]
    s_mov_b32 s34, 0
    v_exp_f32 v44, v160
    v_mfma_f32_16x16x32_bf16 v[128:131], a[228:231], v[68:71], v[128:131]
    v_exp_f32 v45, v161
    v_mfma_f32_16x16x32_bf16 v[128:131], a[232:235], v[72:75], v[128:131]
    ds_read_b64_tr_b16 a[136:137], v32 offset:49152
    v_mfma_f32_16x16x32_bf16 v[128:131], a[236:239], v[76:79], v[128:131]
    s_waitcnt lgkmcnt(3)
    ds_read_b64_tr_b16 a[138:139], v32 offset:50176
    v_cvt_pk_bf16_f32 v208, v44, v45
    v_mfma_f32_16x16x32_bf16 a[0:3], a[128:131], v[192:195], a[0:3]
    v_exp_f32 v46, v162
    v_mfma_f32_16x16x32_bf16 a[4:7], a[128:131], v[196:199], a[4:7]
    v_exp_f32 v47, v163
    v_mfma_f32_16x16x32_bf16 a[8:11], a[128:131], v[200:203], a[8:11]
    ds_read_b128 a[240:243], v26 offset:33792
    v_mfma_f32_16x16x32_bf16 a[12:15], a[128:131], v[204:207], a[12:15]
    ds_read_b128 a[244:247], v27 offset:33792
    v_cvt_pk_bf16_f32 v209, v46, v47
    v_mfma_f32_16x16x32_bf16 v[224:227], v[40:43], v[192:195], v[224:227]
    v_mfma_f32_16x16x32_bf16 v[132:135], a[224:227], v[80:83], v[52:55]
    v_exp_f32 v44, v164
    v_mfma_f32_16x16x32_bf16 v[132:135], a[228:231], v[84:87], v[132:135]
    v_exp_f32 v45, v165
    v_mfma_f32_16x16x32_bf16 v[132:135], a[232:235], v[88:91], v[132:135]
    ds_read_b64_tr_b16 a[140:141], v33 offset:49152
    v_mfma_f32_16x16x32_bf16 v[132:135], a[236:239], v[92:95], v[132:135]
    s_waitcnt lgkmcnt(5)
    ds_read_b64_tr_b16 a[142:143], v33 offset:50176
    v_cvt_pk_bf16_f32 v212, v44, v45
    v_mfma_f32_16x16x32_bf16 a[16:19], a[132:135], v[192:195], a[16:19]
    v_exp_f32 v46, v166
    v_mfma_f32_16x16x32_bf16 a[20:23], a[132:135], v[196:199], a[20:23]
    v_exp_f32 v47, v167
    v_mfma_f32_16x16x32_bf16 a[24:27], a[132:135], v[200:203], a[24:27]
    ds_read_b128 a[248:251], v28 offset:33792
    v_mfma_f32_16x16x32_bf16 a[28:31], a[132:135], v[204:207], a[28:31]
    ds_read_b128 a[252:255], v29 offset:33792
    v_cvt_pk_bf16_f32 v213, v46, v47
    v_mfma_f32_16x16x32_bf16 v[228:231], v[40:43], v[196:199], v[228:231]
    buffer_store_dwordx4 a[144:147], v38, s[8:11], s101 offen offset:0 sc1
    v_mfma_f32_16x16x32_bf16 v[136:139], a[224:227], v[96:99], v[56:59]
    v_exp_f32 v44, v168
    v_mfma_f32_16x16x32_bf16 v[136:139], a[228:231], v[100:103], v[136:139]
    v_exp_f32 v45, v169
    v_mfma_f32_16x16x32_bf16 v[136:139], a[232:235], v[104:107], v[136:139]
    ds_read_b64_tr_b16 a[128:129], v34 offset:49152
    v_mfma_f32_16x16x32_bf16 v[136:139], a[236:239], v[108:111], v[136:139]
    s_waitcnt lgkmcnt(7)
    ds_read_b64_tr_b16 a[130:131], v34 offset:50176
    v_cvt_pk_bf16_f32 v216, v44, v45
    v_mfma_f32_16x16x32_bf16 a[32:35], a[136:139], v[192:195], a[32:35]
    v_exp_f32 v46, v170
    v_mfma_f32_16x16x32_bf16 a[36:39], a[136:139], v[196:199], a[36:39]
    v_exp_f32 v47, v171
    v_mfma_f32_16x16x32_bf16 a[40:43], a[136:139], v[200:203], a[40:43]
    buffer_load_dwordx4 v14, s[20:23], s51 offen offset:2048 lds
    v_mfma_f32_16x16x32_bf16 a[44:47], a[136:139], v[204:207], a[44:47]
    v_cvt_pk_bf16_f32 v217, v46, v47
    v_mfma_f32_16x16x32_bf16 v[140:143], a[224:227], v[112:115], v[60:63]
    v_exp_f32 v44, v172
    v_mfma_f32_16x16x32_bf16 v[140:143], a[228:231], v[116:119], v[140:143]
    v_exp_f32 v45, v173
    v_mfma_f32_16x16x32_bf16 v[140:143], a[232:235], v[120:123], v[140:143]
    ds_read_b64_tr_b16 a[132:133], v35 offset:49152
    v_mfma_f32_16x16x32_bf16 v[140:143], a[236:239], v[124:127], v[140:143]
    s_waitcnt lgkmcnt(5)
    ds_read_b64_tr_b16 a[134:135], v35 offset:50176
    v_cvt_pk_bf16_f32 v220, v44, v45
    v_mfma_f32_16x16x32_bf16 a[48:51], a[140:143], v[192:195], a[48:51]
    v_exp_f32 v46, v174
    v_mfma_f32_16x16x32_bf16 a[52:55], a[140:143], v[196:199], a[52:55]
    v_exp_f32 v47, v175
    v_mfma_f32_16x16x32_bf16 a[56:59], a[140:143], v[200:203], a[56:59]
    buffer_load_dwordx4 v14, s[20:23], s51 offen offset:3072 lds
    v_mfma_f32_16x16x32_bf16 a[60:63], a[140:143], v[204:207], a[60:63]
    v_cvt_pk_bf16_f32 v221, v46, v47
    v_mfma_f32_16x16x32_bf16 v[232:235], v[40:43], v[200:203], v[232:235]
    s_waitcnt lgkmcnt(4)
    v_mfma_f32_16x16x32_bf16 v[144:147], a[240:243], v[64:67], v[48:51]
    v_exp_f32 v44, v176
    v_mfma_f32_16x16x32_bf16 v[144:147], a[244:247], v[68:71], v[144:147]
    v_exp_f32 v45, v177
    v_mfma_f32_16x16x32_bf16 v[144:147], a[248:251], v[72:75], v[144:147]
    ds_read_b64_tr_b16 a[136:137], v36 offset:49152
    v_mfma_f32_16x16x32_bf16 v[144:147], a[252:255], v[76:79], v[144:147]
    s_waitcnt lgkmcnt(3)
    ds_read_b64_tr_b16 a[138:139], v36 offset:50176
    v_cvt_pk_bf16_f32 v210, v44, v45
    v_mfma_f32_16x16x32_bf16 a[64:67], a[128:131], v[192:195], a[64:67]
    v_exp_f32 v46, v178
    v_mfma_f32_16x16x32_bf16 a[68:71], a[128:131], v[196:199], a[68:71]
    v_exp_f32 v47, v179
    v_mfma_f32_16x16x32_bf16 a[72:75], a[128:131], v[200:203], a[72:75]
    ds_read_b128 a[224:227], v26 offset:34816
    v_mfma_f32_16x16x32_bf16 a[76:79], a[128:131], v[204:207], a[76:79]
    ds_read_b128 a[228:231], v27 offset:34816
    v_cvt_pk_bf16_f32 v211, v46, v47
    v_mfma_f32_16x16x32_bf16 v[148:151], a[240:243], v[80:83], v[52:55]
    s_add_u32 s51, s51, 16384
    v_exp_f32 v44, v180
    v_mfma_f32_16x16x32_bf16 v[148:151], a[244:247], v[84:87], v[148:151]
    v_exp_f32 v45, v181
    v_mfma_f32_16x16x32_bf16 v[148:151], a[248:251], v[88:91], v[148:151]
    ds_read_b64_tr_b16 a[140:141], v37 offset:49152
    v_mfma_f32_16x16x32_bf16 v[148:151], a[252:255], v[92:95], v[148:151]
    ds_read_b64_tr_b16 a[142:143], v37 offset:50176
    v_cvt_pk_bf16_f32 v214, v44, v45
    v_mfma_f32_16x16x32_bf16 v[236:239], v[40:43], v[204:207], v[236:239]
    s_waitcnt lgkmcnt(6)
    buffer_store_dwordx4 a[148:151], v38, s[8:11], s101 offen offset:1024 sc1
    v_mfma_f32_16x16x32_bf16 a[80:83], a[132:135], v[192:195], a[80:83]
    v_exp_f32 v46, v182
    v_mfma_f32_16x16x32_bf16 a[84:87], a[132:135], v[196:199], a[84:87]
    v_exp_f32 v47, v183
    v_mfma_f32_16x16x32_bf16 a[88:91], a[132:135], v[200:203], a[88:91]
    ds_read_b128 a[232:235], v28 offset:34816
    v_mfma_f32_16x16x32_bf16 a[92:95], a[132:135], v[204:207], a[92:95]
    ds_read_b128 a[236:239], v29 offset:34816
    v_cvt_pk_bf16_f32 v215, v46, v47
    v_mfma_f32_16x16x32_bf16 v[152:155], a[240:243], v[96:99], v[56:59]
    v_exp_f32 v44, v184
    v_mfma_f32_16x16x32_bf16 v[152:155], a[244:247], v[100:103], v[152:155]
    v_exp_f32 v45, v185
    v_mfma_f32_16x16x32_bf16 v[152:155], a[248:251], v[104:107], v[152:155]
    ds_read_b64_tr_b16 a[128:129], v30 offset:51200
    v_mfma_f32_16x16x32_bf16 v[152:155], a[252:255], v[108:111], v[152:155]
    s_waitcnt lgkmcnt(7)
    ds_read_b64_tr_b16 a[130:131], v30 offset:52224
    v_cvt_pk_bf16_f32 v218, v44, v45
    v_mfma_f32_16x16x32_bf16 a[96:99], a[136:139], v[192:195], a[96:99]
    v_exp_f32 v46, v186
    v_mfma_f32_16x16x32_bf16 a[100:103], a[136:139], v[196:199], a[100:103]
    s_add_u32 m0, s42, 16384
    v_exp_f32 v47, v187
    v_mfma_f32_16x16x32_bf16 a[104:107], a[136:139], v[200:203], a[104:107]
    buffer_load_dwordx4 v15, s[24:27], s52 offen offset:0 lds
    v_mfma_f32_16x16x32_bf16 a[108:111], a[136:139], v[204:207], a[108:111]
    v_cvt_pk_bf16_f32 v219, v46, v47
    v_mfma_f32_16x16x32_bf16 v[156:159], a[240:243], v[112:115], v[60:63]
    v_exp_f32 v44, v188
    v_mfma_f32_16x16x32_bf16 v[156:159], a[244:247], v[116:119], v[156:159]
    v_exp_f32 v45, v189
    v_mfma_f32_16x16x32_bf16 v[156:159], a[248:251], v[120:123], v[156:159]
    ds_read_b64_tr_b16 a[132:133], v31 offset:51200
    v_mfma_f32_16x16x32_bf16 v[156:159], a[252:255], v[124:127], v[156:159]
    s_waitcnt lgkmcnt(5)
    ds_read_b64_tr_b16 a[134:135], v31 offset:52224
    v_cvt_pk_bf16_f32 v222, v44, v45
    v_mfma_f32_16x16x32_bf16 a[112:115], a[140:143], v[192:195], a[112:115]
    v_exp_f32 v46, v190
    v_mfma_f32_16x16x32_bf16 a[116:119], a[140:143], v[196:199], a[116:119]
    v_exp_f32 v47, v191
    v_mfma_f32_16x16x32_bf16 a[120:123], a[140:143], v[200:203], a[120:123]
    buffer_load_dwordx4 v15, s[24:27], s52 offen offset:1024 lds
    v_mfma_f32_16x16x32_bf16 a[124:127], a[140:143], v[204:207], a[124:127]
    s_waitcnt lgkmcnt(4)
    v_cvt_pk_bf16_f32 v223, v46, v47
    v_mfma_f32_16x16x32_bf16 v[160:163], a[224:227], v[64:67], v[48:51]
    v_exp_f32 v44, v128
    v_mfma_f32_16x16x32_bf16 v[160:163], a[228:231], v[68:71], v[160:163]
    v_exp_f32 v45, v129
    v_mfma_f32_16x16x32_bf16 v[160:163], a[232:235], v[72:75], v[160:163]
    ds_read_b64_tr_b16 a[136:137], v32 offset:51200
    v_mfma_f32_16x16x32_bf16 v[160:163], a[236:239], v[76:79], v[160:163]
    s_waitcnt lgkmcnt(3)
    ds_read_b64_tr_b16 a[138:139], v32 offset:52224
    v_cvt_pk_bf16_f32 v192, v44, v45
    v_mfma_f32_16x16x32_bf16 a[0:3], a[128:131], v[208:211], a[0:3]
    v_exp_f32 v46, v130
    v_mfma_f32_16x16x32_bf16 a[4:7], a[128:131], v[212:215], a[4:7]
    v_exp_f32 v47, v131
    v_mfma_f32_16x16x32_bf16 a[8:11], a[128:131], v[216:219], a[8:11]
    ds_read_b128 a[240:243], v26 offset:35840
    v_mfma_f32_16x16x32_bf16 a[12:15], a[128:131], v[220:223], a[12:15]
    ds_read_b128 a[244:247], v27 offset:35840
    v_cvt_pk_bf16_f32 v193, v46, v47
    v_mfma_f32_16x16x32_bf16 v[164:167], a[224:227], v[80:83], v[52:55]
    v_exp_f32 v44, v132
    v_mfma_f32_16x16x32_bf16 v[164:167], a[228:231], v[84:87], v[164:167]
    v_exp_f32 v45, v133
    v_mfma_f32_16x16x32_bf16 v[164:167], a[232:235], v[88:91], v[164:167]
    ds_read_b64_tr_b16 a[140:141], v33 offset:51200
    v_mfma_f32_16x16x32_bf16 v[164:167], a[236:239], v[92:95], v[164:167]
    s_waitcnt lgkmcnt(5)
    ds_read_b64_tr_b16 a[142:143], v33 offset:52224
    v_cvt_pk_bf16_f32 v196, v44, v45
    v_mfma_f32_16x16x32_bf16 a[16:19], a[132:135], v[208:211], a[16:19]
    v_exp_f32 v46, v134
    v_mfma_f32_16x16x32_bf16 a[20:23], a[132:135], v[212:215], a[20:23]
    v_exp_f32 v47, v135
    v_mfma_f32_16x16x32_bf16 a[24:27], a[132:135], v[216:219], a[24:27]
    ds_read_b128 a[248:251], v28 offset:35840
    v_mfma_f32_16x16x32_bf16 a[28:31], a[132:135], v[220:223], a[28:31]
    ds_read_b128 a[252:255], v29 offset:35840
    v_cvt_pk_bf16_f32 v197, v46, v47
    v_mfma_f32_16x16x32_bf16 v[168:171], a[224:227], v[96:99], v[56:59]
    v_exp_f32 v44, v136
    v_mfma_f32_16x16x32_bf16 v[168:171], a[228:231], v[100:103], v[168:171]
    v_exp_f32 v45, v137
    v_mfma_f32_16x16x32_bf16 v[168:171], a[232:235], v[104:107], v[168:171]
    ds_read_b64_tr_b16 a[128:129], v34 offset:51200
    v_mfma_f32_16x16x32_bf16 v[168:171], a[236:239], v[108:111], v[168:171]
    s_waitcnt lgkmcnt(7)
    ds_read_b64_tr_b16 a[130:131], v34 offset:52224
    v_cvt_pk_bf16_f32 v200, v44, v45
    v_mfma_f32_16x16x32_bf16 a[32:35], a[136:139], v[208:211], a[32:35]
    v_exp_f32 v46, v138
    v_mfma_f32_16x16x32_bf16 a[36:39], a[136:139], v[212:215], a[36:39]
    v_exp_f32 v47, v139
    v_mfma_f32_16x16x32_bf16 a[40:43], a[136:139], v[216:219], a[40:43]
    buffer_load_dwordx4 v15, s[24:27], s52 offen offset:2048 lds
    v_mfma_f32_16x16x32_bf16 a[44:47], a[136:139], v[220:223], a[44:47]
    v_cvt_pk_bf16_f32 v201, v46, v47
    v_mfma_f32_16x16x32_bf16 v[172:175], a[224:227], v[112:115], v[60:63]
    v_exp_f32 v44, v140
    v_mfma_f32_16x16x32_bf16 v[172:175], a[228:231], v[116:119], v[172:175]
    v_exp_f32 v45, v141
    v_mfma_f32_16x16x32_bf16 v[172:175], a[232:235], v[120:123], v[172:175]
    ds_read_b64_tr_b16 a[132:133], v35 offset:51200
    v_mfma_f32_16x16x32_bf16 v[172:175], a[236:239], v[124:127], v[172:175]
    s_waitcnt lgkmcnt(5)
    ds_read_b64_tr_b16 a[134:135], v35 offset:52224
    v_cvt_pk_bf16_f32 v204, v44, v45
    v_mfma_f32_16x16x32_bf16 a[48:51], a[140:143], v[208:211], a[48:51]
    v_exp_f32 v46, v142
    v_mfma_f32_16x16x32_bf16 a[52:55], a[140:143], v[212:215], a[52:55]
    v_exp_f32 v47, v143
    v_mfma_f32_16x16x32_bf16 a[56:59], a[140:143], v[216:219], a[56:59]
    buffer_load_dwordx4 v15, s[24:27], s52 offen offset:3072 lds
    v_mfma_f32_16x16x32_bf16 a[60:63], a[140:143], v[220:223], a[60:63]
    s_waitcnt lgkmcnt(4)
    v_cvt_pk_bf16_f32 v205, v46, v47
    v_mfma_f32_16x16x32_bf16 v[176:179], a[240:243], v[64:67], v[48:51]
    s_waitcnt vmcnt(10)
    v_exp_f32 v44, v144
    v_mfma_f32_16x16x32_bf16 v[176:179], a[244:247], v[68:71], v[176:179]
    s_barrier
    v_exp_f32 v45, v145
    v_mfma_f32_16x16x32_bf16 v[176:179], a[248:251], v[72:75], v[176:179]
    ds_read_b64_tr_b16 a[136:137], v36 offset:51200
    v_mfma_f32_16x16x32_bf16 v[176:179], a[252:255], v[76:79], v[176:179]
    ds_read_b64_tr_b16 a[138:139], v36 offset:52224
    v_cvt_pk_bf16_f32 v194, v44, v45
    v_mfma_f32_16x16x32_bf16 v[224:227], v[40:43], v[208:211], v[224:227]
    s_waitcnt lgkmcnt(4)
    v_mfma_f32_16x16x32_bf16 a[64:67], a[128:131], v[208:211], a[64:67]
    v_exp_f32 v46, v146
    v_mfma_f32_16x16x32_bf16 a[68:71], a[128:131], v[212:215], a[68:71]
    v_exp_f32 v47, v147
    v_mfma_f32_16x16x32_bf16 a[72:75], a[128:131], v[216:219], a[72:75]
    ds_read_b128 a[224:227], v26 offset:49152
    v_mfma_f32_16x16x32_bf16 a[76:79], a[128:131], v[220:223], a[76:79]
    ds_read_b128 a[228:231], v27 offset:49152
    v_cvt_pk_bf16_f32 v195, v46, v47
    v_mfma_f32_16x16x32_bf16 v[228:231], v[40:43], v[212:215], v[228:231]
    v_mfma_f32_16x16x32_bf16 v[180:183], a[240:243], v[80:83], v[52:55]
    s_add_u32 s52, s52, 16384
    v_exp_f32 v44, v148
    v_mfma_f32_16x16x32_bf16 v[180:183], a[244:247], v[84:87], v[180:183]
    v_exp_f32 v45, v149
    v_mfma_f32_16x16x32_bf16 v[180:183], a[248:251], v[88:91], v[180:183]
    ds_read_b64_tr_b16 a[140:141], v37 offset:51200
    v_mfma_f32_16x16x32_bf16 v[180:183], a[252:255], v[92:95], v[180:183]
    ds_read_b64_tr_b16 a[142:143], v37 offset:52224
    v_cvt_pk_bf16_f32 v198, v44, v45
    v_mfma_f32_16x16x32_bf16 v[232:235], v[40:43], v[216:219], v[232:235]
    s_waitcnt lgkmcnt(6)
    buffer_store_dwordx4 a[152:155], v38, s[8:11], s101 offen offset:2048 sc1
    v_mfma_f32_16x16x32_bf16 a[80:83], a[132:135], v[208:211], a[80:83]
    v_exp_f32 v46, v150
    v_mfma_f32_16x16x32_bf16 a[84:87], a[132:135], v[212:215], a[84:87]
    v_exp_f32 v47, v151
    v_mfma_f32_16x16x32_bf16 a[88:91], a[132:135], v[216:219], a[88:91]
    ds_read_b128 a[232:235], v28 offset:49152
    v_mfma_f32_16x16x32_bf16 a[92:95], a[132:135], v[220:223], a[92:95]
    ds_read_b128 a[236:239], v29 offset:49152
    v_cvt_pk_bf16_f32 v199, v46, v47
    v_mfma_f32_16x16x32_bf16 v[236:239], v[40:43], v[220:223], v[236:239]
    buffer_store_dwordx4 a[156:159], v38, s[8:11], s101 offen offset:3072 sc1
    v_mfma_f32_16x16x32_bf16 v[184:187], a[240:243], v[96:99], v[56:59]
    s_mov_b32 s101, 0x40000000
    v_exp_f32 v44, v152
    v_mfma_f32_16x16x32_bf16 v[184:187], a[244:247], v[100:103], v[184:187]
    v_exp_f32 v45, v153
    v_mfma_f32_16x16x32_bf16 v[184:187], a[248:251], v[104:107], v[184:187]
    ds_read_b64_tr_b16 a[128:129], v30 offset:0
    v_mov_b32 v24, 1
    v_mfma_f32_16x16x32_bf16 v[184:187], a[252:255], v[108:111], v[184:187]
    s_waitcnt lgkmcnt(7)
    ds_read_b64_tr_b16 a[130:131], v30 offset:1024
    v_cvt_pk_bf16_f32 v202, v44, v45
    v_mfma_f32_16x16x32_bf16 a[96:99], a[136:139], v[208:211], a[96:99]
    v_exp_f32 v46, v154
    v_mfma_f32_16x16x32_bf16 a[100:103], a[136:139], v[212:215], a[100:103]
    s_add_u32 m0, s42, 114688
    v_exp_f32 v47, v155
    v_mfma_f32_16x16x32_bf16 a[104:107], a[136:139], v[216:219], a[104:107]
    buffer_load_dwordx4 v14, s[20:23], s51 offen offset:0 lds
    v_mfma_f32_16x16x32_bf16 a[108:111], a[136:139], v[220:223], a[108:111]
    v_cvt_pk_bf16_f32 v203, v46, v47
    v_mfma_f32_16x16x32_bf16 v[188:191], a[240:243], v[112:115], v[60:63]
    v_exp_f32 v44, v156
    v_mfma_f32_16x16x32_bf16 v[188:191], a[244:247], v[116:119], v[188:191]
    v_exp_f32 v45, v157
    v_mfma_f32_16x16x32_bf16 v[188:191], a[248:251], v[120:123], v[188:191]
    ds_read_b64_tr_b16 a[132:133], v31 offset:0
    v_mfma_f32_16x16x32_bf16 v[188:191], a[252:255], v[124:127], v[188:191]
    s_waitcnt lgkmcnt(5)
    ds_read_b64_tr_b16 a[134:135], v31 offset:1024
    v_cvt_pk_bf16_f32 v206, v44, v45
    v_mfma_f32_16x16x32_bf16 a[112:115], a[140:143], v[208:211], a[112:115]
    v_exp_f32 v46, v158
    v_mfma_f32_16x16x32_bf16 a[116:119], a[140:143], v[212:215], a[116:119]
    v_exp_f32 v47, v159
    v_mfma_f32_16x16x32_bf16 a[120:123], a[140:143], v[216:219], a[120:123]
    buffer_load_dwordx4 v14, s[20:23], s51 offen offset:1024 lds
    v_mfma_f32_16x16x32_bf16 a[124:127], a[140:143], v[220:223], a[124:127]
    s_waitcnt lgkmcnt(4)
    v_cvt_pk_bf16_f32 v207, v46, v47
    s_sub_u32 s53, s53, 1
    s_cmp_lg_u32 s53, 0
    s_cbranch_scc1 L_loopA
    v_cmp_gt_u32 vcc, 0x100, v22
    v_min3_u32 v21, v21, v10, v11
    s_mov_b64 s[90:91], vcc
    v_cmp_gt_u32 vcc, 1, v21
    s_or_b64 vcc, vcc, s[90:91]
    s_cbranch_vccnz L_hw
L_h_ok:
    s_cmp_lg_u32 s36, 0
    s_cbranch_scc1 L_notk
    s_lshl_b32 s48, s38, 2
    s_add_u32 s48, s48, 128
    s_mov_b64 exec, 1
    v_mov_b32 v7, s48
    global_atomic_add v1, v7, v24, s[84:85] sc0 sc1
    s_mov_b64 exec, -1
L_notk:
    s_add_u32 m0, s42, 65536
    s_nop 0
    buffer_load_dwordx4 v38, s[12:15], s59 offen offset:0 sc1 lds
    buffer_load_dwordx4 v38, s[12:15], s59 offen offset:1024 sc1 lds
    buffer_load_dwordx4 v38, s[12:15], s59 offen offset:2048 sc1 lds
    buffer_load_dwordx4 v38, s[12:15], s59 offen offset:3072 sc1 lds
    s_add_u32 s59, s59, 16384
    buffer_load_dwordx4 a[144:147], v38, s[16:19], s58 offen offset:0 sc1
    buffer_load_dwordx4 a[148:151], v38, s[16:19], s58 offen offset:1024 sc1
    buffer_load_dwordx4 a[152:155], v38, s[16:19], s58 offen offset:2048 sc1
    buffer_load_dwordx4 a[156:159], v38, s[16:19], s58 offen offset:3072 sc1
    s_add_u32 s58, s58, 4096
    buffer_load_dwordx4 a[160:163], v38, s[16:19], s58 offen offset:0 sc1
    s_getpc_b64 s[32:33]
L_pc1:
    s_mov_b32 s34, L_code_end - L_pc1
    s_lshr_b32 s48, s2, 3
    s_lshl_b32 s48, s48, 16
    s_lshl_b32 s49, s36, 14
    s_add_u32 s48, s48, s49
    buffer_load_dword v39, v25, s[32:35], s48 offen
    s_add_u32 s48, s48, 8192
    buffer_load_dword v39, v25, s[32:35], s48 offen
    s_add_u32 m0, s42, 114688
    s_mov_b32 s53, 3
    s_waitcnt lgkmcnt(0)
.p2align 3
L_loopB:
    v_mfma_f32_16x16x32_bf16 v[128:131], a[224:227], v[64:67], v[48:51]
    v_exp_f32 v44, v160
    v_mfma_f32_16x16x32_bf16 v[128:131], a[228:231], v[68:71], v[128:131]
    v_exp_f32 v45, v161
    v_mfma_f32_16x16x32_bf16 v[128:131], a[232:235], v[72:75], v[128:131]
    ds_read_b64_tr_b16 a[136:137], v32 offset:0
    v_mfma_f32_16x16x32_bf16 v[128:131], a[236:239], v[76:79], v[128:131]
    ds_read_b64_tr_b16 a[138:139], v32 offset:1024
    v_cvt_pk_bf16_f32 v208, v44, v45
    v_mfma_f32_16x16x32_bf16 a[0:3], a[128:131], v[192:195], a[0:3]
    v_exp_f32 v46, v162
    v_mfma_f32_16x16x32_bf16 a[4:7], a[128:131], v[196:199], a[4:7]
    v_exp_f32 v47, v163
    v_mfma_f32_16x16x32_bf16 a[8:11], a[128:131], v[200:203], a[8:11]
    ds_read_b128 a[240:243], v26 offset:50176
    v_mfma_f32_16x16x32_bf16 a[12:15], a[128:131], v[204:207], a[12:15]
    ds_read_b128 a[244:247], v27 offset:50176
    v_cvt_pk_bf16_f32 v209, v46, v47
    v_mfma_f32_16x16x32_bf16 v[224:227], v[40:43], v[192:195], v[224:227]
    ds_read_b128 a[200:203], v13 offset:22528
    v_mfma_f32_16x16x32_bf16 v[132:135], a[224:227], v[80:83], v[52:55]
    v_exp_f32 v44, v164
    v_mfma_f32_16x16x32_bf16 v[132:135], a[228:231], v[84:87], v[132:135]
    v_exp_f32 v45, v165
    v_mfma_f32_16x16x32_bf16 v[132:135], a[232:235], v[88:91], v[132:135]
    ds_read_b64_tr_b16 a[140:141], v33 offset:0
    v_mfma_f32_16x16x32_bf16 v[132:135], a[236:239], v[92:95], v[132:135]
    s_waitcnt lgkmcnt(7)
    ds_read_b64_tr_b16 a[142:143], v33 offset:1024
    v_cvt_pk_bf16_f32 v212, v44, v45
    v_mfma_f32_16x16x32_bf16 a[16:19], a[132:135], v[192:195], a[16:19]
    v_exp_f32 v46, v166
    v_mfma_f32_16x16x32_bf16 a[20:23], a[132:135], v[196:199], a[20:23]
    v_exp_f32 v47, v167
    v_mfma_f32_16x16x32_bf16 a[24:27], a[132:135], v[200:203], a[24:27]
    ds_read_b128 a[248:251], v28 offset:50176
    v_mfma_f32_16x16x32_bf16 a[28:31], a[132:135], v[204:207], a[28:31]
    ds_read_b128 a[252:255], v29 offset:50176
    v_cvt_pk_bf16_f32 v213, v46, v47
    v_mfma_f32_16x16x32_bf16 v[228:231], v[40:43], v[196:199], v[228:231]
    ds_read_b128 a[204:207], v13 offset:23552
    v_mfma_f32_16x16x32_bf16 v[136:139], a[224:227], v[96:99], v[56:59]
    v_exp_f32 v44, v168
    v_mfma_f32_16x16x32_bf16 v[136:139], a[228:231], v[100:103], v[136:139]
    v_exp_f32 v45, v169
    v_mfma_f32_16x16x32_bf16 v[136:139], a[232:235], v[104:107], v[136:139]
    ds_read_b64_tr_b16 a[128:129], v34 offset:0
    v_mfma_f32_16x16x32_bf16 v[136:139], a[236:239], v[108:111], v[136:139]
    ds_read_b64_tr_b16 a[130:131], v34 offset:1024
    v_cvt_pk_bf16_f32 v216, v44, v45
    v_mfma_f32_16x16x32_bf16 v[240:243], a[192:195], a[164:167], v[240:243]
    s_waitcnt lgkmcnt(10)
    ds_read_b128 a[176:179], v13 offset:24576
    v_mfma_f32_16x16x32_bf16 a[32:35], a[136:139], v[192:195], a[32:35]
    v_exp_f32 v46, v170
    v_mfma_f32_16x16x32_bf16 a[36:39], a[136:139], v[196:199], a[36:39]
    v_exp_f32 v47, v171
    v_mfma_f32_16x16x32_bf16 a[40:43], a[136:139], v[200:203], a[40:43]
    buffer_load_dwordx4 v14, s[20:23], s51 offen offset:2048 lds
    v_mfma_f32_16x16x32_bf16 a[44:47], a[136:139], v[204:207], a[44:47]
    v_cvt_pk_bf16_f32 v217, v46, v47
    v_mfma_f32_16x16x32_bf16 v[244:247], a[196:199], a[164:167], v[244:247]
    ds_read_b128 a[180:183], v13 offset:25600
    v_mfma_f32_16x16x32_bf16 v[140:143], a[224:227], v[112:115], v[60:63]
    v_exp_f32 v44, v172
    v_mfma_f32_16x16x32_bf16 v[140:143], a[228:231], v[116:119], v[140:143]
    v_exp_f32 v45, v173
    v_mfma_f32_16x16x32_bf16 v[140:143], a[232:235], v[120:123], v[140:143]
    ds_read_b64_tr_b16 a[132:133], v35 offset:0
    v_mfma_f32_16x16x32_bf16 v[140:143], a[236:239], v[124:127], v[140:143]
    s_waitcnt lgkmcnt(10)
    ds_read_b64_tr_b16 a[134:135], v35 offset:1024
    v_cvt_pk_bf16_f32 v220, v44, v45
    v_mfma_f32_16x16x32_bf16 v[248:251], a[200:203], a[164:167], v[248:251]
    s_waitcnt lgkmcnt(9)
    ds_read_b128 a[184:187], v13 offset:26624
    v_mfma_f32_16x16x32_bf16 a[48:51], a[140:143], v[192:195], a[48:51]
    v_exp_f32 v46, v174
    v_mfma_f32_16x16x32_bf16 a[52:55], a[140:143], v[196:199], a[52:55]
    v_exp_f32 v47, v175
    v_mfma_f32_16x16x32_bf16 a[56:59], a[140:143], v[200:203], a[56:59]
    buffer_load_dwordx4 v14, s[20:23], s51 offen offset:3072 lds
    v_mfma_f32_16x16x32_bf16 a[60:63], a[140:143], v[204:207], a[60:63]
    v_cvt_pk_bf16_f32 v221, v46, v47
    v_mfma_f32_16x16x32_bf16 v[232:235], v[40:43], v[200:203], v[232:235]
    s_waitcnt lgkmcnt(8)
    v_mfma_f32_16x16x32_bf16 v[144:147], a[240:243], v[64:67], v[48:51]
    v_exp_f32 v44, v176
    v_mfma_f32_16x16x32_bf16 v[144:147], a[244:247], v[68:71], v[144:147]
    v_exp_f32 v45, v177
    v_mfma_f32_16x16x32_bf16 v[144:147], a[248:251], v[72:75], v[144:147]
    ds_read_b64_tr_b16 a[136:137], v36 offset:0
    v_mfma_f32_16x16x32_bf16 v[144:147], a[252:255], v[76:79], v[144:147]
    s_waitcnt lgkmcnt(8)
    ds_read_b64_tr_b16 a[138:139], v36 offset:1024
    v_cvt_pk_bf16_f32 v210, v44, v45
    v_mfma_f32_16x16x32_bf16 v[252:255], a[204:207], a[164:167], v[252:255]
    s_waitcnt lgkmcnt(7)
    buffer_load_dwordx4 a[164:167], v38, s[16:19], s58 offen offset:1024 sc1
    v_mfma_f32_16x16x32_bf16 a[64:67], a[128:131], v[192:195], a[64:67]
    v_exp_f32 v46, v178
    v_mfma_f32_16x16x32_bf16 a[68:71], a[128:131], v[196:199], a[68:71]
    v_exp_f32 v47, v179
    v_mfma_f32_16x16x32_bf16 a[72:75], a[128:131], v[200:203], a[72:75]
    ds_read_b128 a[224:227], v26 offset:51200
    v_mfma_f32_16x16x32_bf16 a[76:79], a[128:131], v[204:207], a[76:79]
    s_waitcnt lgkmcnt(7)
    ds_read_b128 a[228:231], v27 offset:51200
    v_cvt_pk_bf16_f32 v211, v46, v47
    v_mfma_f32_16x16x32_bf16 v[240:243], a[176:179], a[168:171], v[240:243]
    ds_read_b128 a[188:191], v13 offset:27648
    v_mfma_f32_16x16x32_bf16 v[148:151], a[240:243], v[80:83], v[52:55]
    s_add_u32 s51, s51, 16384
    v_exp_f32 v44, v180
    v_mfma_f32_16x16x32_bf16 v[148:151], a[244:247], v[84:87], v[148:151]
    v_exp_f32 v45, v181
    v_mfma_f32_16x16x32_bf16 v[148:151], a[248:251], v[88:91], v[148:151]
    ds_read_b64_tr_b16 a[140:141], v37 offset:0
    v_mfma_f32_16x16x32_bf16 v[148:151], a[252:255], v[92:95], v[148:151]
    ds_read_b64_tr_b16 a[142:143], v37 offset:1024
    v_cvt_pk_bf16_f32 v214, v44, v45
    v_mfma_f32_16x16x32_bf16 v[236:239], v[40:43], v[204:207], v[236:239]
    s_waitcnt lgkmcnt(8)
    ds_read_b128 a[192:195], v13 offset:28672
    v_mfma_f32_16x16x32_bf16 a[80:83], a[132:135], v[192:195], a[80:83]
    v_exp_f32 v46, v182
    v_mfma_f32_16x16x32_bf16 a[84:87], a[132:135], v[196:199], a[84:87]
    v_exp_f32 v47, v183
    v_mfma_f32_16x16x32_bf16 a[88:91], a[132:135], v[200:203], a[88:91]
    ds_read_b128 a[232:235], v28 offset:51200
    v_mfma_f32_16x16x32_bf16 a[92:95], a[132:135], v[204:207], a[92:95]
    ds_read_b128 a[236:239], v29 offset:51200
    v_cvt_pk_bf16_f32 v215, v46, v47
    v_mfma_f32_16x16x32_bf16 v[244:247], a[180:183], a[168:171], v[244:247]
    v_mfma_f32_16x16x32_bf16 v[152:155], a[240:243], v[96:99], v[56:59]
    v_exp_f32 v44, v184
    v_mfma_f32_16x16x32_bf16 v[152:155], a[244:247], v[100:103], v[152:155]
    v_exp_f32 v45, v185
    v_mfma_f32_16x16x32_bf16 v[152:155], a[248:251], v[104:107], v[152:155]
    ds_read_b64_tr_b16 a[128:129], v30 offset:2048
    v_mfma_f32_16x16x32_bf16 v[152:155], a[252:255], v[108:111], v[152:155]
    s_waitcnt lgkmcnt(11)
    ds_read_b64_tr_b16 a[130:131], v30 offset:3072
    v_cvt_pk_bf16_f32 v218, v44, v45
    v_mfma_f32_16x16x32_bf16 v[248:251], a[184:187], a[168:171], v[248:251]
    s_waitcnt lgkmcnt(10)
    ds_read_b128 a[196:199], v13 offset:29696
    v_mfma_f32_16x16x32_bf16 a[96:99], a[136:139], v[192:195], a[96:99]
    v_exp_f32 v46, v186
    v_mfma_f32_16x16x32_bf16 a[100:103], a[136:139], v[196:199], a[100:103]
    s_add_u32 m0, s42, 32768
    v_exp_f32 v47, v187
    v_mfma_f32_16x16x32_bf16 a[104:107], a[136:139], v[200:203], a[104:107]
    buffer_load_dwordx4 v15, s[24:27], s52 offen offset:0 lds
    v_mfma_f32_16x16x32_bf16 a[108:111], a[136:139], v[204:207], a[108:111]
    v_cvt_pk_bf16_f32 v219, v46, v47
    v_mfma_f32_16x16x32_bf16 v[156:159], a[240:243], v[112:115], v[60:63]
    v_exp_f32 v44, v188
    v_mfma_f32_16x16x32_bf16 v[156:159], a[244:247], v[116:119], v[156:159]
    v_exp_f32 v45, v189
    v_mfma_f32_16x16x32_bf16 v[156:159], a[248:251], v[120:123], v[156:159]
    ds_read_b64_tr_b16 a[132:133], v31 offset:2048
    v_mfma_f32_16x16x32_bf16 v[156:159], a[252:255], v[124:127], v[156:159]
    s_waitcnt lgkmcnt(9)
    ds_read_b64_tr_b16 a[134:135], v31 offset:3072
    v_cvt_pk_bf16_f32 v222, v44, v45
    v_mfma_f32_16x16x32_bf16 v[252:255], a[188:191], a[168:171], v[252:255]
    s_waitcnt lgkmcnt(8)
    buffer_load_dwordx4 a[168:171], v38, s[16:19], s58 offen offset:2048 sc1
    v_mfma_f32_16x16x32_bf16 a[112:115], a[140:143], v[192:195], a[112:115]
    v_exp_f32 v46, v190
    v_mfma_f32_16x16x32_bf16 a[116:119], a[140:143], v[196:199], a[116:119]
    v_exp_f32 v47, v191
    v_mfma_f32_16x16x32_bf16 a[120:123], a[140:143], v[200:203], a[120:123]
    buffer_load_dwordx4 v15, s[24:27], s52 offen offset:1024 lds
    v_mfma_f32_16x16x32_bf16 a[124:127], a[140:143], v[204:207], a[124:127]
    s_waitcnt lgkmcnt(5)
    ds_read_b128 a[200:203], v13 offset:30720
    v_cvt_pk_bf16_f32 v223, v46, v47
    v_mfma_f32_16x16x32_bf16 v[160:163], a[224:227], v[64:67], v[48:51]
    v_exp_f32 v44, v128
    v_mfma_f32_16x16x32_bf16 v[160:163], a[228:231], v[68:71], v[160:163]
    v_exp_f32 v45, v129
    v_mfma_f32_16x16x32_bf16 v[160:163], a[232:235], v[72:75], v[160:163]
    ds_read_b64_tr_b16 a[136:137], v32 offset:2048
    v_mfma_f32_16x16x32_bf16 v[160:163], a[236:239], v[76:79], v[160:163]
    ds_read_b64_tr_b16 a[138:139], v32 offset:3072
    v_cvt_pk_bf16_f32 v192, v44, v45
    v_mfma_f32_16x16x32_bf16 v[240:243], a[192:195], a[172:175], v[240:243]
    s_waitcnt lgkmcnt(6)
    ds_read_b128 a[204:207], v13 offset:31744
    v_mfma_f32_16x16x32_bf16 a[0:3], a[128:131], v[208:211], a[0:3]
    v_exp_f32 v46, v130
    v_mfma_f32_16x16x32_bf16 a[4:7], a[128:131], v[212:215], a[4:7]
    v_exp_f32 v47, v131
    v_mfma_f32_16x16x32_bf16 a[8:11], a[128:131], v[216:219], a[8:11]
    ds_read_b128 a[240:243], v26 offset:52224
    v_mfma_f32_16x16x32_bf16 a[12:15], a[128:131], v[220:223], a[12:15]
    ds_read_b128 a[244:247], v27 offset:52224
    v_cvt_pk_bf16_f32 v193, v46, v47
    v_mfma_f32_16x16x32_bf16 v[164:167], a[224:227], v[80:83], v[52:55]
    v_exp_f32 v44, v132
    v_mfma_f32_16x16x32_bf16 v[164:167], a[228:231], v[84:87], v[164:167]
    v_exp_f32 v45, v133
    v_mfma_f32_16x16x32_bf16 v[164:167], a[232:235], v[88:91], v[164:167]
    ds_read_b64_tr_b16 a[140:141], v33 offset:2048
    v_mfma_f32_16x16x32_bf16 v[164:167], a[236:239], v[92:95], v[164:167]
    s_waitcnt lgkmcnt(9)
    ds_read_b64_tr_b16 a[142:143], v33 offset:3072
    v_cvt_pk_bf16_f32 v196, v44, v45
    v_mfma_f32_16x16x32_bf16 v[244:247], a[196:199], a[172:175], v[244:247]
    s_waitcnt lgkmcnt(8)
    v_mfma_f32_16x16x32_bf16 a[16:19], a[132:135], v[208:211], a[16:19]
    v_exp_f32 v46, v134
    v_mfma_f32_16x16x32_bf16 a[20:23], a[132:135], v[212:215], a[20:23]
    v_exp_f32 v47, v135
    v_mfma_f32_16x16x32_bf16 a[24:27], a[132:135], v[216:219], a[24:27]
    ds_read_b128 a[248:251], v28 offset:52224
    v_mfma_f32_16x16x32_bf16 a[28:31], a[132:135], v[220:223], a[28:31]
    ds_read_b128 a[252:255], v29 offset:52224
    v_cvt_pk_bf16_f32 v197, v46, v47
    v_mfma_f32_16x16x32_bf16 v[168:171], a[224:227], v[96:99], v[56:59]
    v_exp_f32 v44, v136
    v_mfma_f32_16x16x32_bf16 v[168:171], a[228:231], v[100:103], v[168:171]
    v_exp_f32 v45, v137
    v_mfma_f32_16x16x32_bf16 v[168:171], a[232:235], v[104:107], v[168:171]
    ds_read_b64_tr_b16 a[128:129], v34 offset:2048
    v_mfma_f32_16x16x32_bf16 v[168:171], a[236:239], v[108:111], v[168:171]
    s_waitcnt lgkmcnt(10)
    ds_read_b64_tr_b16 a[130:131], v34 offset:3072
    v_cvt_pk_bf16_f32 v200, v44, v45
    v_mfma_f32_16x16x32_bf16 v[248:251], a[200:203], a[172:175], v[248:251]
    s_waitcnt lgkmcnt(9)
    v_mfma_f32_16x16x32_bf16 a[32:35], a[136:139], v[208:211], a[32:35]
    v_exp_f32 v46, v138
    v_mfma_f32_16x16x32_bf16 a[36:39], a[136:139], v[212:215], a[36:39]
    v_exp_f32 v47, v139
    v_mfma_f32_16x16x32_bf16 a[40:43], a[136:139], v[216:219], a[40:43]
    buffer_load_dwordx4 v15, s[24:27], s52 offen offset:2048 lds
    v_mfma_f32_16x16x32_bf16 a[44:47], a[136:139], v[220:223], a[44:47]
    v_cvt_pk_bf16_f32 v201, v46, v47
    v_mfma_f32_16x16x32_bf16 v[172:175], a[224:227], v[112:115], v[60:63]
    v_exp_f32 v44, v140
    v_mfma_f32_16x16x32_bf16 v[172:175], a[228:231], v[116:119], v[172:175]
    v_exp_f32 v45, v141
    v_mfma_f32_16x16x32_bf16 v[172:175], a[232:235], v[120:123], v[172:175]
    ds_read_b64_tr_b16 a[132:133], v35 offset:2048
    v_mfma_f32_16x16x32_bf16 v[172:175], a[236:239], v[124:127], v[172:175]
    s_waitcnt lgkmcnt(9)
    ds_read_b64_tr_b16 a[134:135], v35 offset:3072
    v_cvt_pk_bf16_f32 v204, v44, v45
    v_mfma_f32_16x16x32_bf16 v[252:255], a[204:207], a[172:175], v[252:255]
    s_waitcnt lgkmcnt(6)
    buffer_load_dwordx4 a[172:175], v38, s[16:19], s58 offen offset:3072 sc1
    v_mfma_f32_16x16x32_bf16 a[48:51], a[140:143], v[208:211], a[48:51]
    s_add_u32 s58, s58, 4096
    v_exp_f32 v46, v142
    v_mfma_f32_16x16x32_bf16 a[52:55], a[140:143], v[212:215], a[52:55]
    v_exp_f32 v47, v143
    v_mfma_f32_16x16x32_bf16 a[56:59], a[140:143], v[216:219], a[56:59]
    buffer_load_dwordx4 v15, s[24:27], s52 offen offset:3072 lds
    v_mfma_f32_16x16x32_bf16 a[60:63], a[140:143], v[220:223], a[60:63]
    s_waitcnt lgkmcnt(4)
    v_cvt_pk_bf16_f32 v205, v46, v47
    v_mfma_f32_16x16x32_bf16 v[176:179], a[240:243], v[64:67], v[48:51]
    s_waitcnt vmcnt(12)
    v_exp_f32 v44, v144
    v_mfma_f32_16x16x32_bf16 v[176:179], a[244:247], v[68:71], v[176:179]
    s_barrier
    s_cmp_lg_u32 s53, 3
    s_cbranch_scc1 L_ynz
    v_mov_b32 v240, 0
    v_mov_b32 v241, 0
    v_mov_b32 v242, 0
    v_mov_b32 v243, 0
    v_mov_b32 v244, 0
    v_mov_b32 v245, 0
    v_mov_b32 v246, 0
    v_mov_b32 v247, 0
    v_mov_b32 v248, 0
    v_mov_b32 v249, 0
    v_mov_b32 v250, 0
    v_mov_b32 v251, 0
    v_mov_b32 v252, 0
    v_mov_b32 v253, 0
    v_mov_b32 v254, 0
    v_mov_b32 v255, 0
L_ynz:
    v_exp_f32 v45, v145
    v_mfma_f32_16x16x32_bf16 v[176:179], a[248:251], v[72:75], v[176:179]
    s_add_u32 m0, s42, 81920
    ds_read_b64_tr_b16 a[136:137], v36 offset:2048
    ds_read_b128 a[176:179], v13 offset:0
    v_mfma_f32_16x16x32_bf16 v[176:179], a[252:255], v[76:79], v[176:179]
    ds_read_b64_tr_b16 a[138:139], v36 offset:3072
    v_cvt_pk_bf16_f32 v194, v44, v45
    v_mfma_f32_16x16x32_bf16 v[224:227], v[40:43], v[208:211], v[224:227]
    s_waitcnt lgkmcnt(5)
    buffer_load_dwordx4 v38, s[12:15], s59 offen offset:0 sc1 lds
    v_mfma_f32_16x16x32_bf16 a[64:67], a[128:131], v[208:211], a[64:67]
    v_exp_f32 v46, v146
    v_mfma_f32_16x16x32_bf16 a[68:71], a[128:131], v[212:215], a[68:71]
    v_exp_f32 v47, v147
    v_mfma_f32_16x16x32_bf16 a[72:75], a[128:131], v[216:219], a[72:75]
    ds_read_b128 a[224:227], v26 offset:0
    ds_read_b128 a[180:183], v13 offset:1024
    v_mfma_f32_16x16x32_bf16 a[76:79], a[128:131], v[220:223], a[76:79]
    ds_read_b128 a[228:231], v27 offset:0
    v_cvt_pk_bf16_f32 v195, v46, v47
    v_mfma_f32_16x16x32_bf16 v[228:231], v[40:43], v[212:215], v[228:231]
    buffer_load_dwordx4 v38, s[12:15], s59 offen offset:1024 sc1 lds
    v_mfma_f32_16x16x32_bf16 v[180:183], a[240:243], v[80:83], v[52:55]
    s_add_u32 s52, s52, 16384
    v_exp_f32 v44, v148
    v_mfma_f32_16x16x32_bf16 v[180:183], a[244:247], v[84:87], v[180:183]
    v_exp_f32 v45, v149
    v_mfma_f32_16x16x32_bf16 v[180:183], a[248:251], v[88:91], v[180:183]
    ds_read_b64_tr_b16 a[140:141], v37 offset:2048
    v_mfma_f32_16x16x32_bf16 v[180:183], a[252:255], v[92:95], v[180:183]
    ds_read_b64_tr_b16 a[142:143], v37 offset:3072
    v_cvt_pk_bf16_f32 v198, v44, v45
    v_mfma_f32_16x16x32_bf16 v[232:235], v[40:43], v[216:219], v[232:235]
    s_waitcnt lgkmcnt(8)
    buffer_load_dwordx4 v38, s[12:15], s59 offen offset:2048 sc1 lds
    v_mfma_f32_16x16x32_bf16 a[80:83], a[132:135], v[208:211], a[80:83]
    v_exp_f32 v46, v150
    v_mfma_f32_16x16x32_bf16 a[84:87], a[132:135], v[212:215], a[84:87]
    v_exp_f32 v47, v151
    v_mfma_f32_16x16x32_bf16 a[88:91], a[132:135], v[216:219], a[88:91]
    ds_read_b128 a[232:235], v28 offset:0
    v_mfma_f32_16x16x32_bf16 a[92:95], a[132:135], v[220:223], a[92:95]
    ds_read_b128 a[236:239], v29 offset:0
    v_cvt_pk_bf16_f32 v199, v46, v47
    v_mfma_f32_16x16x32_bf16 v[236:239], v[40:43], v[220:223], v[236:239]
    buffer_load_dwordx4 v38, s[12:15], s59 offen offset:3072 sc1 lds
    v_mfma_f32_16x16x32_bf16 v[184:187], a[240:243], v[96:99], v[56:59]
    s_add_u32 s59, s59, 16384
    v_exp_f32 v44, v152
    v_mfma_f32_16x16x32_bf16 v[184:187], a[244:247], v[100:103], v[184:187]
    v_exp_f32 v45, v153
    v_mfma_f32_16x16x32_bf16 v[184:187], a[248:251], v[104:107], v[184:187]
    ds_read_b64_tr_b16 a[128:129], v30 offset:16384
    v_mfma_f32_16x16x32_bf16 v[184:187], a[252:255], v[108:111], v[184:187]
    s_waitcnt lgkmcnt(9)
    ds_read_b64_tr_b16 a[130:131], v30 offset:17408
    v_cvt_pk_bf16_f32 v202, v44, v45
    v_mfma_f32_16x16x32_bf16 v[240:243], a[176:179], a[144:147], v[240:243]
    s_waitcnt lgkmcnt(9)
    ds_read_b128 a[184:187], v13 offset:2048
    v_mfma_f32_16x16x32_bf16 a[96:99], a[136:139], v[208:211], a[96:99]
    v_exp_f32 v46, v154
    v_mfma_f32_16x16x32_bf16 a[100:103], a[136:139], v[212:215], a[100:103]
    s_add_u32 m0, s42, 131072
    v_exp_f32 v47, v155
    v_mfma_f32_16x16x32_bf16 a[104:107], a[136:139], v[216:219], a[104:107]
    buffer_load_dwordx4 v14, s[20:23], s51 offen offset:0 lds
    v_mfma_f32_16x16x32_bf16 a[108:111], a[136:139], v[220:223], a[108:111]
    s_waitcnt lgkmcnt(8)
    ds_read_b128 a[188:191], v13 offset:3072
    v_cvt_pk_bf16_f32 v203, v46, v47
    v_mfma_f32_16x16x32_bf16 v[244:247], a[180:183], a[144:147], v[244:247]
    ds_read_b128 a[192:195], v13 offset:4096
    v_mfma_f32_16x16x32_bf16 v[188:191], a[240:243], v[112:115], v[60:63]
    v_exp_f32 v44, v156
    v_mfma_f32_16x16x32_bf16 v[188:191], a[244:247], v[116:119], v[188:191]
    v_exp_f32 v45, v157
    v_mfma_f32_16x16x32_bf16 v[188:191], a[248:251], v[120:123], v[188:191]
    ds_read_b64_tr_b16 a[132:133], v31 offset:16384
    v_mfma_f32_16x16x32_bf16 v[188:191], a[252:255], v[124:127], v[188:191]
    s_waitcnt lgkmcnt(3)
    ds_read_b64_tr_b16 a[134:135], v31 offset:17408
    v_cvt_pk_bf16_f32 v206, v44, v45
    v_mfma_f32_16x16x32_bf16 v[248:251], a[184:187], a[144:147], v[248:251]
    ds_read_b128 a[196:199], v13 offset:5120
    v_mfma_f32_16x16x32_bf16 a[112:115], a[140:143], v[208:211], a[112:115]
    v_exp_f32 v46, v158
    v_mfma_f32_16x16x32_bf16 a[116:119], a[140:143], v[212:215], a[116:119]
    v_exp_f32 v47, v159
    v_mfma_f32_16x16x32_bf16 a[120:123], a[140:143], v[216:219], a[120:123]
    buffer_load_dwordx4 v14, s[20:23], s51 offen offset:1024 lds
    v_mfma_f32_16x16x32_bf16 a[124:127], a[140:143], v[220:223], a[124:127]
    s_waitcnt lgkmcnt(4)
    v_cvt_pk_bf16_f32 v207, v46, v47
    v_mfma_f32_16x16x32_bf16 v[252:255], a[188:191], a[144:147], v[252:255]
    buffer_load_dwordx4 a[144:147], v38, s[16:19], s58 offen offset:0 sc1
    v_mfma_f32_16x16x32_bf16 v[128:131], a[224:227], v[64:67], v[48:51]
    v_exp_f32 v44, v160
    v_mfma_f32_16x16x32_bf16 v[128:131], a[228:231], v[68:71], v[128:131]
    v_exp_f32 v45, v161
    v_mfma_f32_16x16x32_bf16 v[128:131], a[232:235], v[72:75], v[128:131]
    ds_read_b64_tr_b16 a[136:137], v32 offset:16384
    v_and_b32 v2, 0x1000001f, v1
    v_mfma_f32_16x16x32_bf16 v[128:131], a[236:239], v[76:79], v[128:131]
    ds_read_b64_tr_b16 a[138:139], v32 offset:17408
    v_cvt_pk_bf16_f32 v208, v44, v45
    v_mfma_f32_16x16x32_bf16 a[0:3], a[128:131], v[192:195], a[0:3]
    v_exp_f32 v46, v162
    v_mfma_f32_16x16x32_bf16 a[4:7], a[128:131], v[196:199], a[4:7]
    v_exp_f32 v47, v163
    v_mfma_f32_16x16x32_bf16 a[8:11], a[128:131], v[200:203], a[8:11]
    ds_read_b128 a[240:243], v26 offset:1024
    v_lshlrev_b32 v2, 2, v2
    v_mfma_f32_16x16x32_bf16 a[12:15], a[128:131], v[204:207], a[12:15]
    ds_read_b128 a[244:247], v27 offset:1024
    v_cvt_pk_bf16_f32 v209, v46, v47
    v_mfma_f32_16x16x32_bf16 v[224:227], v[40:43], v[192:195], v[224:227]
    buffer_store_dword v5, v2, s[60:63], s43 offen sc1
    v_mfma_f32_16x16x32_bf16 v[132:135], a[224:227], v[80:83], v[52:55]
    v_exp_f32 v44, v164
    v_mfma_f32_16x16x32_bf16 v[132:135], a[228:231], v[84:87], v[132:135]
    v_exp_f32 v45, v165
    v_mfma_f32_16x16x32_bf16 v[132:135], a[232:235], v[88:91], v[132:135]
    ds_read_b64_tr_b16 a[140:141], v33 offset:16384
    v_mfma_f32_16x16x32_bf16 v[132:135], a[236:239], v[92:95], v[132:135]
    s_waitcnt lgkmcnt(6)
    ds_read_b64_tr_b16 a[142:143], v33 offset:17408
    v_cvt_pk_bf16_f32 v212, v44, v45
    v_mfma_f32_16x16x32_bf16 a[16:19], a[132:135], v[192:195], a[16:19]
    v_exp_f32 v46, v166
    v_mfma_f32_16x16x32_bf16 a[20:23], a[132:135], v[196:199], a[20:23]
    v_exp_f32 v47, v167
    v_mfma_f32_16x16x32_bf16 a[24:27], a[132:135], v[200:203], a[24:27]
    ds_read_b128 a[248:251], v28 offset:1024
    v_mfma_f32_16x16x32_bf16 a[28:31], a[132:135], v[204:207], a[28:31]
    ds_read_b128 a[252:255], v29 offset:1024
    v_cvt_pk_bf16_f32 v213, v46, v47
    v_mfma_f32_16x16x32_bf16 v[228:231], v[40:43], v[196:199], v[228:231]
    ds_read_b128 a[200:203], v13 offset:6144
    v_mfma_f32_16x16x32_bf16 v[136:139], a[224:227], v[96:99], v[56:59]
    v_exp_f32 v44, v168
    v_mfma_f32_16x16x32_bf16 v[136:139], a[228:231], v[100:103], v[136:139]
    v_exp_f32 v45, v169
    v_mfma_f32_16x16x32_bf16 v[136:139], a[232:235], v[104:107], v[136:139]
    ds_read_b64_tr_b16 a[128:129], v34 offset:16384
    v_mfma_f32_16x16x32_bf16 v[136:139], a[236:239], v[108:111], v[136:139]
    ds_read_b64_tr_b16 a[130:131], v34 offset:17408
    v_cvt_pk_bf16_f32 v216, v44, v45
    v_mfma_f32_16x16x32_bf16 v[240:243], a[192:195], a[148:151], v[240:243]
    s_waitcnt lgkmcnt(9)
    ds_read_b128 a[204:207], v13 offset:7168
    v_mfma_f32_16x16x32_bf16 a[32:35], a[136:139], v[192:195], a[32:35]
    v_exp_f32 v46, v170
    v_mfma_f32_16x16x32_bf16 a[36:39], a[136:139], v[196:199], a[36:39]
    v_exp_f32 v47, v171
    v_mfma_f32_16x16x32_bf16 a[40:43], a[136:139], v[200:203], a[40:43]
    buffer_load_dwordx4 v14, s[20:23], s51 offen offset:2048 lds
    v_mfma_f32_16x16x32_bf16 a[44:47], a[136:139], v[204:207], a[44:47]
    ds_read_b128 a[176:179], v13 offset:8192
    v_cvt_pk_bf16_f32 v217, v46, v47
    v_mfma_f32_16x16x32_bf16 v[244:247], a[196:199], a[148:151], v[244:247]
    ds_read_b128 a[180:183], v13 offset:9216
    v_mfma_f32_16x16x32_bf16 v[140:143], a[224:227], v[112:115], v[60:63]
    v_exp_f32 v44, v172
    v_mfma_f32_16x16x32_bf16 v[140:143], a[228:231], v[116:119], v[140:143]
    v_exp_f32 v45, v173
    v_mfma_f32_16x16x32_bf16 v[140:143], a[232:235], v[120:123], v[140:143]
    ds_read_b64_tr_b16 a[132:133], v35 offset:16384
    v_mfma_f32_16x16x32_bf16 v[140:143], a[236:239], v[124:127], v[140:143]
    s_waitcnt lgkmcnt(6)
    ds_read_b64_tr_b16 a[134:135], v35 offset:17408
    v_cvt_pk_bf16_f32 v220, v44, v45
    v_mfma_f32_16x16x32_bf16 v[248:251], a[200:203], a[148:151], v[248:251]
    ds_read_b128 a[184:187], v13 offset:10240
    v_mfma_f32_16x16x32_bf16 a[48:51], a[140:143], v[192:195], a[48:51]
    v_exp_f32 v46, v174
    v_mfma_f32_16x16x32_bf16 a[52:55], a[140:143], v[196:199], a[52:55]
    v_exp_f32 v47, v175
    v_mfma_f32_16x16x32_bf16 a[56:59], a[140:143], v[200:203], a[56:59]
    buffer_load_dwordx4 v14, s[20:23], s51 offen offset:3072 lds
    v_mfma_f32_16x16x32_bf16 a[60:63], a[140:143], v[204:207], a[60:63]
    v_cvt_pk_bf16_f32 v221, v46, v47
    v_mfma_f32_16x16x32_bf16 v[232:235], v[40:43], v[200:203], v[232:235]
    v_mfma_f32_16x16x32_bf16 v[144:147], a[240:243], v[64:67], v[48:51]
    v_exp_f32 v44, v176
    v_mfma_f32_16x16x32_bf16 v[144:147], a[244:247], v[68:71], v[144:147]
    v_exp_f32 v45, v177
    v_mfma_f32_16x16x32_bf16 v[144:147], a[248:251], v[72:75], v[144:147]
    ds_read_b64_tr_b16 a[136:137], v36 offset:16384
    v_mfma_f32_16x16x32_bf16 v[144:147], a[252:255], v[76:79], v[144:147]
    s_waitcnt lgkmcnt(6)
    ds_read_b64_tr_b16 a[138:139], v36 offset:17408
    v_cvt_pk_bf16_f32 v210, v44, v45
    v_mfma_f32_16x16x32_bf16 v[252:255], a[204:207], a[148:151], v[252:255]
    buffer_load_dwordx4 a[148:151], v38, s[16:19], s58 offen offset:1024 sc1
    v_mfma_f32_16x16x32_bf16 a[64:67], a[128:131], v[192:195], a[64:67]
    v_exp_f32 v46, v178
    v_mfma_f32_16x16x32_bf16 a[68:71], a[128:131], v[196:199], a[68:71]
    v_exp_f32 v47, v179
    v_mfma_f32_16x16x32_bf16 a[72:75], a[128:131], v[200:203], a[72:75]
    ds_read_b128 a[224:227], v26 offset:2048
    v_mfma_f32_16x16x32_bf16 a[76:79], a[128:131], v[204:207], a[76:79]
    s_waitcnt lgkmcnt(7)
    ds_read_b128 a[228:231], v27 offset:2048
    v_cvt_pk_bf16_f32 v211, v46, v47
    v_mfma_f32_16x16x32_bf16 v[240:243], a[176:179], a[152:155], v[240:243]
    ds_read_b128 a[188:191], v13 offset:11264
    v_mfma_f32_16x16x32_bf16 v[148:151], a[240:243], v[80:83], v[52:55]
    s_add_u32 s51, s51, 16384
    v_exp_f32 v44, v180
    v_mfma_f32_16x16x32_bf16 v[148:151], a[244:247], v[84:87], v[148:151]
    v_exp_f32 v45, v181
    v_mfma_f32_16x16x32_bf16 v[148:151], a[248:251], v[88:91], v[148:151]
    ds_read_b64_tr_b16 a[140:141], v37 offset:16384
    v_mfma_f32_16x16x32_bf16 v[148:151], a[252:255], v[92:95], v[148:151]
    ds_read_b64_tr_b16 a[142:143], v37 offset:17408
    v_cvt_pk_bf16_f32 v214, v44, v45
    v_mfma_f32_16x16x32_bf16 v[236:239], v[40:43], v[204:207], v[236:239]
    s_waitcnt lgkmcnt(8)
    ds_read_b128 a[192:195], v13 offset:12288
    v_mfma_f32_16x16x32_bf16 a[80:83], a[132:135], v[192:195], a[80:83]
    v_exp_f32 v46, v182
    v_mfma_f32_16x16x32_bf16 a[84:87], a[132:135], v[196:199], a[84:87]
    v_exp_f32 v47, v183
    v_mfma_f32_16x16x32_bf16 a[88:91], a[132:135], v[200:203], a[88:91]
    ds_read_b128 a[232:235], v28 offset:2048
    v_mfma_f32_16x16x32_bf16 a[92:95], a[132:135], v[204:207], a[92:95]
    ds_read_b128 a[236:239], v29 offset:2048
    v_cvt_pk_bf16_f32 v215, v46, v47
    v_mfma_f32_16x16x32_bf16 v[244:247], a[180:183], a[152:155], v[244:247]
    v_mfma_f32_16x16x32_bf16 v[152:155], a[240:243], v[96:99], v[56:59]
    v_exp_f32 v44, v184
    v_mfma_f32_16x16x32_bf16 v[152:155], a[244:247], v[100:103], v[152:155]
    v_exp_f32 v45, v185
    v_mfma_f32_16x16x32_bf16 v[152:155], a[248:251], v[104:107], v[152:155]
    ds_read_b64_tr_b16 a[128:129], v30 offset:18432
    v_mfma_f32_16x16x32_bf16 v[152:155], a[252:255], v[108:111], v[152:155]
    s_waitcnt lgkmcnt(11)
    ds_read_b64_tr_b16 a[130:131], v30 offset:19456
    v_cvt_pk_bf16_f32 v218, v44, v45
    v_mfma_f32_16x16x32_bf16 v[248:251], a[184:187], a[152:155], v[248:251]
    s_waitcnt lgkmcnt(10)
    ds_read_b128 a[196:199], v13 offset:13312
    v_mfma_f32_16x16x32_bf16 a[96:99], a[136:139], v[192:195], a[96:99]
    v_exp_f32 v46, v186
    v_mfma_f32_16x16x32_bf16 a[100:103], a[136:139], v[196:199], a[100:103]
    s_add_u32 m0, s42, 49152
    v_exp_f32 v47, v187
    v_mfma_f32_16x16x32_bf16 a[104:107], a[136:139], v[200:203], a[104:107]
    buffer_load_dwordx4 v15, s[24:27], s52 offen offset:0 lds
    v_mfma_f32_16x16x32_bf16 a[108:111], a[136:139], v[204:207], a[108:111]
    v_cvt_pk_bf16_f32 v219, v46, v47
    v_mfma_f32_16x16x32_bf16 v[156:159], a[240:243], v[112:115], v[60:63]
    v_exp_f32 v44, v188
    v_mfma_f32_16x16x32_bf16 v[156:159], a[244:247], v[116:119], v[156:159]
    v_exp_f32 v45, v189
    v_mfma_f32_16x16x32_bf16 v[156:159], a[248:251], v[120:123], v[156:159]
    ds_read_b64_tr_b16 a[132:133], v31 offset:18432
    v_mfma_f32_16x16x32_bf16 v[156:159], a[252:255], v[124:127], v[156:159]
    s_waitcnt lgkmcnt(9)
    ds_read_b64_tr_b16 a[134:135], v31 offset:19456
    v_cvt_pk_bf16_f32 v222, v44, v45
    v_mfma_f32_16x16x32_bf16 v[252:255], a[188:191], a[152:155], v[252:255]
    s_waitcnt lgkmcnt(8)
    buffer_load_dwordx4 a[152:155], v38, s[16:19], s58 offen offset:2048 sc1
    v_mfma_f32_16x16x32_bf16 a[112:115], a[140:143], v[192:195], a[112:115]
    v_exp_f32 v46, v190
    v_mfma_f32_16x16x32_bf16 a[116:119], a[140:143], v[196:199], a[116:119]
    v_exp_f32 v47, v191
    v_mfma_f32_16x16x32_bf16 a[120:123], a[140:143], v[200:203], a[120:123]
    buffer_load_dwordx4 v15, s[24:27], s52 offen offset:1024 lds
    v_mfma_f32_16x16x32_bf16 a[124:127], a[140:143], v[204:207], a[124:127]
    s_waitcnt lgkmcnt(5)
    ds_read_b128 a[200:203], v13 offset:14336
    v_cvt_pk_bf16_f32 v223, v46, v47
    v_mfma_f32_16x16x32_bf16 v[160:163], a[224:227], v[64:67], v[48:51]
    v_exp_f32 v44, v128
    v_mfma_f32_16x16x32_bf16 v[160:163], a[228:231], v[68:71], v[160:163]
    v_exp_f32 v45, v129
    v_mfma_f32_16x16x32_bf16 v[160:163], a[232:235], v[72:75], v[160:163]
    ds_read_b64_tr_b16 a[136:137], v32 offset:18432
    v_mfma_f32_16x16x32_bf16 v[160:163], a[236:239], v[76:79], v[160:163]
    ds_read_b64_tr_b16 a[138:139], v32 offset:19456
    v_cvt_pk_bf16_f32 v192, v44, v45
    v_mfma_f32_16x16x32_bf16 v[240:243], a[192:195], a[156:159], v[240:243]
    s_waitcnt lgkmcnt(6)
    ds_read_b128 a[204:207], v13 offset:15360
    v_mfma_f32_16x16x32_bf16 a[0:3], a[128:131], v[208:211], a[0:3]
    v_exp_f32 v46, v130
    v_mfma_f32_16x16x32_bf16 a[4:7], a[128:131], v[212:215], a[4:7]
    v_exp_f32 v47, v131
    v_mfma_f32_16x16x32_bf16 a[8:11], a[128:131], v[216:219], a[8:11]
    ds_read_b128 a[240:243], v26 offset:3072
    v_mfma_f32_16x16x32_bf16 a[12:15], a[128:131], v[220:223], a[12:15]
    ds_read_b128 a[244:247], v27 offset:3072
    v_cvt_pk_bf16_f32 v193, v46, v47
    v_mfma_f32_16x16x32_bf16 v[164:167], a[224:227], v[80:83], v[52:55]
    v_exp_f32 v44, v132
    v_mfma_f32_16x16x32_bf16 v[164:167], a[228:231], v[84:87], v[164:167]
    v_exp_f32 v45, v133
    v_mfma_f32_16x16x32_bf16 v[164:167], a[232:235], v[88:91], v[164:167]
    ds_read_b64_tr_b16 a[140:141], v33 offset:18432
    v_mfma_f32_16x16x32_bf16 v[164:167], a[236:239], v[92:95], v[164:167]
    s_waitcnt lgkmcnt(9)
    ds_read_b64_tr_b16 a[142:143], v33 offset:19456
    v_cvt_pk_bf16_f32 v196, v44, v45
    v_mfma_f32_16x16x32_bf16 v[244:247], a[196:199], a[156:159], v[244:247]
    s_waitcnt lgkmcnt(8)
    v_mfma_f32_16x16x32_bf16 a[16:19], a[132:135], v[208:211], a[16:19]
    v_exp_f32 v46, v134
    v_mfma_f32_16x16x32_bf16 a[20:23], a[132:135], v[212:215], a[20:23]
    v_exp_f32 v47, v135
    v_mfma_f32_16x16x32_bf16 a[24:27], a[132:135], v[216:219], a[24:27]
    ds_read_b128 a[248:251], v28 offset:3072
    v_mfma_f32_16x16x32_bf16 a[28:31], a[132:135], v[220:223], a[28:31]
    ds_read_b128 a[252:255], v29 offset:3072
    v_cvt_pk_bf16_f32 v197, v46, v47
    v_mfma_f32_16x16x32_bf16 v[168:171], a[224:227], v[96:99], v[56:59]
    v_exp_f32 v44, v136
    v_mfma_f32_16x16x32_bf16 v[168:171], a[228:231], v[100:103], v[168:171]
    v_exp_f32 v45, v137
    v_mfma_f32_16x16x32_bf16 v[168:171], a[232:235], v[104:107], v[168:171]
    ds_read_b64_tr_b16 a[128:129], v34 offset:18432
    v_mfma_f32_16x16x32_bf16 v[168:171], a[236:239], v[108:111], v[168:171]
    s_waitcnt lgkmcnt(10)
    ds_read_b64_tr_b16 a[130:131], v34 offset:19456
    v_cvt_pk_bf16_f32 v200, v44, v45
    v_mfma_f32_16x16x32_bf16 v[248:251], a[200:203], a[156:159], v[248:251]
    s_waitcnt lgkmcnt(9)
    v_mfma_f32_16x16x32_bf16 a[32:35], a[136:139], v[208:211], a[32:35]
    v_exp_f32 v46, v138
    v_mfma_f32_16x16x32_bf16 a[36:39], a[136:139], v[212:215], a[36:39]
    v_exp_f32 v47, v139
    v_mfma_f32_16x16x32_bf16 a[40:43], a[136:139], v[216:219], a[40:43]
    buffer_load_dwordx4 v15, s[24:27], s52 offen offset:2048 lds
    v_mfma_f32_16x16x32_bf16 a[44:47], a[136:139], v[220:223], a[44:47]
    v_cvt_pk_bf16_f32 v201, v46, v47
    v_mfma_f32_16x16x32_bf16 v[172:175], a[224:227], v[112:115], v[60:63]
    v_exp_f32 v44, v140
    v_mfma_f32_16x16x32_bf16 v[172:175], a[228:231], v[116:119], v[172:175]
    v_exp_f32 v45, v141
    v_mfma_f32_16x16x32_bf16 v[172:175], a[232:235], v[120:123], v[172:175]
    ds_read_b64_tr_b16 a[132:133], v35 offset:18432
    v_mfma_f32_16x16x32_bf16 v[172:175], a[236:239], v[124:127], v[172:175]
    s_waitcnt lgkmcnt(9)
    ds_read_b64_tr_b16 a[134:135], v35 offset:19456
    v_cvt_pk_bf16_f32 v204, v44, v45
    v_mfma_f32_16x16x32_bf16 v[252:255], a[204:207], a[156:159], v[252:255]
    s_waitcnt lgkmcnt(6)
    buffer_load_dwordx4 a[156:159], v38, s[16:19], s58 offen offset:3072 sc1
    v_mfma_f32_16x16x32_bf16 a[48:51], a[140:143], v[208:211], a[48:51]
    s_add_u32 s58, s58, 4096
    v_exp_f32 v46, v142
    v_mfma_f32_16x16x32_bf16 a[52:55], a[140:143], v[212:215], a[52:55]
    v_exp_f32 v47, v143
    v_mfma_f32_16x16x32_bf16 a[56:59], a[140:143], v[216:219], a[56:59]
    buffer_load_dwordx4 v15, s[24:27], s52 offen offset:3072 lds
    v_mfma_f32_16x16x32_bf16 a[60:63], a[140:143], v[220:223], a[60:63]
    s_waitcnt lgkmcnt(4)
    v_cvt_pk_bf16_f32 v205, v46, v47
    v_mfma_f32_16x16x32_bf16 v[176:179], a[240:243], v[64:67], v[48:51]
    s_waitcnt vmcnt(12)
    v_exp_f32 v44, v144
    v_mfma_f32_16x16x32_bf16 v[176:179], a[244:247], v[68:71], v[176:179]
    s_barrier
    v_exp_f32 v45, v145
    v_mfma_f32_16x16x32_bf16 v[176:179], a[248:251], v[72:75], v[176:179]
    s_add_u32 m0, s42, 65536
    ds_read_b64_tr_b16 a[136:137], v36 offset:18432
    ds_read_b128 a[176:179], v13 offset:16384
    v_mfma_f32_16x16x32_bf16 v[176:179], a[252:255], v[76:79], v[176:179]
    ds_read_b64_tr_b16 a[138:139], v36 offset:19456
    v_cvt_pk_bf16_f32 v194, v44, v45
    v_mfma_f32_16x16x32_bf16 v[224:227], v[40:43], v[208:211], v[224:227]
    s_waitcnt lgkmcnt(5)
    buffer_load_dwordx4 v38, s[12:15], s59 offen offset:0 sc1 lds
    v_mfma_f32_16x16x32_bf16 a[64:67], a[128:131], v[208:211], a[64:67]
    v_exp_f32 v46, v146
    v_mfma_f32_16x16x32_bf16 a[68:71], a[128:131], v[212:215], a[68:71]
    v_exp_f32 v47, v147
    v_mfma_f32_16x16x32_bf16 a[72:75], a[128:131], v[216:219], a[72:75]
    ds_read_b128 a[224:227], v26 offset:16384
    ds_read_b128 a[180:183], v13 offset:17408
    v_mfma_f32_16x16x32_bf16 a[76:79], a[128:131], v[220:223], a[76:79]
    ds_read_b128 a[228:231], v27 offset:16384
    v_cvt_pk_bf16_f32 v195, v46, v47
    v_mfma_f32_16x16x32_bf16 v[228:231], v[40:43], v[212:215], v[228:231]
    buffer_load_dwordx4 v38, s[12:15], s59 offen offset:1024 sc1 lds
    v_mfma_f32_16x16x32_bf16 v[180:183], a[240:243], v[80:83], v[52:55]
    s_add_u32 s52, s52, 16384
    v_exp_f32 v44, v148
    v_mfma_f32_16x16x32_bf16 v[180:183], a[244:247], v[84:87], v[180:183]
    v_exp_f32 v45, v149
    v_mfma_f32_16x16x32_bf16 v[180:183], a[248:251], v[88:91], v[180:183]
    ds_read_b64_tr_b16 a[140:141], v37 offset:18432
    v_mfma_f32_16x16x32_bf16 v[180:183], a[252:255], v[92:95], v[180:183]
    ds_read_b64_tr_b16 a[142:143], v37 offset:19456
    v_cvt_pk_bf16_f32 v198, v44, v45
    v_mfma_f32_16x16x32_bf16 v[232:235], v[40:43], v[216:219], v[232:235]
    s_waitcnt lgkmcnt(8)
    buffer_load_dwordx4 v38, s[12:15], s59 offen offset:2048 sc1 lds
    v_mfma_f32_16x16x32_bf16 a[80:83], a[132:135], v[208:211], a[80:83]
    v_exp_f32 v46, v150
    v_mfma_f32_16x16x32_bf16 a[84:87], a[132:135], v[212:215], a[84:87]
    v_exp_f32 v47, v151
    v_mfma_f32_16x16x32_bf16 a[88:91], a[132:135], v[216:219], a[88:91]
    ds_read_b128 a[232:235], v28 offset:16384
    v_mfma_f32_16x16x32_bf16 a[92:95], a[132:135], v[220:223], a[92:95]
    ds_read_b128 a[236:239], v29 offset:16384
    v_cvt_pk_bf16_f32 v199, v46, v47
    v_mfma_f32_16x16x32_bf16 v[236:239], v[40:43], v[220:223], v[236:239]
    buffer_load_dwordx4 v38, s[12:15], s59 offen offset:3072 sc1 lds
    v_mfma_f32_16x16x32_bf16 v[184:187], a[240:243], v[96:99], v[56:59]
    s_add_u32 s59, s59, 16384
    v_exp_f32 v44, v152
    v_mfma_f32_16x16x32_bf16 v[184:187], a[244:247], v[100:103], v[184:187]
    v_exp_f32 v45, v153
    v_mfma_f32_16x16x32_bf16 v[184:187], a[248:251], v[104:107], v[184:187]
    ds_read_b64_tr_b16 a[128:129], v30 offset:32768
    v_mfma_f32_16x16x32_bf16 v[184:187], a[252:255], v[108:111], v[184:187]
    s_waitcnt lgkmcnt(9)
    ds_read_b64_tr_b16 a[130:131], v30 offset:33792
    v_cvt_pk_bf16_f32 v202, v44, v45
    v_mfma_f32_16x16x32_bf16 v[240:243], a[176:179], a[160:163], v[240:243]
    s_waitcnt lgkmcnt(9)
    ds_read_b128 a[184:187], v13 offset:18432
    v_mfma_f32_16x16x32_bf16 a[96:99], a[136:139], v[208:211], a[96:99]
    v_exp_f32 v46, v154
    v_mfma_f32_16x16x32_bf16 a[100:103], a[136:139], v[212:215], a[100:103]
    s_add_u32 m0, s42, 147456
    v_exp_f32 v47, v155
    v_mfma_f32_16x16x32_bf16 a[104:107], a[136:139], v[216:219], a[104:107]
    buffer_load_dwordx4 v14, s[20:23], s51 offen offset:0 lds
    v_mfma_f32_16x16x32_bf16 a[108:111], a[136:139], v[220:223], a[108:111]
    s_waitcnt lgkmcnt(8)
    ds_read_b128 a[188:191], v13 offset:19456
    v_cvt_pk_bf16_f32 v203, v46, v47
    v_mfma_f32_16x16x32_bf16 v[244:247], a[180:183], a[160:163], v[244:247]
    ds_read_b128 a[192:195], v13 offset:20480
    v_mfma_f32_16x16x32_bf16 v[188:191], a[240:243], v[112:115], v[60:63]
    v_exp_f32 v44, v156
    v_mfma_f32_16x16x32_bf16 v[188:191], a[244:247], v[116:119], v[188:191]
    v_exp_f32 v45, v157
    v_mfma_f32_16x16x32_bf16 v[188:191], a[248:251], v[120:123], v[188:191]
    ds_read_b64_tr_b16 a[132:133], v31 offset:32768
    v_mfma_f32_16x16x32_bf16 v[188:191], a[252:255], v[124:127], v[188:191]
    s_waitcnt lgkmcnt(3)
    ds_read_b64_tr_b16 a[134:135], v31 offset:33792
    v_cvt_pk_bf16_f32 v206, v44, v45
    v_mfma_f32_16x16x32_bf16 v[248:251], a[184:187], a[160:163], v[248:251]
    ds_read_b128 a[196:199], v13 offset:21504
    v_mfma_f32_16x16x32_bf16 a[112:115], a[140:143], v[208:211], a[112:115]
    v_exp_f32 v46, v158
    v_mfma_f32_16x16x32_bf16 a[116:119], a[140:143], v[212:215], a[116:119]
    v_exp_f32 v47, v159
    v_mfma_f32_16x16x32_bf16 a[120:123], a[140:143], v[216:219], a[120:123]
    buffer_load_dwordx4 v14, s[20:23], s51 offen offset:1024 lds
    v_mfma_f32_16x16x32_bf16 a[124:127], a[140:143], v[220:223], a[124:127]
    s_waitcnt lgkmcnt(4)
    v_cvt_pk_bf16_f32 v207, v46, v47
    v_mfma_f32_16x16x32_bf16 v[252:255], a[188:191], a[160:163], v[252:255]
    buffer_load_dwordx4 a[160:163], v38, s[16:19], s58 offen offset:0 sc1
    v_mfma_f32_16x16x32_bf16 v[128:131], a[224:227], v[64:67], v[48:51]
    v_exp_f32 v44, v160
    v_mfma_f32_16x16x32_bf16 v[128:131], a[228:231], v[68:71], v[128:131]
    v_exp_f32 v45, v161
    v_mfma_f32_16x16x32_bf16 v[128:131], a[232:235], v[72:75], v[128:131]
    ds_read_b64_tr_b16 a[136:137], v32 offset:32768
    v_mfma_f32_16x16x32_bf16 v[128:131], a[236:239], v[76:79], v[128:131]
    ds_read_b64_tr_b16 a[138:139], v32 offset:33792
    v_cvt_pk_bf16_f32 v208, v44, v45
    v_mfma_f32_16x16x32_bf16 a[0:3], a[128:131], v[192:195], a[0:3]
    v_exp_f32 v46, v162
    v_mfma_f32_16x16x32_bf16 a[4:7], a[128:131], v[196:199], a[4:7]
    v_exp_f32 v47, v163
    v_mfma_f32_16x16x32_bf16 a[8:11], a[128:131], v[200:203], a[8:11]
    ds_read_b128 a[240:243], v26 offset:17408
    v_mfma_f32_16x16x32_bf16 a[12:15], a[128:131], v[204:207], a[12:15]
    ds_read_b128 a[244:247], v27 offset:17408
    v_cvt_pk_bf16_f32 v209, v46, v47
    v_mfma_f32_16x16x32_bf16 v[224:227], v[40:43], v[192:195], v[224:227]
    buffer_load_dword v3, v4, s[60:63], s41 offen sc1
    v_mfma_f32_16x16x32_bf16 v[132:135], a[224:227], v[80:83], v[52:55]
    v_exp_f32 v44, v164
    v_mfma_f32_16x16x32_bf16 v[132:135], a[228:231], v[84:87], v[132:135]
    v_exp_f32 v45, v165
    v_mfma_f32_16x16x32_bf16 v[132:135], a[232:235], v[88:91], v[132:135]
    ds_read_b64_tr_b16 a[140:141], v33 offset:32768
    v_mfma_f32_16x16x32_bf16 v[132:135], a[236:239], v[92:95], v[132:135]
    s_waitcnt lgkmcnt(6)
    ds_read_b64_tr_b16 a[142:143], v33 offset:33792
    v_cvt_pk_bf16_f32 v212, v44, v45
    v_mfma_f32_16x16x32_bf16 a[16:19], a[132:135], v[192:195], a[16:19]
    v_exp_f32 v46, v166
    v_mfma_f32_16x16x32_bf16 a[20:23], a[132:135], v[196:199], a[20:23]
    v_exp_f32 v47, v167
    v_mfma_f32_16x16x32_bf16 a[24:27], a[132:135], v[200:203], a[24:27]
    ds_read_b128 a[248:251], v28 offset:17408
    v_mfma_f32_16x16x32_bf16 a[28:31], a[132:135], v[204:207], a[28:31]
    ds_read_b128 a[252:255], v29 offset:17408
    v_cvt_pk_bf16_f32 v213, v46, v47
    v_mfma_f32_16x16x32_bf16 v[228:231], v[40:43], v[196:199], v[228:231]
    ds_read_b128 a[200:203], v13 offset:22528
    v_mfma_f32_16x16x32_bf16 v[136:139], a[224:227], v[96:99], v[56:59]
    v_exp_f32 v44, v168
    v_mfma_f32_16x16x32_bf16 v[136:139], a[228:231], v[100:103], v[136:139]
    v_exp_f32 v45, v169
    v_mfma_f32_16x16x32_bf16 v[136:139], a[232:235], v[104:107], v[136:139]
    ds_read_b64_tr_b16 a[128:129], v34 offset:32768
    v_mfma_f32_16x16x32_bf16 v[136:139], a[236:239], v[108:111], v[136:139]
    ds_read_b64_tr_b16 a[130:131], v34 offset:33792
    v_cvt_pk_bf16_f32 v216, v44, v45
    v_mfma_f32_16x16x32_bf16 v[240:243], a[192:195], a[164:167], v[240:243]
    s_waitcnt lgkmcnt(9)
    ds_read_b128 a[204:207], v13 offset:23552
    v_mfma_f32_16x16x32_bf16 a[32:35], a[136:139], v[192:195], a[32:35]
    v_exp_f32 v46, v170
    v_mfma_f32_16x16x32_bf16 a[36:39], a[136:139], v[196:199], a[36:39]
    v_exp_f32 v47, v171
    v_mfma_f32_16x16x32_bf16 a[40:43], a[136:139], v[200:203], a[40:43]
    buffer_load_dwordx4 v14, s[20:23], s51 offen offset:2048 lds
    v_mfma_f32_16x16x32_bf16 a[44:47], a[136:139], v[204:207], a[44:47]
    ds_read_b128 a[176:179], v13 offset:24576
    v_cvt_pk_bf16_f32 v217, v46, v47
    v_mfma_f32_16x16x32_bf16 v[244:247], a[196:199], a[164:167], v[244:247]
    ds_read_b128 a[180:183], v13 offset:25600
    v_mfma_f32_16x16x32_bf16 v[140:143], a[224:227], v[112:115], v[60:63]
    v_exp_f32 v44, v172
    v_mfma_f32_16x16x32_bf16 v[140:143], a[228:231], v[116:119], v[140:143]
    v_exp_f32 v45, v173
    v_mfma_f32_16x16x32_bf16 v[140:143], a[232:235], v[120:123], v[140:143]
    ds_read_b64_tr_b16 a[132:133], v35 offset:32768
    v_mfma_f32_16x16x32_bf16 v[140:143], a[236:239], v[124:127], v[140:143]
    s_waitcnt lgkmcnt(6)
    ds_read_b64_tr_b16 a[134:135], v35 offset:33792
    v_cvt_pk_bf16_f32 v220, v44, v45
    v_mfma_f32_16x16x32_bf16 v[248:251], a[200:203], a[164:167], v[248:251]
    ds_read_b128 a[184:187], v13 offset:26624
    v_mfma_f32_16x16x32_bf16 a[48:51], a[140:143], v[192:195], a[48:51]
    v_exp_f32 v46, v174
    v_mfma_f32_16x16x32_bf16 a[52:55], a[140:143], v[196:199], a[52:55]
    v_exp_f32 v47, v175
    v_mfma_f32_16x16x32_bf16 a[56:59], a[140:143], v[200:203], a[56:59]
    buffer_load_dwordx4 v14, s[20:23], s51 offen offset:3072 lds
    v_mfma_f32_16x16x32_bf16 a[60:63], a[140:143], v[204:207], a[60:63]
    v_cvt_pk_bf16_f32 v221, v46, v47
    v_mfma_f32_16x16x32_bf16 v[232:235], v[40:43], v[200:203], v[232:235]
    v_mfma_f32_16x16x32_bf16 v[144:147], a[240:243], v[64:67], v[48:51]
    v_exp_f32 v44, v176
    v_mfma_f32_16x16x32_bf16 v[144:147], a[244:247], v[68:71], v[144:147]
    v_exp_f32 v45, v177
    v_mfma_f32_16x16x32_bf16 v[144:147], a[248:251], v[72:75], v[144:147]
    ds_read_b64_tr_b16 a[136:137], v36 offset:32768
    v_mfma_f32_16x16x32_bf16 v[144:147], a[252:255], v[76:79], v[144:147]
    s_waitcnt lgkmcnt(6)
    ds_read_b64_tr_b16 a[138:139], v36 offset:33792
    v_cvt_pk_bf16_f32 v210, v44, v45
    v_mfma_f32_16x16x32_bf16 v[252:255], a[204:207], a[164:167], v[252:255]
    buffer_load_dwordx4 a[164:167], v38, s[16:19], s58 offen offset:1024 sc1
    v_mfma_f32_16x16x32_bf16 a[64:67], a[128:131], v[192:195], a[64:67]
    v_exp_f32 v46, v178
    v_mfma_f32_16x16x32_bf16 a[68:71], a[128:131], v[196:199], a[68:71]
    v_exp_f32 v47, v179
    v_mfma_f32_16x16x32_bf16 a[72:75], a[128:131], v[200:203], a[72:75]
    ds_read_b128 a[224:227], v26 offset:18432
    v_mfma_f32_16x16x32_bf16 a[76:79], a[128:131], v[204:207], a[76:79]
    s_waitcnt lgkmcnt(7)
    ds_read_b128 a[228:231], v27 offset:18432
    v_cvt_pk_bf16_f32 v211, v46, v47
    v_mfma_f32_16x16x32_bf16 v[240:243], a[176:179], a[168:171], v[240:243]
    ds_read_b128 a[188:191], v13 offset:27648
    v_mfma_f32_16x16x32_bf16 v[148:151], a[240:243], v[80:83], v[52:55]
    s_add_u32 s51, s51, 16384
    v_exp_f32 v44, v180
    v_mfma_f32_16x16x32_bf16 v[148:151], a[244:247], v[84:87], v[148:151]
    v_exp_f32 v45, v181
    v_mfma_f32_16x16x32_bf16 v[148:151], a[248:251], v[88:91], v[148:151]
    ds_read_b64_tr_b16 a[140:141], v37 offset:32768
    v_mfma_f32_16x16x32_bf16 v[148:151], a[252:255], v[92:95], v[148:151]
    ds_read_b64_tr_b16 a[142:143], v37 offset:33792
    v_cvt_pk_bf16_f32 v214, v44, v45
    v_mfma_f32_16x16x32_bf16 v[236:239], v[40:43], v[204:207], v[236:239]
    s_waitcnt lgkmcnt(8)
    ds_read_b128 a[192:195], v13 offset:28672
    v_mfma_f32_16x16x32_bf16 a[80:83], a[132:135], v[192:195], a[80:83]
    v_exp_f32 v46, v182
    v_mfma_f32_16x16x32_bf16 a[84:87], a[132:135], v[196:199], a[84:87]
    v_exp_f32 v47, v183
    v_mfma_f32_16x16x32_bf16 a[88:91], a[132:135], v[200:203], a[88:91]
    ds_read_b128 a[232:235], v28 offset:18432
    v_mfma_f32_16x16x32_bf16 a[92:95], a[132:135], v[204:207], a[92:95]
    ds_read_b128 a[236:239], v29 offset:18432
    v_cvt_pk_bf16_f32 v215, v46, v47
    v_mfma_f32_16x16x32_bf16 v[244:247], a[180:183], a[168:171], v[244:247]
    v_mfma_f32_16x16x32_bf16 v[152:155], a[240:243], v[96:99], v[56:59]
    v_exp_f32 v44, v184
    v_mfma_f32_16x16x32_bf16 v[152:155], a[244:247], v[100:103], v[152:155]
    v_exp_f32 v45, v185
    v_mfma_f32_16x16x32_bf16 v[152:155], a[248:251], v[104:107], v[152:155]
    ds_read_b64_tr_b16 a[128:129], v30 offset:34816
    v_mfma_f32_16x16x32_bf16 v[152:155], a[252:255], v[108:111], v[152:155]
    s_waitcnt lgkmcnt(11)
    ds_read_b64_tr_b16 a[130:131], v30 offset:35840
    v_cvt_pk_bf16_f32 v218, v44, v45
    v_mfma_f32_16x16x32_bf16 v[248:251], a[184:187], a[168:171], v[248:251]
    s_waitcnt lgkmcnt(10)
    ds_read_b128 a[196:199], v13 offset:29696
    v_mfma_f32_16x16x32_bf16 a[96:99], a[136:139], v[192:195], a[96:99]
    v_exp_f32 v46, v186
    v_mfma_f32_16x16x32_bf16 a[100:103], a[136:139], v[196:199], a[100:103]
    s_add_u32 m0, s42, 0
    v_exp_f32 v47, v187
    v_mfma_f32_16x16x32_bf16 a[104:107], a[136:139], v[200:203], a[104:107]
    buffer_load_dwordx4 v15, s[24:27], s52 offen offset:0 lds
    v_mfma_f32_16x16x32_bf16 a[108:111], a[136:139], v[204:207], a[108:111]
    v_cvt_pk_bf16_f32 v219, v46, v47
    v_mfma_f32_16x16x32_bf16 v[156:159], a[240:243], v[112:115], v[60:63]
    v_exp_f32 v44, v188
    v_mfma_f32_16x16x32_bf16 v[156:159], a[244:247], v[116:119], v[156:159]
    v_exp_f32 v45, v189
    v_mfma_f32_16x16x32_bf16 v[156:159], a[248:251], v[120:123], v[156:159]
    ds_read_b64_tr_b16 a[132:133], v31 offset:34816
    v_mfma_f32_16x16x32_bf16 v[156:159], a[252:255], v[124:127], v[156:159]
    s_waitcnt lgkmcnt(9)
    ds_read_b64_tr_b16 a[134:135], v31 offset:35840
    v_cvt_pk_bf16_f32 v222, v44, v45
    v_mfma_f32_16x16x32_bf16 v[252:255], a[188:191], a[168:171], v[252:255]
    s_waitcnt lgkmcnt(8)
    buffer_load_dwordx4 a[168:171], v38, s[16:19], s58 offen offset:2048 sc1
    v_mfma_f32_16x16x32_bf16 a[112:115], a[140:143], v[192:195], a[112:115]
    v_exp_f32 v46, v190
    v_mfma_f32_16x16x32_bf16 a[116:119], a[140:143], v[196:199], a[116:119]
    v_exp_f32 v47, v191
    v_mfma_f32_16x16x32_bf16 a[120:123], a[140:143], v[200:203], a[120:123]
    buffer_load_dwordx4 v15, s[24:27], s52 offen offset:1024 lds
    v_mfma_f32_16x16x32_bf16 a[124:127], a[140:143], v[204:207], a[124:127]
    s_waitcnt lgkmcnt(5)
    ds_read_b128 a[200:203], v13 offset:30720
    v_cvt_pk_bf16_f32 v223, v46, v47
    v_mfma_f32_16x16x32_bf16 v[160:163], a[224:227], v[64:67], v[48:51]
    v_exp_f32 v44, v128
    v_mfma_f32_16x16x32_bf16 v[160:163], a[228:231], v[68:71], v[160:163]
    v_exp_f32 v45, v129
    v_mfma_f32_16x16x32_bf16 v[160:163], a[232:235], v[72:75], v[160:163]
    ds_read_b64_tr_b16 a[136:137], v32 offset:34816
    v_mfma_f32_16x16x32_bf16 v[160:163], a[236:239], v[76:79], v[160:163]
    ds_read_b64_tr_b16 a[138:139], v32 offset:35840
    v_cvt_pk_bf16_f32 v192, v44, v45
    v_mfma_f32_16x16x32_bf16 v[240:243], a[192:195], a[172:175], v[240:243]
    s_waitcnt lgkmcnt(6)
    ds_read_b128 a[204:207], v13 offset:31744
    v_mfma_f32_16x16x32_bf16 a[0:3], a[128:131], v[208:211], a[0:3]
    v_exp_f32 v46, v130
    v_mfma_f32_16x16x32_bf16 a[4:7], a[128:131], v[212:215], a[4:7]
    v_exp_f32 v47, v131
    v_mfma_f32_16x16x32_bf16 a[8:11], a[128:131], v[216:219], a[8:11]
    ds_read_b128 a[240:243], v26 offset:19456
    v_mfma_f32_16x16x32_bf16 a[12:15], a[128:131], v[220:223], a[12:15]
    ds_read_b128 a[244:247], v27 offset:19456
    v_cvt_pk_bf16_f32 v193, v46, v47
    v_mfma_f32_16x16x32_bf16 v[164:167], a[224:227], v[80:83], v[52:55]
    v_exp_f32 v44, v132
    v_mfma_f32_16x16x32_bf16 v[164:167], a[228:231], v[84:87], v[164:167]
    v_exp_f32 v45, v133
    v_mfma_f32_16x16x32_bf16 v[164:167], a[232:235], v[88:91], v[164:167]
    ds_read_b64_tr_b16 a[140:141], v33 offset:34816
    v_mfma_f32_16x16x32_bf16 v[164:167], a[236:239], v[92:95], v[164:167]
    s_waitcnt lgkmcnt(9)
    ds_read_b64_tr_b16 a[142:143], v33 offset:35840
    v_cvt_pk_bf16_f32 v196, v44, v45
    v_mfma_f32_16x16x32_bf16 v[244:247], a[196:199], a[172:175], v[244:247]
    s_waitcnt lgkmcnt(8)
    v_mfma_f32_16x16x32_bf16 a[16:19], a[132:135], v[208:211], a[16:19]
    v_exp_f32 v46, v134
    v_mfma_f32_16x16x32_bf16 a[20:23], a[132:135], v[212:215], a[20:23]
    v_exp_f32 v47, v135
    v_mfma_f32_16x16x32_bf16 a[24:27], a[132:135], v[216:219], a[24:27]
    ds_read_b128 a[248:251], v28 offset:19456
    v_mfma_f32_16x16x32_bf16 a[28:31], a[132:135], v[220:223], a[28:31]
    ds_read_b128 a[252:255], v29 offset:19456
    v_cvt_pk_bf16_f32 v197, v46, v47
    v_mfma_f32_16x16x32_bf16 v[168:171], a[224:227], v[96:99], v[56:59]
    v_exp_f32 v44, v136
    v_mfma_f32_16x16x32_bf16 v[168:171], a[228:231], v[100:103], v[168:171]
    v_exp_f32 v45, v137
    v_mfma_f32_16x16x32_bf16 v[168:171], a[232:235], v[104:107], v[168:171]
    ds_read_b64_tr_b16 a[128:129], v34 offset:34816
    v_mfma_f32_16x16x32_bf16 v[168:171], a[236:239], v[108:111], v[168:171]
    s_waitcnt lgkmcnt(10)
    ds_read_b64_tr_b16 a[130:131], v34 offset:35840
    v_cvt_pk_bf16_f32 v200, v44, v45
    v_mfma_f32_16x16x32_bf16 v[248:251], a[200:203], a[172:175], v[248:251]
    s_waitcnt lgkmcnt(9)
    v_mfma_f32_16x16x32_bf16 a[32:35], a[136:139], v[208:211], a[32:35]
    v_exp_f32 v46, v138
    v_mfma_f32_16x16x32_bf16 a[36:39], a[136:139], v[212:215], a[36:39]
    v_exp_f32 v47, v139
    v_mfma_f32_16x16x32_bf16 a[40:43], a[136:139], v[216:219], a[40:43]
    buffer_load_dwordx4 v15, s[24:27], s52 offen offset:2048 lds
    v_mfma_f32_16x16x32_bf16 a[44:47], a[136:139], v[220:223], a[44:47]
    v_cvt_pk_bf16_f32 v201, v46, v47
    v_mfma_f32_16x16x32_bf16 v[172:175], a[224:227], v[112:115], v[60:63]
    v_exp_f32 v44, v140
    v_mfma_f32_16x16x32_bf16 v[172:175], a[228:231], v[116:119], v[172:175]
    v_exp_f32 v45, v141
    v_mfma_f32_16x16x32_bf16 v[172:175], a[232:235], v[120:123], v[172:175]
    ds_read_b64_tr_b16 a[132:133], v35 offset:34816
    v_mfma_f32_16x16x32_bf16 v[172:175], a[236:239], v[124:127], v[172:175]
    s_waitcnt lgkmcnt(9)
    ds_read_b64_tr_b16 a[134:135], v35 offset:35840
    v_cvt_pk_bf16_f32 v204, v44, v45
    v_mfma_f32_16x16x32_bf16 v[252:255], a[204:207], a[172:175], v[252:255]
    s_waitcnt lgkmcnt(6)
    buffer_load_dwordx4 a[172:175], v38, s[16:19], s58 offen offset:3072 sc1
    v_mfma_f32_16x16x32_bf16 a[48:51], a[140:143], v[208:211], a[48:51]
    s_add_u32 s58, s58, 4096
    v_exp_f32 v46, v142
    v_mfma_f32_16x16x32_bf16 a[52:55], a[140:143], v[212:215], a[52:55]
    v_exp_f32 v47, v143
    v_mfma_f32_16x16x32_bf16 a[56:59], a[140:143], v[216:219], a[56:59]
    buffer_load_dwordx4 v15, s[24:27], s52 offen offset:3072 lds
    v_mfma_f32_16x16x32_bf16 a[60:63], a[140:143], v[220:223], a[60:63]
    s_waitcnt lgkmcnt(4)
    v_cvt_pk_bf16_f32 v205, v46, v47
    v_mfma_f32_16x16x32_bf16 v[176:179], a[240:243], v[64:67], v[48:51]
    s_waitcnt vmcnt(12)
    v_exp_f32 v44, v144
    v_mfma_f32_16x16x32_bf16 v[176:179], a[244:247], v[68:71], v[176:179]
    s_barrier
    v_exp_f32 v45, v145
    v_mfma_f32_16x16x32_bf16 v[176:179], a[248:251], v[72:75], v[176:179]
    s_add_u32 m0, s42, 81920
    ds_read_b64_tr_b16 a[136:137], v36 offset:34816
    ds_read_b128 a[176:179], v13 offset:0
    v_mfma_f32_16x16x32_bf16 v[176:179], a[252:255], v[76:79], v[176:179]
    ds_read_b64_tr_b16 a[138:139], v36 offset:35840
    v_cvt_pk_bf16_f32 v194, v44, v45
    v_mfma_f32_16x16x32_bf16 v[224:227], v[40:43], v[208:211], v[224:227]
    s_waitcnt lgkmcnt(5)
    buffer_load_dwordx4 v38, s[12:15], s59 offen offset:0 sc1 lds
    v_mfma_f32_16x16x32_bf16 a[64:67], a[128:131], v[208:211], a[64:67]
    v_exp_f32 v46, v146
    v_mfma_f32_16x16x32_bf16 a[68:71], a[128:131], v[212:215], a[68:71]
    v_exp_f32 v47, v147
    v_mfma_f32_16x16x32_bf16 a[72:75], a[128:131], v[216:219], a[72:75]
    ds_read_b128 a[224:227], v26 offset:32768
    ds_read_b128 a[180:183], v13 offset:1024
    v_mfma_f32_16x16x32_bf16 a[76:79], a[128:131], v[220:223], a[76:79]
    ds_read_b128 a[228:231], v27 offset:32768
    v_cvt_pk_bf16_f32 v195, v46, v47
    v_mfma_f32_16x16x32_bf16 v[228:231], v[40:43], v[212:215], v[228:231]
    buffer_load_dwordx4 v38, s[12:15], s59 offen offset:1024 sc1 lds
    v_mfma_f32_16x16x32_bf16 v[180:183], a[240:243], v[80:83], v[52:55]
    s_add_u32 s52, s52, 16384
    v_exp_f32 v44, v148
    v_mfma_f32_16x16x32_bf16 v[180:183], a[244:247], v[84:87], v[180:183]
    v_exp_f32 v45, v149
    v_mfma_f32_16x16x32_bf16 v[180:183], a[248:251], v[88:91], v[180:183]
    ds_read_b64_tr_b16 a[140:141], v37 offset:34816
    v_mfma_f32_16x16x32_bf16 v[180:183], a[252:255], v[92:95], v[180:183]
    ds_read_b64_tr_b16 a[142:143], v37 offset:35840
    v_cvt_pk_bf16_f32 v198, v44, v45
    v_mfma_f32_16x16x32_bf16 v[232:235], v[40:43], v[216:219], v[232:235]
    s_waitcnt lgkmcnt(8)
    buffer_load_dwordx4 v38, s[12:15], s59 offen offset:2048 sc1 lds
    v_mfma_f32_16x16x32_bf16 a[80:83], a[132:135], v[208:211], a[80:83]
    v_exp_f32 v46, v150
    v_mfma_f32_16x16x32_bf16 a[84:87], a[132:135], v[212:215], a[84:87]
    v_exp_f32 v47, v151
    v_mfma_f32_16x16x32_bf16 a[88:91], a[132:135], v[216:219], a[88:91]
    ds_read_b128 a[232:235], v28 offset:32768
    v_mfma_f32_16x16x32_bf16 a[92:95], a[132:135], v[220:223], a[92:95]
    ds_read_b128 a[236:239], v29 offset:32768
    v_cvt_pk_bf16_f32 v199, v46, v47
    v_mfma_f32_16x16x32_bf16 v[236:239], v[40:43], v[220:223], v[236:239]
    buffer_load_dwordx4 v38, s[12:15], s59 offen offset:3072 sc1 lds
    v_mfma_f32_16x16x32_bf16 v[184:187], a[240:243], v[96:99], v[56:59]
    s_add_u32 s59, s59, 16384
    v_exp_f32 v44, v152
    v_mfma_f32_16x16x32_bf16 v[184:187], a[244:247], v[100:103], v[184:187]
    v_exp_f32 v45, v153
    v_mfma_f32_16x16x32_bf16 v[184:187], a[248:251], v[104:107], v[184:187]
    ds_read_b64_tr_b16 a[128:129], v30 offset:49152
    v_mfma_f32_16x16x32_bf16 v[184:187], a[252:255], v[108:111], v[184:187]
    s_waitcnt lgkmcnt(9)
    ds_read_b64_tr_b16 a[130:131], v30 offset:50176
    v_cvt_pk_bf16_f32 v202, v44, v45
    v_mfma_f32_16x16x32_bf16 v[240:243], a[176:179], a[144:147], v[240:243]
    s_waitcnt lgkmcnt(9)
    ds_read_b128 a[184:187], v13 offset:2048
    v_mfma_f32_16x16x32_bf16 a[96:99], a[136:139], v[208:211], a[96:99]
    v_exp_f32 v46, v154
    v_mfma_f32_16x16x32_bf16 a[100:103], a[136:139], v[212:215], a[100:103]
    s_add_u32 m0, s42, 98304
    v_exp_f32 v47, v155
    v_mfma_f32_16x16x32_bf16 a[104:107], a[136:139], v[216:219], a[104:107]
    buffer_load_dwordx4 v14, s[20:23], s51 offen offset:0 lds
    v_mfma_f32_16x16x32_bf16 a[108:111], a[136:139], v[220:223], a[108:111]
    s_waitcnt lgkmcnt(8)
    ds_read_b128 a[188:191], v13 offset:3072
    v_cvt_pk_bf16_f32 v203, v46, v47
    v_mfma_f32_16x16x32_bf16 v[244:247], a[180:183], a[144:147], v[244:247]
    ds_read_b128 a[192:195], v13 offset:4096
    v_mfma_f32_16x16x32_bf16 v[188:191], a[240:243], v[112:115], v[60:63]
    v_exp_f32 v44, v156
    v_mfma_f32_16x16x32_bf16 v[188:191], a[244:247], v[116:119], v[188:191]
    v_exp_f32 v45, v157
    v_mfma_f32_16x16x32_bf16 v[188:191], a[248:251], v[120:123], v[188:191]
    ds_read_b64_tr_b16 a[132:133], v31 offset:49152
    v_mfma_f32_16x16x32_bf16 v[188:191], a[252:255], v[124:127], v[188:191]
    s_waitcnt lgkmcnt(3)
    ds_read_b64_tr_b16 a[134:135], v31 offset:50176
    v_cvt_pk_bf16_f32 v206, v44, v45
    v_mfma_f32_16x16x32_bf16 v[248:251], a[184:187], a[144:147], v[248:251]
    ds_read_b128 a[196:199], v13 offset:5120
    v_mfma_f32_16x16x32_bf16 a[112:115], a[140:143], v[208:211], a[112:115]
    v_exp_f32 v46, v158
    v_mfma_f32_16x16x32_bf16 a[116:119], a[140:143], v[212:215], a[116:119]
    v_exp_f32 v47, v159
    v_mfma_f32_16x16x32_bf16 a[120:123], a[140:143], v[216:219], a[120:123]
    buffer_load_dwordx4 v14, s[20:23], s51 offen offset:1024 lds
    v_mfma_f32_16x16x32_bf16 a[124:127], a[140:143], v[220:223], a[124:127]
    s_waitcnt lgkmcnt(4)
    v_cvt_pk_bf16_f32 v207, v46, v47
    v_mfma_f32_16x16x32_bf16 v[252:255], a[188:191], a[144:147], v[252:255]
    buffer_load_dwordx4 a[144:147], v38, s[16:19], s58 offen offset:0 sc1
    v_mfma_f32_16x16x32_bf16 v[128:131], a[224:227], v[64:67], v[48:51]
    v_exp_f32 v44, v160
    v_mfma_f32_16x16x32_bf16 v[128:131], a[228:231], v[68:71], v[128:131]
    v_exp_f32 v45, v161
    v_mfma_f32_16x16x32_bf16 v[128:131], a[232:235], v[72:75], v[128:131]
    ds_read_b64_tr_b16 a[136:137], v32 offset:49152
    v_mfma_f32_16x16x32_bf16 v[128:131], a[236:239], v[76:79], v[128:131]
    ds_read_b64_tr_b16 a[138:139], v32 offset:50176
    v_cvt_pk_bf16_f32 v208, v44, v45
    v_mfma_f32_16x16x32_bf16 a[0:3], a[128:131], v[192:195], a[0:3]
    v_exp_f32 v46, v162
    v_mfma_f32_16x16x32_bf16 a[4:7], a[128:131], v[196:199], a[4:7]
    v_exp_f32 v47, v163
    v_mfma_f32_16x16x32_bf16 a[8:11], a[128:131], v[200:203], a[8:11]
    ds_read_b128 a[240:243], v26 offset:33792
    v_mfma_f32_16x16x32_bf16 a[12:15], a[128:131], v[204:207], a[12:15]
    ds_read_b128 a[244:247], v27 offset:33792
    v_cvt_pk_bf16_f32 v209, v46, v47
    v_mfma_f32_16x16x32_bf16 v[224:227], v[40:43], v[192:195], v[224:227]
    ds_read_b128 a[200:203], v13 offset:6144
    v_mfma_f32_16x16x32_bf16 v[132:135], a[224:227], v[80:83], v[52:55]
    v_exp_f32 v44, v164
    v_mfma_f32_16x16x32_bf16 v[132:135], a[228:231], v[84:87], v[132:135]
    v_exp_f32 v45, v165
    v_mfma_f32_16x16x32_bf16 v[132:135], a[232:235], v[88:91], v[132:135]
    ds_read_b64_tr_b16 a[140:141], v33 offset:49152
    v_mfma_f32_16x16x32_bf16 v[132:135], a[236:239], v[92:95], v[132:135]
    s_waitcnt lgkmcnt(7)
    ds_read_b64_tr_b16 a[142:143], v33 offset:50176
    v_cvt_pk_bf16_f32 v212, v44, v45
    v_mfma_f32_16x16x32_bf16 a[16:19], a[132:135], v[192:195], a[16:19]
    v_exp_f32 v46, v166
    v_mfma_f32_16x16x32_bf16 a[20:23], a[132:135], v[196:199], a[20:23]
    v_exp_f32 v47, v167
    v_mfma_f32_16x16x32_bf16 a[24:27], a[132:135], v[200:203], a[24:27]
    ds_read_b128 a[248:251], v28 offset:33792
    v_mfma_f32_16x16x32_bf16 a[28:31], a[132:135], v[204:207], a[28:31]
    ds_read_b128 a[252:255], v29 offset:33792
    v_cvt_pk_bf16_f32 v213, v46, v47
    v_mfma_f32_16x16x32_bf16 v[228:231], v[40:43], v[196:199], v[228:231]
    ds_read_b128 a[204:207], v13 offset:7168
    v_mfma_f32_16x16x32_bf16 v[136:139], a[224:227], v[96:99], v[56:59]
    v_exp_f32 v44, v168
    v_mfma_f32_16x16x32_bf16 v[136:139], a[228:231], v[100:103], v[136:139]
    v_exp_f32 v45, v169
    v_mfma_f32_16x16x32_bf16 v[136:139], a[232:235], v[104:107], v[136:139]
    ds_read_b64_tr_b16 a[128:129], v34 offset:49152
    v_mfma_f32_16x16x32_bf16 v[136:139], a[236:239], v[108:111], v[136:139]
    ds_read_b64_tr_b16 a[130:131], v34 offset:50176
    v_cvt_pk_bf16_f32 v216, v44, v45
    v_mfma_f32_16x16x32_bf16 v[240:243], a[192:195], a[148:151], v[240:243]
    s_waitcnt lgkmcnt(10)
    ds_read_b128 a[176:179], v13 offset:8192
    v_mfma_f32_16x16x32_bf16 a[32:35], a[136:139], v[192:195], a[32:35]
    v_exp_f32 v46, v170
    v_mfma_f32_16x16x32_bf16 a[36:39], a[136:139], v[196:199], a[36:39]
    v_exp_f32 v47, v171
    v_mfma_f32_16x16x32_bf16 a[40:43], a[136:139], v[200:203], a[40:43]
    buffer_load_dwordx4 v14, s[20:23], s51 offen offset:2048 lds
    v_mfma_f32_16x16x32_bf16 a[44:47], a[136:139], v[204:207], a[44:47]
    v_cvt_pk_bf16_f32 v217, v46, v47
    v_mfma_f32_16x16x32_bf16 v[244:247], a[196:199], a[148:151], v[244:247]
    ds_read_b128 a[180:183], v13 offset:9216
    v_mfma_f32_16x16x32_bf16 v[140:143], a[224:227], v[112:115], v[60:63]
    v_exp_f32 v44, v172
    v_mfma_f32_16x16x32_bf16 v[140:143], a[228:231], v[116:119], v[140:143]
    v_exp_f32 v45, v173
    v_mfma_f32_16x16x32_bf16 v[140:143], a[232:235], v[120:123], v[140:143]
    ds_read_b64_tr_b16 a[132:133], v35 offset:49152
    v_mfma_f32_16x16x32_bf16 v[140:143], a[236:239], v[124:127], v[140:143]
    s_waitcnt lgkmcnt(10)
    ds_read_b64_tr_b16 a[134:135], v35 offset:50176
    v_cvt_pk_bf16_f32 v220, v44, v45
    v_mfma_f32_16x16x32_bf16 v[248:251], a[200:203], a[148:151], v[248:251]
    s_waitcnt lgkmcnt(9)
    ds_read_b128 a[184:187], v13 offset:10240
    v_mfma_f32_16x16x32_bf16 a[48:51], a[140:143], v[192:195], a[48:51]
    v_exp_f32 v46, v174
    v_mfma_f32_16x16x32_bf16 a[52:55], a[140:143], v[196:199], a[52:55]
    v_exp_f32 v47, v175
    v_mfma_f32_16x16x32_bf16 a[56:59], a[140:143], v[200:203], a[56:59]
    buffer_load_dwordx4 v14, s[20:23], s51 offen offset:3072 lds
    v_mfma_f32_16x16x32_bf16 a[60:63], a[140:143], v[204:207], a[60:63]
    v_cvt_pk_bf16_f32 v221, v46, v47
    v_mfma_f32_16x16x32_bf16 v[232:235], v[40:43], v[200:203], v[232:235]
    s_waitcnt lgkmcnt(8)
    v_mfma_f32_16x16x32_bf16 v[144:147], a[240:243], v[64:67], v[48:51]
    v_exp_f32 v44, v176
    v_mfma_f32_16x16x32_bf16 v[144:147], a[244:247], v[68:71], v[144:147]
    v_exp_f32 v45, v177
    v_mfma_f32_16x16x32_bf16 v[144:147], a[248:251], v[72:75], v[144:147]
    ds_read_b64_tr_b16 a[136:137], v36 offset:49152
    v_mfma_f32_16x16x32_bf16 v[144:147], a[252:255], v[76:79], v[144:147]
    s_waitcnt lgkmcnt(8)
    ds_read_b64_tr_b16 a[138:139], v36 offset:50176
    v_cvt_pk_bf16_f32 v210, v44, v45
    v_mfma_f32_16x16x32_bf16 v[252:255], a[204:207], a[148:151], v[252:255]
    s_waitcnt lgkmcnt(7)
    buffer_load_dwordx4 a[148:151], v38, s[16:19], s58 offen offset:1024 sc1
    v_mfma_f32_16x16x32_bf16 a[64:67], a[128:131], v[192:195], a[64:67]
    v_exp_f32 v46, v178
    v_mfma_f32_16x16x32_bf16 a[68:71], a[128:131], v[196:199], a[68:71]
    v_exp_f32 v47, v179
    v_mfma_f32_16x16x32_bf16 a[72:75], a[128:131], v[200:203], a[72:75]
    ds_read_b128 a[224:227], v26 offset:34816
    v_mfma_f32_16x16x32_bf16 a[76:79], a[128:131], v[204:207], a[76:79]
    s_waitcnt lgkmcnt(7)
    ds_read_b128 a[228:231], v27 offset:34816
    v_cvt_pk_bf16_f32 v211, v46, v47
    v_mfma_f32_16x16x32_bf16 v[240:243], a[176:179], a[152:155], v[240:243]
    ds_read_b128 a[188:191], v13 offset:11264
    v_mfma_f32_16x16x32_bf16 v[148:151], a[240:243], v[80:83], v[52:55]
    s_add_u32 s51, s51, 16384
    v_exp_f32 v44, v180
    v_mfma_f32_16x16x32_bf16 v[148:151], a[244:247], v[84:87], v[148:151]
    v_exp_f32 v45, v181
    v_mfma_f32_16x16x32_bf16 v[148:151], a[248:251], v[88:91], v[148:151]
    ds_read_b64_tr_b16 a[140:141], v37 offset:49152
    v_mfma_f32_16x16x32_bf16 v[148:151], a[252:255], v[92:95], v[148:151]
    ds_read_b64_tr_b16 a[142:143], v37 offset:50176
    v_cvt_pk_bf16_f32 v214, v44, v45
    v_mfma_f32_16x16x32_bf16 v[236:239], v[40:43], v[204:207], v[236:239]
    s_waitcnt lgkmcnt(8)
    ds_read_b128 a[192:195], v13 offset:12288
    v_mfma_f32_16x16x32_bf16 a[80:83], a[132:135], v[192:195], a[80:83]
    v_exp_f32 v46, v182
    v_mfma_f32_16x16x32_bf16 a[84:87], a[132:135], v[196:199], a[84:87]
    v_exp_f32 v47, v183
    v_mfma_f32_16x16x32_bf16 a[88:91], a[132:135], v[200:203], a[88:91]
    ds_read_b128 a[232:235], v28 offset:34816
    v_mfma_f32_16x16x32_bf16 a[92:95], a[132:135], v[204:207], a[92:95]
    ds_read_b128 a[236:239], v29 offset:34816
    v_cvt_pk_bf16_f32 v215, v46, v47
    v_mfma_f32_16x16x32_bf16 v[244:247], a[180:183], a[152:155], v[244:247]
    v_mfma_f32_16x16x32_bf16 v[152:155], a[240:243], v[96:99], v[56:59]
    v_exp_f32 v44, v184
    v_mfma_f32_16x16x32_bf16 v[152:155], a[244:247], v[100:103], v[152:155]
    v_exp_f32 v45, v185
    v_mfma_f32_16x16x32_bf16 v[152:155], a[248:251], v[104:107], v[152:155]
    ds_read_b64_tr_b16 a[128:129], v30 offset:51200
    v_mfma_f32_16x16x32_bf16 v[152:155], a[252:255], v[108:111], v[152:155]
    s_waitcnt lgkmcnt(11)
    ds_read_b64_tr_b16 a[130:131], v30 offset:52224
    v_cvt_pk_bf16_f32 v218, v44, v45
    v_mfma_f32_16x16x32_bf16 v[248:251], a[184:187], a[152:155], v[248:251]
    s_waitcnt lgkmcnt(10)
    ds_read_b128 a[196:199], v13 offset:13312
    v_mfma_f32_16x16x32_bf16 a[96:99], a[136:139], v[192:195], a[96:99]
    v_exp_f32 v46, v186
    v_mfma_f32_16x16x32_bf16 a[100:103], a[136:139], v[196:199], a[100:103]
    s_add_u32 m0, s42, 16384
    v_exp_f32 v47, v187
    v_mfma_f32_16x16x32_bf16 a[104:107], a[136:139], v[200:203], a[104:107]
    buffer_load_dwordx4 v15, s[24:27], s52 offen offset:0 lds
    v_mfma_f32_16x16x32_bf16 a[108:111], a[136:139], v[204:207], a[108:111]
    v_cvt_pk_bf16_f32 v219, v46, v47
    v_mfma_f32_16x16x32_bf16 v[156:159], a[240:243], v[112:115], v[60:63]
    v_exp_f32 v44, v188
    v_mfma_f32_16x16x32_bf16 v[156:159], a[244:247], v[116:119], v[156:159]
    v_exp_f32 v45, v189
    v_mfma_f32_16x16x32_bf16 v[156:159], a[248:251], v[120:123], v[156:159]
    ds_read_b64_tr_b16 a[132:133], v31 offset:51200
    v_mfma_f32_16x16x32_bf16 v[156:159], a[252:255], v[124:127], v[156:159]
    s_waitcnt lgkmcnt(9)
    ds_read_b64_tr_b16 a[134:135], v31 offset:52224
    v_cvt_pk_bf16_f32 v222, v44, v45
    v_mfma_f32_16x16x32_bf16 v[252:255], a[188:191], a[152:155], v[252:255]
    s_waitcnt lgkmcnt(8)
    buffer_load_dwordx4 a[152:155], v38, s[16:19], s58 offen offset:2048 sc1
    v_mfma_f32_16x16x32_bf16 a[112:115], a[140:143], v[192:195], a[112:115]
    v_exp_f32 v46, v190
    v_mfma_f32_16x16x32_bf16 a[116:119], a[140:143], v[196:199], a[116:119]
    v_exp_f32 v47, v191
    v_mfma_f32_16x16x32_bf16 a[120:123], a[140:143], v[200:203], a[120:123]
    buffer_load_dwordx4 v15, s[24:27], s52 offen offset:1024 lds
    v_mfma_f32_16x16x32_bf16 a[124:127], a[140:143], v[204:207], a[124:127]
    s_waitcnt lgkmcnt(5)
    ds_read_b128 a[200:203], v13 offset:14336
    v_cvt_pk_bf16_f32 v223, v46, v47
    v_mfma_f32_16x16x32_bf16 v[160:163], a[224:227], v[64:67], v[48:51]
    v_exp_f32 v44, v128
    v_mfma_f32_16x16x32_bf16 v[160:163], a[228:231], v[68:71], v[160:163]
    v_exp_f32 v45, v129
    v_mfma_f32_16x16x32_bf16 v[160:163], a[232:235], v[72:75], v[160:163]
    ds_read_b64_tr_b16 a[136:137], v32 offset:51200
    v_mfma_f32_16x16x32_bf16 v[160:163], a[236:239], v[76:79], v[160:163]
    ds_read_b64_tr_b16 a[138:139], v32 offset:52224
    v_cvt_pk_bf16_f32 v192, v44, v45
    v_mfma_f32_16x16x32_bf16 v[240:243], a[192:195], a[156:159], v[240:243]
    s_waitcnt lgkmcnt(6)
    ds_read_b128 a[204:207], v13 offset:15360
    v_mfma_f32_16x16x32_bf16 a[0:3], a[128:131], v[208:211], a[0:3]
    v_exp_f32 v46, v130
    v_mfma_f32_16x16x32_bf16 a[4:7], a[128:131], v[212:215], a[4:7]
    v_exp_f32 v47, v131
    v_mfma_f32_16x16x32_bf16 a[8:11], a[128:131], v[216:219], a[8:11]
    ds_read_b128 a[240:243], v26 offset:35840
    v_mfma_f32_16x16x32_bf16 a[12:15], a[128:131], v[220:223], a[12:15]
    ds_read_b128 a[244:247], v27 offset:35840
    v_cvt_pk_bf16_f32 v193, v46, v47
    v_mfma_f32_16x16x32_bf16 v[164:167], a[224:227], v[80:83], v[52:55]
    v_exp_f32 v44, v132
    v_mfma_f32_16x16x32_bf16 v[164:167], a[228:231], v[84:87], v[164:167]
    v_exp_f32 v45, v133
    v_mfma_f32_16x16x32_bf16 v[164:167], a[232:235], v[88:91], v[164:167]
    ds_read_b64_tr_b16 a[140:141], v33 offset:51200
    v_mfma_f32_16x16x32_bf16 v[164:167], a[236:239], v[92:95], v[164:167]
    s_waitcnt lgkmcnt(9)
    ds_read_b64_tr_b16 a[142:143], v33 offset:52224
    v_cvt_pk_bf16_f32 v196, v44, v45
    v_mfma_f32_16x16x32_bf16 v[244:247], a[196:199], a[156:159], v[244:247]
    s_waitcnt lgkmcnt(8)
    v_mfma_f32_16x16x32_bf16 a[16:19], a[132:135], v[208:211], a[16:19]
    v_exp_f32 v46, v134
    v_mfma_f32_16x16x32_bf16 a[20:23], a[132:135], v[212:215], a[20:23]
    v_exp_f32 v47, v135
    v_mfma_f32_16x16x32_bf16 a[24:27], a[132:135], v[216:219], a[24:27]
    ds_read_b128 a[248:251], v28 offset:35840
    v_mfma_f32_16x16x32_bf16 a[28:31], a[132:135], v[220:223], a[28:31]
    ds_read_b128 a[252:255], v29 offset:35840
    v_cvt_pk_bf16_f32 v197, v46, v47
    v_mfma_f32_16x16x32_bf16 v[168:171], a[224:227], v[96:99], v[56:59]
    v_exp_f32 v44, v136
    v_mfma_f32_16x16x32_bf16 v[168:171], a[228:231], v[100:103], v[168:171]
    v_exp_f32 v45, v137
    v_mfma_f32_16x16x32_bf16 v[168:171], a[232:235], v[104:107], v[168:171]
    ds_read_b64_tr_b16 a[128:129], v34 offset:51200
    v_mfma_f32_16x16x32_bf16 v[168:171], a[236:239], v[108:111], v[168:171]
    s_waitcnt lgkmcnt(10)
    ds_read_b64_tr_b16 a[130:131], v34 offset:52224
    v_cvt_pk_bf16_f32 v200, v44, v45
    v_mfma_f32_16x16x32_bf16 v[248:251], a[200:203], a[156:159], v[248:251]
    s_waitcnt lgkmcnt(9)
    v_mfma_f32_16x16x32_bf16 a[32:35], a[136:139], v[208:211], a[32:35]
    v_exp_f32 v46, v138
    v_mfma_f32_16x16x32_bf16 a[36:39], a[136:139], v[212:215], a[36:39]
    v_exp_f32 v47, v139
    v_mfma_f32_16x16x32_bf16 a[40:43], a[136:139], v[216:219], a[40:43]
    buffer_load_dwordx4 v15, s[24:27], s52 offen offset:2048 lds
    v_mfma_f32_16x16x32_bf16 a[44:47], a[136:139], v[220:223], a[44:47]
    v_cvt_pk_bf16_f32 v201, v46, v47
    v_mfma_f32_16x16x32_bf16 v[172:175], a[224:227], v[112:115], v[60:63]
    v_exp_f32 v44, v140
    v_mfma_f32_16x16x32_bf16 v[172:175], a[228:231], v[116:119], v[172:175]
    v_exp_f32 v45, v141
    v_mfma_f32_16x16x32_bf16 v[172:175], a[232:235], v[120:123], v[172:175]
    ds_read_b64_tr_b16 a[132:133], v35 offset:51200
    v_mfma_f32_16x16x32_bf16 v[172:175], a[236:239], v[124:127], v[172:175]
    s_waitcnt lgkmcnt(9)
    ds_read_b64_tr_b16 a[134:135], v35 offset:52224
    v_cvt_pk_bf16_f32 v204, v44, v45
    v_mfma_f32_16x16x32_bf16 v[252:255], a[204:207], a[156:159], v[252:255]
    s_waitcnt lgkmcnt(6)
    buffer_load_dwordx4 a[156:159], v38, s[16:19], s58 offen offset:3072 sc1
    v_mfma_f32_16x16x32_bf16 a[48:51], a[140:143], v[208:211], a[48:51]
    s_add_u32 s58, s58, 4096
    v_exp_f32 v46, v142
    v_mfma_f32_16x16x32_bf16 a[52:55], a[140:143], v[212:215], a[52:55]
    v_exp_f32 v47, v143
    v_mfma_f32_16x16x32_bf16 a[56:59], a[140:143], v[216:219], a[56:59]
    buffer_load_dwordx4 v15, s[24:27], s52 offen offset:3072 lds
    v_mfma_f32_16x16x32_bf16 a[60:63], a[140:143], v[220:223], a[60:63]
    s_waitcnt lgkmcnt(4)
    v_cvt_pk_bf16_f32 v205, v46, v47
    v_mfma_f32_16x16x32_bf16 v[176:179], a[240:243], v[64:67], v[48:51]
    s_waitcnt vmcnt(12)
    v_exp_f32 v44, v144
    v_mfma_f32_16x16x32_bf16 v[176:179], a[244:247], v[68:71], v[176:179]
    s_barrier
    v_exp_f32 v45, v145
    v_mfma_f32_16x16x32_bf16 v[176:179], a[248:251], v[72:75], v[176:179]
    s_add_u32 m0, s42, 65536
    ds_read_b64_tr_b16 a[136:137], v36 offset:51200
    ds_read_b128 a[176:179], v13 offset:16384
    v_mfma_f32_16x16x32_bf16 v[176:179], a[252:255], v[76:79], v[176:179]
    ds_read_b64_tr_b16 a[138:139], v36 offset:52224
    v_cvt_pk_bf16_f32 v194, v44, v45
    v_mfma_f32_16x16x32_bf16 v[224:227], v[40:43], v[208:211], v[224:227]
    s_waitcnt lgkmcnt(5)
    buffer_load_dwordx4 v38, s[12:15], s59 offen offset:0 sc1 lds
    v_mfma_f32_16x16x32_bf16 a[64:67], a[128:131], v[208:211], a[64:67]
    v_exp_f32 v46, v146
    v_mfma_f32_16x16x32_bf16 a[68:71], a[128:131], v[212:215], a[68:71]
    v_exp_f32 v47, v147
    v_mfma_f32_16x16x32_bf16 a[72:75], a[128:131], v[216:219], a[72:75]
    ds_read_b128 a[224:227], v26 offset:49152
    ds_read_b128 a[180:183], v13 offset:17408
    v_mfma_f32_16x16x32_bf16 a[76:79], a[128:131], v[220:223], a[76:79]
    ds_read_b128 a[228:231], v27 offset:49152
    v_cvt_pk_bf16_f32 v195, v46, v47
    v_mfma_f32_16x16x32_bf16 v[228:231], v[40:43], v[212:215], v[228:231]
    buffer_load_dwordx4 v38, s[12:15], s59 offen offset:1024 sc1 lds
    v_mfma_f32_16x16x32_bf16 v[180:183], a[240:243], v[80:83], v[52:55]
    s_add_u32 s52, s52, 16384
    v_exp_f32 v44, v148
    v_mfma_f32_16x16x32_bf16 v[180:183], a[244:247], v[84:87], v[180:183]
    v_exp_f32 v45, v149
    v_mfma_f32_16x16x32_bf16 v[180:183], a[248:251], v[88:91], v[180:183]
    ds_read_b64_tr_b16 a[140:141], v37 offset:51200
    v_mfma_f32_16x16x32_bf16 v[180:183], a[252:255], v[92:95], v[180:183]
    ds_read_b64_tr_b16 a[142:143], v37 offset:52224
    v_cvt_pk_bf16_f32 v198, v44, v45
    v_mfma_f32_16x16x32_bf16 v[232:235], v[40:43], v[216:219], v[232:235]
    s_waitcnt lgkmcnt(8)
    buffer_load_dwordx4 v38, s[12:15], s59 offen offset:2048 sc1 lds
    v_mfma_f32_16x16x32_bf16 a[80:83], a[132:135], v[208:211], a[80:83]
    v_exp_f32 v46, v150
    v_mfma_f32_16x16x32_bf16 a[84:87], a[132:135], v[212:215], a[84:87]
    v_exp_f32 v47, v151
    v_mfma_f32_16x16x32_bf16 a[88:91], a[132:135], v[216:219], a[88:91]
    ds_read_b128 a[232:235], v28 offset:49152
    v_mfma_f32_16x16x32_bf16 a[92:95], a[132:135], v[220:223], a[92:95]
    ds_read_b128 a[236:239], v29 offset:49152
    v_cvt_pk_bf16_f32 v199, v46, v47
    v_mfma_f32_16x16x32_bf16 v[236:239], v[40:43], v[220:223], v[236:239]
    buffer_load_dwordx4 v38, s[12:15], s59 offen offset:3072 sc1 lds
    v_mfma_f32_16x16x32_bf16 v[184:187], a[240:243], v[96:99], v[56:59]
    s_add_u32 s59, s59, 16384
    v_exp_f32 v44, v152
    v_mfma_f32_16x16x32_bf16 v[184:187], a[244:247], v[100:103], v[184:187]
    v_exp_f32 v45, v153
    v_mfma_f32_16x16x32_bf16 v[184:187], a[248:251], v[104:107], v[184:187]
    ds_read_b64_tr_b16 a[128:129], v30 offset:0
    v_mfma_f32_16x16x32_bf16 v[184:187], a[252:255], v[108:111], v[184:187]
    s_waitcnt lgkmcnt(9)
    ds_read_b64_tr_b16 a[130:131], v30 offset:1024
    v_cvt_pk_bf16_f32 v202, v44, v45
    v_mfma_f32_16x16x32_bf16 v[240:243], a[176:179], a[160:163], v[240:243]
    s_waitcnt lgkmcnt(9)
    ds_read_b128 a[184:187], v13 offset:18432
    v_mfma_f32_16x16x32_bf16 a[96:99], a[136:139], v[208:211], a[96:99]
    v_exp_f32 v46, v154
    v_mfma_f32_16x16x32_bf16 a[100:103], a[136:139], v[212:215], a[100:103]
    s_add_u32 m0, s42, 114688
    v_exp_f32 v47, v155
    v_mfma_f32_16x16x32_bf16 a[104:107], a[136:139], v[216:219], a[104:107]
    buffer_load_dwordx4 v14, s[20:23], s51 offen offset:0 lds
    v_mfma_f32_16x16x32_bf16 a[108:111], a[136:139], v[220:223], a[108:111]
    s_waitcnt lgkmcnt(8)
    ds_read_b128 a[188:191], v13 offset:19456
    v_cvt_pk_bf16_f32 v203, v46, v47
    v_mfma_f32_16x16x32_bf16 v[244:247], a[180:183], a[160:163], v[244:247]
    ds_read_b128 a[192:195], v13 offset:20480
    v_mfma_f32_16x16x32_bf16 v[188:191], a[240:243], v[112:115], v[60:63]
    v_exp_f32 v44, v156
    v_mfma_f32_16x16x32_bf16 v[188:191], a[244:247], v[116:119], v[188:191]
    v_exp_f32 v45, v157
    v_mfma_f32_16x16x32_bf16 v[188:191], a[248:251], v[120:123], v[188:191]
    ds_read_b64_tr_b16 a[132:133], v31 offset:0
    v_mfma_f32_16x16x32_bf16 v[188:191], a[252:255], v[124:127], v[188:191]
    s_waitcnt lgkmcnt(3)
    ds_read_b64_tr_b16 a[134:135], v31 offset:1024
    v_cvt_pk_bf16_f32 v206, v44, v45
    v_mfma_f32_16x16x32_bf16 v[248:251], a[184:187], a[160:163], v[248:251]
    ds_read_b128 a[196:199], v13 offset:21504
    v_mfma_f32_16x16x32_bf16 a[112:115], a[140:143], v[208:211], a[112:115]
    v_exp_f32 v46, v158
    v_mfma_f32_16x16x32_bf16 a[116:119], a[140:143], v[212:215], a[116:119]
    v_exp_f32 v47, v159
    v_mfma_f32_16x16x32_bf16 a[120:123], a[140:143], v[216:219], a[120:123]
    buffer_load_dwordx4 v14, s[20:23], s51 offen offset:1024 lds
    v_mfma_f32_16x16x32_bf16 a[124:127], a[140:143], v[220:223], a[124:127]
    s_waitcnt lgkmcnt(4)
    v_cvt_pk_bf16_f32 v207, v46, v47
    v_mfma_f32_16x16x32_bf16 v[252:255], a[188:191], a[160:163], v[252:255]
    buffer_load_dwordx4 a[160:163], v38, s[16:19], s58 offen offset:0 sc1
    s_sub_u32 s53, s53, 1
    s_cmp_lg_u32 s53, 0
    s_cbranch_scc1 L_loopB
    v_add_u32 v16, s42, v38
    v_add_u32 v17, 0x10000, v16
    v_add_u32 v18, 0x20000, v16
    v_cmp_eq_u32 vcc, 0, v3
    s_cbranch_vccz L_tb_ok
    s_mov_b32 s49, 0x40000
L_poll_tb:
    buffer_load_dword v3, v4, s[60:63], s41 offen sc1
    s_waitcnt vmcnt(0)
    v_cmp_eq_u32 vcc, 0, v3
    s_cbranch_vccz L_tb_ok
    s_sleep 1
    s_sub_u32 s49, s49, 1
    s_cmp_lg_u32 s49, 0
    s_cbranch_scc1 L_poll_tb
L_tb_ok:
    v_add_u32 v3, -1, v3
    v_and_b32 v3, 31, v3
    v_lshlrev_b32 v21, 2, v3
    v_lshl_add_u32 v3, v3, 12, v6
    s_lshl_b32 s40, s44, 8
    s_lshl_b32 s47, s44, 19
    v_readlane_b32 s64, v3, 0
    v_readlane_b32 s65, v3, 1
    v_readlane_b32 s66, v3, 2
    v_readlane_b32 s67, v3, 3
    v_readlane_b32 s68, v3, 4
    v_readlane_b32 s69, v3, 5
    v_readlane_b32 s70, v3, 6
    v_readlane_b32 s71, v3, 7
    v_readlane_b32 s72, v3, 8
    v_readlane_b32 s73, v3, 9
    v_readlane_b32 s74, v3, 10
    v_readlane_b32 s75, v3, 11
    v_readlane_b32 s76, v3, 12
    v_readlane_b32 s77, v3, 13
    v_readlane_b32 s78, v3, 14
    v_readlane_b32 s79, v3, 15
    v_mfma_f32_16x16x32_bf16 v[128:131], a[224:227], v[64:67], v[48:51]
    v_exp_f32 v44, v160
    v_mfma_f32_16x16x32_bf16 v[128:131], a[228:231], v[68:71], v[128:131]
    v_exp_f32 v45, v161
    v_mfma_f32_16x16x32_bf16 v[128:131], a[232:235], v[72:75], v[128:131]
    ds_read_b64_tr_b16 a[136:137], v32 offset:0
    v_mfma_f32_16x16x32_bf16 v[128:131], a[236:239], v[76:79], v[128:131]
    ds_read_b64_tr_b16 a[138:139], v32 offset:1024
    v_cvt_pk_bf16_f32 v208, v44, v45
    v_mfma_f32_16x16x32_bf16 a[0:3], a[128:131], v[192:195], a[0:3]
    v_exp_f32 v46, v162
    v_mfma_f32_16x16x32_bf16 a[4:7], a[128:131], v[196:199], a[4:7]
    v_exp_f32 v47, v163
    v_mfma_f32_16x16x32_bf16 a[8:11], a[128:131], v[200:203], a[8:11]
    ds_read_b128 a[240:243], v26 offset:50176
    v_mfma_f32_16x16x32_bf16 a[12:15], a[128:131], v[204:207], a[12:15]
    s_lshl_b32 s48, s64, 2
    ds_read_b128 a[244:247], v27 offset:50176
    v_cvt_pk_bf16_f32 v209, v46, v47
    v_mfma_f32_16x16x32_bf16 v[224:227], v[40:43], v[192:195], v[224:227]
    buffer_load_dwordx4 a[144:147], v38, s[8:11], s48 offen offset:0 sc1
    v_mfma_f32_16x16x32_bf16 v[132:135], a[224:227], v[80:83], v[52:55]
    v_exp_f32 v44, v164
    v_mfma_f32_16x16x32_bf16 v[132:135], a[228:231], v[84:87], v[132:135]
    v_exp_f32 v45, v165
    v_mfma_f32_16x16x32_bf16 v[132:135], a[232:235], v[88:91], v[132:135]
    ds_read_b64_tr_b16 a[140:141], v33 offset:0
    v_mfma_f32_16x16x32_bf16 v[132:135], a[236:239], v[92:95], v[132:135]
    s_waitcnt lgkmcnt(6)
    ds_read_b64_tr_b16 a[142:143], v33 offset:1024
    v_cvt_pk_bf16_f32 v212, v44, v45
    v_mfma_f32_16x16x32_bf16 a[16:19], a[132:135], v[192:195], a[16:19]
    v_exp_f32 v46, v166
    v_mfma_f32_16x16x32_bf16 a[20:23], a[132:135], v[196:199], a[20:23]
    v_exp_f32 v47, v167
    v_mfma_f32_16x16x32_bf16 a[24:27], a[132:135], v[200:203], a[24:27]
    ds_read_b128 a[248:251], v28 offset:50176
    v_mfma_f32_16x16x32_bf16 a[28:31], a[132:135], v[204:207], a[28:31]
    ds_read_b128 a[252:255], v29 offset:50176
    v_cvt_pk_bf16_f32 v213, v46, v47
    v_mfma_f32_16x16x32_bf16 v[228:231], v[40:43], v[196:199], v[228:231]
    buffer_load_dwordx4 a[148:151], v38, s[8:11], s48 offen offset:1024 sc1
    v_mfma_f32_16x16x32_bf16 v[136:139], a[224:227], v[96:99], v[56:59]
    v_exp_f32 v44, v168
    v_mfma_f32_16x16x32_bf16 v[136:139], a[228:231], v[100:103], v[136:139]
    v_exp_f32 v45, v169
    v_mfma_f32_16x16x32_bf16 v[136:139], a[232:235], v[104:107], v[136:139]
    ds_read_b64_tr_b16 a[128:129], v34 offset:0
    v_mfma_f32_16x16x32_bf16 v[136:139], a[236:239], v[108:111], v[136:139]
    s_waitcnt lgkmcnt(7)
    ds_read_b64_tr_b16 a[130:131], v34 offset:1024
    v_cvt_pk_bf16_f32 v216, v44, v45
    v_mfma_f32_16x16x32_bf16 a[32:35], a[136:139], v[192:195], a[32:35]
    v_exp_f32 v46, v170
    v_mfma_f32_16x16x32_bf16 a[36:39], a[136:139], v[196:199], a[36:39]
    s_add_u32 m0, s42, 114688
    v_exp_f32 v47, v171
    v_mfma_f32_16x16x32_bf16 a[40:43], a[136:139], v[200:203], a[40:43]
    buffer_load_dwordx4 v14, s[20:23], s51 offen offset:2048 lds
    v_mfma_f32_16x16x32_bf16 a[44:47], a[136:139], v[204:207], a[44:47]
    v_cvt_pk_bf16_f32 v217, v46, v47
    v_mfma_f32_16x16x32_bf16 v[140:143], a[224:227], v[112:115], v[60:63]
    buffer_load_dwordx4 a[152:155], v38, s[8:11], s48 offen offset:2048 sc1
    v_exp_f32 v44, v172
    v_mfma_f32_16x16x32_bf16 v[140:143], a[228:231], v[116:119], v[140:143]
    v_exp_f32 v45, v173
    v_mfma_f32_16x16x32_bf16 v[140:143], a[232:235], v[120:123], v[140:143]
    ds_read_b64_tr_b16 a[132:133], v35 offset:0
    v_mfma_f32_16x16x32_bf16 v[140:143], a[236:239], v[124:127], v[140:143]
    s_waitcnt lgkmcnt(5)
    ds_read_b64_tr_b16 a[134:135], v35 offset:1024
    v_cvt_pk_bf16_f32 v220, v44, v45
    v_mfma_f32_16x16x32_bf16 a[48:51], a[140:143], v[192:195], a[48:51]
    v_exp_f32 v46, v174
    v_mfma_f32_16x16x32_bf16 a[52:55], a[140:143], v[196:199], a[52:55]
    s_add_u32 m0, s42, 114688
    v_exp_f32 v47, v175
    v_mfma_f32_16x16x32_bf16 a[56:59], a[140:143], v[200:203], a[56:59]
    buffer_load_dwordx4 v14, s[20:23], s51 offen offset:3072 lds
    v_mfma_f32_16x16x32_bf16 a[60:63], a[140:143], v[204:207], a[60:63]
    v_cvt_pk_bf16_f32 v221, v46, v47
    v_mfma_f32_16x16x32_bf16 v[232:235], v[40:43], v[200:203], v[232:235]
    s_waitcnt lgkmcnt(4)
    buffer_load_dwordx4 a[156:159], v38, s[8:11], s48 offen offset:3072 sc1
    v_mfma_f32_16x16x32_bf16 v[144:147], a[240:243], v[64:67], v[48:51]
    s_lshl_b32 s48, s64, 2
    v_exp_f32 v44, v176
    v_mfma_f32_16x16x32_bf16 v[144:147], a[244:247], v[68:71], v[144:147]
    v_exp_f32 v45, v177
    v_mfma_f32_16x16x32_bf16 v[144:147], a[248:251], v[72:75], v[144:147]
    ds_read_b64_tr_b16 a[136:137], v36 offset:0
    v_mfma_f32_16x16x32_bf16 v[144:147], a[252:255], v[76:79], v[144:147]
    s_waitcnt lgkmcnt(3)
    ds_read_b64_tr_b16 a[138:139], v36 offset:1024
    v_cvt_pk_bf16_f32 v210, v44, v45
    v_mfma_f32_16x16x32_bf16 a[64:67], a[128:131], v[192:195], a[64:67]
    v_exp_f32 v46, v178
    v_mfma_f32_16x16x32_bf16 a[68:71], a[128:131], v[196:199], a[68:71]
    v_exp_f32 v47, v179
    v_mfma_f32_16x16x32_bf16 a[72:75], a[128:131], v[200:203], a[72:75]
    ds_read_b128 a[224:227], v26 offset:51200
    v_mfma_f32_16x16x32_bf16 a[76:79], a[128:131], v[204:207], a[76:79]
    s_add_u32 s48, s48, 4096
    ds_read_b128 a[228:231], v27 offset:51200
    v_cvt_pk_bf16_f32 v211, v46, v47
    v_mfma_f32_16x16x32_bf16 v[148:151], a[240:243], v[80:83], v[52:55]
    s_add_u32 s51, s51, 16384
    buffer_load_dwordx4 a[160:163], v38, s[8:11], s48 offen offset:0 sc1
    v_exp_f32 v44, v180
    v_mfma_f32_16x16x32_bf16 v[148:151], a[244:247], v[84:87], v[148:151]
    v_exp_f32 v45, v181
    v_mfma_f32_16x16x32_bf16 v[148:151], a[248:251], v[88:91], v[148:151]
    ds_read_b64_tr_b16 a[140:141], v37 offset:0
    v_mfma_f32_16x16x32_bf16 v[148:151], a[252:255], v[92:95], v[148:151]
    ds_read_b64_tr_b16 a[142:143], v37 offset:1024
    v_cvt_pk_bf16_f32 v214, v44, v45
    v_mfma_f32_16x16x32_bf16 v[236:239], v[40:43], v[204:207], v[236:239]
    s_waitcnt lgkmcnt(6)
    buffer_load_dwordx4 a[164:167], v38, s[8:11], s48 offen offset:1024 sc1
    v_mfma_f32_16x16x32_bf16 a[80:83], a[132:135], v[192:195], a[80:83]
    v_exp_f32 v46, v182
    v_mfma_f32_16x16x32_bf16 a[84:87], a[132:135], v[196:199], a[84:87]
    v_exp_f32 v47, v183
    v_mfma_f32_16x16x32_bf16 a[88:91], a[132:135], v[200:203], a[88:91]
    ds_read_b128 a[232:235], v28 offset:51200
    v_mfma_f32_16x16x32_bf16 a[92:95], a[132:135], v[204:207], a[92:95]
    ds_read_b128 a[236:239], v29 offset:51200
    v_cvt_pk_bf16_f32 v215, v46, v47
    v_mfma_f32_16x16x32_bf16 v[152:155], a[240:243], v[96:99], v[56:59]
    v_exp_f32 v44, v184
    v_mfma_f32_16x16x32_bf16 v[152:155], a[244:247], v[100:103], v[152:155]
    buffer_load_dwordx4 a[168:171], v38, s[8:11], s48 offen offset:2048 sc1
    v_exp_f32 v45, v185
    v_mfma_f32_16x16x32_bf16 v[152:155], a[248:251], v[104:107], v[152:155]
    ds_read_b64_tr_b16 a[128:129], v30 offset:2048
    v_mfma_f32_16x16x32_bf16 v[152:155], a[252:255], v[108:111], v[152:155]
    s_waitcnt lgkmcnt(7)
    ds_read_b64_tr_b16 a[130:131], v30 offset:3072
    v_cvt_pk_bf16_f32 v218, v44, v45
    v_mfma_f32_16x16x32_bf16 a[96:99], a[136:139], v[192:195], a[96:99]
    v_exp_f32 v46, v186
    v_mfma_f32_16x16x32_bf16 a[100:103], a[136:139], v[196:199], a[100:103]
    s_add_u32 m0, s42, 32768
    v_exp_f32 v47, v187
    v_mfma_f32_16x16x32_bf16 a[104:107], a[136:139], v[200:203], a[104:107]
    buffer_load_dwordx4 v15, s[24:27], s52 offen offset:0 lds
    v_mfma_f32_16x16x32_bf16 a[108:111], a[136:139], v[204:207], a[108:111]
    v_cvt_pk_bf16_f32 v219, v46, v47
    v_mfma_f32_16x16x32_bf16 v[156:159], a[240:243], v[112:115], v[60:63]
    buffer_load_dwordx4 a[172:175], v38, s[8:11], s48 offen offset:3072 sc1
    v_exp_f32 v44, v188
    v_mfma_f32_16x16x32_bf16 v[156:159], a[244:247], v[116:119], v[156:159]
    v_exp_f32 v45, v189
    v_mfma_f32_16x16x32_bf16 v[156:159], a[248:251], v[120:123], v[156:159]
    ds_read_b64_tr_b16 a[132:133], v31 offset:2048
    v_mfma_f32_16x16x32_bf16 v[156:159], a[252:255], v[124:127], v[156:159]
    s_waitcnt lgkmcnt(5)
    ds_read_b64_tr_b16 a[134:135], v31 offset:3072
    v_cvt_pk_bf16_f32 v222, v44, v45
    v_mfma_f32_16x16x32_bf16 a[112:115], a[140:143], v[192:195], a[112:115]
    v_exp_f32 v46, v190
    v_mfma_f32_16x16x32_bf16 a[116:119], a[140:143], v[196:199], a[116:119]
    s_add_u32 m0, s42, 32768
    v_exp_f32 v47, v191
    v_mfma_f32_16x16x32_bf16 a[120:123], a[140:143], v[200:203], a[120:123]
    buffer_load_dwordx4 v15, s[24:27], s52 offen offset:1024 lds
    v_mfma_f32_16x16x32_bf16 a[124:127], a[140:143], v[204:207], a[124:127]
    s_waitcnt lgkmcnt(4)
    s_lshl_b32 s48, s65, 2
    v_cvt_pk_bf16_f32 v223, v46, v47
    v_mfma_f32_16x16x32_bf16 v[160:163], a[224:227], v[64:67], v[48:51]
    buffer_load_dwordx4 a[176:179], v38, s[8:11], s48 offen offset:0 sc1
    v_exp_f32 v44, v128
    v_mfma_f32_16x16x32_bf16 v[160:163], a[228:231], v[68:71], v[160:163]
    v_exp_f32 v45, v129
    v_mfma_f32_16x16x32_bf16 v[160:163], a[232:235], v[72:75], v[160:163]
    ds_read_b64_tr_b16 a[136:137], v32 offset:2048
    v_mfma_f32_16x16x32_bf16 v[160:163], a[236:239], v[76:79], v[160:163]
    s_waitcnt lgkmcnt(3)
    ds_read_b64_tr_b16 a[138:139], v32 offset:3072
    v_cvt_pk_bf16_f32 v192, v44, v45
    v_mfma_f32_16x16x32_bf16 a[0:3], a[128:131], v[208:211], a[0:3]
    v_exp_f32 v46, v130
    v_mfma_f32_16x16x32_bf16 a[4:7], a[128:131], v[212:215], a[4:7]
    v_exp_f32 v47, v131
    v_mfma_f32_16x16x32_bf16 a[8:11], a[128:131], v[216:219], a[8:11]
    ds_read_b128 a[240:243], v26 offset:52224
    v_mfma_f32_16x16x32_bf16 a[12:15], a[128:131], v[220:223], a[12:15]
    ds_read_b128 a[244:247], v27 offset:52224
    v_cvt_pk_bf16_f32 v193, v46, v47
    v_mfma_f32_16x16x32_bf16 v[164:167], a[224:227], v[80:83], v[52:55]
    buffer_load_dwordx4 a[180:183], v38, s[8:11], s48 offen offset:1024 sc1
    v_exp_f32 v44, v132
    v_mfma_f32_16x16x32_bf16 v[164:167], a[228:231], v[84:87], v[164:167]
    v_exp_f32 v45, v133
    v_mfma_f32_16x16x32_bf16 v[164:167], a[232:235], v[88:91], v[164:167]
    ds_read_b64_tr_b16 a[140:141], v33 offset:2048
    v_mfma_f32_16x16x32_bf16 v[164:167], a[236:239], v[92:95], v[164:167]
    s_waitcnt lgkmcnt(5)
    ds_read_b64_tr_b16 a[142:143], v33 offset:3072
    v_cvt_pk_bf16_f32 v196, v44, v45
    v_mfma_f32_16x16x32_bf16 a[16:19], a[132:135], v[208:211], a[16:19]
    v_exp_f32 v46, v134
    v_mfma_f32_16x16x32_bf16 a[20:23], a[132:135], v[212:215], a[20:23]
    v_exp_f32 v47, v135
    v_mfma_f32_16x16x32_bf16 a[24:27], a[132:135], v[216:219], a[24:27]
    ds_read_b128 a[248:251], v28 offset:52224
    v_mfma_f32_16x16x32_bf16 a[28:31], a[132:135], v[220:223], a[28:31]
    ds_read_b128 a[252:255], v29 offset:52224
    v_cvt_pk_bf16_f32 v197, v46, v47
    v_mfma_f32_16x16x32_bf16 v[168:171], a[224:227], v[96:99], v[56:59]
    buffer_load_dwordx4 a[184:187], v38, s[8:11], s48 offen offset:2048 sc1
    v_exp_f32 v44, v136
    v_mfma_f32_16x16x32_bf16 v[168:171], a[228:231], v[100:103], v[168:171]
    v_exp_f32 v45, v137
    v_mfma_f32_16x16x32_bf16 v[168:171], a[232:235], v[104:107], v[168:171]
    ds_read_b64_tr_b16 a[128:129], v34 offset:2048
    v_mfma_f32_16x16x32_bf16 v[168:171], a[236:239], v[108:111], v[168:171]
    s_waitcnt lgkmcnt(7)
    ds_read_b64_tr_b16 a[130:131], v34 offset:3072
    v_cvt_pk_bf16_f32 v200, v44, v45
    v_mfma_f32_16x16x32_bf16 a[32:35], a[136:139], v[208:211], a[32:35]
    v_exp_f32 v46, v138
    v_mfma_f32_16x16x32_bf16 a[36:39], a[136:139], v[212:215], a[36:39]
    s_add_u32 m0, s42, 32768
    v_exp_f32 v47, v139
    v_mfma_f32_16x16x32_bf16 a[40:43], a[136:139], v[216:219], a[40:43]
    buffer_load_dwordx4 v15, s[24:27], s52 offen offset:2048 lds
    v_mfma_f32_16x16x32_bf16 a[44:47], a[136:139], v[220:223], a[44:47]
    v_cvt_pk_bf16_f32 v201, v46, v47
    v_mfma_f32_16x16x32_bf16 v[172:175], a[224:227], v[112:115], v[60:63]
    buffer_load_dwordx4 a[188:191], v38, s[8:11], s48 offen offset:3072 sc1
    v_exp_f32 v44, v140
    v_mfma_f32_16x16x32_bf16 v[172:175], a[228:231], v[116:119], v[172:175]
    v_exp_f32 v45, v141
    v_mfma_f32_16x16x32_bf16 v[172:175], a[232:235], v[120:123], v[172:175]
    ds_read_b64_tr_b16 a[132:133], v35 offset:2048
    v_mfma_f32_16x16x32_bf16 v[172:175], a[236:239], v[124:127], v[172:175]
    s_waitcnt lgkmcnt(5)
    ds_read_b64_tr_b16 a[134:135], v35 offset:3072
    v_cvt_pk_bf16_f32 v204, v44, v45
    v_mfma_f32_16x16x32_bf16 a[48:51], a[140:143], v[208:211], a[48:51]
    v_exp_f32 v46, v142
    v_mfma_f32_16x16x32_bf16 a[52:55], a[140:143], v[212:215], a[52:55]
    s_add_u32 m0, s42, 32768
    v_exp_f32 v47, v143
    v_mfma_f32_16x16x32_bf16 a[56:59], a[140:143], v[216:219], a[56:59]
    buffer_load_dwordx4 v15, s[24:27], s52 offen offset:3072 lds
    v_mfma_f32_16x16x32_bf16 a[60:63], a[140:143], v[220:223], a[60:63]
    s_waitcnt lgkmcnt(4)
    v_cvt_pk_bf16_f32 v205, v46, v47
    v_mfma_f32_16x16x32_bf16 v[176:179], a[240:243], v[64:67], v[48:51]
    s_waitcnt vmcnt(18)
    v_exp_f32 v44, v144
    v_mfma_f32_16x16x32_bf16 v[176:179], a[244:247], v[68:71], v[176:179]
    s_barrier
    v_exp_f32 v45, v145
    v_mfma_f32_16x16x32_bf16 v[176:179], a[248:251], v[72:75], v[176:179]
    ds_read_b64_tr_b16 a[136:137], v36 offset:2048
    v_mfma_f32_16x16x32_bf16 v[176:179], a[252:255], v[76:79], v[176:179]
    ds_read_b64_tr_b16 a[138:139], v36 offset:3072
    v_cvt_pk_bf16_f32 v194, v44, v45
    v_mfma_f32_16x16x32_bf16 v[224:227], v[40:43], v[208:211], v[224:227]
    s_waitcnt lgkmcnt(4)
    v_mfma_f32_16x16x32_bf16 a[64:67], a[128:131], v[208:211], a[64:67]
    v_exp_f32 v46, v146
    v_mfma_f32_16x16x32_bf16 a[68:71], a[128:131], v[212:215], a[68:71]
    v_exp_f32 v47, v147
    v_mfma_f32_16x16x32_bf16 a[72:75], a[128:131], v[216:219], a[72:75]
    ds_read_b128 a[224:227], v26 offset:0
    v_mfma_f32_16x16x32_bf16 a[76:79], a[128:131], v[220:223], a[76:79]
    ds_read_b128 a[228:231], v27 offset:0
    v_cvt_pk_bf16_f32 v195, v46, v47
    v_mfma_f32_16x16x32_bf16 v[228:231], v[40:43], v[212:215], v[228:231]
    v_mfma_f32_16x16x32_bf16 v[180:183], a[240:243], v[80:83], v[52:55]
    s_add_u32 s52, s52, 16384
    v_exp_f32 v44, v148
    v_mfma_f32_16x16x32_bf16 v[180:183], a[244:247], v[84:87], v[180:183]
    v_exp_f32 v45, v149
    v_mfma_f32_16x16x32_bf16 v[180:183], a[248:251], v[88:91], v[180:183]
    ds_read_b64_tr_b16 a[140:141], v37 offset:2048
    v_mfma_f32_16x16x32_bf16 v[180:183], a[252:255], v[92:95], v[180:183]
    ds_read_b64_tr_b16 a[142:143], v37 offset:3072
    v_cvt_pk_bf16_f32 v198, v44, v45
    v_mfma_f32_16x16x32_bf16 v[232:235], v[40:43], v[216:219], v[232:235]
    s_waitcnt lgkmcnt(6)
    v_mfma_f32_16x16x32_bf16 a[80:83], a[132:135], v[208:211], a[80:83]
    v_exp_f32 v46, v150
    v_mfma_f32_16x16x32_bf16 a[84:87], a[132:135], v[212:215], a[84:87]
    v_exp_f32 v47, v151
    v_mfma_f32_16x16x32_bf16 a[88:91], a[132:135], v[216:219], a[88:91]
    ds_read_b128 a[232:235], v28 offset:0
    v_mfma_f32_16x16x32_bf16 a[92:95], a[132:135], v[220:223], a[92:95]
    ds_read_b128 a[236:239], v29 offset:0
    v_cvt_pk_bf16_f32 v199, v46, v47
    v_mfma_f32_16x16x32_bf16 v[236:239], v[40:43], v[220:223], v[236:239]
    v_mfma_f32_16x16x32_bf16 v[184:187], a[240:243], v[96:99], v[56:59]
    v_exp_f32 v44, v152
    v_mfma_f32_16x16x32_bf16 v[184:187], a[244:247], v[100:103], v[184:187]
    v_exp_f32 v45, v153
    v_mfma_f32_16x16x32_bf16 v[184:187], a[248:251], v[104:107], v[184:187]
    ds_read_b64_tr_b16 a[128:129], v30 offset:16384
    v_mfma_f32_16x16x32_bf16 v[184:187], a[252:255], v[108:111], v[184:187]
    s_waitcnt lgkmcnt(7)
    ds_read_b64_tr_b16 a[130:131], v30 offset:17408
    v_cvt_pk_bf16_f32 v202, v44, v45
    v_mfma_f32_16x16x32_bf16 a[96:99], a[136:139], v[208:211], a[96:99]
    v_exp_f32 v46, v154
    v_mfma_f32_16x16x32_bf16 a[100:103], a[136:139], v[212:215], a[100:103]
    v_exp_f32 v47, v155
    v_mfma_f32_16x16x32_bf16 a[104:107], a[136:139], v[216:219], a[104:107]
    v_mfma_f32_16x16x32_bf16 a[108:111], a[136:139], v[220:223], a[108:111]
    v_cvt_pk_bf16_f32 v203, v46, v47
    v_mfma_f32_16x16x32_bf16 v[188:191], a[240:243], v[112:115], v[60:63]
    v_exp_f32 v44, v156
    v_mfma_f32_16x16x32_bf16 v[188:191], a[244:247], v[116:119], v[188:191]
    v_exp_f32 v45, v157
    v_mfma_f32_16x16x32_bf16 v[188:191], a[248:251], v[120:123], v[188:191]
    ds_read_b64_tr_b16 a[132:133], v31 offset:16384
    v_mfma_f32_16x16x32_bf16 v[188:191], a[252:255], v[124:127], v[188:191]
    s_waitcnt lgkmcnt(5)
    ds_read_b64_tr_b16 a[134:135], v31 offset:17408
    v_cvt_pk_bf16_f32 v206, v44, v45
    v_mfma_f32_16x16x32_bf16 a[112:115], a[140:143], v[208:211], a[112:115]
    v_exp_f32 v46, v158
    v_mfma_f32_16x16x32_bf16 a[116:119], a[140:143], v[212:215], a[116:119]
    v_exp_f32 v47, v159
    v_mfma_f32_16x16x32_bf16 a[120:123], a[140:143], v[216:219], a[120:123]
    v_mfma_f32_16x16x32_bf16 a[124:127], a[140:143], v[220:223], a[124:127]
    s_waitcnt lgkmcnt(4)
    v_cvt_pk_bf16_f32 v207, v46, v47
    v_mfma_f32_16x16x32_bf16 v[128:131], a[224:227], v[64:67], v[48:51]
    s_lshl_b32 s48, s65, 2
    v_exp_f32 v44, v160
    v_mfma_f32_16x16x32_bf16 v[128:131], a[228:231], v[68:71], v[128:131]
    v_exp_f32 v45, v161
    v_mfma_f32_16x16x32_bf16 v[128:131], a[232:235], v[72:75], v[128:131]
    ds_read_b64_tr_b16 a[136:137], v32 offset:16384
    v_mfma_f32_16x16x32_bf16 v[128:131], a[236:239], v[76:79], v[128:131]
    s_waitcnt lgkmcnt(3)
    ds_read_b64_tr_b16 a[138:139], v32 offset:17408
    v_cvt_pk_bf16_f32 v208, v44, v45
    v_mfma_f32_16x16x32_bf16 a[0:3], a[128:131], v[192:195], a[0:3]
    v_exp_f32 v46, v162
    v_mfma_f32_16x16x32_bf16 a[4:7], a[128:131], v[196:199], a[4:7]
    v_exp_f32 v47, v163
    v_mfma_f32_16x16x32_bf16 a[8:11], a[128:131], v[200:203], a[8:11]
    ds_read_b128 a[240:243], v26 offset:1024
    v_mfma_f32_16x16x32_bf16 a[12:15], a[128:131], v[204:207], a[12:15]
    s_add_u32 s48, s48, 4096
    ds_read_b128 a[244:247], v27 offset:1024
    v_cvt_pk_bf16_f32 v209, v46, v47
    v_mfma_f32_16x16x32_bf16 v[224:227], v[40:43], v[192:195], v[224:227]
    buffer_load_dwordx4 a[192:195], v38, s[8:11], s48 offen offset:0 sc1
    v_mfma_f32_16x16x32_bf16 v[132:135], a[224:227], v[80:83], v[52:55]
    v_exp_f32 v44, v164
    v_mfma_f32_16x16x32_bf16 v[132:135], a[228:231], v[84:87], v[132:135]
    v_exp_f32 v45, v165
    v_mfma_f32_16x16x32_bf16 v[132:135], a[232:235], v[88:91], v[132:135]
    ds_read_b64_tr_b16 a[140:141], v33 offset:16384
    v_mfma_f32_16x16x32_bf16 v[132:135], a[236:239], v[92:95], v[132:135]
    s_waitcnt lgkmcnt(5)
    ds_read_b64_tr_b16 a[142:143], v33 offset:17408
    v_cvt_pk_bf16_f32 v212, v44, v45
    v_mfma_f32_16x16x32_bf16 a[16:19], a[132:135], v[192:195], a[16:19]
    buffer_load_dwordx4 a[196:199], v38, s[8:11], s48 offen offset:1024 sc1
    v_exp_f32 v46, v166
    v_mfma_f32_16x16x32_bf16 a[20:23], a[132:135], v[196:199], a[20:23]
    v_exp_f32 v47, v167
    v_mfma_f32_16x16x32_bf16 a[24:27], a[132:135], v[200:203], a[24:27]
    ds_read_b128 a[248:251], v28 offset:1024
    v_mfma_f32_16x16x32_bf16 a[28:31], a[132:135], v[204:207], a[28:31]
    ds_read_b128 a[252:255], v29 offset:1024
    v_cvt_pk_bf16_f32 v213, v46, v47
    v_mfma_f32_16x16x32_bf16 v[228:231], v[40:43], v[196:199], v[228:231]
    buffer_load_dwordx4 a[200:203], v38, s[8:11], s48 offen offset:2048 sc1
    v_mfma_f32_16x16x32_bf16 v[136:139], a[224:227], v[96:99], v[56:59]
    v_exp_f32 v44, v168
    v_mfma_f32_16x16x32_bf16 v[136:139], a[228:231], v[100:103], v[136:139]
    v_exp_f32 v45, v169
    v_mfma_f32_16x16x32_bf16 v[136:139], a[232:235], v[104:107], v[136:139]
    ds_read_b64_tr_b16 a[128:129], v34 offset:16384
    v_mfma_f32_16x16x32_bf16 v[136:139], a[236:239], v[108:111], v[136:139]
    s_waitcnt lgkmcnt(7)
    ds_read_b64_tr_b16 a[130:131], v34 offset:17408
    v_cvt_pk_bf16_f32 v216, v44, v45
    v_mfma_f32_16x16x32_bf16 a[32:35], a[136:139], v[192:195], a[32:35]
    v_exp_f32 v46, v170
    v_mfma_f32_16x16x32_bf16 a[36:39], a[136:139], v[196:199], a[36:39]
    v_exp_f32 v47, v171
    v_mfma_f32_16x16x32_bf16 a[40:43], a[136:139], v[200:203], a[40:43]
    buffer_load_dwordx4 a[204:207], v38, s[8:11], s48 offen offset:3072 sc1
    v_mfma_f32_16x16x32_bf16 a[44:47], a[136:139], v[204:207], a[44:47]
    v_cvt_pk_bf16_f32 v217, v46, v47
    v_mfma_f32_16x16x32_bf16 v[140:143], a[224:227], v[112:115], v[60:63]
    v_exp_f32 v44, v172
    v_mfma_f32_16x16x32_bf16 v[140:143], a[228:231], v[116:119], v[140:143]
    v_exp_f32 v45, v173
    v_mfma_f32_16x16x32_bf16 v[140:143], a[232:235], v[120:123], v[140:143]
    ds_read_b64_tr_b16 a[132:133], v35 offset:16384
    v_mfma_f32_16x16x32_bf16 v[140:143], a[236:239], v[124:127], v[140:143]
    s_waitcnt lgkmcnt(5)
    ds_read_b64_tr_b16 a[134:135], v35 offset:17408
    v_cvt_pk_bf16_f32 v220, v44, v45
    v_mfma_f32_16x16x32_bf16 a[48:51], a[140:143], v[192:195], a[48:51]
    v_exp_f32 v46, v174
    v_mfma_f32_16x16x32_bf16 a[52:55], a[140:143], v[196:199], a[52:55]
    s_lshl_b32 s48, s66, 2
    v_exp_f32 v47, v175
    v_mfma_f32_16x16x32_bf16 a[56:59], a[140:143], v[200:203], a[56:59]
    buffer_load_dwordx4 a[208:211], v38, s[8:11], s48 offen offset:0 sc1
    v_mfma_f32_16x16x32_bf16 a[60:63], a[140:143], v[204:207], a[60:63]
    v_cvt_pk_bf16_f32 v221, v46, v47
    v_mfma_f32_16x16x32_bf16 v[232:235], v[40:43], v[200:203], v[232:235]
    s_waitcnt lgkmcnt(4)
    buffer_load_dwordx4 a[212:215], v38, s[8:11], s48 offen offset:1024 sc1
    v_mfma_f32_16x16x32_bf16 v[144:147], a[240:243], v[64:67], v[48:51]
    v_exp_f32 v44, v176
    v_mfma_f32_16x16x32_bf16 v[144:147], a[244:247], v[68:71], v[144:147]
    v_exp_f32 v45, v177
    v_mfma_f32_16x16x32_bf16 v[144:147], a[248:251], v[72:75], v[144:147]
    ds_read_b64_tr_b16 a[136:137], v36 offset:16384
    v_mfma_f32_16x16x32_bf16 v[144:147], a[252:255], v[76:79], v[144:147]
    s_waitcnt lgkmcnt(3)
    ds_read_b64_tr_b16 a[138:139], v36 offset:17408
    v_cvt_pk_bf16_f32 v210, v44, v45
    v_mfma_f32_16x16x32_bf16 a[64:67], a[128:131], v[192:195], a[64:67]
    buffer_load_dwordx4 a[216:219], v38, s[8:11], s48 offen offset:2048 sc1
    v_exp_f32 v46, v178
    v_mfma_f32_16x16x32_bf16 a[68:71], a[128:131], v[196:199], a[68:71]
    v_exp_f32 v47, v179
    v_mfma_f32_16x16x32_bf16 a[72:75], a[128:131], v[200:203], a[72:75]
    ds_read_b128 a[224:227], v26 offset:2048
    v_mfma_f32_16x16x32_bf16 a[76:79], a[128:131], v[204:207], a[76:79]
    ds_read_b128 a[228:231], v27 offset:2048
    v_cvt_pk_bf16_f32 v211, v46, v47
    v_mfma_f32_16x16x32_bf16 v[148:151], a[240:243], v[80:83], v[52:55]
    s_add_u32 s51, s51, 16384
    v_exp_f32 v44, v180
    v_mfma_f32_16x16x32_bf16 v[148:151], a[244:247], v[84:87], v[148:151]
    v_exp_f32 v45, v181
    v_mfma_f32_16x16x32_bf16 v[148:151], a[248:251], v[88:91], v[148:151]
    ds_read_b64_tr_b16 a[140:141], v37 offset:16384
    v_mfma_f32_16x16x32_bf16 v[148:151], a[252:255], v[92:95], v[148:151]
    ds_read_b64_tr_b16 a[142:143], v37 offset:17408
    v_cvt_pk_bf16_f32 v214, v44, v45
    v_mfma_f32_16x16x32_bf16 v[236:239], v[40:43], v[204:207], v[236:239]
    s_waitcnt lgkmcnt(6)
    buffer_load_dwordx4 a[220:223], v38, s[8:11], s48 offen offset:3072 sc1
    v_mfma_f32_16x16x32_bf16 a[80:83], a[132:135], v[192:195], a[80:83]
    s_lshl_b32 s48, s72, 2
    v_exp_f32 v46, v182
    v_mfma_f32_16x16x32_bf16 a[84:87], a[132:135], v[196:199], a[84:87]
    v_exp_f32 v47, v183
    v_mfma_f32_16x16x32_bf16 a[88:91], a[132:135], v[200:203], a[88:91]
    ds_read_b128 a[232:235], v28 offset:2048
    v_mfma_f32_16x16x32_bf16 a[92:95], a[132:135], v[204:207], a[92:95]
    ds_read_b128 a[236:239], v29 offset:2048
    v_cvt_pk_bf16_f32 v215, v46, v47
    v_mfma_f32_16x16x32_bf16 v[152:155], a[240:243], v[96:99], v[56:59]
    s_add_u32 m0, s42, 131072
    v_exp_f32 v44, v184
    v_mfma_f32_16x16x32_bf16 v[152:155], a[244:247], v[100:103], v[152:155]
    buffer_load_dwordx4 v38, s[8:11], s48 offen offset:0 sc1 lds
    v_exp_f32 v45, v185
    v_mfma_f32_16x16x32_bf16 v[152:155], a[248:251], v[104:107], v[152:155]
    ds_read_b64_tr_b16 a[128:129], v30 offset:18432
    v_mfma_f32_16x16x32_bf16 v[152:155], a[252:255], v[108:111], v[152:155]
    s_waitcnt lgkmcnt(7)
    ds_read_b64_tr_b16 a[130:131], v30 offset:19456
    v_cvt_pk_bf16_f32 v218, v44, v45
    v_mfma_f32_16x16x32_bf16 a[96:99], a[136:139], v[192:195], a[96:99]
    v_exp_f32 v46, v186
    v_mfma_f32_16x16x32_bf16 a[100:103], a[136:139], v[196:199], a[100:103]
    s_add_u32 m0, s42, 49152
    v_exp_f32 v47, v187
    v_mfma_f32_16x16x32_bf16 a[104:107], a[136:139], v[200:203], a[104:107]
    buffer_load_dwordx4 v15, s[24:27], s52 offen offset:0 lds
    v_mfma_f32_16x16x32_bf16 a[108:111], a[136:139], v[204:207], a[108:111]
    s_add_u32 m0, s42, 131072
    v_cvt_pk_bf16_f32 v219, v46, v47
    v_mfma_f32_16x16x32_bf16 v[156:159], a[240:243], v[112:115], v[60:63]
    buffer_load_dwordx4 v38, s[8:11], s48 offen offset:1024 sc1 lds
    v_exp_f32 v44, v188
    v_mfma_f32_16x16x32_bf16 v[156:159], a[244:247], v[116:119], v[156:159]
    v_exp_f32 v45, v189
    v_mfma_f32_16x16x32_bf16 v[156:159], a[248:251], v[120:123], v[156:159]
    ds_read_b64_tr_b16 a[132:133], v31 offset:18432
    v_mfma_f32_16x16x32_bf16 v[156:159], a[252:255], v[124:127], v[156:159]
    s_waitcnt lgkmcnt(5)
    ds_read_b64_tr_b16 a[134:135], v31 offset:19456
    v_cvt_pk_bf16_f32 v222, v44, v45
    v_mfma_f32_16x16x32_bf16 a[112:115], a[140:143], v[192:195], a[112:115]
    v_exp_f32 v46, v190
    v_mfma_f32_16x16x32_bf16 a[116:119], a[140:143], v[196:199], a[116:119]
    s_add_u32 m0, s42, 49152
    v_exp_f32 v47, v191
    v_mfma_f32_16x16x32_bf16 a[120:123], a[140:143], v[200:203], a[120:123]
    buffer_load_dwordx4 v15, s[24:27], s52 offen offset:1024 lds
    v_mfma_f32_16x16x32_bf16 a[124:127], a[140:143], v[204:207], a[124:127]
    s_waitcnt lgkmcnt(4)
    s_add_u32 m0, s42, 131072
    v_cvt_pk_bf16_f32 v223, v46, v47
    v_mfma_f32_16x16x32_bf16 v[160:163], a[224:227], v[64:67], v[48:51]
    buffer_load_dwordx4 v38, s[8:11], s48 offen offset:2048 sc1 lds
    v_exp_f32 v44, v128
    v_mfma_f32_16x16x32_bf16 v[160:163], a[228:231], v[68:71], v[160:163]
    v_exp_f32 v45, v129
    v_mfma_f32_16x16x32_bf16 v[160:163], a[232:235], v[72:75], v[160:163]
    ds_read_b64_tr_b16 a[136:137], v32 offset:18432
    v_mfma_f32_16x16x32_bf16 v[160:163], a[236:239], v[76:79], v[160:163]
    s_waitcnt lgkmcnt(3)
    ds_read_b64_tr_b16 a[138:139], v32 offset:19456
    v_cvt_pk_bf16_f32 v192, v44, v45
    v_mfma_f32_16x16x32_bf16 a[0:3], a[128:131], v[208:211], a[0:3]
    s_add_u32 m0, s42, 131072
    v_exp_f32 v46, v130
    v_mfma_f32_16x16x32_bf16 a[4:7], a[128:131], v[212:215], a[4:7]
    buffer_load_dwordx4 v38, s[8:11], s48 offen offset:3072 sc1 lds
    v_exp_f32 v47, v131
    v_mfma_f32_16x16x32_bf16 a[8:11], a[128:131], v[216:219], a[8:11]
    s_lshl_b32 s48, s68, 2
    ds_read_b128 a[240:243], v26 offset:3072
    v_mfma_f32_16x16x32_bf16 a[12:15], a[128:131], v[220:223], a[12:15]
    ds_read_b128 a[244:247], v27 offset:3072
    v_cvt_pk_bf16_f32 v193, v46, v47
    v_mfma_f32_16x16x32_bf16 v[164:167], a[224:227], v[80:83], v[52:55]
    v_exp_f32 v44, v132
    v_mfma_f32_16x16x32_bf16 v[164:167], a[228:231], v[84:87], v[164:167]
    v_exp_f32 v45, v133
    v_mfma_f32_16x16x32_bf16 v[164:167], a[232:235], v[88:91], v[164:167]
    ds_read_b64_tr_b16 a[140:141], v33 offset:18432
    v_mfma_f32_16x16x32_bf16 v[164:167], a[236:239], v[92:95], v[164:167]
    s_waitcnt lgkmcnt(5)
    s_add_u32 m0, s42, 65536
    ds_read_b64_tr_b16 a[142:143], v33 offset:19456
    v_cvt_pk_bf16_f32 v196, v44, v45
    v_mfma_f32_16x16x32_bf16 a[16:19], a[132:135], v[208:211], a[16:19]
    buffer_load_dwordx4 v38, s[8:11], s48 offen offset:0 sc1 lds
    v_exp_f32 v46, v134
    v_mfma_f32_16x16x32_bf16 a[20:23], a[132:135], v[212:215], a[20:23]
    v_exp_f32 v47, v135
    v_mfma_f32_16x16x32_bf16 a[24:27], a[132:135], v[216:219], a[24:27]
    ds_read_b128 a[248:251], v28 offset:3072
    v_mfma_f32_16x16x32_bf16 a[28:31], a[132:135], v[220:223], a[28:31]
    ds_read_b128 a[252:255], v29 offset:3072
    v_cvt_pk_bf16_f32 v197, v46, v47
    v_mfma_f32_16x16x32_bf16 v[168:171], a[224:227], v[96:99], v[56:59]
    s_add_u32 m0, s42, 65536
    v_exp_f32 v44, v136
    v_mfma_f32_16x16x32_bf16 v[168:171], a[228:231], v[100:103], v[168:171]
    buffer_load_dwordx4 v38, s[8:11], s48 offen offset:1024 sc1 lds
    v_exp_f32 v45, v137
    v_mfma_f32_16x16x32_bf16 v[168:171], a[232:235], v[104:107], v[168:171]
    ds_read_b64_tr_b16 a[128:129], v34 offset:18432
    v_mfma_f32_16x16x32_bf16 v[168:171], a[236:239], v[108:111], v[168:171]
    s_waitcnt lgkmcnt(7)
    ds_read_b64_tr_b16 a[130:131], v34 offset:19456
    v_cvt_pk_bf16_f32 v200, v44, v45
    v_mfma_f32_16x16x32_bf16 a[32:35], a[136:139], v[208:211], a[32:35]
    v_exp_f32 v46, v138
    v_mfma_f32_16x16x32_bf16 a[36:39], a[136:139], v[212:215], a[36:39]
    s_add_u32 m0, s42, 49152
    v_exp_f32 v47, v139
    v_mfma_f32_16x16x32_bf16 a[40:43], a[136:139], v[216:219], a[40:43]
    buffer_load_dwordx4 v15, s[24:27], s52 offen offset:2048 lds
    v_mfma_f32_16x16x32_bf16 a[44:47], a[136:139], v[220:223], a[44:47]
    s_add_u32 m0, s42, 65536
    v_cvt_pk_bf16_f32 v201, v46, v47
    v_mfma_f32_16x16x32_bf16 v[172:175], a[224:227], v[112:115], v[60:63]
    buffer_load_dwordx4 v38, s[8:11], s48 offen offset:2048 sc1 lds
    v_exp_f32 v44, v140
    v_mfma_f32_16x16x32_bf16 v[172:175], a[228:231], v[116:119], v[172:175]
    v_exp_f32 v45, v141
    v_mfma_f32_16x16x32_bf16 v[172:175], a[232:235], v[120:123], v[172:175]
    ds_read_b64_tr_b16 a[132:133], v35 offset:18432
    v_mfma_f32_16x16x32_bf16 v[172:175], a[236:239], v[124:127], v[172:175]
    s_waitcnt lgkmcnt(5)
    ds_read_b64_tr_b16 a[134:135], v35 offset:19456
    v_cvt_pk_bf16_f32 v204, v44, v45
    v_mfma_f32_16x16x32_bf16 a[48:51], a[140:143], v[208:211], a[48:51]
    v_exp_f32 v46, v142
    v_mfma_f32_16x16x32_bf16 a[52:55], a[140:143], v[212:215], a[52:55]
    s_add_u32 m0, s42, 49152
    v_exp_f32 v47, v143
    v_mfma_f32_16x16x32_bf16 a[56:59], a[140:143], v[216:219], a[56:59]
    buffer_load_dwordx4 v15, s[24:27], s52 offen offset:3072 lds
    v_mfma_f32_16x16x32_bf16 a[60:63], a[140:143], v[220:223], a[60:63]
    s_waitcnt lgkmcnt(4)
    s_add_u32 m0, s42, 65536
    v_cvt_pk_bf16_f32 v205, v46, v47
    v_mfma_f32_16x16x32_bf16 v[176:179], a[240:243], v[64:67], v[48:51]
    s_waitcnt vmcnt(19)
    buffer_load_dwordx4 v38, s[8:11], s48 offen offset:3072 sc1 lds
    v_exp_f32 v44, v144
    v_mfma_f32_16x16x32_bf16 v[176:179], a[244:247], v[68:71], v[176:179]
    s_barrier
    v_exp_f32 v45, v145
    v_mfma_f32_16x16x32_bf16 v[176:179], a[248:251], v[72:75], v[176:179]
    ds_read_b64_tr_b16 a[136:137], v36 offset:18432
    v_mfma_f32_16x16x32_bf16 v[176:179], a[252:255], v[76:79], v[176:179]
    ds_read_b64_tr_b16 a[138:139], v36 offset:19456
    v_cvt_pk_bf16_f32 v194, v44, v45
    v_mfma_f32_16x16x32_bf16 v[224:227], v[40:43], v[208:211], v[224:227]
    s_waitcnt lgkmcnt(4)
    v_mfma_f32_16x16x32_bf16 a[64:67], a[128:131], v[208:211], a[64:67]
    v_exp_f32 v46, v146
    v_mfma_f32_16x16x32_bf16 a[68:71], a[128:131], v[212:215], a[68:71]
    v_exp_f32 v47, v147
    v_mfma_f32_16x16x32_bf16 a[72:75], a[128:131], v[216:219], a[72:75]
    ds_read_b128 a[224:227], v26 offset:16384
    v_mfma_f32_16x16x32_bf16 a[76:79], a[128:131], v[220:223], a[76:79]
    ds_read_b128 a[228:231], v27 offset:16384
    v_cvt_pk_bf16_f32 v195, v46, v47
    v_mfma_f32_16x16x32_bf16 v[228:231], v[40:43], v[212:215], v[228:231]
    v_mfma_f32_16x16x32_bf16 v[180:183], a[240:243], v[80:83], v[52:55]
    s_add_u32 s52, s52, 16384
    v_exp_f32 v44, v148
    v_mfma_f32_16x16x32_bf16 v[180:183], a[244:247], v[84:87], v[180:183]
    v_exp_f32 v45, v149
    v_mfma_f32_16x16x32_bf16 v[180:183], a[248:251], v[88:91], v[180:183]
    ds_read_b64_tr_b16 a[140:141], v37 offset:18432
    v_mfma_f32_16x16x32_bf16 v[180:183], a[252:255], v[92:95], v[180:183]
    ds_read_b64_tr_b16 a[142:143], v37 offset:19456
    v_cvt_pk_bf16_f32 v198, v44, v45
    v_mfma_f32_16x16x32_bf16 v[232:235], v[40:43], v[216:219], v[232:235]
    s_waitcnt lgkmcnt(6)
    v_mfma_f32_16x16x32_bf16 a[80:83], a[132:135], v[208:211], a[80:83]
    v_exp_f32 v46, v150
    v_mfma_f32_16x16x32_bf16 a[84:87], a[132:135], v[212:215], a[84:87]
    v_exp_f32 v47, v151
    v_mfma_f32_16x16x32_bf16 a[88:91], a[132:135], v[216:219], a[88:91]
    ds_read_b128 a[232:235], v28 offset:16384
    v_mfma_f32_16x16x32_bf16 a[92:95], a[132:135], v[220:223], a[92:95]
    ds_read_b128 a[236:239], v29 offset:16384
    v_cvt_pk_bf16_f32 v199, v46, v47
    v_mfma_f32_16x16x32_bf16 v[236:239], v[40:43], v[220:223], v[236:239]
    v_mfma_f32_16x16x32_bf16 v[184:187], a[240:243], v[96:99], v[56:59]
    v_exp_f32 v44, v152
    v_mfma_f32_16x16x32_bf16 v[184:187], a[244:247], v[100:103], v[184:187]
    v_exp_f32 v45, v153
    v_mfma_f32_16x16x32_bf16 v[184:187], a[248:251], v[104:107], v[184:187]
    ds_read_b64_tr_b16 a[128:129], v30 offset:32768
    v_mfma_f32_16x16x32_bf16 v[184:187], a[252:255], v[108:111], v[184:187]
    s_waitcnt lgkmcnt(7)
    ds_read_b64_tr_b16 a[130:131], v30 offset:33792
    v_cvt_pk_bf16_f32 v202, v44, v45
    v_mfma_f32_16x16x32_bf16 a[96:99], a[136:139], v[208:211], a[96:99]
    v_exp_f32 v46, v154
    v_mfma_f32_16x16x32_bf16 a[100:103], a[136:139], v[212:215], a[100:103]
    v_exp_f32 v47, v155
    v_mfma_f32_16x16x32_bf16 a[104:107], a[136:139], v[216:219], a[104:107]
    v_mfma_f32_16x16x32_bf16 a[108:111], a[136:139], v[220:223], a[108:111]
    v_cvt_pk_bf16_f32 v203, v46, v47
    v_mfma_f32_16x16x32_bf16 v[188:191], a[240:243], v[112:115], v[60:63]
    v_exp_f32 v44, v156
    v_mfma_f32_16x16x32_bf16 v[188:191], a[244:247], v[116:119], v[188:191]
    v_exp_f32 v45, v157
    v_mfma_f32_16x16x32_bf16 v[188:191], a[248:251], v[120:123], v[188:191]
    ds_read_b64_tr_b16 a[132:133], v31 offset:32768
    v_mfma_f32_16x16x32_bf16 v[188:191], a[252:255], v[124:127], v[188:191]
    s_waitcnt lgkmcnt(5)
    ds_read_b64_tr_b16 a[134:135], v31 offset:33792
    v_cvt_pk_bf16_f32 v206, v44, v45
    v_mfma_f32_16x16x32_bf16 a[112:115], a[140:143], v[208:211], a[112:115]
    v_exp_f32 v46, v158
    v_mfma_f32_16x16x32_bf16 a[116:119], a[140:143], v[212:215], a[116:119]
    v_exp_f32 v47, v159
    v_mfma_f32_16x16x32_bf16 a[120:123], a[140:143], v[216:219], a[120:123]
    v_mfma_f32_16x16x32_bf16 a[124:127], a[140:143], v[220:223], a[124:127]
    s_waitcnt lgkmcnt(4)
    v_cvt_pk_bf16_f32 v207, v46, v47
    v_mfma_f32_16x16x32_bf16 v[128:131], a[224:227], v[64:67], v[48:51]
    s_lshl_b32 s48, s72, 2
    v_exp_f32 v44, v160
    v_mfma_f32_16x16x32_bf16 v[128:131], a[228:231], v[68:71], v[128:131]
    s_add_u32 s48, s48, 4096
    v_exp_f32 v45, v161
    v_mfma_f32_16x16x32_bf16 v[128:131], a[232:235], v[72:75], v[128:131]
    ds_read_b64_tr_b16 a[136:137], v32 offset:32768
    v_mfma_f32_16x16x32_bf16 v[128:131], a[236:239], v[76:79], v[128:131]
    s_waitcnt lgkmcnt(3)
    ds_read_b64_tr_b16 a[138:139], v32 offset:33792
    v_cvt_pk_bf16_f32 v208, v44, v45
    v_mfma_f32_16x16x32_bf16 a[0:3], a[128:131], v[192:195], a[0:3]
    s_add_u32 m0, s42, 81920
    v_exp_f32 v46, v162
    v_mfma_f32_16x16x32_bf16 a[4:7], a[128:131], v[196:199], a[4:7]
    buffer_load_dwordx4 v38, s[8:11], s48 offen offset:0 sc1 lds
    v_exp_f32 v47, v163
    v_mfma_f32_16x16x32_bf16 a[8:11], a[128:131], v[200:203], a[8:11]
    ds_read_b128 a[240:243], v26 offset:17408
    v_mfma_f32_16x16x32_bf16 a[12:15], a[128:131], v[204:207], a[12:15]
    s_add_u32 m0, s42, 81920
    ds_read_b128 a[244:247], v27 offset:17408
    v_cvt_pk_bf16_f32 v209, v46, v47
    v_mfma_f32_16x16x32_bf16 v[224:227], v[40:43], v[192:195], v[224:227]
    buffer_load_dwordx4 v38, s[8:11], s48 offen offset:1024 sc1 lds
    v_mfma_f32_16x16x32_bf16 v[132:135], a[224:227], v[80:83], v[52:55]
    v_exp_f32 v44, v164
    v_mfma_f32_16x16x32_bf16 v[132:135], a[228:231], v[84:87], v[132:135]
    v_exp_f32 v45, v165
    v_mfma_f32_16x16x32_bf16 v[132:135], a[232:235], v[88:91], v[132:135]
    ds_read_b64_tr_b16 a[140:141], v33 offset:32768
    v_mfma_f32_16x16x32_bf16 v[132:135], a[236:239], v[92:95], v[132:135]
    s_waitcnt lgkmcnt(5)
    s_add_u32 m0, s42, 81920
    ds_read_b64_tr_b16 a[142:143], v33 offset:33792
    v_cvt_pk_bf16_f32 v212, v44, v45
    v_mfma_f32_16x16x32_bf16 a[16:19], a[132:135], v[192:195], a[16:19]
    buffer_load_dwordx4 v38, s[8:11], s48 offen offset:2048 sc1 lds
    v_exp_f32 v46, v166
    v_mfma_f32_16x16x32_bf16 a[20:23], a[132:135], v[196:199], a[20:23]
    v_exp_f32 v47, v167
    v_mfma_f32_16x16x32_bf16 a[24:27], a[132:135], v[200:203], a[24:27]
    ds_read_b128 a[248:251], v28 offset:17408
    v_mfma_f32_16x16x32_bf16 a[28:31], a[132:135], v[204:207], a[28:31]
    s_add_u32 m0, s42, 81920
    ds_read_b128 a[252:255], v29 offset:17408
    v_cvt_pk_bf16_f32 v213, v46, v47
    v_mfma_f32_16x16x32_bf16 v[228:231], v[40:43], v[196:199], v[228:231]
    buffer_load_dwordx4 v38, s[8:11], s48 offen offset:3072 sc1 lds
    v_mfma_f32_16x16x32_bf16 v[136:139], a[224:227], v[96:99], v[56:59]
    s_lshl_b32 s48, s68, 2
    v_exp_f32 v44, v168
    v_mfma_f32_16x16x32_bf16 v[136:139], a[228:231], v[100:103], v[136:139]
    s_add_u32 s48, s48, 4096
    v_exp_f32 v45, v169
    v_mfma_f32_16x16x32_bf16 v[136:139], a[232:235], v[104:107], v[136:139]
    ds_read_b64_tr_b16 a[128:129], v34 offset:32768
    v_mfma_f32_16x16x32_bf16 v[136:139], a[236:239], v[108:111], v[136:139]
    s_waitcnt lgkmcnt(7)
    ds_read_b64_tr_b16 a[130:131], v34 offset:33792
    v_cvt_pk_bf16_f32 v216, v44, v45
    v_mfma_f32_16x16x32_bf16 a[32:35], a[136:139], v[192:195], a[32:35]
    v_exp_f32 v46, v170
    v_mfma_f32_16x16x32_bf16 a[36:39], a[136:139], v[196:199], a[36:39]
    s_add_u32 m0, s42, 147456
    v_exp_f32 v47, v171
    v_mfma_f32_16x16x32_bf16 a[40:43], a[136:139], v[200:203], a[40:43]
    buffer_load_dwordx4 v38, s[8:11], s48 offen offset:0 sc1 lds
    v_mfma_f32_16x16x32_bf16 a[44:47], a[136:139], v[204:207], a[44:47]
    v_cvt_pk_bf16_f32 v217, v46, v47
    v_mfma_f32_16x16x32_bf16 v[140:143], a[224:227], v[112:115], v[60:63]
    v_exp_f32 v44, v172
    v_mfma_f32_16x16x32_bf16 v[140:143], a[228:231], v[116:119], v[140:143]
    v_exp_f32 v45, v173
    v_mfma_f32_16x16x32_bf16 v[140:143], a[232:235], v[120:123], v[140:143]
    ds_read_b64_tr_b16 a[132:133], v35 offset:32768
    v_mfma_f32_16x16x32_bf16 v[140:143], a[236:239], v[124:127], v[140:143]
    s_waitcnt lgkmcnt(5)
    s_add_u32 m0, s42, 147456
    ds_read_b64_tr_b16 a[134:135], v35 offset:33792
    v_cvt_pk_bf16_f32 v220, v44, v45
    v_mfma_f32_16x16x32_bf16 a[48:51], a[140:143], v[192:195], a[48:51]
    buffer_load_dwordx4 v38, s[8:11], s48 offen offset:1024 sc1 lds
    v_exp_f32 v46, v174
    v_mfma_f32_16x16x32_bf16 a[52:55], a[140:143], v[196:199], a[52:55]
    s_add_u32 m0, s42, 147456
    v_exp_f32 v47, v175
    v_mfma_f32_16x16x32_bf16 a[56:59], a[140:143], v[200:203], a[56:59]
    buffer_load_dwordx4 v38, s[8:11], s48 offen offset:2048 sc1 lds
    v_mfma_f32_16x16x32_bf16 a[60:63], a[140:143], v[204:207], a[60:63]
    s_add_u32 m0, s42, 147456
    v_cvt_pk_bf16_f32 v221, v46, v47
    v_mfma_f32_16x16x32_bf16 v[232:235], v[40:43], v[200:203], v[232:235]
    s_waitcnt lgkmcnt(4)
    buffer_load_dwordx4 v38, s[8:11], s48 offen offset:3072 sc1 lds
    v_mfma_f32_16x16x32_bf16 v[144:147], a[240:243], v[64:67], v[48:51]
    s_lshl_b32 s48, s73, 2
    v_exp_f32 v44, v176
    v_mfma_f32_16x16x32_bf16 v[144:147], a[244:247], v[68:71], v[144:147]
    v_exp_f32 v45, v177
    v_mfma_f32_16x16x32_bf16 v[144:147], a[248:251], v[72:75], v[144:147]
    ds_read_b64_tr_b16 a[136:137], v36 offset:32768
    v_mfma_f32_16x16x32_bf16 v[144:147], a[252:255], v[76:79], v[144:147]
    s_waitcnt lgkmcnt(3)
    s_add_u32 m0, s42, 98304
    ds_read_b64_tr_b16 a[138:139], v36 offset:33792
    v_cvt_pk_bf16_f32 v210, v44, v45
    v_mfma_f32_16x16x32_bf16 a[64:67], a[128:131], v[192:195], a[64:67]
    buffer_load_dwordx4 v38, s[8:11], s48 offen offset:0 sc1 lds
    v_exp_f32 v46, v178
    v_mfma_f32_16x16x32_bf16 a[68:71], a[128:131], v[196:199], a[68:71]
    v_exp_f32 v47, v179
    v_mfma_f32_16x16x32_bf16 a[72:75], a[128:131], v[200:203], a[72:75]
    ds_read_b128 a[224:227], v26 offset:18432
    v_mfma_f32_16x16x32_bf16 a[76:79], a[128:131], v[204:207], a[76:79]
    s_add_u32 m0, s42, 98304
    ds_read_b128 a[228:231], v27 offset:18432
    v_cvt_pk_bf16_f32 v211, v46, v47
    v_mfma_f32_16x16x32_bf16 v[148:151], a[240:243], v[80:83], v[52:55]
    s_add_u32 s51, s51, 16384
    buffer_load_dwordx4 v38, s[8:11], s48 offen offset:1024 sc1 lds
    v_exp_f32 v44, v180
    v_mfma_f32_16x16x32_bf16 v[148:151], a[244:247], v[84:87], v[148:151]
    v_exp_f32 v45, v181
    v_mfma_f32_16x16x32_bf16 v[148:151], a[248:251], v[88:91], v[148:151]
    ds_read_b64_tr_b16 a[140:141], v37 offset:32768
    v_mfma_f32_16x16x32_bf16 v[148:151], a[252:255], v[92:95], v[148:151]
    s_add_u32 m0, s42, 98304
    ds_read_b64_tr_b16 a[142:143], v37 offset:33792
    v_cvt_pk_bf16_f32 v214, v44, v45
    v_mfma_f32_16x16x32_bf16 v[236:239], v[40:43], v[204:207], v[236:239]
    s_waitcnt lgkmcnt(6)
    buffer_load_dwordx4 v38, s[8:11], s48 offen offset:2048 sc1 lds
    v_mfma_f32_16x16x32_bf16 a[80:83], a[132:135], v[192:195], a[80:83]
    v_exp_f32 v46, v182
    v_mfma_f32_16x16x32_bf16 a[84:87], a[132:135], v[196:199], a[84:87]
    v_exp_f32 v47, v183
    v_mfma_f32_16x16x32_bf16 a[88:91], a[132:135], v[200:203], a[88:91]
    ds_read_b128 a[232:235], v28 offset:18432
    v_mfma_f32_16x16x32_bf16 a[92:95], a[132:135], v[204:207], a[92:95]
    s_add_u32 m0, s42, 98304
    ds_read_b128 a[236:239], v29 offset:18432
    v_cvt_pk_bf16_f32 v215, v46, v47
    v_mfma_f32_16x16x32_bf16 v[152:155], a[240:243], v[96:99], v[56:59]
    buffer_load_dwordx4 v38, s[8:11], s48 offen offset:3072 sc1 lds
    v_exp_f32 v44, v184
    v_mfma_f32_16x16x32_bf16 v[152:155], a[244:247], v[100:103], v[152:155]
    s_lshl_b32 s48, s70, 2
    v_exp_f32 v45, v185
    v_mfma_f32_16x16x32_bf16 v[152:155], a[248:251], v[104:107], v[152:155]
    ds_read_b64_tr_b16 a[128:129], v30 offset:34816
    v_mfma_f32_16x16x32_bf16 v[152:155], a[252:255], v[108:111], v[152:155]
    s_waitcnt lgkmcnt(7)
    ds_read_b64_tr_b16 a[130:131], v30 offset:35840
    v_cvt_pk_bf16_f32 v218, v44, v45
    v_mfma_f32_16x16x32_bf16 a[96:99], a[136:139], v[192:195], a[96:99]
    v_exp_f32 v46, v186
    v_mfma_f32_16x16x32_bf16 a[100:103], a[136:139], v[196:199], a[100:103]
    s_add_u32 m0, s42, 0
    v_exp_f32 v47, v187
    v_mfma_f32_16x16x32_bf16 a[104:107], a[136:139], v[200:203], a[104:107]
    buffer_load_dwordx4 v38, s[8:11], s48 offen offset:0 sc1 lds
    v_mfma_f32_16x16x32_bf16 a[108:111], a[136:139], v[204:207], a[108:111]
    v_cvt_pk_bf16_f32 v219, v46, v47
    v_mfma_f32_16x16x32_bf16 v[156:159], a[240:243], v[112:115], v[60:63]
    v_exp_f32 v44, v188
    v_mfma_f32_16x16x32_bf16 v[156:159], a[244:247], v[116:119], v[156:159]
    v_exp_f32 v45, v189
    v_mfma_f32_16x16x32_bf16 v[156:159], a[248:251], v[120:123], v[156:159]
    ds_read_b64_tr_b16 a[132:133], v31 offset:34816
    v_mfma_f32_16x16x32_bf16 v[156:159], a[252:255], v[124:127], v[156:159]
    s_waitcnt lgkmcnt(5)
    s_add_u32 m0, s42, 0
    ds_read_b64_tr_b16 a[134:135], v31 offset:35840
    v_cvt_pk_bf16_f32 v222, v44, v45
    v_mfma_f32_16x16x32_bf16 a[112:115], a[140:143], v[192:195], a[112:115]
    buffer_load_dwordx4 v38, s[8:11], s48 offen offset:1024 sc1 lds
    v_exp_f32 v46, v190
    v_mfma_f32_16x16x32_bf16 a[116:119], a[140:143], v[196:199], a[116:119]
    s_add_u32 m0, s42, 0
    v_exp_f32 v47, v191
    v_mfma_f32_16x16x32_bf16 a[120:123], a[140:143], v[200:203], a[120:123]
    buffer_load_dwordx4 v38, s[8:11], s48 offen offset:2048 sc1 lds
    v_mfma_f32_16x16x32_bf16 a[124:127], a[140:143], v[204:207], a[124:127]
    s_waitcnt lgkmcnt(4)
    v_cvt_pk_bf16_f32 v223, v46, v47
    v_mfma_f32_16x16x32_bf16 v[160:163], a[224:227], v[64:67], v[48:51]
    v_exp_f32 v44, v128
    v_mfma_f32_16x16x32_bf16 v[160:163], a[228:231], v[68:71], v[160:163]
    v_exp_f32 v45, v129
    v_mfma_f32_16x16x32_bf16 v[160:163], a[232:235], v[72:75], v[160:163]
    ds_read_b64_tr_b16 a[136:137], v32 offset:34816
    v_mfma_f32_16x16x32_bf16 v[160:163], a[236:239], v[76:79], v[160:163]
    s_waitcnt lgkmcnt(3)
    s_add_u32 m0, s42, 0
    ds_read_b64_tr_b16 a[138:139], v32 offset:35840
    v_cvt_pk_bf16_f32 v192, v44, v45
    v_mfma_f32_16x16x32_bf16 a[0:3], a[128:131], v[208:211], a[0:3]
    buffer_load_dwordx4 v38, s[8:11], s48 offen offset:3072 sc1 lds
    v_exp_f32 v46, v130
    v_mfma_f32_16x16x32_bf16 a[4:7], a[128:131], v[212:215], a[4:7]
    v_exp_f32 v47, v131
    v_mfma_f32_16x16x32_bf16 a[8:11], a[128:131], v[216:219], a[8:11]
    ds_read_b128 a[240:243], v26 offset:19456
    v_mfma_f32_16x16x32_bf16 a[12:15], a[128:131], v[220:223], a[12:15]
    ds_read_b128 a[244:247], v27 offset:19456
    v_cvt_pk_bf16_f32 v193, v46, v47
    v_mfma_f32_16x16x32_bf16 v[164:167], a[224:227], v[80:83], v[52:55]
    v_exp_f32 v44, v132
    v_mfma_f32_16x16x32_bf16 v[164:167], a[228:231], v[84:87], v[164:167]
    v_exp_f32 v45, v133
    v_mfma_f32_16x16x32_bf16 v[164:167], a[232:235], v[88:91], v[164:167]
    ds_read_b64_tr_b16 a[140:141], v33 offset:34816
    v_mfma_f32_16x16x32_bf16 v[164:167], a[236:239], v[92:95], v[164:167]
    s_waitcnt lgkmcnt(5)
    ds_read_b64_tr_b16 a[142:143], v33 offset:35840
    v_cvt_pk_bf16_f32 v196, v44, v45
    v_mfma_f32_16x16x32_bf16 a[16:19], a[132:135], v[208:211], a[16:19]
    v_exp_f32 v46, v134
    v_mfma_f32_16x16x32_bf16 a[20:23], a[132:135], v[212:215], a[20:23]
    v_exp_f32 v47, v135
    v_mfma_f32_16x16x32_bf16 a[24:27], a[132:135], v[216:219], a[24:27]
    ds_read_b128 a[248:251], v28 offset:19456
    v_mfma_f32_16x16x32_bf16 a[28:31], a[132:135], v[220:223], a[28:31]
    ds_read_b128 a[252:255], v29 offset:19456
    v_cvt_pk_bf16_f32 v197, v46, v47
    v_mfma_f32_16x16x32_bf16 v[168:171], a[224:227], v[96:99], v[56:59]
    v_exp_f32 v44, v136
    v_mfma_f32_16x16x32_bf16 v[168:171], a[228:231], v[100:103], v[168:171]
    v_exp_f32 v45, v137
    v_mfma_f32_16x16x32_bf16 v[168:171], a[232:235], v[104:107], v[168:171]
    ds_read_b64_tr_b16 a[128:129], v34 offset:34816
    v_mfma_f32_16x16x32_bf16 v[168:171], a[236:239], v[108:111], v[168:171]
    s_waitcnt lgkmcnt(7)
    ds_read_b64_tr_b16 a[130:131], v34 offset:35840
    v_cvt_pk_bf16_f32 v200, v44, v45
    v_mfma_f32_16x16x32_bf16 a[32:35], a[136:139], v[208:211], a[32:35]
    v_exp_f32 v46, v138
    v_mfma_f32_16x16x32_bf16 a[36:39], a[136:139], v[212:215], a[36:39]
    v_exp_f32 v47, v139
    v_mfma_f32_16x16x32_bf16 a[40:43], a[136:139], v[216:219], a[40:43]
    v_mfma_f32_16x16x32_bf16 a[44:47], a[136:139], v[220:223], a[44:47]
    v_cvt_pk_bf16_f32 v201, v46, v47
    v_mfma_f32_16x16x32_bf16 v[172:175], a[224:227], v[112:115], v[60:63]
    v_exp_f32 v44, v140
    v_mfma_f32_16x16x32_bf16 v[172:175], a[228:231], v[116:119], v[172:175]
    v_exp_f32 v45, v141
    v_mfma_f32_16x16x32_bf16 v[172:175], a[232:235], v[120:123], v[172:175]
    ds_read_b64_tr_b16 a[132:133], v35 offset:34816
    v_mfma_f32_16x16x32_bf16 v[172:175], a[236:239], v[124:127], v[172:175]
    s_waitcnt lgkmcnt(5)
    ds_read_b64_tr_b16 a[134:135], v35 offset:35840
    v_cvt_pk_bf16_f32 v204, v44, v45
    v_mfma_f32_16x16x32_bf16 a[48:51], a[140:143], v[208:211], a[48:51]
    v_exp_f32 v46, v142
    v_mfma_f32_16x16x32_bf16 a[52:55], a[140:143], v[212:215], a[52:55]
    v_exp_f32 v47, v143
    v_mfma_f32_16x16x32_bf16 a[56:59], a[140:143], v[216:219], a[56:59]
    v_mfma_f32_16x16x32_bf16 a[60:63], a[140:143], v[220:223], a[60:63]
    s_waitcnt lgkmcnt(4)
    v_cvt_pk_bf16_f32 v205, v46, v47
    v_mfma_f32_16x16x32_bf16 v[176:179], a[240:243], v[64:67], v[48:51]
    s_waitcnt vmcnt(17)
    v_exp_f32 v44, v144
    v_mfma_f32_16x16x32_bf16 v[176:179], a[244:247], v[68:71], v[176:179]
    s_barrier
    v_exp_f32 v45, v145
    v_mfma_f32_16x16x32_bf16 v[176:179], a[248:251], v[72:75], v[176:179]
    s_lshl_b32 s48, s73, 2
    ds_read_b64_tr_b16 a[136:137], v36 offset:34816
    v_mfma_f32_16x16x32_bf16 v[176:179], a[252:255], v[76:79], v[176:179]
    s_add_u32 s48, s48, 4096
    s_add_u32 m0, s42, 114688
    ds_read_b64_tr_b16 a[138:139], v36 offset:35840
    v_cvt_pk_bf16_f32 v194, v44, v45
    v_mfma_f32_16x16x32_bf16 v[224:227], v[40:43], v[208:211], v[224:227]
    s_waitcnt lgkmcnt(4)
    buffer_load_dwordx4 v38, s[8:11], s48 offen offset:0 sc1 lds
    v_mfma_f32_16x16x32_bf16 a[64:67], a[128:131], v[208:211], a[64:67]
    v_exp_f32 v46, v146
    v_mfma_f32_16x16x32_bf16 a[68:71], a[128:131], v[212:215], a[68:71]
    s_add_u32 m0, s42, 114688
    v_exp_f32 v47, v147
    v_mfma_f32_16x16x32_bf16 a[72:75], a[128:131], v[216:219], a[72:75]
    buffer_load_dwordx4 v38, s[8:11], s48 offen offset:1024 sc1 lds
    v_mfma_f32_16x16x32_bf16 a[76:79], a[128:131], v[220:223], a[76:79]
    s_add_u32 m0, s42, 114688
    v_cvt_pk_bf16_f32 v195, v46, v47
    v_mfma_f32_16x16x32_bf16 v[228:231], v[40:43], v[212:215], v[228:231]
    buffer_load_dwordx4 v38, s[8:11], s48 offen offset:2048 sc1 lds
    v_mfma_f32_16x16x32_bf16 v[180:183], a[240:243], v[80:83], v[52:55]
    s_add_u32 s52, s52, 16384
    v_exp_f32 v44, v148
    v_mfma_f32_16x16x32_bf16 v[180:183], a[244:247], v[84:87], v[180:183]
    v_exp_f32 v45, v149
    v_mfma_f32_16x16x32_bf16 v[180:183], a[248:251], v[88:91], v[180:183]
    ds_read_b64_tr_b16 a[140:141], v37 offset:34816
    v_mfma_f32_16x16x32_bf16 v[180:183], a[252:255], v[92:95], v[180:183]
    s_add_u32 m0, s42, 114688
    ds_read_b64_tr_b16 a[142:143], v37 offset:35840
    v_cvt_pk_bf16_f32 v198, v44, v45
    v_mfma_f32_16x16x32_bf16 v[232:235], v[40:43], v[216:219], v[232:235]
    s_waitcnt lgkmcnt(4)
    buffer_load_dwordx4 v38, s[8:11], s48 offen offset:3072 sc1 lds
    v_mfma_f32_16x16x32_bf16 a[80:83], a[132:135], v[208:211], a[80:83]
    s_lshl_b32 s48, s70, 2
    v_exp_f32 v46, v150
    v_mfma_f32_16x16x32_bf16 a[84:87], a[132:135], v[212:215], a[84:87]
    s_add_u32 s48, s48, 4096
    s_add_u32 m0, s42, 16384
    v_exp_f32 v47, v151
    v_mfma_f32_16x16x32_bf16 a[88:91], a[132:135], v[216:219], a[88:91]
    buffer_load_dwordx4 v38, s[8:11], s48 offen offset:0 sc1 lds
    v_mfma_f32_16x16x32_bf16 a[92:95], a[132:135], v[220:223], a[92:95]
    s_add_u32 m0, s42, 16384
    v_cvt_pk_bf16_f32 v199, v46, v47
    v_mfma_f32_16x16x32_bf16 v[236:239], v[40:43], v[220:223], v[236:239]
    buffer_load_dwordx4 v38, s[8:11], s48 offen offset:1024 sc1 lds
    v_mfma_f32_16x16x32_bf16 v[184:187], a[240:243], v[96:99], v[56:59]
    v_exp_f32 v44, v152
    v_mfma_f32_16x16x32_bf16 v[184:187], a[244:247], v[100:103], v[184:187]
    v_exp_f32 v45, v153
    v_mfma_f32_16x16x32_bf16 v[184:187], a[248:251], v[104:107], v[184:187]
    ds_read_b64_tr_b16 a[128:129], v30 offset:49152
    v_mfma_f32_16x16x32_bf16 v[184:187], a[252:255], v[108:111], v[184:187]
    s_waitcnt lgkmcnt(3)
    s_add_u32 m0, s42, 16384
    ds_read_b64_tr_b16 a[130:131], v30 offset:50176
    v_cvt_pk_bf16_f32 v202, v44, v45
    v_mfma_f32_16x16x32_bf16 a[96:99], a[136:139], v[208:211], a[96:99]
    buffer_load_dwordx4 v38, s[8:11], s48 offen offset:2048 sc1 lds
    v_exp_f32 v46, v154
    v_mfma_f32_16x16x32_bf16 a[100:103], a[136:139], v[212:215], a[100:103]
    s_add_u32 m0, s42, 16384
    v_exp_f32 v47, v155
    v_mfma_f32_16x16x32_bf16 a[104:107], a[136:139], v[216:219], a[104:107]
    buffer_load_dwordx4 v38, s[8:11], s48 offen offset:3072 sc1 lds
    v_mfma_f32_16x16x32_bf16 a[108:111], a[136:139], v[220:223], a[108:111]
    v_cvt_pk_bf16_f32 v203, v46, v47
    v_mfma_f32_16x16x32_bf16 v[188:191], a[240:243], v[112:115], v[60:63]
    v_exp_f32 v44, v156
    v_mfma_f32_16x16x32_bf16 v[188:191], a[244:247], v[116:119], v[188:191]
    v_exp_f32 v45, v157
    v_mfma_f32_16x16x32_bf16 v[188:191], a[248:251], v[120:123], v[188:191]
    ds_read_b64_tr_b16 a[132:133], v31 offset:49152
    v_mfma_f32_16x16x32_bf16 v[188:191], a[252:255], v[124:127], v[188:191]
    s_waitcnt lgkmcnt(3)
    ds_read_b64_tr_b16 a[134:135], v31 offset:50176
    v_cvt_pk_bf16_f32 v206, v44, v45
    v_mfma_f32_16x16x32_bf16 a[112:115], a[140:143], v[208:211], a[112:115]
    v_exp_f32 v46, v158
    v_mfma_f32_16x16x32_bf16 a[116:119], a[140:143], v[212:215], a[116:119]
    v_exp_f32 v47, v159
    v_mfma_f32_16x16x32_bf16 a[120:123], a[140:143], v[216:219], a[120:123]
    v_mfma_f32_16x16x32_bf16 a[124:127], a[140:143], v[220:223], a[124:127]
    s_waitcnt lgkmcnt(2)
    v_cvt_pk_bf16_f32 v207, v46, v47
    v_mfma_f32_16x16x32_bf16 a[0:3], a[128:131], v[192:195], a[0:3]
    s_lshl_b32 s48, s66, 2
    s_add_u32 s48, s48, 4096
    ds_read_b64_tr_b16 a[136:137], v32 offset:49152
    ds_read_b64_tr_b16 a[138:139], v32 offset:50176
    v_exp_f32 v44, v160
    v_mfma_f32_16x16x32_bf16 a[4:7], a[128:131], v[196:199], a[4:7]
    buffer_load_dwordx4 a[224:227], v38, s[8:11], s48 offen offset:0 sc1
    v_exp_f32 v45, v161
    v_mfma_f32_16x16x32_bf16 a[8:11], a[128:131], v[200:203], a[8:11]
    v_cvt_pk_bf16_f32 v208, v44, v45
    v_exp_f32 v46, v162
    v_mfma_f32_16x16x32_bf16 a[12:15], a[128:131], v[204:207], a[12:15]
    s_waitcnt lgkmcnt(2)
    buffer_load_dwordx4 a[228:231], v38, s[8:11], s48 offen offset:1024 sc1
    v_exp_f32 v47, v163
    v_mfma_f32_16x16x32_bf16 a[16:19], a[132:135], v[192:195], a[16:19]
    ds_read_b64_tr_b16 a[140:141], v33 offset:49152
    ds_read_b64_tr_b16 a[142:143], v33 offset:50176
    v_cvt_pk_bf16_f32 v209, v46, v47
    v_mfma_f32_16x16x32_bf16 a[20:23], a[132:135], v[196:199], a[20:23]
    v_exp_f32 v44, v164
    v_exp_f32 v45, v165
    v_mfma_f32_16x16x32_bf16 a[24:27], a[132:135], v[200:203], a[24:27]
    v_cvt_pk_bf16_f32 v212, v44, v45
    v_exp_f32 v46, v166
    v_mfma_f32_16x16x32_bf16 a[28:31], a[132:135], v[204:207], a[28:31]
    s_waitcnt lgkmcnt(2)
    buffer_load_dwordx4 a[232:235], v38, s[8:11], s48 offen offset:2048 sc1
    v_exp_f32 v47, v167
    v_mfma_f32_16x16x32_bf16 a[32:35], a[136:139], v[192:195], a[32:35]
    ds_read_b64_tr_b16 a[128:129], v34 offset:49152
    ds_read_b64_tr_b16 a[130:131], v34 offset:50176
    v_cvt_pk_bf16_f32 v213, v46, v47
    v_mfma_f32_16x16x32_bf16 a[36:39], a[136:139], v[196:199], a[36:39]
    v_exp_f32 v44, v168
    v_exp_f32 v45, v169
    v_mfma_f32_16x16x32_bf16 a[40:43], a[136:139], v[200:203], a[40:43]
    v_cvt_pk_bf16_f32 v216, v44, v45
    v_exp_f32 v46, v170
    v_mfma_f32_16x16x32_bf16 a[44:47], a[136:139], v[204:207], a[44:47]
    s_waitcnt lgkmcnt(2)
    buffer_load_dwordx4 a[236:239], v38, s[8:11], s48 offen offset:3072 sc1
    v_exp_f32 v47, v171
    v_mfma_f32_16x16x32_bf16 a[48:51], a[140:143], v[192:195], a[48:51]
    ds_read_b64_tr_b16 a[132:133], v35 offset:49152
    ds_read_b64_tr_b16 a[134:135], v35 offset:50176
    v_cvt_pk_bf16_f32 v217, v46, v47
    v_mfma_f32_16x16x32_bf16 a[52:55], a[140:143], v[196:199], a[52:55]
    v_exp_f32 v44, v172
    v_exp_f32 v45, v173
    v_mfma_f32_16x16x32_bf16 a[56:59], a[140:143], v[200:203], a[56:59]
    s_lshl_b32 s48, s67, 2
    v_cvt_pk_bf16_f32 v220, v44, v45
    v_exp_f32 v46, v174
    v_mfma_f32_16x16x32_bf16 a[60:63], a[140:143], v[204:207], a[60:63]
    s_waitcnt lgkmcnt(2)
    buffer_load_dwordx4 a[240:243], v38, s[8:11], s48 offen offset:0 sc1
    v_exp_f32 v47, v175
    v_mfma_f32_16x16x32_bf16 a[64:67], a[128:131], v[192:195], a[64:67]
    ds_read_b64_tr_b16 a[136:137], v36 offset:49152
    ds_read_b64_tr_b16 a[138:139], v36 offset:50176
    v_cvt_pk_bf16_f32 v221, v46, v47
    v_mfma_f32_16x16x32_bf16 a[68:71], a[128:131], v[196:199], a[68:71]
    v_exp_f32 v44, v176
    v_exp_f32 v45, v177
    v_mfma_f32_16x16x32_bf16 a[72:75], a[128:131], v[200:203], a[72:75]
    buffer_load_dwordx4 a[244:247], v38, s[8:11], s48 offen offset:1024 sc1
    v_cvt_pk_bf16_f32 v210, v44, v45
    v_mfma_f32_16x16x32_bf16 a[76:79], a[128:131], v[204:207], a[76:79]
    s_waitcnt lgkmcnt(2)
    v_exp_f32 v46, v178
    v_exp_f32 v47, v179
    v_mfma_f32_16x16x32_bf16 a[80:83], a[132:135], v[192:195], a[80:83]
    ds_read_b64_tr_b16 a[140:141], v37 offset:49152
    ds_read_b64_tr_b16 a[142:143], v37 offset:50176
    v_cvt_pk_bf16_f32 v211, v46, v47
    v_mfma_f32_16x16x32_bf16 a[84:87], a[132:135], v[196:199], a[84:87]
    v_exp_f32 v44, v180
    v_exp_f32 v45, v181
    v_mfma_f32_16x16x32_bf16 a[88:91], a[132:135], v[200:203], a[88:91]
    buffer_load_dwordx4 a[248:251], v38, s[8:11], s48 offen offset:2048 sc1
    v_cvt_pk_bf16_f32 v214, v44, v45
    v_mfma_f32_16x16x32_bf16 a[92:95], a[132:135], v[204:207], a[92:95]
    s_waitcnt lgkmcnt(2)
    v_exp_f32 v46, v182
    v_exp_f32 v47, v183
    v_mfma_f32_16x16x32_bf16 a[96:99], a[136:139], v[192:195], a[96:99]
    ds_read_b64_tr_b16 a[128:129], v30 offset:51200
    ds_read_b64_tr_b16 a[130:131], v30 offset:52224
    v_cvt_pk_bf16_f32 v215, v46, v47
    v_mfma_f32_16x16x32_bf16 a[100:103], a[136:139], v[196:199], a[100:103]
    v_exp_f32 v44, v184
    v_exp_f32 v45, v185
    v_mfma_f32_16x16x32_bf16 a[104:107], a[136:139], v[200:203], a[104:107]
    buffer_load_dwordx4 a[252:255], v38, s[8:11], s48 offen offset:3072 sc1
    v_cvt_pk_bf16_f32 v218, v44, v45
    v_mfma_f32_16x16x32_bf16 a[108:111], a[136:139], v[204:207], a[108:111]
    s_waitcnt lgkmcnt(2)
    v_exp_f32 v46, v186
    v_exp_f32 v47, v187
    v_mfma_f32_16x16x32_bf16 a[112:115], a[140:143], v[192:195], a[112:115]
    ds_read_b64_tr_b16 a[132:133], v31 offset:51200
    ds_read_b64_tr_b16 a[134:135], v31 offset:52224
    v_cvt_pk_bf16_f32 v219, v46, v47
    v_mfma_f32_16x16x32_bf16 a[116:119], a[140:143], v[196:199], a[116:119]
    v_exp_f32 v44, v188
    v_exp_f32 v45, v189
    v_mfma_f32_16x16x32_bf16 a[120:123], a[140:143], v[200:203], a[120:123]
    v_cvt_pk_bf16_f32 v222, v44, v45
    v_mfma_f32_16x16x32_bf16 a[124:127], a[140:143], v[204:207], a[124:127]
    v_exp_f32 v46, v190
    v_exp_f32 v47, v191
    v_mfma_f32_16x16x32_bf16 v[224:227], v[40:43], v[192:195], v[224:227]
    v_cvt_pk_bf16_f32 v223, v46, v47
    v_mfma_f32_16x16x32_bf16 v[228:231], v[40:43], v[196:199], v[228:231]
    v_mfma_f32_16x16x32_bf16 v[232:235], v[40:43], v[200:203], v[232:235]
    buffer_load_dword v23, v21, s[60:63], s40 offen sc1
    v_mfma_f32_16x16x32_bf16 v[236:239], v[40:43], v[204:207], v[236:239]
    s_waitcnt lgkmcnt(2)
    v_mfma_f32_16x16x32_bf16 v[224:227], v[40:43], v[208:211], v[224:227]
    v_mfma_f32_16x16x32_bf16 v[228:231], v[40:43], v[212:215], v[228:231]
    v_mfma_f32_16x16x32_bf16 v[232:235], v[40:43], v[216:219], v[232:235]
    v_mfma_f32_16x16x32_bf16 v[236:239], v[40:43], v[220:223], v[236:239]
    v_mfma_f32_16x16x32_bf16 a[0:3], a[128:131], v[208:211], a[0:3]
    ds_read_b64_tr_b16 a[136:137], v32 offset:51200
    v_mfma_f32_16x16x32_bf16 a[4:7], a[128:131], v[212:215], a[4:7]
    ds_read_b64_tr_b16 a[138:139], v32 offset:52224
    v_mfma_f32_16x16x32_bf16 a[8:11], a[128:131], v[216:219], a[8:11]
    v_mfma_f32_16x16x32_bf16 a[12:15], a[128:131], v[220:223], a[12:15]
    s_waitcnt lgkmcnt(2)
    v_mfma_f32_16x16x32_bf16 a[16:19], a[132:135], v[208:211], a[16:19]
    ds_read_b64_tr_b16 a[140:141], v33 offset:51200
    v_add_f32 v9, v224, v228
    v_add_f32 v9, v9, v232
    v_add_f32 v9, v9, v236
    v_cmp_ngt_f32 vcc, 0x53800000, v9
    s_cbranch_vccnz L_slow
    v_mfma_f32_16x16x32_bf16 a[20:23], a[132:135], v[212:215], a[20:23]
    s_lshl_b32 s48, s67, 2
    s_add_u32 s48, s48, 4096
    ds_read_b64_tr_b16 a[142:143], v33 offset:52224
    v_mfma_f32_16x16x32_bf16 a[24:27], a[132:135], v[216:219], a[24:27]
    buffer_load_dwordx4 v[64:67], v38, s[8:11], s48 offen offset:0 sc1
    v_mfma_f32_16x16x32_bf16 a[28:31], a[132:135], v[220:223], a[28:31]
    s_waitcnt lgkmcnt(2)
    v_mfma_f32_16x16x32_bf16 a[32:35], a[136:139], v[208:211], a[32:35]
    ds_read_b64_tr_b16 a[128:129], v34 offset:51200
    v_mfma_f32_16x16x32_bf16 a[36:39], a[136:139], v[212:215], a[36:39]
    ds_read_b64_tr_b16 a[130:131], v34 offset:52224
    v_mfma_f32_16x16x32_bf16 a[40:43], a[136:139], v[216:219], a[40:43]
    buffer_load_dwordx4 v[68:71], v38, s[8:11], s48 offen offset:1024 sc1
    v_mfma_f32_16x16x32_bf16 a[44:47], a[136:139], v[220:223], a[44:47]
    s_waitcnt lgkmcnt(2)
    v_mfma_f32_16x16x32_bf16 a[48:51], a[140:143], v[208:211], a[48:51]
    ds_read_b64_tr_b16 a[132:133], v35 offset:51200
    v_mfma_f32_16x16x32_bf16 a[52:55], a[140:143], v[212:215], a[52:55]
    ds_read_b64_tr_b16 a[134:135], v35 offset:52224
    v_mfma_f32_16x16x32_bf16 a[56:59], a[140:143], v[216:219], a[56:59]
    buffer_load_dwordx4 v[72:75], v38, s[8:11], s48 offen offset:2048 sc1
    v_mfma_f32_16x16x32_bf16 a[60:63], a[140:143], v[220:223], a[60:63]
    s_waitcnt lgkmcnt(2)
    v_mfma_f32_16x16x32_bf16 a[64:67], a[128:131], v[208:211], a[64:67]
    ds_read_b64_tr_b16 a[136:137], v36 offset:51200
    v_mfma_f32_16x16x32_bf16 a[68:71], a[128:131], v[212:215], a[68:71]
    ds_read_b64_tr_b16 a[138:139], v36 offset:52224
    v_mfma_f32_16x16x32_bf16 a[72:75], a[128:131], v[216:219], a[72:75]
    buffer_load_dwordx4 v[76:79], v38, s[8:11], s48 offen offset:3072 sc1
    v_mfma_f32_16x16x32_bf16 a[76:79], a[128:131], v[220:223], a[76:79]
    s_waitcnt lgkmcnt(2)
    v_mfma_f32_16x16x32_bf16 a[80:83], a[132:135], v[208:211], a[80:83]
    ds_read_b64_tr_b16 a[140:141], v37 offset:51200
    v_mfma_f32_16x16x32_bf16 a[84:87], a[132:135], v[212:215], a[84:87]
    s_lshl_b32 s48, s69, 2
    ds_read_b64_tr_b16 a[142:143], v37 offset:52224
    v_mfma_f32_16x16x32_bf16 a[88:91], a[132:135], v[216:219], a[88:91]
    buffer_load_dwordx4 v[80:83], v38, s[8:11], s48 offen offset:0 sc1
    v_mfma_f32_16x16x32_bf16 a[92:95], a[132:135], v[220:223], a[92:95]
    s_waitcnt lgkmcnt(2)
    v_mfma_f32_16x16x32_bf16 a[96:99], a[136:139], v[208:211], a[96:99]
    buffer_load_dwordx4 v[84:87], v38, s[8:11], s48 offen offset:1024 sc1
    v_mfma_f32_16x16x32_bf16 a[100:103], a[136:139], v[212:215], a[100:103]
    v_mfma_f32_16x16x32_bf16 a[104:107], a[136:139], v[216:219], a[104:107]
    buffer_load_dwordx4 v[88:91], v38, s[8:11], s48 offen offset:2048 sc1
    v_mfma_f32_16x16x32_bf16 a[108:111], a[136:139], v[220:223], a[108:111]
    s_waitcnt lgkmcnt(0)
    v_mfma_f32_16x16x32_bf16 a[112:115], a[140:143], v[208:211], a[112:115]
    buffer_load_dwordx4 v[92:95], v38, s[8:11], s48 offen offset:3072 sc1
    v_mfma_f32_16x16x32_bf16 a[116:119], a[140:143], v[212:215], a[116:119]
    v_mfma_f32_16x16x32_bf16 a[120:123], a[140:143], v[216:219], a[120:123]
    v_mfma_f32_16x16x32_bf16 a[124:127], a[140:143], v[220:223], a[124:127]
    s_mov_b32 s53, 0
L_slow_done:
    v_add_u32 v28, s47, v38
    v_add_u32 v29, 131072, v28
    v_add_u32 v30, 262144, v28
    v_add_u32 v31, 393216, v28
    v_mov_b32 v26, v38
    s_waitcnt vmcnt(8)
    v_cmp_eq_u32 vcc, 0, v23
    s_and_b32 s49, vcc_lo, 0xff
    s_mov_b32 s50, s49
    s_cbranch_scc1 L_skip0
    buffer_load_dwordx4 v[48:51], v28, s[28:31], s64 offen offset:0 sc1
    buffer_load_dwordx4 v[52:55], v29, s[28:31], s64 offen offset:0 sc1
    buffer_load_dwordx4 v[56:59], v30, s[28:31], s64 offen offset:0 sc1
    buffer_load_dwordx4 v[60:63], v31, s[28:31], s64 offen offset:0 sc1
    buffer_load_dwordx4 v[192:195], v28, s[28:31], s64 offen offset:1024 sc1
    buffer_load_dwordx4 v[196:199], v29, s[28:31], s64 offen offset:1024 sc1
    buffer_load_dwordx4 v[200:203], v30, s[28:31], s64 offen offset:1024 sc1
    buffer_load_dwordx4 v[204:207], v31, s[28:31], s64 offen offset:1024 sc1
L_skip0:
    v_rcp_f32 v40, v224
    v_rcp_f32 v41, v224
    v_rcp_f32 v42, v228
    v_rcp_f32 v43, v228
    v_rcp_f32 v44, v232
    v_rcp_f32 v45, v232
    v_rcp_f32 v46, v236
    v_rcp_f32 v47, v236
    s_lshl_b32 s49, s37, 12
    s_lshl_b32 s54, s54, 17
    s_add_u32 s54, s54, s49
    s_lshl_b32 s55, s55, 17
    s_add_u32 s55, s55, s49
    s_lshl_b32 s56, s56, 17
    s_add_u32 s56, s56, s49
    s_lshl_b32 s57, s57, 17
    s_add_u32 s57, s57, s49
    v_accvgpr_read_b32 v128, a0
    v_accvgpr_read_b32 v129, a1
    v_accvgpr_read_b32 v130, a2
    v_accvgpr_read_b32 v131, a3
    v_accvgpr_read_b32 v132, a16
    v_accvgpr_read_b32 v133, a17
    v_accvgpr_read_b32 v134, a18
    v_accvgpr_read_b32 v135, a19
    v_pk_mul_f32 v[128:129], v[128:129], v[40:41]
    v_pk_mul_f32 v[130:131], v[130:131], v[40:41]
    v_pk_mul_f32 v[132:133], v[132:133], v[40:41]
    v_pk_mul_f32 v[134:135], v[134:135], v[40:41]
    v_cvt_pk_bf16_f32 v160, v128, v129
    v_cvt_pk_bf16_f32 v161, v130, v131
    v_cvt_pk_bf16_f32 v162, v132, v133
    v_cvt_pk_bf16_f32 v163, v134, v135
    buffer_store_dwordx4 v[160:163], v38, s[28:31], s54 offen offset:0 sc1
    v_accvgpr_read_b32 v136, a4
    v_accvgpr_read_b32 v137, a5
    v_accvgpr_read_b32 v138, a6
    v_accvgpr_read_b32 v139, a7
    v_accvgpr_read_b32 v140, a20
    v_accvgpr_read_b32 v141, a21
    v_accvgpr_read_b32 v142, a22
    v_accvgpr_read_b32 v143, a23
    v_pk_mul_f32 v[136:137], v[136:137], v[42:43]
    v_pk_mul_f32 v[138:139], v[138:139], v[42:43]
    v_pk_mul_f32 v[140:141], v[140:141], v[42:43]
    v_pk_mul_f32 v[142:143], v[142:143], v[42:43]
    v_cvt_pk_bf16_f32 v164, v136, v137
    v_cvt_pk_bf16_f32 v165, v138, v139
    v_cvt_pk_bf16_f32 v166, v140, v141
    v_cvt_pk_bf16_f32 v167, v142, v143
    buffer_store_dwordx4 v[164:167], v38, s[28:31], s55 offen offset:0 sc1
    v_accvgpr_read_b32 v144, a8
    v_accvgpr_read_b32 v145, a9
    v_accvgpr_read_b32 v146, a10
    v_accvgpr_read_b32 v147, a11
    v_accvgpr_read_b32 v148, a24
    v_accvgpr_read_b32 v149, a25
    v_accvgpr_read_b32 v150, a26
    v_accvgpr_read_b32 v151, a27
    v_pk_mul_f32 v[144:145], v[144:145], v[44:45]
    v_pk_mul_f32 v[146:147], v[146:147], v[44:45]
    v_pk_mul_f32 v[148:149], v[148:149], v[44:45]
    v_pk_mul_f32 v[150:151], v[150:151], v[44:45]
    v_cvt_pk_bf16_f32 v168, v144, v145
    v_cvt_pk_bf16_f32 v169, v146, v147
    v_cvt_pk_bf16_f32 v170, v148, v149
    v_cvt_pk_bf16_f32 v171, v150, v151
    buffer_store_dwordx4 v[168:171], v38, s[28:31], s56 offen offset:0 sc1
    v_accvgpr_read_b32 v152, a12
    v_accvgpr_read_b32 v153, a13
    v_accvgpr_read_b32 v154, a14
    v_accvgpr_read_b32 v155, a15
    v_accvgpr_read_b32 v156, a28
    v_accvgpr_read_b32 v157, a29
    v_accvgpr_read_b32 v158, a30
    v_accvgpr_read_b32 v159, a31
    v_pk_mul_f32 v[152:153], v[152:153], v[46:47]
    v_pk_mul_f32 v[154:155], v[154:155], v[46:47]
    v_pk_mul_f32 v[156:157], v[156:157], v[46:47]
    v_pk_mul_f32 v[158:159], v[158:159], v[46:47]
    v_cvt_pk_bf16_f32 v172, v152, v153
    v_cvt_pk_bf16_f32 v173, v154, v155
    v_cvt_pk_bf16_f32 v174, v156, v157
    v_cvt_pk_bf16_f32 v175, v158, v159
    buffer_store_dwordx4 v[172:175], v38, s[28:31], s57 offen offset:0 sc1
    v_accvgpr_read_b32 v128, a32
    v_accvgpr_read_b32 v129, a33
    v_accvgpr_read_b32 v130, a34
    v_accvgpr_read_b32 v131, a35
    v_accvgpr_read_b32 v132, a48
    v_accvgpr_read_b32 v133, a49
    v_accvgpr_read_b32 v134, a50
    v_accvgpr_read_b32 v135, a51
    v_pk_mul_f32 v[128:129], v[128:129], v[40:41]
    v_pk_mul_f32 v[130:131], v[130:131], v[40:41]
    v_pk_mul_f32 v[132:133], v[132:133], v[40:41]
    v_pk_mul_f32 v[134:135], v[134:135], v[40:41]
    v_cvt_pk_bf16_f32 v176, v128, v129
    v_cvt_pk_bf16_f32 v177, v130, v131
    v_cvt_pk_bf16_f32 v178, v132, v133
    v_cvt_pk_bf16_f32 v179, v134, v135
    buffer_store_dwordx4 v[176:179], v38, s[28:31], s54 offen offset:1024 sc1
    v_accvgpr_read_b32 v136, a36
    v_accvgpr_read_b32 v137, a37
    v_accvgpr_read_b32 v138, a38
    v_accvgpr_read_b32 v139, a39
    v_accvgpr_read_b32 v140, a52
    v_accvgpr_read_b32 v141, a53
    v_accvgpr_read_b32 v142, a54
    v_accvgpr_read_b32 v143, a55
    v_pk_mul_f32 v[136:137], v[136:137], v[42:43]
    v_pk_mul_f32 v[138:139], v[138:139], v[42:43]
    v_pk_mul_f32 v[140:141], v[140:141], v[42:43]
    v_pk_mul_f32 v[142:143], v[142:143], v[42:43]
    v_cvt_pk_bf16_f32 v180, v136, v137
    v_cvt_pk_bf16_f32 v181, v138, v139
    v_cvt_pk_bf16_f32 v182, v140, v141
    v_cvt_pk_bf16_f32 v183, v142, v143
    buffer_store_dwordx4 v[180:183], v38, s[28:31], s55 offen offset:1024 sc1
    v_accvgpr_read_b32 v144, a40
    v_accvgpr_read_b32 v145, a41
    v_accvgpr_read_b32 v146, a42
    v_accvgpr_read_b32 v147, a43
    v_accvgpr_read_b32 v148, a56
    v_accvgpr_read_b32 v149, a57
    v_accvgpr_read_b32 v150, a58
    v_accvgpr_read_b32 v151, a59
    v_pk_mul_f32 v[144:145], v[144:145], v[44:45]
    v_pk_mul_f32 v[146:147], v[146:147], v[44:45]
    v_pk_mul_f32 v[148:149], v[148:149], v[44:45]
    v_pk_mul_f32 v[150:151], v[150:151], v[44:45]
    v_cvt_pk_bf16_f32 v184, v144, v145
    v_cvt_pk_bf16_f32 v185, v146, v147
    v_cvt_pk_bf16_f32 v186, v148, v149
    v_cvt_pk_bf16_f32 v187, v150, v151
    buffer_store_dwordx4 v[184:187], v38, s[28:31], s56 offen offset:1024 sc1
    v_accvgpr_read_b32 v152, a44
    v_accvgpr_read_b32 v153, a45
    v_accvgpr_read_b32 v154, a46
    v_accvgpr_read_b32 v155, a47
    v_accvgpr_read_b32 v156, a60
    v_accvgpr_read_b32 v157, a61
    v_accvgpr_read_b32 v158, a62
    v_accvgpr_read_b32 v159, a63
    v_pk_mul_f32 v[152:153], v[152:153], v[46:47]
    v_pk_mul_f32 v[154:155], v[154:155], v[46:47]
    v_pk_mul_f32 v[156:157], v[156:157], v[46:47]
    v_pk_mul_f32 v[158:159], v[158:159], v[46:47]
    v_cvt_pk_bf16_f32 v188, v152, v153
    v_cvt_pk_bf16_f32 v189, v154, v155
    v_cvt_pk_bf16_f32 v190, v156, v157
    v_cvt_pk_bf16_f32 v191, v158, v159
    buffer_store_dwordx4 v[188:191], v38, s[28:31], s57 offen offset:1024 sc1
    v_accvgpr_read_b32 v128, a64
    v_accvgpr_read_b32 v129, a65
    v_accvgpr_read_b32 v130, a66
    v_accvgpr_read_b32 v131, a67
    v_accvgpr_read_b32 v132, a80
    v_accvgpr_read_b32 v133, a81
    v_accvgpr_read_b32 v134, a82
    v_accvgpr_read_b32 v135, a83
    v_pk_mul_f32 v[128:129], v[128:129], v[40:41]
    v_pk_mul_f32 v[130:131], v[130:131], v[40:41]
    v_pk_mul_f32 v[132:133], v[132:133], v[40:41]
    v_pk_mul_f32 v[134:135], v[134:135], v[40:41]
    v_cvt_pk_bf16_f32 v160, v128, v129
    v_cvt_pk_bf16_f32 v161, v130, v131
    v_cvt_pk_bf16_f32 v162, v132, v133
    v_cvt_pk_bf16_f32 v163, v134, v135
    buffer_store_dwordx4 v[160:163], v38, s[28:31], s54 offen offset:2048 sc1
    v_accvgpr_read_b32 v136, a68
    v_accvgpr_read_b32 v137, a69
    v_accvgpr_read_b32 v138, a70
    v_accvgpr_read_b32 v139, a71
    v_accvgpr_read_b32 v140, a84
    v_accvgpr_read_b32 v141, a85
    v_accvgpr_read_b32 v142, a86
    v_accvgpr_read_b32 v143, a87
    v_pk_mul_f32 v[136:137], v[136:137], v[42:43]
    v_pk_mul_f32 v[138:139], v[138:139], v[42:43]
    v_pk_mul_f32 v[140:141], v[140:141], v[42:43]
    v_pk_mul_f32 v[142:143], v[142:143], v[42:43]
    v_cvt_pk_bf16_f32 v164, v136, v137
    v_cvt_pk_bf16_f32 v165, v138, v139
    v_cvt_pk_bf16_f32 v166, v140, v141
    v_cvt_pk_bf16_f32 v167, v142, v143
    buffer_store_dwordx4 v[164:167], v38, s[28:31], s55 offen offset:2048 sc1
    v_accvgpr_read_b32 v144, a72
    v_accvgpr_read_b32 v145, a73
    v_accvgpr_read_b32 v146, a74
    v_accvgpr_read_b32 v147, a75
    v_accvgpr_read_b32 v148, a88
    v_accvgpr_read_b32 v149, a89
    v_accvgpr_read_b32 v150, a90
    v_accvgpr_read_b32 v151, a91
    v_pk_mul_f32 v[144:145], v[144:145], v[44:45]
    v_pk_mul_f32 v[146:147], v[146:147], v[44:45]
    v_pk_mul_f32 v[148:149], v[148:149], v[44:45]
    v_pk_mul_f32 v[150:151], v[150:151], v[44:45]
    v_cvt_pk_bf16_f32 v168, v144, v145
    v_cvt_pk_bf16_f32 v169, v146, v147
    v_cvt_pk_bf16_f32 v170, v148, v149
    v_cvt_pk_bf16_f32 v171, v150, v151
    buffer_store_dwordx4 v[168:171], v38, s[28:31], s56 offen offset:2048 sc1
    v_accvgpr_read_b32 v152, a76
    v_accvgpr_read_b32 v153, a77
    v_accvgpr_read_b32 v154, a78
    v_accvgpr_read_b32 v155, a79
    v_accvgpr_read_b32 v156, a92
    v_accvgpr_read_b32 v157, a93
    v_accvgpr_read_b32 v158, a94
    v_accvgpr_read_b32 v159, a95
    v_pk_mul_f32 v[152:153], v[152:153], v[46:47]
    v_pk_mul_f32 v[154:155], v[154:155], v[46:47]
    v_pk_mul_f32 v[156:157], v[156:157], v[46:47]
    v_pk_mul_f32 v[158:159], v[158:159], v[46:47]
    v_cvt_pk_bf16_f32 v172, v152, v153
    v_cvt_pk_bf16_f32 v173, v154, v155
    v_cvt_pk_bf16_f32 v174, v156, v157
    v_cvt_pk_bf16_f32 v175, v158, v159
    buffer_store_dwordx4 v[172:175], v38, s[28:31], s57 offen offset:2048 sc1
    v_accvgpr_read_b32 v128, a96
    v_accvgpr_read_b32 v129, a97
    v_accvgpr_read_b32 v130, a98
    v_accvgpr_read_b32 v131, a99
    v_accvgpr_read_b32 v132, a112
    v_accvgpr_read_b32 v133, a113
    v_accvgpr_read_b32 v134, a114
    v_accvgpr_read_b32 v135, a115
    v_pk_mul_f32 v[128:129], v[128:129], v[40:41]
    v_pk_mul_f32 v[130:131], v[130:131], v[40:41]
    v_pk_mul_f32 v[132:133], v[132:133], v[40:41]
    v_pk_mul_f32 v[134:135], v[134:135], v[40:41]
    v_cvt_pk_bf16_f32 v176, v128, v129
    v_cvt_pk_bf16_f32 v177, v130, v131
    v_cvt_pk_bf16_f32 v178, v132, v133
    v_cvt_pk_bf16_f32 v179, v134, v135
    buffer_store_dwordx4 v[176:179], v38, s[28:31], s54 offen offset:3072 sc1
    v_accvgpr_read_b32 v136, a100
    v_accvgpr_read_b32 v137, a101
    v_accvgpr_read_b32 v138, a102
    v_accvgpr_read_b32 v139, a103
    v_accvgpr_read_b32 v140, a116
    v_accvgpr_read_b32 v141, a117
    v_accvgpr_read_b32 v142, a118
    v_accvgpr_read_b32 v143, a119
    v_pk_mul_f32 v[136:137], v[136:137], v[42:43]
    v_pk_mul_f32 v[138:139], v[138:139], v[42:43]
    v_pk_mul_f32 v[140:141], v[140:141], v[42:43]
    v_pk_mul_f32 v[142:143], v[142:143], v[42:43]
    v_cvt_pk_bf16_f32 v180, v136, v137
    v_cvt_pk_bf16_f32 v181, v138, v139
    v_cvt_pk_bf16_f32 v182, v140, v141
    v_cvt_pk_bf16_f32 v183, v142, v143
    buffer_store_dwordx4 v[180:183], v38, s[28:31], s55 offen offset:3072 sc1
    v_accvgpr_read_b32 v144, a104
    v_accvgpr_read_b32 v145, a105
    v_accvgpr_read_b32 v146, a106
    v_accvgpr_read_b32 v147, a107
    v_accvgpr_read_b32 v148, a120
    v_accvgpr_read_b32 v149, a121
    v_accvgpr_read_b32 v150, a122
    v_accvgpr_read_b32 v151, a123
    v_pk_mul_f32 v[144:145], v[144:145], v[44:45]
    v_pk_mul_f32 v[146:147], v[146:147], v[44:45]
    v_pk_mul_f32 v[148:149], v[148:149], v[44:45]
    v_pk_mul_f32 v[150:151], v[150:151], v[44:45]
    v_cvt_pk_bf16_f32 v184, v144, v145
    v_cvt_pk_bf16_f32 v185, v146, v147
    v_cvt_pk_bf16_f32 v186, v148, v149
    v_cvt_pk_bf16_f32 v187, v150, v151
    buffer_store_dwordx4 v[184:187], v38, s[28:31], s56 offen offset:3072 sc1
    v_accvgpr_read_b32 v152, a108
    v_accvgpr_read_b32 v153, a109
    v_accvgpr_read_b32 v154, a110
    v_accvgpr_read_b32 v155, a111
    v_accvgpr_read_b32 v156, a124
    v_accvgpr_read_b32 v157, a125
    v_accvgpr_read_b32 v158, a126
    v_accvgpr_read_b32 v159, a127
    v_pk_mul_f32 v[152:153], v[152:153], v[46:47]
    v_pk_mul_f32 v[154:155], v[154:155], v[46:47]
    v_pk_mul_f32 v[156:157], v[156:157], v[46:47]
    v_pk_mul_f32 v[158:159], v[158:159], v[46:47]
    v_cvt_pk_bf16_f32 v188, v152, v153
    v_cvt_pk_bf16_f32 v189, v154, v155
    v_cvt_pk_bf16_f32 v190, v156, v157
    v_cvt_pk_bf16_f32 v191, v158, v159
    buffer_store_dwordx4 v[188:191], v38, s[28:31], s57 offen offset:3072 sc1
    v_lshlrev_b32 v27, 15, v0
    v_mul_f32 v128, 0xbfb8aa3b, v240
    v_mul_f32 v129, 0xbfb8aa3b, v241
    v_mul_f32 v130, 0xbfb8aa3b, v242
    v_mul_f32 v131, 0xbfb8aa3b, v243
    v_mul_f32 v132, 0xbfb8aa3b, v244
    v_mul_f32 v133, 0xbfb8aa3b, v245
    v_mul_f32 v134, 0xbfb8aa3b, v246
    v_mul_f32 v135, 0xbfb8aa3b, v247
    v_mul_f32 v136, 0xbfb8aa3b, v248
    v_mul_f32 v137, 0xbfb8aa3b, v249
    v_mul_f32 v138, 0xbfb8aa3b, v250
    v_mul_f32 v139, 0xbfb8aa3b, v251
    v_mul_f32 v140, 0xbfb8aa3b, v252
    v_mul_f32 v141, 0xbfb8aa3b, v253
    v_mul_f32 v142, 0xbfb8aa3b, v254
    v_mul_f32 v143, 0xbfb8aa3b, v255
    v_exp_f32 v128, v128
    v_exp_f32 v129, v129
    v_exp_f32 v130, v130
    v_exp_f32 v131, v131
    v_exp_f32 v132, v132
    v_exp_f32 v133, v133
    v_exp_f32 v134, v134
    v_exp_f32 v135, v135
    v_exp_f32 v136, v136
    v_exp_f32 v137, v137
    v_exp_f32 v138, v138
    v_exp_f32 v139, v139
    v_exp_f32 v140, v140
    v_exp_f32 v141, v141
    v_exp_f32 v142, v142
    v_exp_f32 v143, v143
    v_add_f32 v128, 1.0, v128
    v_add_f32 v129, 1.0, v129
    v_add_f32 v130, 1.0, v130
    v_add_f32 v131, 1.0, v131
    v_add_f32 v132, 1.0, v132
    v_add_f32 v133, 1.0, v133
    v_add_f32 v134, 1.0, v134
    v_add_f32 v135, 1.0, v135
    v_add_f32 v136, 1.0, v136
    v_add_f32 v137, 1.0, v137
    v_add_f32 v138, 1.0, v138
    v_add_f32 v139, 1.0, v139
    v_add_f32 v140, 1.0, v140
    v_add_f32 v141, 1.0, v141
    v_add_f32 v142, 1.0, v142
    v_add_f32 v143, 1.0, v143
    v_rcp_f32 v128, v128
    v_rcp_f32 v129, v129
    v_rcp_f32 v130, v130
    v_rcp_f32 v131, v131
    v_rcp_f32 v132, v132
    v_rcp_f32 v133, v133
    v_rcp_f32 v134, v134
    v_rcp_f32 v135, v135
    v_rcp_f32 v136, v136
    v_rcp_f32 v137, v137
    v_rcp_f32 v138, v138
    v_rcp_f32 v139, v139
    v_rcp_f32 v140, v140
    v_rcp_f32 v141, v141
    v_rcp_f32 v142, v142
    v_rcp_f32 v143, v143
    v_mul_f32 v240, v128, v240
    v_mul_f32 v241, v129, v241
    v_mul_f32 v242, v130, v242
    v_mul_f32 v243, v131, v243
    v_mul_f32 v244, v132, v244
    v_mul_f32 v245, v133, v245
    v_mul_f32 v246, v134, v246
    v_mul_f32 v247, v135, v247
    v_mul_f32 v248, v136, v248
    v_mul_f32 v249, v137, v249
    v_mul_f32 v250, v138, v250
    v_mul_f32 v251, v139, v251
    v_mul_f32 v252, v140, v252
    v_mul_f32 v253, v141, v253
    v_mul_f32 v254, v142, v254
    v_mul_f32 v255, v143, v255
    s_mov_b32 s12, s82
    s_mov_b32 s13, s83
    s_mov_b32 s14, 2097152
    s_mov_b32 s15, 0x00020000
    v_lshrrev_b32 v9, 3, v0
    v_and_b32 v8, 7, v0
    v_lshlrev_b32 v25, 10, v9
    v_lshl_add_u32 v25, v8, 4, v25
    v_lshlrev_b32 v1, 1, v8
    v_xor_b32 v1, v1, v9
    v_lshlrev_b32 v1, 4, v1
    v_lshl_add_u32 v6, v8, 9, v1
    v_xor_b32 v7, 128, v6
    v_lshrrev_b32 v9, 4, v0
    v_and_b32 v8, 15, v0
    v_and_b32 v1, 2, v9
    v_xor_b32 v8, v8, v1
    v_lshlrev_b32 v8, 4, v8
    v_lshl_add_u32 v8, v9, 8, v8
    v_add_u32 v8, s42, v8
    v_xor_b32 v2, 0, v8
    v_xor_b32 v3, 64, v8
    v_xor_b32 v4, 128, v8
    v_xor_b32 v5, 192, v8
    s_lshl_b32 s89, s44, 16
    s_lshl_b32 s49, s36, 14
    s_add_u32 s89, s89, s49
    s_lshl_b32 s49, s45, 7
    s_add_u32 s89, s89, s49
    s_lshl_b32 s48, s69, 2
    s_add_u32 s48, s48, 4096
    s_nop 0
    buffer_load_dwordx4 v[96:99], v26, s[8:11], s48 offen offset:0 sc1
    buffer_load_dwordx4 v[100:103], v26, s[8:11], s48 offen offset:1024 sc1
    buffer_load_dwordx4 v[104:107], v26, s[8:11], s48 offen offset:2048 sc1
    buffer_load_dwordx4 v[108:111], v26, s[8:11], s48 offen offset:3072 sc1
    s_waitcnt vmcnt(4)
    buffer_store_dword v24, v27, s[60:63], s88 offen sc1
    s_cmp_lg_u32 s53, 0
    s_cbranch_scc1 L_nobar
    s_barrier
L_nobar:
    ds_write_b128 v2, v[240:243] offset:32768
    ds_write_b128 v3, v[244:247] offset:33792
    ds_write_b128 v4, v[248:251] offset:34816
    ds_write_b128 v5, v[252:255] offset:35840
    v_add_u32 v8, s42, v6
    v_add_u32 v9, s42, v7
    ds_read_b128 v[240:243], v8 offset:32768
    ds_read_b128 v[244:247], v8 offset:33024
    ds_read_b128 v[248:251], v9 offset:32768
    ds_read_b128 v[252:255], v9 offset:33024
    s_lshl_b32 s49, s36, 14
    v_add_u32 v6, s49, v6
    v_add_u32 v7, s49, v7
    s_lshl_b32 s48, s71, 2
    s_nop 0
    buffer_load_dwordx4 v[112:115], v26, s[8:11], s48 offen offset:0 sc1
    buffer_load_dwordx4 v[116:119], v26, s[8:11], s48 offen offset:1024 sc1
    buffer_load_dwordx4 v[120:123], v26, s[8:11], s48 offen offset:2048 sc1
    buffer_load_dwordx4 v[124:127], v26, s[8:11], s48 offen offset:3072 sc1
    s_lshl_b32 s48, s71, 2
    s_add_u32 s48, s48, 4096
    s_nop 0
    buffer_load_dwordx4 a[128:131], v26, s[8:11], s48 offen offset:0 sc1
    buffer_load_dwordx4 a[132:135], v26, s[8:11], s48 offen offset:1024 sc1
    buffer_load_dwordx4 a[136:139], v26, s[8:11], s48 offen offset:2048 sc1
    buffer_load_dwordx4 a[140:143], v26, s[8:11], s48 offen offset:3072 sc1
    s_lshl_b32 s48, s74, 2
    s_nop 0
    buffer_load_dwordx4 a[64:67], v26, s[8:11], s48 offen offset:0 sc1
    buffer_load_dwordx4 a[68:71], v26, s[8:11], s48 offen offset:1024 sc1
    buffer_load_dwordx4 a[72:75], v26, s[8:11], s48 offen offset:2048 sc1
    buffer_load_dwordx4 a[76:79], v26, s[8:11], s48 offen offset:3072 sc1
    s_lshl_b32 s48, s74, 2
    s_add_u32 s48, s48, 4096
    s_nop 0
    buffer_load_dwordx4 a[80:83], v26, s[8:11], s48 offen offset:0 sc1
    buffer_load_dwordx4 a[84:87], v26, s[8:11], s48 offen offset:1024 sc1
    buffer_load_dwordx4 a[88:91], v26, s[8:11], s48 offen offset:2048 sc1
    buffer_load_dwordx4 a[92:95], v26, s[8:11], s48 offen offset:3072 sc1
    s_lshl_b32 s48, s75, 2
    s_nop 0
    buffer_load_dwordx4 a[96:99], v26, s[8:11], s48 offen offset:0 sc1
    buffer_load_dwordx4 a[100:103], v26, s[8:11], s48 offen offset:1024 sc1
    buffer_load_dwordx4 a[104:107], v26, s[8:11], s48 offen offset:2048 sc1
    buffer_load_dwordx4 a[108:111], v26, s[8:11], s48 offen offset:3072 sc1
    s_lshl_b32 s48, s75, 2
    s_add_u32 s48, s48, 4096
    s_nop 0
    buffer_load_dwordx4 a[112:115], v26, s[8:11], s48 offen offset:0 sc1
    buffer_load_dwordx4 a[116:119], v26, s[8:11], s48 offen offset:1024 sc1
    buffer_load_dwordx4 a[120:123], v26, s[8:11], s48 offen offset:2048 sc1
    buffer_load_dwordx4 a[124:127], v26, s[8:11], s48 offen offset:3072 sc1
    s_waitcnt lgkmcnt(0)
    s_lshl_b32 s48, s76, 2
    s_add_u32 m0, s42, 32768
    s_nop 0
    buffer_load_dwordx4 v38, s[8:11], s48 offen offset:0 sc1 lds
    buffer_load_dwordx4 v38, s[8:11], s48 offen offset:1024 sc1 lds
    buffer_load_dwordx4 v38, s[8:11], s48 offen offset:2048 sc1 lds
    buffer_load_dwordx4 v38, s[8:11], s48 offen offset:3072 sc1 lds
    s_lshl_b32 s48, s76, 2
    s_add_u32 s48, s48, 4096
    s_add_u32 m0, s42, 49152
    s_nop 0
    buffer_load_dwordx4 v38, s[8:11], s48 offen offset:0 sc1 lds
    buffer_load_dwordx4 v38, s[8:11], s48 offen offset:1024 sc1 lds
    buffer_load_dwordx4 v38, s[8:11], s48 offen offset:2048 sc1 lds
    buffer_load_dwordx4 v38, s[8:11], s48 offen offset:3072 sc1 lds
    s_cmp_lg_u32 s50, 0
    s_cbranch_scc1 L_w0
L_r0:
    buffer_load_dwordx4 v[176:179], v28, s[28:31], s65 offen offset:0 sc1
    buffer_load_dwordx4 v[180:183], v29, s[28:31], s65 offen offset:0 sc1
    buffer_load_dwordx4 v[184:187], v30, s[28:31], s65 offen offset:0 sc1
    buffer_load_dwordx4 v[188:191], v31, s[28:31], s65 offen offset:0 sc1
    buffer_load_dwordx4 v[160:163], v28, s[28:31], s65 offen offset:1024 sc1
    buffer_load_dwordx4 v[164:167], v29, s[28:31], s65 offen offset:1024 sc1
    buffer_load_dwordx4 v[168:171], v30, s[28:31], s65 offen offset:1024 sc1
    buffer_load_dwordx4 v[172:175], v31, s[28:31], s65 offen offset:1024 sc1
    buffer_load_dwordx4 v[128:131], v28, s[28:31], s66 offen offset:0 sc1
    buffer_load_dwordx4 v[132:135], v29, s[28:31], s66 offen offset:0 sc1
    buffer_load_dwordx4 v[136:139], v30, s[28:31], s66 offen offset:0 sc1
    buffer_load_dwordx4 v[140:143], v31, s[28:31], s66 offen offset:0 sc1
    buffer_load_dwordx4 v[32:35], v28, s[28:31], s66 offen offset:1024 sc1
    buffer_load_dwordx4 v[36:39], v29, s[28:31], s66 offen offset:1024 sc1
    buffer_load_dwordx4 v[40:43], v30, s[28:31], s66 offen offset:1024 sc1
    buffer_load_dwordx4 v[44:47], v31, s[28:31], s66 offen offset:1024 sc1
    buffer_load_dword v23, v21, s[60:63], s40 offen sc1
    v_mfma_f32_16x16x32_bf16 a[0:3], a[144:147], v[48:51], 0
    buffer_load_dwordx4 v[144:147], v28, s[28:31], s67 offen offset:0 sc1
    v_mfma_f32_16x16x32_bf16 a[4:7], a[144:147], v[52:55], 0
    v_mfma_f32_16x16x32_bf16 a[8:11], a[144:147], v[56:59], 0
    v_mfma_f32_16x16x32_bf16 a[12:15], a[144:147], v[60:63], 0
    v_mfma_f32_16x16x32_bf16 a[16:19], a[148:151], v[48:51], 0
    buffer_load_dwordx4 v[148:151], v29, s[28:31], s67 offen offset:0 sc1
    v_mfma_f32_16x16x32_bf16 a[20:23], a[148:151], v[52:55], 0
    v_mfma_f32_16x16x32_bf16 a[24:27], a[148:151], v[56:59], 0
    v_mfma_f32_16x16x32_bf16 a[28:31], a[148:151], v[60:63], 0
    v_mfma_f32_16x16x32_bf16 a[32:35], a[152:155], v[48:51], 0
    buffer_load_dwordx4 v[152:155], v30, s[28:31], s67 offen offset:0 sc1
    v_mfma_f32_16x16x32_bf16 a[36:39], a[152:155], v[52:55], 0
    v_mfma_f32_16x16x32_bf16 a[40:43], a[152:155], v[56:59], 0
    v_mfma_f32_16x16x32_bf16 a[44:47], a[152:155], v[60:63], 0
    v_mfma_f32_16x16x32_bf16 a[48:51], a[156:159], v[48:51], 0
    buffer_load_dwordx4 v[156:159], v31, s[28:31], s67 offen offset:0 sc1
    v_mfma_f32_16x16x32_bf16 a[52:55], a[156:159], v[52:55], 0
    v_mfma_f32_16x16x32_bf16 a[56:59], a[156:159], v[56:59], 0
    v_mfma_f32_16x16x32_bf16 a[60:63], a[156:159], v[60:63], 0
    v_mfma_f32_16x16x32_bf16 a[0:3], a[160:163], v[192:195], a[0:3]
    s_lshl_b32 s48, s77, 2
    buffer_load_dwordx4 v[48:51], v28, s[28:31], s67 offen offset:1024 sc1
    v_mfma_f32_16x16x32_bf16 a[4:7], a[160:163], v[196:199], a[4:7]
    v_mfma_f32_16x16x32_bf16 a[8:11], a[160:163], v[200:203], a[8:11]
    buffer_load_dwordx4 v[208:211], v26, s[8:11], s48 offen offset:0 sc1
    v_mfma_f32_16x16x32_bf16 a[12:15], a[160:163], v[204:207], a[12:15]
    v_mfma_f32_16x16x32_bf16 a[16:19], a[164:167], v[192:195], a[16:19]
    buffer_load_dwordx4 v[52:55], v29, s[28:31], s67 offen offset:1024 sc1
    v_mfma_f32_16x16x32_bf16 a[20:23], a[164:167], v[196:199], a[20:23]
    v_mfma_f32_16x16x32_bf16 a[24:27], a[164:167], v[200:203], a[24:27]
    buffer_load_dwordx4 v[212:215], v26, s[8:11], s48 offen offset:1024 sc1
    v_mfma_f32_16x16x32_bf16 a[28:31], a[164:167], v[204:207], a[28:31]
    v_mfma_f32_16x16x32_bf16 a[32:35], a[168:171], v[192:195], a[32:35]
    buffer_load_dwordx4 v[56:59], v30, s[28:31], s67 offen offset:1024 sc1
    v_mfma_f32_16x16x32_bf16 a[36:39], a[168:171], v[196:199], a[36:39]
    v_mfma_f32_16x16x32_bf16 a[40:43], a[168:171], v[200:203], a[40:43]
    buffer_load_dwordx4 v[216:219], v26, s[8:11], s48 offen offset:2048 sc1
    v_mfma_f32_16x16x32_bf16 a[44:47], a[168:171], v[204:207], a[44:47]
    v_mfma_f32_16x16x32_bf16 a[48:51], a[172:175], v[192:195], a[48:51]
    buffer_load_dwordx4 v[60:63], v31, s[28:31], s67 offen offset:1024 sc1
    v_mfma_f32_16x16x32_bf16 a[52:55], a[172:175], v[196:199], a[52:55]
    v_mfma_f32_16x16x32_bf16 a[56:59], a[172:175], v[200:203], a[56:59]
    buffer_load_dwordx4 v[220:223], v26, s[8:11], s48 offen offset:3072 sc1
    v_mfma_f32_16x16x32_bf16 a[60:63], a[172:175], v[204:207], a[60:63]
    s_waitcnt vmcnt(25)
    v_mfma_f32_16x16x32_bf16 a[0:3], a[176:179], v[176:179], a[0:3]
    buffer_load_dwordx4 v[192:195], v28, s[28:31], s68 offen offset:0 sc1
    v_mfma_f32_16x16x32_bf16 a[4:7], a[176:179], v[180:183], a[4:7]
    v_mfma_f32_16x16x32_bf16 a[8:11], a[176:179], v[184:187], a[8:11]
    v_mfma_f32_16x16x32_bf16 a[12:15], a[176:179], v[188:191], a[12:15]
    v_mfma_f32_16x16x32_bf16 a[16:19], a[180:183], v[176:179], a[16:19]
    buffer_load_dwordx4 v[196:199], v29, s[28:31], s68 offen offset:0 sc1
    v_mfma_f32_16x16x32_bf16 a[20:23], a[180:183], v[180:183], a[20:23]
    v_mfma_f32_16x16x32_bf16 a[24:27], a[180:183], v[184:187], a[24:27]
    v_mfma_f32_16x16x32_bf16 a[28:31], a[180:183], v[188:191], a[28:31]
    v_mfma_f32_16x16x32_bf16 a[32:35], a[184:187], v[176:179], a[32:35]
    buffer_load_dwordx4 v[200:203], v30, s[28:31], s68 offen offset:0 sc1
    v_mfma_f32_16x16x32_bf16 a[36:39], a[184:187], v[180:183], a[36:39]
    v_mfma_f32_16x16x32_bf16 a[40:43], a[184:187], v[184:187], a[40:43]
    v_mfma_f32_16x16x32_bf16 a[44:47], a[184:187], v[188:191], a[44:47]
    v_mfma_f32_16x16x32_bf16 a[48:51], a[188:191], v[176:179], a[48:51]
    buffer_load_dwordx4 v[204:207], v31, s[28:31], s68 offen offset:0 sc1
    v_mfma_f32_16x16x32_bf16 a[52:55], a[188:191], v[180:183], a[52:55]
    v_mfma_f32_16x16x32_bf16 a[56:59], a[188:191], v[184:187], a[56:59]
    v_mfma_f32_16x16x32_bf16 a[60:63], a[188:191], v[188:191], a[60:63]
    s_waitcnt vmcnt(25)
    v_mfma_f32_16x16x32_bf16 a[0:3], a[192:195], v[160:163], a[0:3]
    s_lshl_b32 s48, s77, 2
    buffer_load_dwordx4 v[176:179], v28, s[28:31], s68 offen offset:1024 sc1
    v_mfma_f32_16x16x32_bf16 a[4:7], a[192:195], v[164:167], a[4:7]
    s_add_u32 s48, s48, 4096
    v_mfma_f32_16x16x32_bf16 a[8:11], a[192:195], v[168:171], a[8:11]
    buffer_load_dwordx4 v[224:227], v26, s[8:11], s48 offen offset:0 sc1
    v_mfma_f32_16x16x32_bf16 a[12:15], a[192:195], v[172:175], a[12:15]
    v_mfma_f32_16x16x32_bf16 a[16:19], a[196:199], v[160:163], a[16:19]
    buffer_load_dwordx4 v[180:183], v29, s[28:31], s68 offen offset:1024 sc1
    v_mfma_f32_16x16x32_bf16 a[20:23], a[196:199], v[164:167], a[20:23]
    v_mfma_f32_16x16x32_bf16 a[24:27], a[196:199], v[168:171], a[24:27]
    buffer_load_dwordx4 v[228:231], v26, s[8:11], s48 offen offset:1024 sc1
    v_mfma_f32_16x16x32_bf16 a[28:31], a[196:199], v[172:175], a[28:31]
    v_mfma_f32_16x16x32_bf16 a[32:35], a[200:203], v[160:163], a[32:35]
    buffer_load_dwordx4 v[184:187], v30, s[28:31], s68 offen offset:1024 sc1
    v_mfma_f32_16x16x32_bf16 a[36:39], a[200:203], v[164:167], a[36:39]
    v_mfma_f32_16x16x32_bf16 a[40:43], a[200:203], v[168:171], a[40:43]
    buffer_load_dwordx4 v[232:235], v26, s[8:11], s48 offen offset:2048 sc1
    v_mfma_f32_16x16x32_bf16 a[44:47], a[200:203], v[172:175], a[44:47]
    v_mfma_f32_16x16x32_bf16 a[48:51], a[204:207], v[160:163], a[48:51]
    buffer_load_dwordx4 v[188:191], v31, s[28:31], s68 offen offset:1024 sc1
    v_mfma_f32_16x16x32_bf16 a[52:55], a[204:207], v[164:167], a[52:55]
    v_mfma_f32_16x16x32_bf16 a[56:59], a[204:207], v[168:171], a[56:59]
    buffer_load_dwordx4 v[236:239], v26, s[8:11], s48 offen offset:3072 sc1
    v_mfma_f32_16x16x32_bf16 a[60:63], a[204:207], v[172:175], a[60:63]
    s_waitcnt vmcnt(29)
    s_waitcnt vmcnt(24)
    v_cmp_eq_u32 vcc, 0, v23
    s_and_b32 s49, vcc_lo, 0xff00
    s_cbranch_scc1 L_w1
L_r1:
    v_mfma_f32_16x16x32_bf16 a[0:3], a[208:211], v[128:131], a[0:3]
    buffer_load_dwordx4 v[160:163], v28, s[28:31], s72 offen offset:0 sc1
    v_mfma_f32_16x16x32_bf16 a[4:7], a[208:211], v[132:135], a[4:7]
    v_mfma_f32_16x16x32_bf16 a[8:11], a[208:211], v[136:139], a[8:11]
    buffer_load_dwordx4 a[192:195], v28, s[28:31], s72 offen offset:1024 sc1
    v_mfma_f32_16x16x32_bf16 a[12:15], a[208:211], v[140:143], a[12:15]
    v_mfma_f32_16x16x32_bf16 a[16:19], a[212:215], v[128:131], a[16:19]
    buffer_load_dwordx4 v[164:167], v29, s[28:31], s72 offen offset:0 sc1
    v_mfma_f32_16x16x32_bf16 a[20:23], a[212:215], v[132:135], a[20:23]
    v_mfma_f32_16x16x32_bf16 a[24:27], a[212:215], v[136:139], a[24:27]
    buffer_load_dwordx4 a[196:199], v29, s[28:31], s72 offen offset:1024 sc1
    v_mfma_f32_16x16x32_bf16 a[28:31], a[212:215], v[140:143], a[28:31]
    v_mfma_f32_16x16x32_bf16 a[32:35], a[216:219], v[128:131], a[32:35]
    buffer_load_dwordx4 v[168:171], v30, s[28:31], s72 offen offset:0 sc1
    v_mfma_f32_16x16x32_bf16 a[36:39], a[216:219], v[132:135], a[36:39]
    v_mfma_f32_16x16x32_bf16 a[40:43], a[216:219], v[136:139], a[40:43]
    buffer_load_dwordx4 a[200:203], v30, s[28:31], s72 offen offset:1024 sc1
    v_mfma_f32_16x16x32_bf16 a[44:47], a[216:219], v[140:143], a[44:47]
    v_mfma_f32_16x16x32_bf16 a[48:51], a[220:223], v[128:131], a[48:51]
    buffer_load_dwordx4 v[172:175], v31, s[28:31], s72 offen offset:0 sc1
    v_mfma_f32_16x16x32_bf16 a[52:55], a[220:223], v[132:135], a[52:55]
    v_mfma_f32_16x16x32_bf16 a[56:59], a[220:223], v[136:139], a[56:59]
    buffer_load_dwordx4 a[204:207], v31, s[28:31], s72 offen offset:1024 sc1
    v_mfma_f32_16x16x32_bf16 a[60:63], a[220:223], v[140:143], a[60:63]
    v_mfma_f32_16x16x32_bf16 a[0:3], a[224:227], v[32:35], a[0:3]
    buffer_load_dwordx4 v[128:131], v28, s[28:31], s69 offen offset:0 sc1
    v_mfma_f32_16x16x32_bf16 a[4:7], a[224:227], v[36:39], a[4:7]
    v_mfma_f32_16x16x32_bf16 a[8:11], a[224:227], v[40:43], a[8:11]
    buffer_load_dwordx4 a[208:211], v28, s[28:31], s69 offen offset:1024 sc1
    v_mfma_f32_16x16x32_bf16 a[12:15], a[224:227], v[44:47], a[12:15]
    v_mfma_f32_16x16x32_bf16 a[16:19], a[228:231], v[32:35], a[16:19]
    buffer_load_dwordx4 v[132:135], v29, s[28:31], s69 offen offset:0 sc1
    v_mfma_f32_16x16x32_bf16 a[20:23], a[228:231], v[36:39], a[20:23]
    v_mfma_f32_16x16x32_bf16 a[24:27], a[228:231], v[40:43], a[24:27]
    buffer_load_dwordx4 a[212:215], v29, s[28:31], s69 offen offset:1024 sc1
    v_mfma_f32_16x16x32_bf16 a[28:31], a[228:231], v[44:47], a[28:31]
    v_mfma_f32_16x16x32_bf16 a[32:35], a[232:235], v[32:35], a[32:35]
    buffer_load_dwordx4 v[136:139], v30, s[28:31], s69 offen offset:0 sc1
    v_mfma_f32_16x16x32_bf16 a[36:39], a[232:235], v[36:39], a[36:39]
    v_mfma_f32_16x16x32_bf16 a[40:43], a[232:235], v[40:43], a[40:43]
    buffer_load_dwordx4 a[216:219], v30, s[28:31], s69 offen offset:1024 sc1
    v_mfma_f32_16x16x32_bf16 a[44:47], a[232:235], v[44:47], a[44:47]
    v_mfma_f32_16x16x32_bf16 a[48:51], a[236:239], v[32:35], a[48:51]
    buffer_load_dwordx4 v[140:143], v31, s[28:31], s69 offen offset:0 sc1
    v_mfma_f32_16x16x32_bf16 a[52:55], a[236:239], v[36:39], a[52:55]
    v_mfma_f32_16x16x32_bf16 a[56:59], a[236:239], v[40:43], a[56:59]
    buffer_load_dwordx4 a[220:223], v31, s[28:31], s69 offen offset:1024 sc1
    v_mfma_f32_16x16x32_bf16 a[60:63], a[236:239], v[44:47], a[60:63]
    s_waitcnt vmcnt(36)
    v_mfma_f32_16x16x32_bf16 a[0:3], a[240:243], v[144:147], a[0:3]
    buffer_load_dwordx4 v[32:35], v28, s[28:31], s70 offen offset:0 sc1
    v_mfma_f32_16x16x32_bf16 a[4:7], a[240:243], v[148:151], a[4:7]
    ds_read_b128 a[144:147], v17 offset:0
    v_mfma_f32_16x16x32_bf16 a[8:11], a[240:243], v[152:155], a[8:11]
    v_mfma_f32_16x16x32_bf16 a[12:15], a[240:243], v[156:159], a[12:15]
    v_mfma_f32_16x16x32_bf16 a[16:19], a[244:247], v[144:147], a[16:19]
    buffer_load_dwordx4 v[36:39], v29, s[28:31], s70 offen offset:0 sc1
    v_mfma_f32_16x16x32_bf16 a[20:23], a[244:247], v[148:151], a[20:23]
    ds_read_b128 a[148:151], v17 offset:1024
    v_mfma_f32_16x16x32_bf16 a[24:27], a[244:247], v[152:155], a[24:27]
    v_mfma_f32_16x16x32_bf16 a[28:31], a[244:247], v[156:159], a[28:31]
    v_mfma_f32_16x16x32_bf16 a[32:35], a[248:251], v[144:147], a[32:35]
    buffer_load_dwordx4 v[40:43], v30, s[28:31], s70 offen offset:0 sc1
    v_mfma_f32_16x16x32_bf16 a[36:39], a[248:251], v[148:151], a[36:39]
    ds_read_b128 a[152:155], v17 offset:2048
    v_mfma_f32_16x16x32_bf16 a[40:43], a[248:251], v[152:155], a[40:43]
    v_mfma_f32_16x16x32_bf16 a[44:47], a[248:251], v[156:159], a[44:47]
    v_mfma_f32_16x16x32_bf16 a[48:51], a[252:255], v[144:147], a[48:51]
    buffer_load_dwordx4 v[44:47], v31, s[28:31], s70 offen offset:0 sc1
    v_mfma_f32_16x16x32_bf16 a[52:55], a[252:255], v[148:151], a[52:55]
    ds_read_b128 a[156:159], v17 offset:3072
    v_mfma_f32_16x16x32_bf16 a[56:59], a[252:255], v[152:155], a[56:59]
    v_mfma_f32_16x16x32_bf16 a[60:63], a[252:255], v[156:159], a[60:63]
    s_waitcnt vmcnt(33)
    v_mfma_f32_16x16x32_bf16 a[0:3], v[64:67], v[48:51], a[0:3]
    buffer_load_dwordx4 v[144:147], v28, s[28:31], s70 offen offset:1024 sc1
    v_mfma_f32_16x16x32_bf16 a[4:7], v[64:67], v[52:55], a[4:7]
    s_lshl_b32 s48, s78, 2
    ds_read_b128 a[160:163], v18 offset:16384
    v_mfma_f32_16x16x32_bf16 a[8:11], v[64:67], v[56:59], a[8:11]
    buffer_load_dwordx4 a[176:179], v26, s[8:11], s48 offen offset:0 sc1
    v_mfma_f32_16x16x32_bf16 a[12:15], v[64:67], v[60:63], a[12:15]
    v_mfma_f32_16x16x32_bf16 a[16:19], v[68:71], v[48:51], a[16:19]
    buffer_load_dwordx4 v[148:151], v29, s[28:31], s70 offen offset:1024 sc1
    v_mfma_f32_16x16x32_bf16 a[20:23], v[68:71], v[52:55], a[20:23]
    ds_read_b128 a[164:167], v18 offset:17408
    v_mfma_f32_16x16x32_bf16 a[24:27], v[68:71], v[56:59], a[24:27]
    buffer_load_dwordx4 a[180:183], v26, s[8:11], s48 offen offset:1024 sc1
    v_mfma_f32_16x16x32_bf16 a[28:31], v[68:71], v[60:63], a[28:31]
    v_mfma_f32_16x16x32_bf16 a[32:35], v[72:75], v[48:51], a[32:35]
    buffer_load_dwordx4 v[152:155], v30, s[28:31], s70 offen offset:1024 sc1
    v_mfma_f32_16x16x32_bf16 a[36:39], v[72:75], v[52:55], a[36:39]
    ds_read_b128 a[168:171], v18 offset:18432
    v_mfma_f32_16x16x32_bf16 a[40:43], v[72:75], v[56:59], a[40:43]
    buffer_load_dwordx4 a[184:187], v26, s[8:11], s48 offen offset:2048 sc1
    v_mfma_f32_16x16x32_bf16 a[44:47], v[72:75], v[60:63], a[44:47]
    v_mfma_f32_16x16x32_bf16 a[48:51], v[76:79], v[48:51], a[48:51]
    buffer_load_dwordx4 v[156:159], v31, s[28:31], s70 offen offset:1024 sc1
    v_mfma_f32_16x16x32_bf16 a[52:55], v[76:79], v[52:55], a[52:55]
    ds_read_b128 a[172:175], v18 offset:19456
    v_mfma_f32_16x16x32_bf16 a[56:59], v[76:79], v[56:59], a[56:59]
    buffer_load_dwordx4 a[188:191], v26, s[8:11], s48 offen offset:3072 sc1
    v_mfma_f32_16x16x32_bf16 a[60:63], v[76:79], v[60:63], a[60:63]
    s_waitcnt vmcnt(36)
    s_waitcnt lgkmcnt(4)
    v_mfma_f32_16x16x32_bf16 a[0:3], a[144:147], v[192:195], a[0:3]
    buffer_load_dwordx4 v[48:51], v28, s[28:31], s71 offen offset:0 sc1
    v_mfma_f32_16x16x32_bf16 a[4:7], a[144:147], v[196:199], a[4:7]
    v_mfma_f32_16x16x32_bf16 a[8:11], a[144:147], v[200:203], a[8:11]
    v_mfma_f32_16x16x32_bf16 a[12:15], a[144:147], v[204:207], a[12:15]
    v_mfma_f32_16x16x32_bf16 a[16:19], a[148:151], v[192:195], a[16:19]
    buffer_load_dwordx4 v[52:55], v29, s[28:31], s71 offen offset:0 sc1
    v_mfma_f32_16x16x32_bf16 a[20:23], a[148:151], v[196:199], a[20:23]
    v_mfma_f32_16x16x32_bf16 a[24:27], a[148:151], v[200:203], a[24:27]
    v_mfma_f32_16x16x32_bf16 a[28:31], a[148:151], v[204:207], a[28:31]
    v_mfma_f32_16x16x32_bf16 a[32:35], a[152:155], v[192:195], a[32:35]
    buffer_load_dwordx4 v[56:59], v30, s[28:31], s71 offen offset:0 sc1
    v_mfma_f32_16x16x32_bf16 a[36:39], a[152:155], v[196:199], a[36:39]
    v_mfma_f32_16x16x32_bf16 a[40:43], a[152:155], v[200:203], a[40:43]
    v_mfma_f32_16x16x32_bf16 a[44:47], a[152:155], v[204:207], a[44:47]
    v_mfma_f32_16x16x32_bf16 a[48:51], a[156:159], v[192:195], a[48:51]
    buffer_load_dwordx4 v[60:63], v31, s[28:31], s71 offen offset:0 sc1
    v_mfma_f32_16x16x32_bf16 a[52:55], a[156:159], v[196:199], a[52:55]
    v_mfma_f32_16x16x32_bf16 a[56:59], a[156:159], v[200:203], a[56:59]
    v_mfma_f32_16x16x32_bf16 a[60:63], a[156:159], v[204:207], a[60:63]
    s_waitcnt vmcnt(33)
    s_waitcnt lgkmcnt(0)
    v_mfma_f32_16x16x32_bf16 a[0:3], a[160:163], v[176:179], a[0:3]
    s_lshl_b32 s48, s78, 2
    buffer_load_dwordx4 v[192:195], v28, s[28:31], s71 offen offset:1024 sc1
    v_mfma_f32_16x16x32_bf16 a[4:7], a[160:163], v[180:183], a[4:7]
    s_add_u32 s48, s48, 4096
    v_mfma_f32_16x16x32_bf16 a[8:11], a[160:163], v[184:187], a[8:11]
    buffer_load_dwordx4 a[224:227], v26, s[8:11], s48 offen offset:0 sc1
    v_mfma_f32_16x16x32_bf16 a[12:15], a[160:163], v[188:191], a[12:15]
    v_mfma_f32_16x16x32_bf16 a[16:19], a[164:167], v[176:179], a[16:19]
    buffer_load_dwordx4 v[196:199], v29, s[28:31], s71 offen offset:1024 sc1
    v_mfma_f32_16x16x32_bf16 a[20:23], a[164:167], v[180:183], a[20:23]
    v_mfma_f32_16x16x32_bf16 a[24:27], a[164:167], v[184:187], a[24:27]
    buffer_load_dwordx4 a[228:231], v26, s[8:11], s48 offen offset:1024 sc1
    v_mfma_f32_16x16x32_bf16 a[28:31], a[164:167], v[188:191], a[28:31]
    v_mfma_f32_16x16x32_bf16 a[32:35], a[168:171], v[176:179], a[32:35]
    buffer_load_dwordx4 v[200:203], v30, s[28:31], s71 offen offset:1024 sc1
    v_mfma_f32_16x16x32_bf16 a[36:39], a[168:171], v[180:183], a[36:39]
    v_mfma_f32_16x16x32_bf16 a[40:43], a[168:171], v[184:187], a[40:43]
    buffer_load_dwordx4 a[232:235], v26, s[8:11], s48 offen offset:2048 sc1
    v_mfma_f32_16x16x32_bf16 a[44:47], a[168:171], v[188:191], a[44:47]
    v_mfma_f32_16x16x32_bf16 a[48:51], a[172:175], v[176:179], a[48:51]
    buffer_load_dwordx4 v[204:207], v31, s[28:31], s71 offen offset:1024 sc1
    v_mfma_f32_16x16x32_bf16 a[52:55], a[172:175], v[180:183], a[52:55]
    v_mfma_f32_16x16x32_bf16 a[56:59], a[172:175], v[184:187], a[56:59]
    buffer_load_dwordx4 a[236:239], v26, s[8:11], s48 offen offset:3072 sc1
    v_mfma_f32_16x16x32_bf16 a[60:63], a[172:175], v[188:191], a[60:63]
    s_waitcnt vmcnt(25)
    v_mfma_f32_16x16x32_bf16 a[0:3], v[80:83], v[128:131], a[0:3]
    v_mfma_f32_16x16x32_bf16 a[4:7], v[80:83], v[132:135], a[4:7]
    ds_read_b128 a[240:243], v16 offset:0
    v_mfma_f32_16x16x32_bf16 a[8:11], v[80:83], v[136:139], a[8:11]
    v_mfma_f32_16x16x32_bf16 a[12:15], v[80:83], v[140:143], a[12:15]
    v_mfma_f32_16x16x32_bf16 a[16:19], v[84:87], v[128:131], a[16:19]
    v_mfma_f32_16x16x32_bf16 a[20:23], v[84:87], v[132:135], a[20:23]
    ds_read_b128 a[244:247], v16 offset:1024
    v_mfma_f32_16x16x32_bf16 a[24:27], v[84:87], v[136:139], a[24:27]
    v_mfma_f32_16x16x32_bf16 a[28:31], v[84:87], v[140:143], a[28:31]
    v_mfma_f32_16x16x32_bf16 a[32:35], v[88:91], v[128:131], a[32:35]
    v_mfma_f32_16x16x32_bf16 a[36:39], v[88:91], v[132:135], a[36:39]
    ds_read_b128 a[248:251], v16 offset:2048
    v_mfma_f32_16x16x32_bf16 a[40:43], v[88:91], v[136:139], a[40:43]
    v_mfma_f32_16x16x32_bf16 a[44:47], v[88:91], v[140:143], a[44:47]
    v_mfma_f32_16x16x32_bf16 a[48:51], v[92:95], v[128:131], a[48:51]
    v_mfma_f32_16x16x32_bf16 a[52:55], v[92:95], v[132:135], a[52:55]
    ds_read_b128 a[252:255], v16 offset:3072
    v_mfma_f32_16x16x32_bf16 a[56:59], v[92:95], v[136:139], a[56:59]
    v_mfma_f32_16x16x32_bf16 a[60:63], v[92:95], v[140:143], a[60:63]
    s_waitcnt vmcnt(24)
    v_mfma_f32_16x16x32_bf16 a[0:3], v[96:99], a[208:211], a[0:3]
    v_mfma_f32_16x16x32_bf16 a[4:7], v[96:99], a[212:215], a[4:7]
    s_lshl_b32 s48, s79, 2
    ds_read_b128 v[64:67], v16 offset:16384
    v_mfma_f32_16x16x32_bf16 a[8:11], v[96:99], a[216:219], a[8:11]
    buffer_load_dwordx4 a[144:147], v26, s[8:11], s48 offen offset:0 sc1
    v_mfma_f32_16x16x32_bf16 a[12:15], v[96:99], a[220:223], a[12:15]
    v_mfma_f32_16x16x32_bf16 a[16:19], v[100:103], a[208:211], a[16:19]
    v_mfma_f32_16x16x32_bf16 a[20:23], v[100:103], a[212:215], a[20:23]
    ds_read_b128 v[68:71], v16 offset:17408
    v_mfma_f32_16x16x32_bf16 a[24:27], v[100:103], a[216:219], a[24:27]
    buffer_load_dwordx4 a[148:151], v26, s[8:11], s48 offen offset:1024 sc1
    v_mfma_f32_16x16x32_bf16 a[28:31], v[100:103], a[220:223], a[28:31]
    v_mfma_f32_16x16x32_bf16 a[32:35], v[104:107], a[208:211], a[32:35]
    v_mfma_f32_16x16x32_bf16 a[36:39], v[104:107], a[212:215], a[36:39]
    ds_read_b128 v[72:75], v16 offset:18432
    v_mfma_f32_16x16x32_bf16 a[40:43], v[104:107], a[216:219], a[40:43]
    buffer_load_dwordx4 a[152:155], v26, s[8:11], s48 offen offset:2048 sc1
    v_mfma_f32_16x16x32_bf16 a[44:47], v[104:107], a[220:223], a[44:47]
    v_mfma_f32_16x16x32_bf16 a[48:51], v[108:111], a[208:211], a[48:51]
    v_mfma_f32_16x16x32_bf16 a[52:55], v[108:111], a[212:215], a[52:55]
    ds_read_b128 v[76:79], v16 offset:19456
    v_mfma_f32_16x16x32_bf16 a[56:59], v[108:111], a[216:219], a[56:59]
    buffer_load_dwordx4 a[156:159], v26, s[8:11], s48 offen offset:3072 sc1
    v_mfma_f32_16x16x32_bf16 a[60:63], v[108:111], a[220:223], a[60:63]
    s_waitcnt vmcnt(24)
    s_waitcnt lgkmcnt(4)
    v_mfma_f32_16x16x32_bf16 a[0:3], a[240:243], v[32:35], a[0:3]
    buffer_load_dwordx4 a[208:211], v28, s[28:31], s73 offen offset:0 sc1
    v_mfma_f32_16x16x32_bf16 a[4:7], a[240:243], v[36:39], a[4:7]
    v_mfma_f32_16x16x32_bf16 a[8:11], a[240:243], v[40:43], a[8:11]
    v_mfma_f32_16x16x32_bf16 a[12:15], a[240:243], v[44:47], a[12:15]
    v_mfma_f32_16x16x32_bf16 a[16:19], a[244:247], v[32:35], a[16:19]
    buffer_load_dwordx4 a[212:215], v29, s[28:31], s73 offen offset:0 sc1
    v_mfma_f32_16x16x32_bf16 a[20:23], a[244:247], v[36:39], a[20:23]
    v_mfma_f32_16x16x32_bf16 a[24:27], a[244:247], v[40:43], a[24:27]
    v_mfma_f32_16x16x32_bf16 a[28:31], a[244:247], v[44:47], a[28:31]
    v_mfma_f32_16x16x32_bf16 a[32:35], a[248:251], v[32:35], a[32:35]
    buffer_load_dwordx4 a[216:219], v30, s[28:31], s73 offen offset:0 sc1
    v_mfma_f32_16x16x32_bf16 a[36:39], a[248:251], v[36:39], a[36:39]
    v_mfma_f32_16x16x32_bf16 a[40:43], a[248:251], v[40:43], a[40:43]
    v_mfma_f32_16x16x32_bf16 a[44:47], a[248:251], v[44:47], a[44:47]
    v_mfma_f32_16x16x32_bf16 a[48:51], a[252:255], v[32:35], a[48:51]
    buffer_load_dwordx4 a[220:223], v31, s[28:31], s73 offen offset:0 sc1
    v_mfma_f32_16x16x32_bf16 a[52:55], a[252:255], v[36:39], a[52:55]
    v_mfma_f32_16x16x32_bf16 a[56:59], a[252:255], v[40:43], a[56:59]
    v_mfma_f32_16x16x32_bf16 a[60:63], a[252:255], v[44:47], a[60:63]
    s_waitcnt vmcnt(21)
    s_waitcnt lgkmcnt(0)
    v_mfma_f32_16x16x32_bf16 a[0:3], v[64:67], v[144:147], a[0:3]
    s_lshl_b32 s48, s79, 2
    buffer_load_dwordx4 v[32:35], v28, s[28:31], s73 offen offset:1024 sc1
    v_mfma_f32_16x16x32_bf16 a[4:7], v[64:67], v[148:151], a[4:7]
    s_add_u32 s48, s48, 4096
    v_mfma_f32_16x16x32_bf16 a[8:11], v[64:67], v[152:155], a[8:11]
    buffer_load_dwordx4 a[160:163], v26, s[8:11], s48 offen offset:0 sc1
    v_mfma_f32_16x16x32_bf16 a[12:15], v[64:67], v[156:159], a[12:15]
    v_mfma_f32_16x16x32_bf16 a[16:19], v[68:71], v[144:147], a[16:19]
    buffer_load_dwordx4 v[36:39], v29, s[28:31], s73 offen offset:1024 sc1
    v_mfma_f32_16x16x32_bf16 a[20:23], v[68:71], v[148:151], a[20:23]
    v_mfma_f32_16x16x32_bf16 a[24:27], v[68:71], v[152:155], a[24:27]
    buffer_load_dwordx4 a[164:167], v26, s[8:11], s48 offen offset:1024 sc1
    v_mfma_f32_16x16x32_bf16 a[28:31], v[68:71], v[156:159], a[28:31]
    v_mfma_f32_16x16x32_bf16 a[32:35], v[72:75], v[144:147], a[32:35]
    buffer_load_dwordx4 v[40:43], v30, s[28:31], s73 offen offset:1024 sc1
    v_mfma_f32_16x16x32_bf16 a[36:39], v[72:75], v[148:151], a[36:39]
    v_mfma_f32_16x16x32_bf16 a[40:43], v[72:75], v[152:155], a[40:43]
    buffer_load_dwordx4 a[168:171], v26, s[8:11], s48 offen offset:2048 sc1
    v_mfma_f32_16x16x32_bf16 a[44:47], v[72:75], v[156:159], a[44:47]
    v_mfma_f32_16x16x32_bf16 a[48:51], v[76:79], v[144:147], a[48:51]
    buffer_load_dwordx4 v[44:47], v31, s[28:31], s73 offen offset:1024 sc1
    v_mfma_f32_16x16x32_bf16 a[52:55], v[76:79], v[148:151], a[52:55]
    v_mfma_f32_16x16x32_bf16 a[56:59], v[76:79], v[152:155], a[56:59]
    buffer_load_dwordx4 a[172:175], v26, s[8:11], s48 offen offset:3072 sc1
    v_mfma_f32_16x16x32_bf16 a[60:63], v[76:79], v[156:159], a[60:63]
    s_waitcnt vmcnt(24)
    v_mfma_f32_16x16x32_bf16 a[0:3], v[112:115], v[48:51], a[0:3]
    buffer_load_dwordx4 v[144:147], v28, s[28:31], s74 offen offset:0 sc1
    v_mfma_f32_16x16x32_bf16 a[4:7], v[112:115], v[52:55], a[4:7]
    ds_read_b128 v[176:179], v18 offset:0
    v_mfma_f32_16x16x32_bf16 a[8:11], v[112:115], v[56:59], a[8:11]
    v_mfma_f32_16x16x32_bf16 a[12:15], v[112:115], v[60:63], a[12:15]
    v_mfma_f32_16x16x32_bf16 a[16:19], v[116:119], v[48:51], a[16:19]
    buffer_load_dwordx4 v[148:151], v29, s[28:31], s74 offen offset:0 sc1
    v_mfma_f32_16x16x32_bf16 a[20:23], v[116:119], v[52:55], a[20:23]
    ds_read_b128 v[180:183], v18 offset:1024
    v_mfma_f32_16x16x32_bf16 a[24:27], v[116:119], v[56:59], a[24:27]
    v_mfma_f32_16x16x32_bf16 a[28:31], v[116:119], v[60:63], a[28:31]
    v_mfma_f32_16x16x32_bf16 a[32:35], v[120:123], v[48:51], a[32:35]
    buffer_load_dwordx4 v[152:155], v30, s[28:31], s74 offen offset:0 sc1
    v_mfma_f32_16x16x32_bf16 a[36:39], v[120:123], v[52:55], a[36:39]
    ds_read_b128 v[184:187], v18 offset:2048
    v_mfma_f32_16x16x32_bf16 a[40:43], v[120:123], v[56:59], a[40:43]
    v_mfma_f32_16x16x32_bf16 a[44:47], v[120:123], v[60:63], a[44:47]
    v_mfma_f32_16x16x32_bf16 a[48:51], v[124:127], v[48:51], a[48:51]
    buffer_load_dwordx4 v[156:159], v31, s[28:31], s74 offen offset:0 sc1
    v_mfma_f32_16x16x32_bf16 a[52:55], v[124:127], v[52:55], a[52:55]
    ds_read_b128 v[188:191], v18 offset:3072
    v_mfma_f32_16x16x32_bf16 a[56:59], v[124:127], v[56:59], a[56:59]
    v_mfma_f32_16x16x32_bf16 a[60:63], v[124:127], v[60:63], a[60:63]
    s_waitcnt vmcnt(21)
    v_mfma_f32_16x16x32_bf16 a[0:3], a[128:131], v[192:195], a[0:3]
    buffer_load_dwordx4 v[48:51], v28, s[28:31], s74 offen offset:1024 sc1
    v_mfma_f32_16x16x32_bf16 a[4:7], a[128:131], v[196:199], a[4:7]
    ds_read_b128 v[80:83], v17 offset:16384
    v_mfma_f32_16x16x32_bf16 a[8:11], a[128:131], v[200:203], a[8:11]
    v_mfma_f32_16x16x32_bf16 a[12:15], a[128:131], v[204:207], a[12:15]
    v_mfma_f32_16x16x32_bf16 a[16:19], a[132:135], v[192:195], a[16:19]
    buffer_load_dwordx4 v[52:55], v29, s[28:31], s74 offen offset:1024 sc1
    v_mfma_f32_16x16x32_bf16 a[20:23], a[132:135], v[196:199], a[20:23]
    ds_read_b128 v[84:87], v17 offset:17408
    v_mfma_f32_16x16x32_bf16 a[24:27], a[132:135], v[200:203], a[24:27]
    v_mfma_f32_16x16x32_bf16 a[28:31], a[132:135], v[204:207], a[28:31]
    v_mfma_f32_16x16x32_bf16 a[32:35], a[136:139], v[192:195], a[32:35]
    buffer_load_dwordx4 v[56:59], v30, s[28:31], s74 offen offset:1024 sc1
    v_mfma_f32_16x16x32_bf16 a[36:39], a[136:139], v[196:199], a[36:39]
    ds_read_b128 v[88:91], v17 offset:18432
    v_mfma_f32_16x16x32_bf16 a[40:43], a[136:139], v[200:203], a[40:43]
    v_mfma_f32_16x16x32_bf16 a[44:47], a[136:139], v[204:207], a[44:47]
    v_mfma_f32_16x16x32_bf16 a[48:51], a[140:143], v[192:195], a[48:51]
    buffer_load_dwordx4 v[60:63], v31, s[28:31], s74 offen offset:1024 sc1
    v_mfma_f32_16x16x32_bf16 a[52:55], a[140:143], v[196:199], a[52:55]
    ds_read_b128 v[92:95], v17 offset:19456
    v_mfma_f32_16x16x32_bf16 a[56:59], a[140:143], v[200:203], a[56:59]
    v_mfma_f32_16x16x32_bf16 a[60:63], a[140:143], v[204:207], a[60:63]
    s_waitcnt lgkmcnt(4)
    v_mfma_f32_16x16x32_bf16 a[0:3], v[176:179], v[160:163], a[0:3]
    buffer_load_dwordx4 v[192:195], v28, s[28:31], s75 offen offset:0 sc1
    v_mfma_f32_16x16x32_bf16 a[4:7], v[176:179], v[164:167], a[4:7]
    ds_read_b128 v[128:131], v17 offset:32768
    v_mfma_f32_16x16x32_bf16 a[8:11], v[176:179], v[168:171], a[8:11]
    v_mfma_f32_16x16x32_bf16 a[12:15], v[176:179], v[172:175], a[12:15]
    v_mfma_f32_16x16x32_bf16 a[16:19], v[180:183], v[160:163], a[16:19]
    buffer_load_dwordx4 v[196:199], v29, s[28:31], s75 offen offset:0 sc1
    v_mfma_f32_16x16x32_bf16 a[20:23], v[180:183], v[164:167], a[20:23]
    ds_read_b128 v[132:135], v17 offset:33792
    v_mfma_f32_16x16x32_bf16 a[24:27], v[180:183], v[168:171], a[24:27]
    v_mfma_f32_16x16x32_bf16 a[28:31], v[180:183], v[172:175], a[28:31]
    v_mfma_f32_16x16x32_bf16 a[32:35], v[184:187], v[160:163], a[32:35]
    buffer_load_dwordx4 v[200:203], v30, s[28:31], s75 offen offset:0 sc1
    v_mfma_f32_16x16x32_bf16 a[36:39], v[184:187], v[164:167], a[36:39]
    ds_read_b128 v[136:139], v17 offset:34816
    v_mfma_f32_16x16x32_bf16 a[40:43], v[184:187], v[168:171], a[40:43]
    v_mfma_f32_16x16x32_bf16 a[44:47], v[184:187], v[172:175], a[44:47]
    v_mfma_f32_16x16x32_bf16 a[48:51], v[188:191], v[160:163], a[48:51]
    buffer_load_dwordx4 v[204:207], v31, s[28:31], s75 offen offset:0 sc1
    v_mfma_f32_16x16x32_bf16 a[52:55], v[188:191], v[164:167], a[52:55]
    ds_read_b128 v[140:143], v17 offset:35840
    v_mfma_f32_16x16x32_bf16 a[56:59], v[188:191], v[168:171], a[56:59]
    v_mfma_f32_16x16x32_bf16 a[60:63], v[188:191], v[172:175], a[60:63]
    s_waitcnt lgkmcnt(4)
    v_mfma_f32_16x16x32_bf16 a[0:3], v[80:83], a[192:195], a[0:3]
    buffer_load_dwordx4 v[160:163], v28, s[28:31], s75 offen offset:1024 sc1
    v_mfma_f32_16x16x32_bf16 a[4:7], v[80:83], a[196:199], a[4:7]
    ds_read_b128 v[96:99], v17 offset:49152
    v_mfma_f32_16x16x32_bf16 a[8:11], v[80:83], a[200:203], a[8:11]
    v_mfma_f32_16x16x32_bf16 a[12:15], v[80:83], a[204:207], a[12:15]
    v_mfma_f32_16x16x32_bf16 a[16:19], v[84:87], a[192:195], a[16:19]
    buffer_load_dwordx4 v[164:167], v29, s[28:31], s75 offen offset:1024 sc1
    v_mfma_f32_16x16x32_bf16 a[20:23], v[84:87], a[196:199], a[20:23]
    ds_read_b128 v[100:103], v17 offset:50176
    v_mfma_f32_16x16x32_bf16 a[24:27], v[84:87], a[200:203], a[24:27]
    v_mfma_f32_16x16x32_bf16 a[28:31], v[84:87], a[204:207], a[28:31]
    v_mfma_f32_16x16x32_bf16 a[32:35], v[88:91], a[192:195], a[32:35]
    buffer_load_dwordx4 v[168:171], v30, s[28:31], s75 offen offset:1024 sc1
    v_mfma_f32_16x16x32_bf16 a[36:39], v[88:91], a[196:199], a[36:39]
    ds_read_b128 v[104:107], v17 offset:51200
    v_mfma_f32_16x16x32_bf16 a[40:43], v[88:91], a[200:203], a[40:43]
    v_mfma_f32_16x16x32_bf16 a[44:47], v[88:91], a[204:207], a[44:47]
    v_mfma_f32_16x16x32_bf16 a[48:51], v[92:95], a[192:195], a[48:51]
    buffer_load_dwordx4 v[172:175], v31, s[28:31], s75 offen offset:1024 sc1
    v_mfma_f32_16x16x32_bf16 a[52:55], v[92:95], a[196:199], a[52:55]
    ds_read_b128 v[108:111], v17 offset:52224
    v_mfma_f32_16x16x32_bf16 a[56:59], v[92:95], a[200:203], a[56:59]
    v_mfma_f32_16x16x32_bf16 a[60:63], v[92:95], a[204:207], a[60:63]
    s_waitcnt vmcnt(24)
    s_waitcnt lgkmcnt(4)
    v_mfma_f32_16x16x32_bf16 a[0:3], v[128:131], a[208:211], a[0:3]
    buffer_load_dwordx4 a[192:195], v28, s[28:31], s76 offen offset:0 sc1
    v_mfma_f32_16x16x32_bf16 a[4:7], v[128:131], a[212:215], a[4:7]
    v_mfma_f32_16x16x32_bf16 a[8:11], v[128:131], a[216:219], a[8:11]
    v_mfma_f32_16x16x32_bf16 a[12:15], v[128:131], a[220:223], a[12:15]
    v_mfma_f32_16x16x32_bf16 a[16:19], v[132:135], a[208:211], a[16:19]
    buffer_load_dwordx4 a[196:199], v29, s[28:31], s76 offen offset:0 sc1
    v_mfma_f32_16x16x32_bf16 a[20:23], v[132:135], a[212:215], a[20:23]
    v_mfma_f32_16x16x32_bf16 a[24:27], v[132:135], a[216:219], a[24:27]
    v_mfma_f32_16x16x32_bf16 a[28:31], v[132:135], a[220:223], a[28:31]
    v_mfma_f32_16x16x32_bf16 a[32:35], v[136:139], a[208:211], a[32:35]
    buffer_load_dwordx4 a[200:203], v30, s[28:31], s76 offen offset:0 sc1
    v_mfma_f32_16x16x32_bf16 a[36:39], v[136:139], a[212:215], a[36:39]
    v_mfma_f32_16x16x32_bf16 a[40:43], v[136:139], a[216:219], a[40:43]
    v_mfma_f32_16x16x32_bf16 a[44:47], v[136:139], a[220:223], a[44:47]
    v_mfma_f32_16x16x32_bf16 a[48:51], v[140:143], a[208:211], a[48:51]
    buffer_load_dwordx4 a[204:207], v31, s[28:31], s76 offen offset:0 sc1
    v_mfma_f32_16x16x32_bf16 a[52:55], v[140:143], a[212:215], a[52:55]
    v_mfma_f32_16x16x32_bf16 a[56:59], v[140:143], a[216:219], a[56:59]
    v_mfma_f32_16x16x32_bf16 a[60:63], v[140:143], a[220:223], a[60:63]
    s_waitcnt vmcnt(21)
    s_waitcnt lgkmcnt(0)
    v_mfma_f32_16x16x32_bf16 a[0:3], v[96:99], v[32:35], a[0:3]
    buffer_load_dwordx4 a[208:211], v28, s[28:31], s76 offen offset:1024 sc1
    v_mfma_f32_16x16x32_bf16 a[4:7], v[96:99], v[36:39], a[4:7]
    v_mfma_f32_16x16x32_bf16 a[8:11], v[96:99], v[40:43], a[8:11]
    v_mfma_f32_16x16x32_bf16 a[12:15], v[96:99], v[44:47], a[12:15]
    v_mfma_f32_16x16x32_bf16 a[16:19], v[100:103], v[32:35], a[16:19]
    buffer_load_dwordx4 a[212:215], v29, s[28:31], s76 offen offset:1024 sc1
    v_mfma_f32_16x16x32_bf16 a[20:23], v[100:103], v[36:39], a[20:23]
    v_mfma_f32_16x16x32_bf16 a[24:27], v[100:103], v[40:43], a[24:27]
    v_mfma_f32_16x16x32_bf16 a[28:31], v[100:103], v[44:47], a[28:31]
    v_mfma_f32_16x16x32_bf16 a[32:35], v[104:107], v[32:35], a[32:35]
    buffer_load_dwordx4 a[216:219], v30, s[28:31], s76 offen offset:1024 sc1
    v_mfma_f32_16x16x32_bf16 a[36:39], v[104:107], v[36:39], a[36:39]
    v_mfma_f32_16x16x32_bf16 a[40:43], v[104:107], v[40:43], a[40:43]
    v_mfma_f32_16x16x32_bf16 a[44:47], v[104:107], v[44:47], a[44:47]
    v_mfma_f32_16x16x32_bf16 a[48:51], v[108:111], v[32:35], a[48:51]
    buffer_load_dwordx4 a[220:223], v31, s[28:31], s76 offen offset:1024 sc1
    v_mfma_f32_16x16x32_bf16 a[52:55], v[108:111], v[36:39], a[52:55]
    v_mfma_f32_16x16x32_bf16 a[56:59], v[108:111], v[40:43], a[56:59]
    v_mfma_f32_16x16x32_bf16 a[60:63], v[108:111], v[44:47], a[60:63]
    s_waitcnt vmcnt(20)
    v_mfma_f32_16x16x32_bf16 a[0:3], a[64:67], v[144:147], a[0:3]
    buffer_load_dwordx4 v[32:35], v28, s[28:31], s77 offen offset:0 sc1
    v_mfma_f32_16x16x32_bf16 a[4:7], a[64:67], v[148:151], a[4:7]
    v_mfma_f32_16x16x32_bf16 a[8:11], a[64:67], v[152:155], a[8:11]
    v_mfma_f32_16x16x32_bf16 a[12:15], a[64:67], v[156:159], a[12:15]
    v_mfma_f32_16x16x32_bf16 a[16:19], a[68:71], v[144:147], a[16:19]
    buffer_load_dwordx4 v[36:39], v29, s[28:31], s77 offen offset:0 sc1
    v_mfma_f32_16x16x32_bf16 a[20:23], a[68:71], v[148:151], a[20:23]
    v_mfma_f32_16x16x32_bf16 a[24:27], a[68:71], v[152:155], a[24:27]
    v_mfma_f32_16x16x32_bf16 a[28:31], a[68:71], v[156:159], a[28:31]
    v_mfma_f32_16x16x32_bf16 a[32:35], a[72:75], v[144:147], a[32:35]
    buffer_load_dwordx4 v[40:43], v30, s[28:31], s77 offen offset:0 sc1
    v_mfma_f32_16x16x32_bf16 a[36:39], a[72:75], v[148:151], a[36:39]
    v_mfma_f32_16x16x32_bf16 a[40:43], a[72:75], v[152:155], a[40:43]
    v_mfma_f32_16x16x32_bf16 a[44:47], a[72:75], v[156:159], a[44:47]
    v_mfma_f32_16x16x32_bf16 a[48:51], a[76:79], v[144:147], a[48:51]
    buffer_load_dwordx4 v[44:47], v31, s[28:31], s77 offen offset:0 sc1
    v_mfma_f32_16x16x32_bf16 a[52:55], a[76:79], v[148:151], a[52:55]
    v_mfma_f32_16x16x32_bf16 a[56:59], a[76:79], v[152:155], a[56:59]
    v_mfma_f32_16x16x32_bf16 a[60:63], a[76:79], v[156:159], a[60:63]
    s_waitcnt vmcnt(20)
    v_mfma_f32_16x16x32_bf16 a[0:3], a[80:83], v[48:51], a[0:3]
    buffer_load_dwordx4 v[144:147], v28, s[28:31], s77 offen offset:1024 sc1
    v_mfma_f32_16x16x32_bf16 a[4:7], a[80:83], v[52:55], a[4:7]
    v_mfma_f32_16x16x32_bf16 a[8:11], a[80:83], v[56:59], a[8:11]
    v_mfma_f32_16x16x32_bf16 a[12:15], a[80:83], v[60:63], a[12:15]
    v_mfma_f32_16x16x32_bf16 a[16:19], a[84:87], v[48:51], a[16:19]
    buffer_load_dwordx4 v[148:151], v29, s[28:31], s77 offen offset:1024 sc1
    v_mfma_f32_16x16x32_bf16 a[20:23], a[84:87], v[52:55], a[20:23]
    v_mfma_f32_16x16x32_bf16 a[24:27], a[84:87], v[56:59], a[24:27]
    v_mfma_f32_16x16x32_bf16 a[28:31], a[84:87], v[60:63], a[28:31]
    v_mfma_f32_16x16x32_bf16 a[32:35], a[88:91], v[48:51], a[32:35]
    buffer_load_dwordx4 v[152:155], v30, s[28:31], s77 offen offset:1024 sc1
    v_mfma_f32_16x16x32_bf16 a[36:39], a[88:91], v[52:55], a[36:39]
    v_mfma_f32_16x16x32_bf16 a[40:43], a[88:91], v[56:59], a[40:43]
    v_mfma_f32_16x16x32_bf16 a[44:47], a[88:91], v[60:63], a[44:47]
    v_mfma_f32_16x16x32_bf16 a[48:51], a[92:95], v[48:51], a[48:51]
    buffer_load_dwordx4 v[156:159], v31, s[28:31], s77 offen offset:1024 sc1
    v_mfma_f32_16x16x32_bf16 a[52:55], a[92:95], v[52:55], a[52:55]
    v_mfma_f32_16x16x32_bf16 a[56:59], a[92:95], v[56:59], a[56:59]
    v_mfma_f32_16x16x32_bf16 a[60:63], a[92:95], v[60:63], a[60:63]
    s_waitcnt vmcnt(20)
    v_mfma_f32_16x16x32_bf16 a[0:3], a[96:99], v[192:195], a[0:3]
    buffer_load_dwordx4 v[48:51], v28, s[28:31], s78 offen offset:0 sc1
    v_mfma_f32_16x16x32_bf16 a[4:7], a[96:99], v[196:199], a[4:7]
    ds_read_b128 a[240:243], v16 offset:32768
    v_mfma_f32_16x16x32_bf16 a[8:11], a[96:99], v[200:203], a[8:11]
    v_mfma_f32_16x16x32_bf16 a[12:15], a[96:99], v[204:207], a[12:15]
    v_mfma_f32_16x16x32_bf16 a[16:19], a[100:103], v[192:195], a[16:19]
    buffer_load_dwordx4 v[52:55], v29, s[28:31], s78 offen offset:0 sc1
    v_mfma_f32_16x16x32_bf16 a[20:23], a[100:103], v[196:199], a[20:23]
    ds_read_b128 a[244:247], v16 offset:33792
    v_mfma_f32_16x16x32_bf16 a[24:27], a[100:103], v[200:203], a[24:27]
    v_mfma_f32_16x16x32_bf16 a[28:31], a[100:103], v[204:207], a[28:31]
    v_mfma_f32_16x16x32_bf16 a[32:35], a[104:107], v[192:195], a[32:35]
    buffer_load_dwordx4 v[56:59], v30, s[28:31], s78 offen offset:0 sc1
    v_mfma_f32_16x16x32_bf16 a[36:39], a[104:107], v[196:199], a[36:39]
    ds_read_b128 a[248:251], v16 offset:34816
    v_mfma_f32_16x16x32_bf16 a[40:43], a[104:107], v[200:203], a[40:43]
    v_mfma_f32_16x16x32_bf16 a[44:47], a[104:107], v[204:207], a[44:47]
    v_mfma_f32_16x16x32_bf16 a[48:51], a[108:111], v[192:195], a[48:51]
    buffer_load_dwordx4 v[60:63], v31, s[28:31], s78 offen offset:0 sc1
    v_mfma_f32_16x16x32_bf16 a[52:55], a[108:111], v[196:199], a[52:55]
    ds_read_b128 a[252:255], v16 offset:35840
    v_mfma_f32_16x16x32_bf16 a[56:59], a[108:111], v[200:203], a[56:59]
    v_mfma_f32_16x16x32_bf16 a[60:63], a[108:111], v[204:207], a[60:63]
    s_waitcnt vmcnt(20)
    v_mfma_f32_16x16x32_bf16 a[0:3], a[112:115], v[160:163], a[0:3]
    buffer_load_dwordx4 v[192:195], v28, s[28:31], s78 offen offset:1024 sc1
    v_mfma_f32_16x16x32_bf16 a[4:7], a[112:115], v[164:167], a[4:7]
    ds_read_b128 v[64:67], v16 offset:49152
    v_mfma_f32_16x16x32_bf16 a[8:11], a[112:115], v[168:171], a[8:11]
    v_mfma_f32_16x16x32_bf16 a[12:15], a[112:115], v[172:175], a[12:15]
    v_mfma_f32_16x16x32_bf16 a[16:19], a[116:119], v[160:163], a[16:19]
    buffer_load_dwordx4 v[196:199], v29, s[28:31], s78 offen offset:1024 sc1
    v_mfma_f32_16x16x32_bf16 a[20:23], a[116:119], v[164:167], a[20:23]
    ds_read_b128 v[68:71], v16 offset:50176
    v_mfma_f32_16x16x32_bf16 a[24:27], a[116:119], v[168:171], a[24:27]
    v_mfma_f32_16x16x32_bf16 a[28:31], a[116:119], v[172:175], a[28:31]
    v_mfma_f32_16x16x32_bf16 a[32:35], a[120:123], v[160:163], a[32:35]
    buffer_load_dwordx4 v[200:203], v30, s[28:31], s78 offen offset:1024 sc1
    v_mfma_f32_16x16x32_bf16 a[36:39], a[120:123], v[164:167], a[36:39]
    ds_read_b128 v[72:75], v16 offset:51200
    v_mfma_f32_16x16x32_bf16 a[40:43], a[120:123], v[168:171], a[40:43]
    v_mfma_f32_16x16x32_bf16 a[44:47], a[120:123], v[172:175], a[44:47]
    v_mfma_f32_16x16x32_bf16 a[48:51], a[124:127], v[160:163], a[48:51]
    buffer_load_dwordx4 v[204:207], v31, s[28:31], s78 offen offset:1024 sc1
    v_mfma_f32_16x16x32_bf16 a[52:55], a[124:127], v[164:167], a[52:55]
    ds_read_b128 v[76:79], v16 offset:52224
    v_mfma_f32_16x16x32_bf16 a[56:59], a[124:127], v[168:171], a[56:59]
    v_mfma_f32_16x16x32_bf16 a[60:63], a[124:127], v[172:175], a[60:63]
    s_waitcnt vmcnt(20)
    s_waitcnt lgkmcnt(4)
    v_mfma_f32_16x16x32_bf16 a[0:3], a[240:243], a[192:195], a[0:3]
    buffer_load_dwordx4 v[160:163], v28, s[28:31], s79 offen offset:0 sc1
    v_mfma_f32_16x16x32_bf16 a[4:7], a[240:243], a[196:199], a[4:7]
    v_mfma_f32_16x16x32_bf16 a[8:11], a[240:243], a[200:203], a[8:11]
    v_mfma_f32_16x16x32_bf16 a[12:15], a[240:243], a[204:207], a[12:15]
    v_mfma_f32_16x16x32_bf16 a[16:19], a[244:247], a[192:195], a[16:19]
    buffer_load_dwordx4 v[164:167], v29, s[28:31], s79 offen offset:0 sc1
    v_mfma_f32_16x16x32_bf16 a[20:23], a[244:247], a[196:199], a[20:23]
    v_mfma_f32_16x16x32_bf16 a[24:27], a[244:247], a[200:203], a[24:27]
    v_mfma_f32_16x16x32_bf16 a[28:31], a[244:247], a[204:207], a[28:31]
    v_mfma_f32_16x16x32_bf16 a[32:35], a[248:251], a[192:195], a[32:35]
    buffer_load_dwordx4 v[168:171], v30, s[28:31], s79 offen offset:0 sc1
    v_mfma_f32_16x16x32_bf16 a[36:39], a[248:251], a[196:199], a[36:39]
    v_mfma_f32_16x16x32_bf16 a[40:43], a[248:251], a[200:203], a[40:43]
    v_mfma_f32_16x16x32_bf16 a[44:47], a[248:251], a[204:207], a[44:47]
    v_mfma_f32_16x16x32_bf16 a[48:51], a[252:255], a[192:195], a[48:51]
    buffer_load_dwordx4 v[172:175], v31, s[28:31], s79 offen offset:0 sc1
    v_mfma_f32_16x16x32_bf16 a[52:55], a[252:255], a[196:199], a[52:55]
    v_mfma_f32_16x16x32_bf16 a[56:59], a[252:255], a[200:203], a[56:59]
    v_mfma_f32_16x16x32_bf16 a[60:63], a[252:255], a[204:207], a[60:63]
    s_waitcnt vmcnt(20)
    s_waitcnt lgkmcnt(0)
    v_mfma_f32_16x16x32_bf16 a[0:3], v[64:67], a[208:211], a[0:3]
    buffer_load_dwordx4 a[192:195], v28, s[28:31], s79 offen offset:1024 sc1
    v_mfma_f32_16x16x32_bf16 a[4:7], v[64:67], a[212:215], a[4:7]
    s_add_u32 s49, s89, 8192
    buffer_load_dwordx4 v[176:179], v25, s[4:7], s89 offen
    v_mfma_f32_16x16x32_bf16 a[8:11], v[64:67], a[216:219], a[8:11]
    buffer_load_dwordx4 v[180:183], v25, s[4:7], s49 offen
    v_mfma_f32_16x16x32_bf16 a[12:15], v[64:67], a[220:223], a[12:15]
    v_mfma_f32_16x16x32_bf16 a[16:19], v[68:71], a[208:211], a[16:19]
    buffer_load_dwordx4 a[196:199], v29, s[28:31], s79 offen offset:1024 sc1
    v_mfma_f32_16x16x32_bf16 a[20:23], v[68:71], a[212:215], a[20:23]
    v_mfma_f32_16x16x32_bf16 a[24:27], v[68:71], a[216:219], a[24:27]
    v_mfma_f32_16x16x32_bf16 a[28:31], v[68:71], a[220:223], a[28:31]
    v_mfma_f32_16x16x32_bf16 a[32:35], v[72:75], a[208:211], a[32:35]
    buffer_load_dwordx4 a[200:203], v30, s[28:31], s79 offen offset:1024 sc1
    v_mfma_f32_16x16x32_bf16 a[36:39], v[72:75], a[212:215], a[36:39]
    v_mfma_f32_16x16x32_bf16 a[40:43], v[72:75], a[216:219], a[40:43]
    v_mfma_f32_16x16x32_bf16 a[44:47], v[72:75], a[220:223], a[44:47]
    v_mfma_f32_16x16x32_bf16 a[48:51], v[76:79], a[208:211], a[48:51]
    buffer_load_dwordx4 a[204:207], v31, s[28:31], s79 offen offset:1024 sc1
    v_mfma_f32_16x16x32_bf16 a[52:55], v[76:79], a[212:215], a[52:55]
    v_mfma_f32_16x16x32_bf16 a[56:59], v[76:79], a[216:219], a[56:59]
    v_mfma_f32_16x16x32_bf16 a[60:63], v[76:79], a[220:223], a[60:63]
    s_waitcnt vmcnt(22)
    v_mfma_f32_16x16x32_bf16 a[0:3], v[208:211], v[32:35], a[0:3]
    v_mfma_f32_16x16x32_bf16 a[4:7], v[208:211], v[36:39], a[4:7]
    v_mfma_f32_16x16x32_bf16 a[8:11], v[208:211], v[40:43], a[8:11]
    v_mfma_f32_16x16x32_bf16 a[12:15], v[208:211], v[44:47], a[12:15]
    v_mfma_f32_16x16x32_bf16 a[16:19], v[212:215], v[32:35], a[16:19]
    v_mfma_f32_16x16x32_bf16 a[20:23], v[212:215], v[36:39], a[20:23]
    v_mfma_f32_16x16x32_bf16 a[24:27], v[212:215], v[40:43], a[24:27]
    v_mfma_f32_16x16x32_bf16 a[28:31], v[212:215], v[44:47], a[28:31]
    v_mfma_f32_16x16x32_bf16 a[32:35], v[216:219], v[32:35], a[32:35]
    v_mfma_f32_16x16x32_bf16 a[36:39], v[216:219], v[36:39], a[36:39]
    v_mfma_f32_16x16x32_bf16 a[40:43], v[216:219], v[40:43], a[40:43]
    v_mfma_f32_16x16x32_bf16 a[44:47], v[216:219], v[44:47], a[44:47]
    v_mfma_f32_16x16x32_bf16 a[48:51], v[220:223], v[32:35], a[48:51]
    v_mfma_f32_16x16x32_bf16 a[52:55], v[220:223], v[36:39], a[52:55]
    v_mfma_f32_16x16x32_bf16 a[56:59], v[220:223], v[40:43], a[56:59]
    v_mfma_f32_16x16x32_bf16 a[60:63], v[220:223], v[44:47], a[60:63]
    s_waitcnt vmcnt(18)
    v_mfma_f32_16x16x32_bf16 a[0:3], v[224:227], v[144:147], a[0:3]
    v_mfma_f32_16x16x32_bf16 a[4:7], v[224:227], v[148:151], a[4:7]
    v_mfma_f32_16x16x32_bf16 a[8:11], v[224:227], v[152:155], a[8:11]
    v_mfma_f32_16x16x32_bf16 a[12:15], v[224:227], v[156:159], a[12:15]
    v_mfma_f32_16x16x32_bf16 a[16:19], v[228:231], v[144:147], a[16:19]
    v_mfma_f32_16x16x32_bf16 a[20:23], v[228:231], v[148:151], a[20:23]
    v_mfma_f32_16x16x32_bf16 a[24:27], v[228:231], v[152:155], a[24:27]
    v_mfma_f32_16x16x32_bf16 a[28:31], v[228:231], v[156:159], a[28:31]
    v_mfma_f32_16x16x32_bf16 a[32:35], v[232:235], v[144:147], a[32:35]
    v_mfma_f32_16x16x32_bf16 a[36:39], v[232:235], v[148:151], a[36:39]
    v_mfma_f32_16x16x32_bf16 a[40:43], v[232:235], v[152:155], a[40:43]
    v_mfma_f32_16x16x32_bf16 a[44:47], v[232:235], v[156:159], a[44:47]
    v_mfma_f32_16x16x32_bf16 a[48:51], v[236:239], v[144:147], a[48:51]
    v_mfma_f32_16x16x32_bf16 a[52:55], v[236:239], v[148:151], a[52:55]
    v_mfma_f32_16x16x32_bf16 a[56:59], v[236:239], v[152:155], a[56:59]
    v_mfma_f32_16x16x32_bf16 a[60:63], v[236:239], v[156:159], a[60:63]
    s_waitcnt vmcnt(14)
    v_mfma_f32_16x16x32_bf16 a[0:3], a[176:179], v[48:51], a[0:3]
    v_mfma_f32_16x16x32_bf16 a[4:7], a[176:179], v[52:55], a[4:7]
    v_mfma_f32_16x16x32_bf16 a[8:11], a[176:179], v[56:59], a[8:11]
    v_mfma_f32_16x16x32_bf16 a[12:15], a[176:179], v[60:63], a[12:15]
    v_mfma_f32_16x16x32_bf16 a[16:19], a[180:183], v[48:51], a[16:19]
    v_mfma_f32_16x16x32_bf16 a[20:23], a[180:183], v[52:55], a[20:23]
    v_mfma_f32_16x16x32_bf16 a[24:27], a[180:183], v[56:59], a[24:27]
    v_mfma_f32_16x16x32_bf16 a[28:31], a[180:183], v[60:63], a[28:31]
    v_mfma_f32_16x16x32_bf16 a[32:35], a[184:187], v[48:51], a[32:35]
    v_mfma_f32_16x16x32_bf16 a[36:39], a[184:187], v[52:55], a[36:39]
    v_mfma_f32_16x16x32_bf16 a[40:43], a[184:187], v[56:59], a[40:43]
    v_mfma_f32_16x16x32_bf16 a[44:47], a[184:187], v[60:63], a[44:47]
    v_mfma_f32_16x16x32_bf16 a[48:51], a[188:191], v[48:51], a[48:51]
    v_mfma_f32_16x16x32_bf16 a[52:55], a[188:191], v[52:55], a[52:55]
    v_mfma_f32_16x16x32_bf16 a[56:59], a[188:191], v[56:59], a[56:59]
    v_mfma_f32_16x16x32_bf16 a[60:63], a[188:191], v[60:63], a[60:63]
    s_waitcnt vmcnt(10)
    v_mfma_f32_16x16x32_bf16 a[0:3], a[224:227], v[192:195], a[0:3]
    v_mfma_f32_16x16x32_bf16 a[4:7], a[224:227], v[196:199], a[4:7]
    v_mfma_f32_16x16x32_bf16 a[8:11], a[224:227], v[200:203], a[8:11]
    v_mfma_f32_16x16x32_bf16 a[12:15], a[224:227], v[204:207], a[12:15]
    v_mfma_f32_16x16x32_bf16 a[16:19], a[228:231], v[192:195], a[16:19]
    v_mfma_f32_16x16x32_bf16 a[20:23], a[228:231], v[196:199], a[20:23]
    v_mfma_f32_16x16x32_bf16 a[24:27], a[228:231], v[200:203], a[24:27]
    v_mfma_f32_16x16x32_bf16 a[28:31], a[228:231], v[204:207], a[28:31]
    v_mfma_f32_16x16x32_bf16 a[32:35], a[232:235], v[192:195], a[32:35]
    v_mfma_f32_16x16x32_bf16 a[36:39], a[232:235], v[196:199], a[36:39]
    v_mfma_f32_16x16x32_bf16 a[40:43], a[232:235], v[200:203], a[40:43]
    v_mfma_f32_16x16x32_bf16 a[44:47], a[232:235], v[204:207], a[44:47]
    v_mfma_f32_16x16x32_bf16 a[48:51], a[236:239], v[192:195], a[48:51]
    v_mfma_f32_16x16x32_bf16 a[52:55], a[236:239], v[196:199], a[52:55]
    v_mfma_f32_16x16x32_bf16 a[56:59], a[236:239], v[200:203], a[56:59]
    v_mfma_f32_16x16x32_bf16 a[60:63], a[236:239], v[204:207], a[60:63]
    s_waitcnt vmcnt(6)
    s_waitcnt vmcnt(0)
    v_mfma_f32_16x16x32_bf16 a[0:3], a[144:147], v[160:163], a[0:3]
    v_mfma_f32_16x16x32_bf16 a[0:3], a[160:163], a[192:195], a[0:3]
    v_mfma_f32_16x16x32_bf16 a[4:7], a[144:147], v[164:167], a[4:7]
    v_mfma_f32_16x16x32_bf16 a[4:7], a[160:163], a[196:199], a[4:7]
    v_mfma_f32_16x16x32_bf16 a[8:11], a[144:147], v[168:171], a[8:11]
    v_mfma_f32_16x16x32_bf16 a[8:11], a[160:163], a[200:203], a[8:11]
    v_mfma_f32_16x16x32_bf16 a[12:15], a[144:147], v[172:175], a[12:15]
    v_mfma_f32_16x16x32_bf16 a[12:15], a[160:163], a[204:207], a[12:15]
    v_mfma_f32_16x16x32_bf16 a[16:19], a[148:151], v[160:163], a[16:19]
    v_mfma_f32_16x16x32_bf16 a[16:19], a[164:167], a[192:195], a[16:19]
    ds_write_b128 v2, a[0:3] offset:0
    v_mfma_f32_16x16x32_bf16 a[20:23], a[148:151], v[164:167], a[20:23]
    v_mfma_f32_16x16x32_bf16 a[20:23], a[164:167], a[196:199], a[20:23]
    ds_write_b128 v2, a[4:7] offset:16384
    v_mfma_f32_16x16x32_bf16 a[24:27], a[148:151], v[168:171], a[24:27]
    v_mfma_f32_16x16x32_bf16 a[24:27], a[164:167], a[200:203], a[24:27]
    ds_write_b128 v2, a[8:11] offset:32768
    v_mfma_f32_16x16x32_bf16 a[28:31], a[148:151], v[172:175], a[28:31]
    v_mfma_f32_16x16x32_bf16 a[28:31], a[164:167], a[204:207], a[28:31]
    ds_write_b128 v2, a[12:15] offset:49152
    v_mfma_f32_16x16x32_bf16 a[32:35], a[152:155], v[160:163], a[32:35]
    v_mfma_f32_16x16x32_bf16 a[32:35], a[168:171], a[192:195], a[32:35]
    ds_write_b128 v3, a[16:19] offset:1024
    v_mfma_f32_16x16x32_bf16 a[36:39], a[152:155], v[164:167], a[36:39]
    v_mfma_f32_16x16x32_bf16 a[36:39], a[168:171], a[196:199], a[36:39]
    ds_write_b128 v3, a[20:23] offset:17408
    v_mfma_f32_16x16x32_bf16 a[40:43], a[152:155], v[168:171], a[40:43]
    v_mfma_f32_16x16x32_bf16 a[40:43], a[168:171], a[200:203], a[40:43]
    ds_write_b128 v3, a[24:27] offset:33792
    v_mfma_f32_16x16x32_bf16 a[44:47], a[152:155], v[172:175], a[44:47]
    v_mfma_f32_16x16x32_bf16 a[44:47], a[168:171], a[204:207], a[44:47]
    ds_write_b128 v3, a[28:31] offset:50176
    v_mfma_f32_16x16x32_bf16 a[48:51], a[156:159], v[160:163], a[48:51]
    v_mfma_f32_16x16x32_bf16 a[48:51], a[172:175], a[192:195], a[48:51]
    ds_write_b128 v4, a[32:35] offset:2048
    v_mfma_f32_16x16x32_bf16 a[52:55], a[156:159], v[164:167], a[52:55]
    v_mfma_f32_16x16x32_bf16 a[52:55], a[172:175], a[196:199], a[52:55]
    ds_write_b128 v4, a[36:39] offset:18432
    v_mfma_f32_16x16x32_bf16 a[56:59], a[156:159], v[168:171], a[56:59]
    v_mfma_f32_16x16x32_bf16 a[56:59], a[172:175], a[200:203], a[56:59]
    ds_write_b128 v4, a[40:43] offset:34816
    v_mfma_f32_16x16x32_bf16 a[60:63], a[156:159], v[172:175], a[60:63]
    v_mfma_f32_16x16x32_bf16 a[60:63], a[172:175], a[204:207], a[60:63]
    ds_write_b128 v4, a[44:47] offset:51200
    s_waitcnt vmcnt(0)
    v_lshlrev_b32 v128, 16, v176
    v_and_b32 v129, 0xffff0000, v176
    v_lshlrev_b32 v130, 16, v177
    v_and_b32 v131, 0xffff0000, v177
    ds_write_b128 v5, a[48:51] offset:3072
    v_lshlrev_b32 v132, 16, v178
    v_and_b32 v133, 0xffff0000, v178
    v_lshlrev_b32 v134, 16, v179
    v_and_b32 v135, 0xffff0000, v179
    ds_write_b128 v5, a[52:55] offset:19456
    v_lshlrev_b32 v136, 16, v180
    v_and_b32 v137, 0xffff0000, v180
    v_lshlrev_b32 v138, 16, v181
    v_and_b32 v139, 0xffff0000, v181
    ds_write_b128 v5, a[56:59] offset:35840
    v_lshlrev_b32 v140, 16, v182
    v_and_b32 v141, 0xffff0000, v182
    v_lshlrev_b32 v142, 16, v183
    v_and_b32 v143, 0xffff0000, v183
    ds_write_b128 v5, a[60:63] offset:52224
    s_waitcnt lgkmcnt(0)
    s_barrier
    ds_read_b128 v[64:67], v6 offset:0
    ds_read_b128 v[80:83], v6 offset:4096
    ds_read_b128 v[96:99], v6 offset:8192
    ds_read_b128 v[112:115], v6 offset:12288
    ds_read_b128 v[68:71], v6 offset:256
    ds_read_b128 v[84:87], v6 offset:4352
    ds_read_b128 v[100:103], v6 offset:8448
    ds_read_b128 v[116:119], v6 offset:12544
    ds_read_b128 v[72:75], v7 offset:0
    ds_read_b128 v[88:91], v7 offset:4096
    ds_read_b128 v[104:107], v7 offset:8192
    ds_read_b128 v[120:123], v7 offset:12288
    ds_read_b128 v[76:79], v7 offset:256
    ds_read_b128 v[92:95], v7 offset:4352
    ds_read_b128 v[108:111], v7 offset:8448
    ds_read_b128 v[124:127], v7 offset:12544
    s_waitcnt lgkmcnt(8)
    v_pk_add_f32 v[64:65], v[64:65], v[80:81]
    v_pk_add_f32 v[96:97], v[96:97], v[112:113]
    v_pk_add_f32 v[66:67], v[66:67], v[82:83]
    v_pk_add_f32 v[98:99], v[98:99], v[114:115]
    v_pk_add_f32 v[68:69], v[68:69], v[84:85]
    v_pk_add_f32 v[100:101], v[100:101], v[116:117]
    v_pk_add_f32 v[70:71], v[70:71], v[86:87]
    v_pk_add_f32 v[102:103], v[102:103], v[118:119]
    v_pk_add_f32 v[64:65], v[64:65], v[96:97]
    v_pk_add_f32 v[66:67], v[66:67], v[98:99]
    v_pk_add_f32 v[68:69], v[68:69], v[100:101]
    v_pk_add_f32 v[70:71], v[70:71], v[102:103]
    v_pk_fma_f32 v[128:129], v[64:65], v[240:241], v[128:129]
    v_pk_fma_f32 v[130:131], v[66:67], v[242:243], v[130:131]
    v_pk_fma_f32 v[132:133], v[68:69], v[244:245], v[132:133]
    v_pk_fma_f32 v[134:135], v[70:71], v[246:247], v[134:135]
    v_cvt_pk_bf16_f32 v144, v128, v129
    v_cvt_pk_bf16_f32 v145, v130, v131
    v_cvt_pk_bf16_f32 v146, v132, v133
    v_cvt_pk_bf16_f32 v147, v134, v135
    buffer_store_dwordx4 v[144:147], v25, s[12:15], s89 offen
    s_waitcnt lgkmcnt(0)
    v_pk_add_f32 v[72:73], v[72:73], v[88:89]
    v_pk_add_f32 v[104:105], v[104:105], v[120:121]
    v_pk_add_f32 v[74:75], v[74:75], v[90:91]
    v_pk_add_f32 v[106:107], v[106:107], v[122:123]
    v_pk_add_f32 v[76:77], v[76:77], v[92:93]
    v_pk_add_f32 v[108:109], v[108:109], v[124:125]
    v_pk_add_f32 v[78:79], v[78:79], v[94:95]
    v_pk_add_f32 v[110:111], v[110:111], v[126:127]
    v_pk_add_f32 v[72:73], v[72:73], v[104:105]
    v_pk_add_f32 v[74:75], v[74:75], v[106:107]
    v_pk_add_f32 v[76:77], v[76:77], v[108:109]
    v_pk_add_f32 v[78:79], v[78:79], v[110:111]
    v_pk_fma_f32 v[136:137], v[72:73], v[248:249], v[136:137]
    v_pk_fma_f32 v[138:139], v[74:75], v[250:251], v[138:139]
    v_pk_fma_f32 v[140:141], v[76:77], v[252:253], v[140:141]
    v_pk_fma_f32 v[142:143], v[78:79], v[254:255], v[142:143]
    v_cvt_pk_bf16_f32 v148, v136, v137
    v_cvt_pk_bf16_f32 v149, v138, v139
    v_cvt_pk_bf16_f32 v150, v140, v141
    v_cvt_pk_bf16_f32 v151, v142, v143
    buffer_store_dwordx4 v[148:151], v25, s[12:15], s49 offen
    s_waitcnt vmcnt(0)
L_done:
    s_endpgm
L_ew:
    s_mov_b32 s89, 0x40000
L_ew1:
    v_mov_b32 v47, 0
    global_load_dword v45, v47, s[84:85] sc1
    s_waitcnt vmcnt(0)
    buffer_load_dword v46, v62, s[60:63], 0 offen sc1
    s_waitcnt vmcnt(0)
    v_cmp_gt_u32 vcc, 0x100, v45
    s_mov_b64 s[90:91], vcc
    v_cmp_eq_u32 vcc, 0, v46
    s_or_b64 vcc, vcc, s[90:91]
    s_cbranch_vccz L_er
    s_sleep 1
    s_sub_u32 s89, s89, 1
    s_cmp_lg_u32 s89, 0
    s_cbranch_scc1 L_ew1
    s_branch L_er
L_hw:
    s_mov_b32 s49, 0x40000
L_hw1:
    global_load_dword v22, v9, s[84:85] sc1
    s_waitcnt vmcnt(0)
    buffer_load_dword v21, v20, s[60:63], s40 offen sc1
    buffer_load_dwordx2 v[10:11], v12, s[60:63], 0 offen sc1
    s_waitcnt vmcnt(0)
    v_cmp_gt_u32 vcc, 0x100, v22
    v_min3_u32 v21, v21, v10, v11
    s_mov_b64 s[90:91], vcc
    v_cmp_gt_u32 vcc, 1, v21
    s_or_b64 vcc, vcc, s[90:91]
    s_cbranch_vccz L_h_ok
    s_sleep 1
    s_sub_u32 s49, s49, 1
    s_cmp_lg_u32 s49, 0
    s_cbranch_scc1 L_hw1
    s_branch L_h_ok
L_w0:
    s_mov_b32 s53, 0x40000
L_w0_l:
    buffer_load_dword v23, v21, s[60:63], s40 offen sc1
    s_waitcnt vmcnt(0)
    v_cmp_eq_u32 vcc, 0, v23
    s_and_b32 s49, vcc_lo, 0xff
    s_cbranch_scc0 L_w0_d
    s_sleep 1
    s_sub_u32 s53, s53, 1
    s_cmp_lg_u32 s53, 0
    s_cbranch_scc1 L_w0_l
L_w0_d:
    buffer_load_dwordx4 v[48:51], v28, s[28:31], s64 offen offset:0 sc1
    buffer_load_dwordx4 v[52:55], v29, s[28:31], s64 offen offset:0 sc1
    buffer_load_dwordx4 v[56:59], v30, s[28:31], s64 offen offset:0 sc1
    buffer_load_dwordx4 v[60:63], v31, s[28:31], s64 offen offset:0 sc1
    buffer_load_dwordx4 v[192:195], v28, s[28:31], s64 offen offset:1024 sc1
    buffer_load_dwordx4 v[196:199], v29, s[28:31], s64 offen offset:1024 sc1
    buffer_load_dwordx4 v[200:203], v30, s[28:31], s64 offen offset:1024 sc1
    buffer_load_dwordx4 v[204:207], v31, s[28:31], s64 offen offset:1024 sc1
    s_waitcnt vmcnt(0)
    s_branch L_r0
L_w1:
    s_mov_b32 s53, 0x40000
L_w1_l:
    buffer_load_dword v23, v21, s[60:63], s40 offen sc1
    s_waitcnt vmcnt(0)
    v_cmp_eq_u32 vcc, 0, v23
    s_and_b32 s49, vcc_lo, 0xff00
    s_cbranch_scc0 L_w1_d
    s_sleep 1
    s_sub_u32 s53, s53, 1
    s_cmp_lg_u32 s53, 0
    s_cbranch_scc1 L_w1_l
L_w1_d:
    s_branch L_r1
L_code_end:
L_slow:
    s_waitcnt vmcnt(0) lgkmcnt(0)
    s_barrier
    s_mov_b32 s53, 1
    s_mov_b32 s89, s42
    s_add_u32 s50, s89, 65536
    v_lshrrev_b32 v1, 4, v0
    v_and_b32 v2, 15, v0
    v_bfe_u32 v3, v0, 2, 2
    v_and_b32 v4, 3, v0
    v_lshrrev_b32 v5, 3, v0
    v_and_b32 v6, 7, v0
    v_lshlrev_b32 v7, 14, v3
    v_lshl_add_u32 v7, v4, 8, v7
    v_add_u32 v7, s89, v7
    v_xor_b32 v8, v1, v2
    v_xor_b32 v9, 0, v8
    v_lshl_add_u32 v26, v9, 4, v7
    v_xor_b32 v9, 4, v8
    v_lshl_add_u32 v27, v9, 4, v7
    v_xor_b32 v9, 8, v8
    v_lshl_add_u32 v28, v9, 4, v7
    v_xor_b32 v9, 12, v8
    v_lshl_add_u32 v29, v9, 4, v7
    v_lshlrev_b32 v7, 14, v1
    v_lshl_add_u32 v7, v3, 8, v7
    v_lshl_add_u32 v7, v4, 3, v7
    v_add_u32 v7, s50, v7
    v_and_b32 v8, 1, v1
    v_lshlrev_b32 v8, 2, v8
    v_or_b32 v8, v8, v3
    v_xor_b32 v9, 0, v8
    v_lshl_add_u32 v30, v9, 5, v7
    v_xor_b32 v9, 1, v8
    v_lshl_add_u32 v31, v9, 5, v7
    v_xor_b32 v9, 2, v8
    v_lshl_add_u32 v32, v9, 5, v7
    v_xor_b32 v9, 3, v8
    v_lshl_add_u32 v33, v9, 5, v7
    v_xor_b32 v9, 4, v8
    v_lshl_add_u32 v34, v9, 5, v7
    v_xor_b32 v9, 5, v8
    v_lshl_add_u32 v35, v9, 5, v7
    v_xor_b32 v9, 6, v8
    v_lshl_add_u32 v36, v9, 5, v7
    v_xor_b32 v9, 7, v8
    v_lshl_add_u32 v37, v9, 5, v7
    v_or_b32 v7, 0, v1
    v_xor_b32 v7, v7, v2
    v_lshlrev_b32 v7, 4, v7
    v_lshl_add_u32 v192, v1, 8, v7
    v_add_u32 v192, 0, v192
    v_or_b32 v7, 0, v1
    v_lshlrev_b32 v7, 1, v7
    v_xor_b32 v7, v7, v2
    v_lshlrev_b32 v7, 4, v7
    v_lshl_add_u32 v196, v1, 8, v7
    v_add_u32 v196, 0, v196
    v_or_b32 v7, 4, v1
    v_xor_b32 v7, v7, v2
    v_lshlrev_b32 v7, 4, v7
    v_lshl_add_u32 v193, v1, 8, v7
    v_add_u32 v193, 4096, v193
    v_or_b32 v7, 4, v1
    v_lshlrev_b32 v7, 1, v7
    v_xor_b32 v7, v7, v2
    v_lshlrev_b32 v7, 4, v7
    v_lshl_add_u32 v197, v1, 8, v7
    v_add_u32 v197, 4096, v197
    v_or_b32 v7, 8, v1
    v_xor_b32 v7, v7, v2
    v_lshlrev_b32 v7, 4, v7
    v_lshl_add_u32 v194, v1, 8, v7
    v_add_u32 v194, 8192, v194
    v_or_b32 v7, 0, v1
    v_lshlrev_b32 v7, 1, v7
    v_xor_b32 v7, v7, v2
    v_lshlrev_b32 v7, 4, v7
    v_lshl_add_u32 v198, v1, 8, v7
    v_add_u32 v198, 8192, v198
    v_or_b32 v7, 12, v1
    v_xor_b32 v7, v7, v2
    v_lshlrev_b32 v7, 4, v7
    v_lshl_add_u32 v195, v1, 8, v7
    v_add_u32 v195, 12288, v195
    v_or_b32 v7, 4, v1
    v_lshlrev_b32 v7, 1, v7
    v_xor_b32 v7, v7, v2
    v_lshlrev_b32 v7, 4, v7
    v_lshl_add_u32 v199, v1, 8, v7
    v_add_u32 v199, 12288, v199
    v_mov_b32 v1, 0xff800000
    v_mov_b32 v2, 0xff800000
    v_mov_b32 v3, 0xff800000
    v_mov_b32 v4, 0xff800000
    s_mov_b32 s48, 0
L_slow1:
    s_add_u32 m0, s89, 0
    s_nop 0
    buffer_load_dwordx4 v192, s[20:23], s48 offen offset:0 lds
    buffer_load_dwordx4 v192, s[20:23], s48 offen offset:1024 lds
    buffer_load_dwordx4 v192, s[20:23], s48 offen offset:2048 lds
    buffer_load_dwordx4 v192, s[20:23], s48 offen offset:3072 lds
    s_add_u32 m0, s89, 16384
    s_nop 0
    buffer_load_dwordx4 v193, s[20:23], s48 offen offset:0 lds
    buffer_load_dwordx4 v193, s[20:23], s48 offen offset:1024 lds
    buffer_load_dwordx4 v193, s[20:23], s48 offen offset:2048 lds
    buffer_load_dwordx4 v193, s[20:23], s48 offen offset:3072 lds
    s_add_u32 m0, s89, 32768
    s_nop 0
    buffer_load_dwordx4 v194, s[20:23], s48 offen offset:0 lds
    buffer_load_dwordx4 v194, s[20:23], s48 offen offset:1024 lds
    buffer_load_dwordx4 v194, s[20:23], s48 offen offset:2048 lds
    buffer_load_dwordx4 v194, s[20:23], s48 offen offset:3072 lds
    s_add_u32 m0, s89, 49152
    s_nop 0
    buffer_load_dwordx4 v195, s[20:23], s48 offen offset:0 lds
    buffer_load_dwordx4 v195, s[20:23], s48 offen offset:1024 lds
    buffer_load_dwordx4 v195, s[20:23], s48 offen offset:2048 lds
    buffer_load_dwordx4 v195, s[20:23], s48 offen offset:3072 lds
    s_waitcnt vmcnt(0)
    ds_read_b128 a[224:227], v26 offset:0
    ds_read_b128 a[228:231], v27 offset:0
    ds_read_b128 a[232:235], v28 offset:0
    ds_read_b128 a[236:239], v29 offset:0
    ds_read_b128 a[240:243], v26 offset:1024
    ds_read_b128 a[244:247], v27 offset:1024
    ds_read_b128 a[248:251], v28 offset:1024
    ds_read_b128 a[252:255], v29 offset:1024
    s_waitcnt lgkmcnt(0)
    v_mfma_f32_16x16x32_bf16 v[128:131], a[224:227], v[64:67], 0
    v_mfma_f32_16x16x32_bf16 v[128:131], a[228:231], v[68:71], v[128:131]
    v_mfma_f32_16x16x32_bf16 v[128:131], a[232:235], v[72:75], v[128:131]
    v_mfma_f32_16x16x32_bf16 v[128:131], a[236:239], v[76:79], v[128:131]
    v_mfma_f32_16x16x32_bf16 v[132:135], a[224:227], v[80:83], 0
    v_mfma_f32_16x16x32_bf16 v[132:135], a[228:231], v[84:87], v[132:135]
    v_mfma_f32_16x16x32_bf16 v[132:135], a[232:235], v[88:91], v[132:135]
    v_mfma_f32_16x16x32_bf16 v[132:135], a[236:239], v[92:95], v[132:135]
    v_mfma_f32_16x16x32_bf16 v[136:139], a[224:227], v[96:99], 0
    v_mfma_f32_16x16x32_bf16 v[136:139], a[228:231], v[100:103], v[136:139]
    v_mfma_f32_16x16x32_bf16 v[136:139], a[232:235], v[104:107], v[136:139]
    v_mfma_f32_16x16x32_bf16 v[136:139], a[236:239], v[108:111], v[136:139]
    v_mfma_f32_16x16x32_bf16 v[140:143], a[224:227], v[112:115], 0
    v_mfma_f32_16x16x32_bf16 v[140:143], a[228:231], v[116:119], v[140:143]
    v_mfma_f32_16x16x32_bf16 v[140:143], a[232:235], v[120:123], v[140:143]
    v_mfma_f32_16x16x32_bf16 v[140:143], a[236:239], v[124:127], v[140:143]
    v_mfma_f32_16x16x32_bf16 v[144:147], a[240:243], v[64:67], 0
    v_mfma_f32_16x16x32_bf16 v[144:147], a[244:247], v[68:71], v[144:147]
    v_mfma_f32_16x16x32_bf16 v[144:147], a[248:251], v[72:75], v[144:147]
    v_mfma_f32_16x16x32_bf16 v[144:147], a[252:255], v[76:79], v[144:147]
    v_mfma_f32_16x16x32_bf16 v[148:151], a[240:243], v[80:83], 0
    v_mfma_f32_16x16x32_bf16 v[148:151], a[244:247], v[84:87], v[148:151]
    v_mfma_f32_16x16x32_bf16 v[148:151], a[248:251], v[88:91], v[148:151]
    v_mfma_f32_16x16x32_bf16 v[148:151], a[252:255], v[92:95], v[148:151]
    v_mfma_f32_16x16x32_bf16 v[152:155], a[240:243], v[96:99], 0
    v_mfma_f32_16x16x32_bf16 v[152:155], a[244:247], v[100:103], v[152:155]
    v_mfma_f32_16x16x32_bf16 v[152:155], a[248:251], v[104:107], v[152:155]
    v_mfma_f32_16x16x32_bf16 v[152:155], a[252:255], v[108:111], v[152:155]
    v_mfma_f32_16x16x32_bf16 v[156:159], a[240:243], v[112:115], 0
    v_mfma_f32_16x16x32_bf16 v[156:159], a[244:247], v[116:119], v[156:159]
    v_mfma_f32_16x16x32_bf16 v[156:159], a[248:251], v[120:123], v[156:159]
    v_mfma_f32_16x16x32_bf16 v[156:159], a[252:255], v[124:127], v[156:159]
    s_nop 7
    v_max3_f32 v1, v1, v128, v129
    v_max3_f32 v1, v1, v130, v131
    v_max3_f32 v1, v1, v144, v145
    v_max3_f32 v1, v1, v146, v147
    v_max3_f32 v2, v2, v132, v133
    v_max3_f32 v2, v2, v134, v135
    v_max3_f32 v2, v2, v148, v149
    v_max3_f32 v2, v2, v150, v151
    v_max3_f32 v3, v3, v136, v137
    v_max3_f32 v3, v3, v138, v139
    v_max3_f32 v3, v3, v152, v153
    v_max3_f32 v3, v3, v154, v155
    v_max3_f32 v4, v4, v140, v141
    v_max3_f32 v4, v4, v142, v143
    v_max3_f32 v4, v4, v156, v157
    v_max3_f32 v4, v4, v158, v159
    ds_read_b128 a[224:227], v26 offset:2048
    ds_read_b128 a[228:231], v27 offset:2048
    ds_read_b128 a[232:235], v28 offset:2048
    ds_read_b128 a[236:239], v29 offset:2048
    ds_read_b128 a[240:243], v26 offset:3072
    ds_read_b128 a[244:247], v27 offset:3072
    ds_read_b128 a[248:251], v28 offset:3072
    ds_read_b128 a[252:255], v29 offset:3072
    s_waitcnt lgkmcnt(0)
    v_mfma_f32_16x16x32_bf16 v[128:131], a[224:227], v[64:67], 0
    v_mfma_f32_16x16x32_bf16 v[128:131], a[228:231], v[68:71], v[128:131]
    v_mfma_f32_16x16x32_bf16 v[128:131], a[232:235], v[72:75], v[128:131]
    v_mfma_f32_16x16x32_bf16 v[128:131], a[236:239], v[76:79], v[128:131]
    v_mfma_f32_16x16x32_bf16 v[132:135], a[224:227], v[80:83], 0
    v_mfma_f32_16x16x32_bf16 v[132:135], a[228:231], v[84:87], v[132:135]
    v_mfma_f32_16x16x32_bf16 v[132:135], a[232:235], v[88:91], v[132:135]
    v_mfma_f32_16x16x32_bf16 v[132:135], a[236:239], v[92:95], v[132:135]
    v_mfma_f32_16x16x32_bf16 v[136:139], a[224:227], v[96:99], 0
    v_mfma_f32_16x16x32_bf16 v[136:139], a[228:231], v[100:103], v[136:139]
    v_mfma_f32_16x16x32_bf16 v[136:139], a[232:235], v[104:107], v[136:139]
    v_mfma_f32_16x16x32_bf16 v[136:139], a[236:239], v[108:111], v[136:139]
    v_mfma_f32_16x16x32_bf16 v[140:143], a[224:227], v[112:115], 0
    v_mfma_f32_16x16x32_bf16 v[140:143], a[228:231], v[116:119], v[140:143]
    v_mfma_f32_16x16x32_bf16 v[140:143], a[232:235], v[120:123], v[140:143]
    v_mfma_f32_16x16x32_bf16 v[140:143], a[236:239], v[124:127], v[140:143]
    v_mfma_f32_16x16x32_bf16 v[144:147], a[240:243], v[64:67], 0
    v_mfma_f32_16x16x32_bf16 v[144:147], a[244:247], v[68:71], v[144:147]
    v_mfma_f32_16x16x32_bf16 v[144:147], a[248:251], v[72:75], v[144:147]
    v_mfma_f32_16x16x32_bf16 v[144:147], a[252:255], v[76:79], v[144:147]
    v_mfma_f32_16x16x32_bf16 v[148:151], a[240:243], v[80:83], 0
    v_mfma_f32_16x16x32_bf16 v[148:151], a[244:247], v[84:87], v[148:151]
    v_mfma_f32_16x16x32_bf16 v[148:151], a[248:251], v[88:91], v[148:151]
    v_mfma_f32_16x16x32_bf16 v[148:151], a[252:255], v[92:95], v[148:151]
    v_mfma_f32_16x16x32_bf16 v[152:155], a[240:243], v[96:99], 0
    v_mfma_f32_16x16x32_bf16 v[152:155], a[244:247], v[100:103], v[152:155]
    v_mfma_f32_16x16x32_bf16 v[152:155], a[248:251], v[104:107], v[152:155]
    v_mfma_f32_16x16x32_bf16 v[152:155], a[252:255], v[108:111], v[152:155]
    v_mfma_f32_16x16x32_bf16 v[156:159], a[240:243], v[112:115], 0
    v_mfma_f32_16x16x32_bf16 v[156:159], a[244:247], v[116:119], v[156:159]
    v_mfma_f32_16x16x32_bf16 v[156:159], a[248:251], v[120:123], v[156:159]
    v_mfma_f32_16x16x32_bf16 v[156:159], a[252:255], v[124:127], v[156:159]
    s_nop 7
    v_max3_f32 v1, v1, v128, v129
    v_max3_f32 v1, v1, v130, v131
    v_max3_f32 v1, v1, v144, v145
    v_max3_f32 v1, v1, v146, v147
    v_max3_f32 v2, v2, v132, v133
    v_max3_f32 v2, v2, v134, v135
    v_max3_f32 v2, v2, v148, v149
    v_max3_f32 v2, v2, v150, v151
    v_max3_f32 v3, v3, v136, v137
    v_max3_f32 v3, v3, v138, v139
    v_max3_f32 v3, v3, v152, v153
    v_max3_f32 v3, v3, v154, v155
    v_max3_f32 v4, v4, v140, v141
    v_max3_f32 v4, v4, v142, v143
    v_max3_f32 v4, v4, v156, v157
    v_max3_f32 v4, v4, v158, v159
    s_add_u32 s48, s48, 16384
    s_cmp_lt_u32 s48, 0x80000
    s_cbranch_scc1 L_slow1
    v_mov_b32 v5, v1
    v_mov_b32 v6, v2
    v_mov_b32 v7, v3
    v_mov_b32 v8, v4
    s_nop 0
    v_permlane16_swap_b32 v1, v5
    v_permlane16_swap_b32 v2, v6
    v_permlane16_swap_b32 v3, v7
    v_permlane16_swap_b32 v4, v8
    v_max_f32 v1, v1, v5
    v_max_f32 v2, v2, v6
    v_max_f32 v3, v3, v7
    v_max_f32 v4, v4, v8
    v_mov_b32 v5, v1
    v_mov_b32 v6, v2
    v_mov_b32 v7, v3
    v_mov_b32 v8, v4
    s_nop 0
    v_permlane32_swap_b32 v1, v5
    v_permlane32_swap_b32 v2, v6
    v_permlane32_swap_b32 v3, v7
    v_permlane32_swap_b32 v4, v8
    v_max_f32 v1, v1, v5
    v_max_f32 v2, v2, v6
    v_max_f32 v3, v3, v7
    v_max_f32 v4, v4, v8
    v_sub_f32 v48, 0, v1
    v_sub_f32 v49, 0, v1
    v_sub_f32 v50, 0, v1
    v_sub_f32 v51, 0, v1
    v_sub_f32 v52, 0, v2
    v_sub_f32 v53, 0, v2
    v_sub_f32 v54, 0, v2
    v_sub_f32 v55, 0, v2
    v_sub_f32 v56, 0, v3
    v_sub_f32 v57, 0, v3
    v_sub_f32 v58, 0, v3
    v_sub_f32 v59, 0, v3
    v_sub_f32 v60, 0, v4
    v_sub_f32 v61, 0, v4
    v_sub_f32 v62, 0, v4
    v_sub_f32 v63, 0, v4
    v_accvgpr_write_b32 a0, 0
    v_accvgpr_write_b32 a1, 0
    v_accvgpr_write_b32 a2, 0
    v_accvgpr_write_b32 a3, 0
    v_accvgpr_write_b32 a4, 0
    v_accvgpr_write_b32 a5, 0
    v_accvgpr_write_b32 a6, 0
    v_accvgpr_write_b32 a7, 0
    v_accvgpr_write_b32 a8, 0
    v_accvgpr_write_b32 a9, 0
    v_accvgpr_write_b32 a10, 0
    v_accvgpr_write_b32 a11, 0
    v_accvgpr_write_b32 a12, 0
    v_accvgpr_write_b32 a13, 0
    v_accvgpr_write_b32 a14, 0
    v_accvgpr_write_b32 a15, 0
    v_accvgpr_write_b32 a16, 0
    v_accvgpr_write_b32 a17, 0
    v_accvgpr_write_b32 a18, 0
    v_accvgpr_write_b32 a19, 0
    v_accvgpr_write_b32 a20, 0
    v_accvgpr_write_b32 a21, 0
    v_accvgpr_write_b32 a22, 0
    v_accvgpr_write_b32 a23, 0
    v_accvgpr_write_b32 a24, 0
    v_accvgpr_write_b32 a25, 0
    v_accvgpr_write_b32 a26, 0
    v_accvgpr_write_b32 a27, 0
    v_accvgpr_write_b32 a28, 0
    v_accvgpr_write_b32 a29, 0
    v_accvgpr_write_b32 a30, 0
    v_accvgpr_write_b32 a31, 0
    v_accvgpr_write_b32 a32, 0
    v_accvgpr_write_b32 a33, 0
    v_accvgpr_write_b32 a34, 0
    v_accvgpr_write_b32 a35, 0
    v_accvgpr_write_b32 a36, 0
    v_accvgpr_write_b32 a37, 0
    v_accvgpr_write_b32 a38, 0
    v_accvgpr_write_b32 a39, 0
    v_accvgpr_write_b32 a40, 0
    v_accvgpr_write_b32 a41, 0
    v_accvgpr_write_b32 a42, 0
    v_accvgpr_write_b32 a43, 0
    v_accvgpr_write_b32 a44, 0
    v_accvgpr_write_b32 a45, 0
    v_accvgpr_write_b32 a46, 0
    v_accvgpr_write_b32 a47, 0
    v_accvgpr_write_b32 a48, 0
    v_accvgpr_write_b32 a49, 0
    v_accvgpr_write_b32 a50, 0
    v_accvgpr_write_b32 a51, 0
    v_accvgpr_write_b32 a52, 0
    v_accvgpr_write_b32 a53, 0
    v_accvgpr_write_b32 a54, 0
    v_accvgpr_write_b32 a55, 0
    v_accvgpr_write_b32 a56, 0
    v_accvgpr_write_b32 a57, 0
    v_accvgpr_write_b32 a58, 0
    v_accvgpr_write_b32 a59, 0
    v_accvgpr_write_b32 a60, 0
    v_accvgpr_write_b32 a61, 0
    v_accvgpr_write_b32 a62, 0
    v_accvgpr_write_b32 a63, 0
    v_accvgpr_write_b32 a64, 0
    v_accvgpr_write_b32 a65, 0
    v_accvgpr_write_b32 a66, 0
    v_accvgpr_write_b32 a67, 0
    v_accvgpr_write_b32 a68, 0
    v_accvgpr_write_b32 a69, 0
    v_accvgpr_write_b32 a70, 0
    v_accvgpr_write_b32 a71, 0
    v_accvgpr_write_b32 a72, 0
    v_accvgpr_write_b32 a73, 0
    v_accvgpr_write_b32 a74, 0
    v_accvgpr_write_b32 a75, 0
    v_accvgpr_write_b32 a76, 0
    v_accvgpr_write_b32 a77, 0
    v_accvgpr_write_b32 a78, 0
    v_accvgpr_write_b32 a79, 0
    v_accvgpr_write_b32 a80, 0
    v_accvgpr_write_b32 a81, 0
    v_accvgpr_write_b32 a82, 0
    v_accvgpr_write_b32 a83, 0
    v_accvgpr_write_b32 a84, 0
    v_accvgpr_write_b32 a85, 0
    v_accvgpr_write_b32 a86, 0
    v_accvgpr_write_b32 a87, 0
    v_accvgpr_write_b32 a88, 0
    v_accvgpr_write_b32 a89, 0
    v_accvgpr_write_b32 a90, 0
    v_accvgpr_write_b32 a91, 0
    v_accvgpr_write_b32 a92, 0
    v_accvgpr_write_b32 a93, 0
    v_accvgpr_write_b32 a94, 0
    v_accvgpr_write_b32 a95, 0
    v_accvgpr_write_b32 a96, 0
    v_accvgpr_write_b32 a97, 0
    v_accvgpr_write_b32 a98, 0
    v_accvgpr_write_b32 a99, 0
    v_accvgpr_write_b32 a100, 0
    v_accvgpr_write_b32 a101, 0
    v_accvgpr_write_b32 a102, 0
    v_accvgpr_write_b32 a103, 0
    v_accvgpr_write_b32 a104, 0
    v_accvgpr_write_b32 a105, 0
    v_accvgpr_write_b32 a106, 0
    v_accvgpr_write_b32 a107, 0
    v_accvgpr_write_b32 a108, 0
    v_accvgpr_write_b32 a109, 0
    v_accvgpr_write_b32 a110, 0
    v_accvgpr_write_b32 a111, 0
    v_accvgpr_write_b32 a112, 0
    v_accvgpr_write_b32 a113, 0
    v_accvgpr_write_b32 a114, 0
    v_accvgpr_write_b32 a115, 0
    v_accvgpr_write_b32 a116, 0
    v_accvgpr_write_b32 a117, 0
    v_accvgpr_write_b32 a118, 0
    v_accvgpr_write_b32 a119, 0
    v_accvgpr_write_b32 a120, 0
    v_accvgpr_write_b32 a121, 0
    v_accvgpr_write_b32 a122, 0
    v_accvgpr_write_b32 a123, 0
    v_accvgpr_write_b32 a124, 0
    v_accvgpr_write_b32 a125, 0
    v_accvgpr_write_b32 a126, 0
    v_accvgpr_write_b32 a127, 0
    v_mov_b32 v224, 0
    v_mov_b32 v225, 0
    v_mov_b32 v226, 0
    v_mov_b32 v227, 0
    v_mov_b32 v228, 0
    v_mov_b32 v229, 0
    v_mov_b32 v230, 0
    v_mov_b32 v231, 0
    v_mov_b32 v232, 0
    v_mov_b32 v233, 0
    v_mov_b32 v234, 0
    v_mov_b32 v235, 0
    v_mov_b32 v236, 0
    v_mov_b32 v237, 0
    v_mov_b32 v238, 0
    v_mov_b32 v239, 0
    s_mov_b32 s48, 0
L_slow2:
    s_add_u32 m0, s89, 0
    s_nop 0
    buffer_load_dwordx4 v192, s[20:23], s48 offen offset:0 lds
    buffer_load_dwordx4 v192, s[20:23], s48 offen offset:1024 lds
    buffer_load_dwordx4 v192, s[20:23], s48 offen offset:2048 lds
    buffer_load_dwordx4 v192, s[20:23], s48 offen offset:3072 lds
    s_add_u32 m0, s50, 0
    s_nop 0
    buffer_load_dwordx4 v196, s[24:27], s48 offen offset:0 lds
    buffer_load_dwordx4 v196, s[24:27], s48 offen offset:1024 lds
    buffer_load_dwordx4 v196, s[24:27], s48 offen offset:2048 lds
    buffer_load_dwordx4 v196, s[24:27], s48 offen offset:3072 lds
    s_add_u32 m0, s89, 16384
    s_nop 0
    buffer_load_dwordx4 v193, s[20:23], s48 offen offset:0 lds
    buffer_load_dwordx4 v193, s[20:23], s48 offen offset:1024 lds
    buffer_load_dwordx4 v193, s[20:23], s48 offen offset:2048 lds
    buffer_load_dwordx4 v193, s[20:23], s48 offen offset:3072 lds
    s_add_u32 m0, s50, 16384
    s_nop 0
    buffer_load_dwordx4 v197, s[24:27], s48 offen offset:0 lds
    buffer_load_dwordx4 v197, s[24:27], s48 offen offset:1024 lds
    buffer_load_dwordx4 v197, s[24:27], s48 offen offset:2048 lds
    buffer_load_dwordx4 v197, s[24:27], s48 offen offset:3072 lds
    s_add_u32 m0, s89, 32768
    s_nop 0
    buffer_load_dwordx4 v194, s[20:23], s48 offen offset:0 lds
    buffer_load_dwordx4 v194, s[20:23], s48 offen offset:1024 lds
    buffer_load_dwordx4 v194, s[20:23], s48 offen offset:2048 lds
    buffer_load_dwordx4 v194, s[20:23], s48 offen offset:3072 lds
    s_add_u32 m0, s50, 32768
    s_nop 0
    buffer_load_dwordx4 v198, s[24:27], s48 offen offset:0 lds
    buffer_load_dwordx4 v198, s[24:27], s48 offen offset:1024 lds
    buffer_load_dwordx4 v198, s[24:27], s48 offen offset:2048 lds
    buffer_load_dwordx4 v198, s[24:27], s48 offen offset:3072 lds
    s_add_u32 m0, s89, 49152
    s_nop 0
    buffer_load_dwordx4 v195, s[20:23], s48 offen offset:0 lds
    buffer_load_dwordx4 v195, s[20:23], s48 offen offset:1024 lds
    buffer_load_dwordx4 v195, s[20:23], s48 offen offset:2048 lds
    buffer_load_dwordx4 v195, s[20:23], s48 offen offset:3072 lds
    s_add_u32 m0, s50, 49152
    s_nop 0
    buffer_load_dwordx4 v199, s[24:27], s48 offen offset:0 lds
    buffer_load_dwordx4 v199, s[24:27], s48 offen offset:1024 lds
    buffer_load_dwordx4 v199, s[24:27], s48 offen offset:2048 lds
    buffer_load_dwordx4 v199, s[24:27], s48 offen offset:3072 lds
    s_waitcnt vmcnt(0)
    ds_read_b128 a[224:227], v26 offset:0
    ds_read_b128 a[228:231], v27 offset:0
    ds_read_b128 a[232:235], v28 offset:0
    ds_read_b128 a[236:239], v29 offset:0
    ds_read_b128 a[240:243], v26 offset:1024
    ds_read_b128 a[244:247], v27 offset:1024
    ds_read_b128 a[248:251], v28 offset:1024
    ds_read_b128 a[252:255], v29 offset:1024
    s_waitcnt lgkmcnt(0)
    v_mfma_f32_16x16x32_bf16 v[128:131], a[224:227], v[64:67], v[48:51]
    v_mfma_f32_16x16x32_bf16 v[128:131], a[228:231], v[68:71], v[128:131]
    v_mfma_f32_16x16x32_bf16 v[128:131], a[232:235], v[72:75], v[128:131]
    v_mfma_f32_16x16x32_bf16 v[128:131], a[236:239], v[76:79], v[128:131]
    v_mfma_f32_16x16x32_bf16 v[132:135], a[224:227], v[80:83], v[52:55]
    v_mfma_f32_16x16x32_bf16 v[132:135], a[228:231], v[84:87], v[132:135]
    v_mfma_f32_16x16x32_bf16 v[132:135], a[232:235], v[88:91], v[132:135]
    v_mfma_f32_16x16x32_bf16 v[132:135], a[236:239], v[92:95], v[132:135]
    v_mfma_f32_16x16x32_bf16 v[136:139], a[224:227], v[96:99], v[56:59]
    v_mfma_f32_16x16x32_bf16 v[136:139], a[228:231], v[100:103], v[136:139]
    v_mfma_f32_16x16x32_bf16 v[136:139], a[232:235], v[104:107], v[136:139]
    v_mfma_f32_16x16x32_bf16 v[136:139], a[236:239], v[108:111], v[136:139]
    v_mfma_f32_16x16x32_bf16 v[140:143], a[224:227], v[112:115], v[60:63]
    v_mfma_f32_16x16x32_bf16 v[140:143], a[228:231], v[116:119], v[140:143]
    v_mfma_f32_16x16x32_bf16 v[140:143], a[232:235], v[120:123], v[140:143]
    v_mfma_f32_16x16x32_bf16 v[140:143], a[236:239], v[124:127], v[140:143]
    v_mfma_f32_16x16x32_bf16 v[144:147], a[240:243], v[64:67], v[48:51]
    v_mfma_f32_16x16x32_bf16 v[144:147], a[244:247], v[68:71], v[144:147]
    v_mfma_f32_16x16x32_bf16 v[144:147], a[248:251], v[72:75], v[144:147]
    v_mfma_f32_16x16x32_bf16 v[144:147], a[252:255], v[76:79], v[144:147]
    v_mfma_f32_16x16x32_bf16 v[148:151], a[240:243], v[80:83], v[52:55]
    v_mfma_f32_16x16x32_bf16 v[148:151], a[244:247], v[84:87], v[148:151]
    v_mfma_f32_16x16x32_bf16 v[148:151], a[248:251], v[88:91], v[148:151]
    v_mfma_f32_16x16x32_bf16 v[148:151], a[252:255], v[92:95], v[148:151]
    v_mfma_f32_16x16x32_bf16 v[152:155], a[240:243], v[96:99], v[56:59]
    v_mfma_f32_16x16x32_bf16 v[152:155], a[244:247], v[100:103], v[152:155]
    v_mfma_f32_16x16x32_bf16 v[152:155], a[248:251], v[104:107], v[152:155]
    v_mfma_f32_16x16x32_bf16 v[152:155], a[252:255], v[108:111], v[152:155]
    v_mfma_f32_16x16x32_bf16 v[156:159], a[240:243], v[112:115], v[60:63]
    v_mfma_f32_16x16x32_bf16 v[156:159], a[244:247], v[116:119], v[156:159]
    v_mfma_f32_16x16x32_bf16 v[156:159], a[248:251], v[120:123], v[156:159]
    v_mfma_f32_16x16x32_bf16 v[156:159], a[252:255], v[124:127], v[156:159]
    s_nop 7
    v_exp_f32 v128, v128
    v_exp_f32 v129, v129
    v_exp_f32 v130, v130
    v_exp_f32 v131, v131
    v_exp_f32 v132, v132
    v_exp_f32 v133, v133
    v_exp_f32 v134, v134
    v_exp_f32 v135, v135
    v_exp_f32 v136, v136
    v_exp_f32 v137, v137
    v_exp_f32 v138, v138
    v_exp_f32 v139, v139
    v_exp_f32 v140, v140
    v_exp_f32 v141, v141
    v_exp_f32 v142, v142
    v_exp_f32 v143, v143
    v_exp_f32 v144, v144
    v_exp_f32 v145, v145
    v_exp_f32 v146, v146
    v_exp_f32 v147, v147
    v_exp_f32 v148, v148
    v_exp_f32 v149, v149
    v_exp_f32 v150, v150
    v_exp_f32 v151, v151
    v_exp_f32 v152, v152
    v_exp_f32 v153, v153
    v_exp_f32 v154, v154
    v_exp_f32 v155, v155
    v_exp_f32 v156, v156
    v_exp_f32 v157, v157
    v_exp_f32 v158, v158
    v_exp_f32 v159, v159
    s_nop 0
    v_cvt_pk_bf16_f32 v208, v128, v129
    v_cvt_pk_bf16_f32 v209, v130, v131
    v_cvt_pk_bf16_f32 v212, v132, v133
    v_cvt_pk_bf16_f32 v213, v134, v135
    v_cvt_pk_bf16_f32 v216, v136, v137
    v_cvt_pk_bf16_f32 v217, v138, v139
    v_cvt_pk_bf16_f32 v220, v140, v141
    v_cvt_pk_bf16_f32 v221, v142, v143
    v_cvt_pk_bf16_f32 v210, v144, v145
    v_cvt_pk_bf16_f32 v211, v146, v147
    v_cvt_pk_bf16_f32 v214, v148, v149
    v_cvt_pk_bf16_f32 v215, v150, v151
    v_cvt_pk_bf16_f32 v218, v152, v153
    v_cvt_pk_bf16_f32 v219, v154, v155
    v_cvt_pk_bf16_f32 v222, v156, v157
    v_cvt_pk_bf16_f32 v223, v158, v159
    ds_read_b64_tr_b16 a[224:225], v30 offset:0
    ds_read_b64_tr_b16 a[226:227], v30 offset:1024
    ds_read_b64_tr_b16 a[228:229], v31 offset:0
    ds_read_b64_tr_b16 a[230:231], v31 offset:1024
    ds_read_b64_tr_b16 a[232:233], v32 offset:0
    ds_read_b64_tr_b16 a[234:235], v32 offset:1024
    ds_read_b64_tr_b16 a[236:237], v33 offset:0
    ds_read_b64_tr_b16 a[238:239], v33 offset:1024
    ds_read_b64_tr_b16 a[240:241], v34 offset:0
    ds_read_b64_tr_b16 a[242:243], v34 offset:1024
    ds_read_b64_tr_b16 a[244:245], v35 offset:0
    ds_read_b64_tr_b16 a[246:247], v35 offset:1024
    ds_read_b64_tr_b16 a[248:249], v36 offset:0
    ds_read_b64_tr_b16 a[250:251], v36 offset:1024
    ds_read_b64_tr_b16 a[252:253], v37 offset:0
    ds_read_b64_tr_b16 a[254:255], v37 offset:1024
    s_waitcnt lgkmcnt(0)
    v_mfma_f32_16x16x32_bf16 a[0:3], a[224:227], v[208:211], a[0:3]
    v_mfma_f32_16x16x32_bf16 a[4:7], a[224:227], v[212:215], a[4:7]
    v_mfma_f32_16x16x32_bf16 a[8:11], a[224:227], v[216:219], a[8:11]
    v_mfma_f32_16x16x32_bf16 a[12:15], a[224:227], v[220:223], a[12:15]
    v_mfma_f32_16x16x32_bf16 a[16:19], a[228:231], v[208:211], a[16:19]
    v_mfma_f32_16x16x32_bf16 a[20:23], a[228:231], v[212:215], a[20:23]
    v_mfma_f32_16x16x32_bf16 a[24:27], a[228:231], v[216:219], a[24:27]
    v_mfma_f32_16x16x32_bf16 a[28:31], a[228:231], v[220:223], a[28:31]
    v_mfma_f32_16x16x32_bf16 a[32:35], a[232:235], v[208:211], a[32:35]
    v_mfma_f32_16x16x32_bf16 a[36:39], a[232:235], v[212:215], a[36:39]
    v_mfma_f32_16x16x32_bf16 a[40:43], a[232:235], v[216:219], a[40:43]
    v_mfma_f32_16x16x32_bf16 a[44:47], a[232:235], v[220:223], a[44:47]
    v_mfma_f32_16x16x32_bf16 a[48:51], a[236:239], v[208:211], a[48:51]
    v_mfma_f32_16x16x32_bf16 a[52:55], a[236:239], v[212:215], a[52:55]
    v_mfma_f32_16x16x32_bf16 a[56:59], a[236:239], v[216:219], a[56:59]
    v_mfma_f32_16x16x32_bf16 a[60:63], a[236:239], v[220:223], a[60:63]
    v_mfma_f32_16x16x32_bf16 a[64:67], a[240:243], v[208:211], a[64:67]
    v_mfma_f32_16x16x32_bf16 a[68:71], a[240:243], v[212:215], a[68:71]
    v_mfma_f32_16x16x32_bf16 a[72:75], a[240:243], v[216:219], a[72:75]
    v_mfma_f32_16x16x32_bf16 a[76:79], a[240:243], v[220:223], a[76:79]
    v_mfma_f32_16x16x32_bf16 a[80:83], a[244:247], v[208:211], a[80:83]
    v_mfma_f32_16x16x32_bf16 a[84:87], a[244:247], v[212:215], a[84:87]
    v_mfma_f32_16x16x32_bf16 a[88:91], a[244:247], v[216:219], a[88:91]
    v_mfma_f32_16x16x32_bf16 a[92:95], a[244:247], v[220:223], a[92:95]
    v_mfma_f32_16x16x32_bf16 a[96:99], a[248:251], v[208:211], a[96:99]
    v_mfma_f32_16x16x32_bf16 a[100:103], a[248:251], v[212:215], a[100:103]
    v_mfma_f32_16x16x32_bf16 a[104:107], a[248:251], v[216:219], a[104:107]
    v_mfma_f32_16x16x32_bf16 a[108:111], a[248:251], v[220:223], a[108:111]
    v_mfma_f32_16x16x32_bf16 a[112:115], a[252:255], v[208:211], a[112:115]
    v_mfma_f32_16x16x32_bf16 a[116:119], a[252:255], v[212:215], a[116:119]
    v_mfma_f32_16x16x32_bf16 a[120:123], a[252:255], v[216:219], a[120:123]
    v_mfma_f32_16x16x32_bf16 a[124:127], a[252:255], v[220:223], a[124:127]
    v_mfma_f32_16x16x32_bf16 v[224:227], v[40:43], v[208:211], v[224:227]
    v_mfma_f32_16x16x32_bf16 v[228:231], v[40:43], v[212:215], v[228:231]
    v_mfma_f32_16x16x32_bf16 v[232:235], v[40:43], v[216:219], v[232:235]
    v_mfma_f32_16x16x32_bf16 v[236:239], v[40:43], v[220:223], v[236:239]
    ds_read_b128 a[224:227], v26 offset:2048
    ds_read_b128 a[228:231], v27 offset:2048
    ds_read_b128 a[232:235], v28 offset:2048
    ds_read_b128 a[236:239], v29 offset:2048
    ds_read_b128 a[240:243], v26 offset:3072
    ds_read_b128 a[244:247], v27 offset:3072
    ds_read_b128 a[248:251], v28 offset:3072
    ds_read_b128 a[252:255], v29 offset:3072
    s_waitcnt lgkmcnt(0)
    v_mfma_f32_16x16x32_bf16 v[128:131], a[224:227], v[64:67], v[48:51]
    v_mfma_f32_16x16x32_bf16 v[128:131], a[228:231], v[68:71], v[128:131]
    v_mfma_f32_16x16x32_bf16 v[128:131], a[232:235], v[72:75], v[128:131]
    v_mfma_f32_16x16x32_bf16 v[128:131], a[236:239], v[76:79], v[128:131]
    v_mfma_f32_16x16x32_bf16 v[132:135], a[224:227], v[80:83], v[52:55]
    v_mfma_f32_16x16x32_bf16 v[132:135], a[228:231], v[84:87], v[132:135]
    v_mfma_f32_16x16x32_bf16 v[132:135], a[232:235], v[88:91], v[132:135]
    v_mfma_f32_16x16x32_bf16 v[132:135], a[236:239], v[92:95], v[132:135]
    v_mfma_f32_16x16x32_bf16 v[136:139], a[224:227], v[96:99], v[56:59]
    v_mfma_f32_16x16x32_bf16 v[136:139], a[228:231], v[100:103], v[136:139]
    v_mfma_f32_16x16x32_bf16 v[136:139], a[232:235], v[104:107], v[136:139]
    v_mfma_f32_16x16x32_bf16 v[136:139], a[236:239], v[108:111], v[136:139]
    v_mfma_f32_16x16x32_bf16 v[140:143], a[224:227], v[112:115], v[60:63]
    v_mfma_f32_16x16x32_bf16 v[140:143], a[228:231], v[116:119], v[140:143]
    v_mfma_f32_16x16x32_bf16 v[140:143], a[232:235], v[120:123], v[140:143]
    v_mfma_f32_16x16x32_bf16 v[140:143], a[236:239], v[124:127], v[140:143]
    v_mfma_f32_16x16x32_bf16 v[144:147], a[240:243], v[64:67], v[48:51]
    v_mfma_f32_16x16x32_bf16 v[144:147], a[244:247], v[68:71], v[144:147]
    v_mfma_f32_16x16x32_bf16 v[144:147], a[248:251], v[72:75], v[144:147]
    v_mfma_f32_16x16x32_bf16 v[144:147], a[252:255], v[76:79], v[144:147]
    v_mfma_f32_16x16x32_bf16 v[148:151], a[240:243], v[80:83], v[52:55]
    v_mfma_f32_16x16x32_bf16 v[148:151], a[244:247], v[84:87], v[148:151]
    v_mfma_f32_16x16x32_bf16 v[148:151], a[248:251], v[88:91], v[148:151]
    v_mfma_f32_16x16x32_bf16 v[148:151], a[252:255], v[92:95], v[148:151]
    v_mfma_f32_16x16x32_bf16 v[152:155], a[240:243], v[96:99], v[56:59]
    v_mfma_f32_16x16x32_bf16 v[152:155], a[244:247], v[100:103], v[152:155]
    v_mfma_f32_16x16x32_bf16 v[152:155], a[248:251], v[104:107], v[152:155]
    v_mfma_f32_16x16x32_bf16 v[152:155], a[252:255], v[108:111], v[152:155]
    v_mfma_f32_16x16x32_bf16 v[156:159], a[240:243], v[112:115], v[60:63]
    v_mfma_f32_16x16x32_bf16 v[156:159], a[244:247], v[116:119], v[156:159]
    v_mfma_f32_16x16x32_bf16 v[156:159], a[248:251], v[120:123], v[156:159]
    v_mfma_f32_16x16x32_bf16 v[156:159], a[252:255], v[124:127], v[156:159]
    s_nop 7
    v_exp_f32 v128, v128
    v_exp_f32 v129, v129
    v_exp_f32 v130, v130
    v_exp_f32 v131, v131
    v_exp_f32 v132, v132
    v_exp_f32 v133, v133
    v_exp_f32 v134, v134
    v_exp_f32 v135, v135
    v_exp_f32 v136, v136
    v_exp_f32 v137, v137
    v_exp_f32 v138, v138
    v_exp_f32 v139, v139
    v_exp_f32 v140, v140
    v_exp_f32 v141, v141
    v_exp_f32 v142, v142
    v_exp_f32 v143, v143
    v_exp_f32 v144, v144
    v_exp_f32 v145, v145
    v_exp_f32 v146, v146
    v_exp_f32 v147, v147
    v_exp_f32 v148, v148
    v_exp_f32 v149, v149
    v_exp_f32 v150, v150
    v_exp_f32 v151, v151
    v_exp_f32 v152, v152
    v_exp_f32 v153, v153
    v_exp_f32 v154, v154
    v_exp_f32 v155, v155
    v_exp_f32 v156, v156
    v_exp_f32 v157, v157
    v_exp_f32 v158, v158
    v_exp_f32 v159, v159
    s_nop 0
    v_cvt_pk_bf16_f32 v208, v128, v129
    v_cvt_pk_bf16_f32 v209, v130, v131
    v_cvt_pk_bf16_f32 v212, v132, v133
    v_cvt_pk_bf16_f32 v213, v134, v135
    v_cvt_pk_bf16_f32 v216, v136, v137
    v_cvt_pk_bf16_f32 v217, v138, v139
    v_cvt_pk_bf16_f32 v220, v140, v141
    v_cvt_pk_bf16_f32 v221, v142, v143
    v_cvt_pk_bf16_f32 v210, v144, v145
    v_cvt_pk_bf16_f32 v211, v146, v147
    v_cvt_pk_bf16_f32 v214, v148, v149
    v_cvt_pk_bf16_f32 v215, v150, v151
    v_cvt_pk_bf16_f32 v218, v152, v153
    v_cvt_pk_bf16_f32 v219, v154, v155
    v_cvt_pk_bf16_f32 v222, v156, v157
    v_cvt_pk_bf16_f32 v223, v158, v159
    ds_read_b64_tr_b16 a[224:225], v30 offset:2048
    ds_read_b64_tr_b16 a[226:227], v30 offset:3072
    ds_read_b64_tr_b16 a[228:229], v31 offset:2048
    ds_read_b64_tr_b16 a[230:231], v31 offset:3072
    ds_read_b64_tr_b16 a[232:233], v32 offset:2048
    ds_read_b64_tr_b16 a[234:235], v32 offset:3072
    ds_read_b64_tr_b16 a[236:237], v33 offset:2048
    ds_read_b64_tr_b16 a[238:239], v33 offset:3072
    ds_read_b64_tr_b16 a[240:241], v34 offset:2048
    ds_read_b64_tr_b16 a[242:243], v34 offset:3072
    ds_read_b64_tr_b16 a[244:245], v35 offset:2048
    ds_read_b64_tr_b16 a[246:247], v35 offset:3072
    ds_read_b64_tr_b16 a[248:249], v36 offset:2048
    ds_read_b64_tr_b16 a[250:251], v36 offset:3072
    ds_read_b64_tr_b16 a[252:253], v37 offset:2048
    ds_read_b64_tr_b16 a[254:255], v37 offset:3072
    s_waitcnt lgkmcnt(0)
    v_mfma_f32_16x16x32_bf16 a[0:3], a[224:227], v[208:211], a[0:3]
    v_mfma_f32_16x16x32_bf16 a[4:7], a[224:227], v[212:215], a[4:7]
    v_mfma_f32_16x16x32_bf16 a[8:11], a[224:227], v[216:219], a[8:11]
    v_mfma_f32_16x16x32_bf16 a[12:15], a[224:227], v[220:223], a[12:15]
    v_mfma_f32_16x16x32_bf16 a[16:19], a[228:231], v[208:211], a[16:19]
    v_mfma_f32_16x16x32_bf16 a[20:23], a[228:231], v[212:215], a[20:23]
    v_mfma_f32_16x16x32_bf16 a[24:27], a[228:231], v[216:219], a[24:27]
    v_mfma_f32_16x16x32_bf16 a[28:31], a[228:231], v[220:223], a[28:31]
    v_mfma_f32_16x16x32_bf16 a[32:35], a[232:235], v[208:211], a[32:35]
    v_mfma_f32_16x16x32_bf16 a[36:39], a[232:235], v[212:215], a[36:39]
    v_mfma_f32_16x16x32_bf16 a[40:43], a[232:235], v[216:219], a[40:43]
    v_mfma_f32_16x16x32_bf16 a[44:47], a[232:235], v[220:223], a[44:47]
    v_mfma_f32_16x16x32_bf16 a[48:51], a[236:239], v[208:211], a[48:51]
    v_mfma_f32_16x16x32_bf16 a[52:55], a[236:239], v[212:215], a[52:55]
    v_mfma_f32_16x16x32_bf16 a[56:59], a[236:239], v[216:219], a[56:59]
    v_mfma_f32_16x16x32_bf16 a[60:63], a[236:239], v[220:223], a[60:63]
    v_mfma_f32_16x16x32_bf16 a[64:67], a[240:243], v[208:211], a[64:67]
    v_mfma_f32_16x16x32_bf16 a[68:71], a[240:243], v[212:215], a[68:71]
    v_mfma_f32_16x16x32_bf16 a[72:75], a[240:243], v[216:219], a[72:75]
    v_mfma_f32_16x16x32_bf16 a[76:79], a[240:243], v[220:223], a[76:79]
    v_mfma_f32_16x16x32_bf16 a[80:83], a[244:247], v[208:211], a[80:83]
    v_mfma_f32_16x16x32_bf16 a[84:87], a[244:247], v[212:215], a[84:87]
    v_mfma_f32_16x16x32_bf16 a[88:91], a[244:247], v[216:219], a[88:91]
    v_mfma_f32_16x16x32_bf16 a[92:95], a[244:247], v[220:223], a[92:95]
    v_mfma_f32_16x16x32_bf16 a[96:99], a[248:251], v[208:211], a[96:99]
    v_mfma_f32_16x16x32_bf16 a[100:103], a[248:251], v[212:215], a[100:103]
    v_mfma_f32_16x16x32_bf16 a[104:107], a[248:251], v[216:219], a[104:107]
    v_mfma_f32_16x16x32_bf16 a[108:111], a[248:251], v[220:223], a[108:111]
    v_mfma_f32_16x16x32_bf16 a[112:115], a[252:255], v[208:211], a[112:115]
    v_mfma_f32_16x16x32_bf16 a[116:119], a[252:255], v[212:215], a[116:119]
    v_mfma_f32_16x16x32_bf16 a[120:123], a[252:255], v[216:219], a[120:123]
    v_mfma_f32_16x16x32_bf16 a[124:127], a[252:255], v[220:223], a[124:127]
    v_mfma_f32_16x16x32_bf16 v[224:227], v[40:43], v[208:211], v[224:227]
    v_mfma_f32_16x16x32_bf16 v[228:231], v[40:43], v[212:215], v[228:231]
    v_mfma_f32_16x16x32_bf16 v[232:235], v[40:43], v[216:219], v[232:235]
    v_mfma_f32_16x16x32_bf16 v[236:239], v[40:43], v[220:223], v[236:239]
    s_add_u32 s48, s48, 16384
    s_cmp_lt_u32 s48, 0x80000
    s_cbranch_scc1 L_slow2
    s_nop 7
    s_lshl_b32 s48, s72, 2
    s_add_u32 m0, s42, 131072
    s_nop 0
    buffer_load_dwordx4 v38, s[8:11], s48 offen offset:0 sc1 lds
    buffer_load_dwordx4 v38, s[8:11], s48 offen offset:1024 sc1 lds
    buffer_load_dwordx4 v38, s[8:11], s48 offen offset:2048 sc1 lds
    buffer_load_dwordx4 v38, s[8:11], s48 offen offset:3072 sc1 lds
    s_lshl_b32 s48, s68, 2
    s_add_u32 m0, s42, 65536
    s_nop 0
    buffer_load_dwordx4 v38, s[8:11], s48 offen offset:0 sc1 lds
    buffer_load_dwordx4 v38, s[8:11], s48 offen offset:1024 sc1 lds
    buffer_load_dwordx4 v38, s[8:11], s48 offen offset:2048 sc1 lds
    buffer_load_dwordx4 v38, s[8:11], s48 offen offset:3072 sc1 lds
    s_lshl_b32 s48, s72, 2
    s_add_u32 s48, s48, 4096
    s_add_u32 m0, s42, 81920
    s_nop 0
    buffer_load_dwordx4 v38, s[8:11], s48 offen offset:0 sc1 lds
    buffer_load_dwordx4 v38, s[8:11], s48 offen offset:1024 sc1 lds
    buffer_load_dwordx4 v38, s[8:11], s48 offen offset:2048 sc1 lds
    buffer_load_dwordx4 v38, s[8:11], s48 offen offset:3072 sc1 lds
    s_lshl_b32 s48, s68, 2
    s_add_u32 s48, s48, 4096
    s_add_u32 m0, s42, 147456
    s_nop 0
    buffer_load_dwordx4 v38, s[8:11], s48 offen offset:0 sc1 lds
    buffer_load_dwordx4 v38, s[8:11], s48 offen offset:1024 sc1 lds
    buffer_load_dwordx4 v38, s[8:11], s48 offen offset:2048 sc1 lds
    buffer_load_dwordx4 v38, s[8:11], s48 offen offset:3072 sc1 lds
    s_lshl_b32 s48, s73, 2
    s_add_u32 m0, s42, 98304
    s_nop 0
    buffer_load_dwordx4 v38, s[8:11], s48 offen offset:0 sc1 lds
    buffer_load_dwordx4 v38, s[8:11], s48 offen offset:1024 sc1 lds
    buffer_load_dwordx4 v38, s[8:11], s48 offen offset:2048 sc1 lds
    buffer_load_dwordx4 v38, s[8:11], s48 offen offset:3072 sc1 lds
    s_lshl_b32 s48, s70, 2
    s_add_u32 m0, s42, 0
    s_nop 0
    buffer_load_dwordx4 v38, s[8:11], s48 offen offset:0 sc1 lds
    buffer_load_dwordx4 v38, s[8:11], s48 offen offset:1024 sc1 lds
    buffer_load_dwordx4 v38, s[8:11], s48 offen offset:2048 sc1 lds
    buffer_load_dwordx4 v38, s[8:11], s48 offen offset:3072 sc1 lds
    s_lshl_b32 s48, s73, 2
    s_add_u32 s48, s48, 4096
    s_add_u32 m0, s42, 114688
    s_nop 0
    buffer_load_dwordx4 v38, s[8:11], s48 offen offset:0 sc1 lds
    buffer_load_dwordx4 v38, s[8:11], s48 offen offset:1024 sc1 lds
    buffer_load_dwordx4 v38, s[8:11], s48 offen offset:2048 sc1 lds
    buffer_load_dwordx4 v38, s[8:11], s48 offen offset:3072 sc1 lds
    s_lshl_b32 s48, s70, 2
    s_add_u32 s48, s48, 4096
    s_add_u32 m0, s42, 16384
    s_nop 0
    buffer_load_dwordx4 v38, s[8:11], s48 offen offset:0 sc1 lds
    buffer_load_dwordx4 v38, s[8:11], s48 offen offset:1024 sc1 lds
    buffer_load_dwordx4 v38, s[8:11], s48 offen offset:2048 sc1 lds
    buffer_load_dwordx4 v38, s[8:11], s48 offen offset:3072 sc1 lds
    s_lshl_b32 s48, s66, 2
    s_add_u32 s48, s48, 4096
    s_nop 0
    buffer_load_dwordx4 a[224:227], v38, s[8:11], s48 offen offset:0 sc1
    buffer_load_dwordx4 a[228:231], v38, s[8:11], s48 offen offset:1024 sc1
    buffer_load_dwordx4 a[232:235], v38, s[8:11], s48 offen offset:2048 sc1
    buffer_load_dwordx4 a[236:239], v38, s[8:11], s48 offen offset:3072 sc1
    s_lshl_b32 s48, s67, 2
    s_nop 0
    buffer_load_dwordx4 a[240:243], v38, s[8:11], s48 offen offset:0 sc1
    buffer_load_dwordx4 a[244:247], v38, s[8:11], s48 offen offset:1024 sc1
    buffer_load_dwordx4 a[248:251], v38, s[8:11], s48 offen offset:2048 sc1
    buffer_load_dwordx4 a[252:255], v38, s[8:11], s48 offen offset:3072 sc1
    s_lshl_b32 s48, s67, 2
    s_add_u32 s48, s48, 4096
    s_nop 0
    buffer_load_dwordx4 v[64:67], v38, s[8:11], s48 offen offset:0 sc1
    buffer_load_dwordx4 v[68:71], v38, s[8:11], s48 offen offset:1024 sc1
    buffer_load_dwordx4 v[72:75], v38, s[8:11], s48 offen offset:2048 sc1
    buffer_load_dwordx4 v[76:79], v38, s[8:11], s48 offen offset:3072 sc1
    s_lshl_b32 s48, s69, 2
    s_nop 0
    buffer_load_dwordx4 v[80:83], v38, s[8:11], s48 offen offset:0 sc1
    buffer_load_dwordx4 v[84:87], v38, s[8:11], s48 offen offset:1024 sc1
    buffer_load_dwordx4 v[88:91], v38, s[8:11], s48 offen offset:2048 sc1
    buffer_load_dwordx4 v[92:95], v38, s[8:11], s48 offen offset:3072 sc1
    s_waitcnt vmcnt(0)
    s_branch L_slow_done

.section .rodata,"a"
.p2align 6
.amdhsa_kernel recurrent_scan__gqa_block_cached__glu_gated_bilinear__prompt_kernel
  .amdhsa_next_free_vgpr 512
  .amdhsa_next_free_sgpr 102
  .amdhsa_accum_offset 256
  .amdhsa_group_segment_fixed_size 0
  .amdhsa_kernarg_size 96
  .amdhsa_user_sgpr_count 2
  .amdhsa_user_sgpr_kernarg_segment_ptr 1
  .amdhsa_system_sgpr_workgroup_id_x 1
.end_amdhsa_kernel
```
